```python
import torch

def _softmax(x, axis=-1):
    return torch.softmax(x, dim=axis)
def _gelu(x):
    return torch.nn.functional.gelu(x, approximate="tanh")
def _silu(x):
    return torch.nn.functional.silu(x)
def _sigmoid(x):
    return torch.sigmoid(x)
def _layernorm(x, axis=-1, eps=1e-5):
    m = x.mean(dim=axis, keepdim=True)
    v = x.var(dim=axis, keepdim=True, unbiased=False)
    return (x - m) / torch.sqrt(v + eps)
def _scatter_add(tgt, idx, src, axis=0):
    return tgt.clone().index_add_(axis, idx, src)
def _segment_sum(src, seg, n):
    out = torch.zeros((n,) + src.shape[1:], dtype=src.dtype)
    return out.index_add_(0, seg, src)
def _pad(x, pw):
    flat = tuple(v for pair in reversed(pw) for v in pair)
    return torch.nn.functional.pad(x, flat)

kernel_name = 'recurrent_scan__spectral_gfnet__glu_gated_geglu__prompt'

def setup_inputs():

    _w = (lambda a: (lambda t: t.to(torch.bfloat16) if t.is_floating_point() else t)(torch.as_tensor(a)))
    def _A_setup():
        B, S, D = 1, 2048, 512
        Df = D // 2 + 1
        return {
            "x": _w((lambda *s: torch.randn(*s, dtype=torch.bfloat16) * 0.2)(B, S, D)),
            "w_r": _w((lambda *s: torch.randn(*s, dtype=torch.bfloat16) * 1.6)(S, Df) * 0.02),
            "w_i": _w((lambda *s: torch.randn(*s, dtype=torch.bfloat16) * 1.6)(S, Df) * 0.02),
        }
    _A_in = _A_setup()

    def _B_setup():
        B, S, Dm, Df = 1, 2048, 512, 1792
        return {
            "x": _w((lambda *s: torch.randn(*s, dtype=torch.bfloat16) * 0.2)(B, S, Dm)),
            "w_gate": _w((lambda *s: torch.randn(*s, dtype=torch.bfloat16) * 0.8)(Dm, Df) * (Dm ** -0.5)),
            "w_up": _w((lambda *s: torch.randn(*s, dtype=torch.bfloat16) * 0.8)(Dm, Df) * (Dm ** -0.5)),
            "w_down": _w((lambda *s: torch.randn(*s, dtype=torch.bfloat16) * 0.8)(Df, Dm) * (Df ** -0.5)),
        }
    _B_in = _B_setup()

    return {
        "A_x": _A_in["x"],
        "A_w_r": _A_in["w_r"],
        "A_w_i": _A_in["w_i"],
        "B_x": _B_in["x"],
        "B_w_gate": _B_in["w_gate"],
        "B_w_up": _B_in["w_up"],
        "B_w_down": _B_in["w_down"],
    }

def reference(A_x, A_w_r, A_w_i, B_x, B_w_gate, B_w_up, B_w_down):
    def _A_ref(x, w_r, w_i):
        B, S, D = x.shape
        X = (lambda x, axes=(-2,-1): torch.fft.rfft2(x.float(), dim=axes))(x, axes=(-2, -1))
        W = w_r + 1j * w_i
        X = X * W
        y = (lambda x, s, axes=(-2,-1): torch.fft.irfft2(x, s=s, dim=axes).to(torch.bfloat16))(X, (S, D), axes=(-2, -1))
        return y

    def _B_ref(x, w_gate, w_up, w_down):
        g = torch.einsum("bsd,df->bsf", x, w_gate)
        u = torch.einsum("bsd,df->bsf", x, w_up)
        h = _gelu(g) * u
        return torch.einsum("bsf,fd->bsd", h, w_down)

    x = A_x
    xn = _layernorm(x, axis=-1)
    s = _A_ref(xn, A_w_r, A_w_i)
    g = _silu(_B_ref(xn, B_w_gate, B_w_up, B_w_down))
    return x + s * g
```

```asm
; @launch grid=(256,1,1) block=(256,1,1) lds=163840
.amdgcn_target "amdgcn-amd-amdhsa--gfx950"
.text
.globl recurrent_scan__spectral_gfnet__glu_gated_geglu__prompt_kernel
.p2align 8
.type recurrent_scan__spectral_gfnet__glu_gated_geglu__prompt_kernel,@function
recurrent_scan__spectral_gfnet__glu_gated_geglu__prompt_kernel:
    s_cmp_ge_u32 s2, 256
    s_cbranch_scc1 K_END
    s_load_dwordx2 s[4:5], s[0:1], 0
    s_load_dwordx4 s[8:11], s[0:1], 8
    s_load_dwordx2 s[12:13], s[0:1], 32
    s_load_dwordx2 s[58:59], s[0:1], 40
    s_load_dwordx2 s[14:15], s[0:1], 64
    s_load_dwordx2 s[6:7], s[0:1], 72
    s_and_b32 s16, s2, 7
    s_lshr_b32 s17, s2, 3
    v_lshrrev_b32 v1, 6, v0
    s_nop 0
    v_readfirstlane_b32 s18, v1
    s_cmp_ge_u32 s17, 28
    s_cbranch_scc0 ROLE_G
    s_branch ROLE_F
K_END:
    s_endpgm
ROLE_G:
    s_nop 4
    s_and_b32 s21, s16, 3
    s_lshl_b32 s21, s21, 2
    s_and_b32 s52, s17, 3
    s_add_u32 s21, s21, s52
    s_lshr_b32 s53, s17, 2
    s_lshr_b32 s20, s16, 2
    s_mul_i32 s20, s20, 7
    s_add_u32 s20, s20, s53
    s_lshl_b32 s19, s21, 2
    s_add_u32 s19, s19, s18
    v_and_b32 v1, 63, v0
    v_lshlrev_b32 v2, 4, v1
    v_lshrrev_b32 v96, 3, v1
    v_and_b32 v97, 7, v1
    v_lshrrev_b32 v98, 4, v1
    v_xor_b32 v97, v97, v98
    v_lshlrev_b32 v99, 16, v96
    v_lshl_add_u32 v20, v97, 4, v99
    v_xor_b32 v97, 4, v97
    v_lshl_add_u32 v21, v97, 4, v99
    v_add_u32 v21, 523264, v21
    v_add_u32 v22, 1046528, v20
    v_add_u32 v23, 1046528, v21
    s_lshl_b32 s53, s18, 12
    s_lshl_b32 s54, s19, 10
    s_waitcnt lgkmcnt(0)
    s_mov_b32 s36, s4
    s_mov_b32 s37, s5
    s_mov_b32 s38, 2097152
    s_mov_b32 s39, 0x00020000
    s_mov_b32 s24, s6
    s_mov_b32 s25, s7
    s_mov_b32 s26, 17825792
    s_mov_b32 s27, 0x00020000
    s_mov_b32 s48, s14
    s_mov_b32 s49, s15
    s_mov_b32 s50, 256
    s_mov_b32 s51, 0x00020000
    s_load_dwordx4 s[4:7], s[0:1], 48
    s_add_u32 m0, s53, 0
    s_add_u32 s55, s54, 0
    buffer_load_dwordx4 v20, s[36:39], s55 offen offset:0 lds
    buffer_load_dwordx4 v21, s[36:39], s55 offen offset:1024 lds
    buffer_load_dwordx4 v22, s[36:39], s55 offen offset:2048 lds
    buffer_load_dwordx4 v23, s[36:39], s55 offen offset:3072 lds
    s_add_u32 m0, s53, 16384
    s_add_u32 s55, s54, 128
    buffer_load_dwordx4 v20, s[36:39], s55 offen offset:0 lds
    buffer_load_dwordx4 v21, s[36:39], s55 offen offset:1024 lds
    buffer_load_dwordx4 v22, s[36:39], s55 offen offset:2048 lds
    buffer_load_dwordx4 v23, s[36:39], s55 offen offset:3072 lds
    v_and_b32 v14, 31, v1
    s_getpc_b64 s[96:97]
G_PC:
    s_sub_u32 s96, s96, G_PC-recurrent_scan__spectral_gfnet__glu_gated_geglu__prompt_kernel
    s_subb_u32 s97, s97, 0
    s_mov_b32 s98, CODE_END-recurrent_scan__spectral_gfnet__glu_gated_geglu__prompt_kernel
    s_mov_b32 s99, 0x00020000
    s_lshl_b32 s100, s17, 12
    v_lshlrev_b32 v108, 4, v0
    buffer_load_dwordx4 v[224:227], v108, s[96:99], s100 offen
    v_lshrrev_b32 v15, 5, v1
    v_and_b32 v98, 1, v1
    v_lshrrev_b32 v99, 1, v14
    s_lshl_b32 s62, s20, 4
    v_add3_u32 v99, s62, v99, 1
    v_lshlrev_b32 v210, 31, v99
    v_or_b32 v210, 1.0, v210
    v_cvt_f32_u32 v101, v98
    v_cvt_f32_u32 v99, v99
    v_mul_f32 v99, 0x3b000000, v99
    v_mul_f32 v101, 0xbe800000, v101
    s_mul_i32 s100, s2, 7168
    s_add_u32 s101, s100, 4096
    v_lshlrev_b32 v108, 4, v0
    s_mov_b32 s96, s12
    s_mov_b32 s97, s13
    s_mov_b32 s98, 1835008
    s_mov_b32 s99, 0x00020000
    buffer_load_dwordx4 v[224:227], v108, s[96:99], s100 offen
    v_add_f32 v101, 0x3e800000, v101
    s_lshl_b32 s62, s18, 6
    v_lshl_add_u32 v100, v15, 3, s62
    v_cvt_f32_u32 v100, v100
    v_fma_f32 v80, -v100, v99, v101
    v_mul_f32 v100, 0x41800000, v99
    v_sub_f32 v101, 0x3e800000, v100
    v_sin_f32 v101, v101
    v_sub_f32 v81, v80, v99
    v_sub_f32 v82, v81, v99
    v_sub_f32 v83, v82, v99
    buffer_load_dwordx4 v[224:227], v108, s[96:99], s101 offen
    v_sub_f32 v84, v83, v99
    v_sub_f32 v85, v84, v99
    v_sub_f32 v86, v85, v99
    v_sub_f32 v87, v86, v99
    v_sub_f32 v88, v80, v100
    v_sub_f32 v89, v81, v100
    v_sub_f32 v90, v82, v100
    v_sub_f32 v91, v83, v100
    v_sub_f32 v92, v84, v100
    v_sub_f32 v93, v85, v100
    v_sub_f32 v94, v86, v100
    v_sub_f32 v95, v87, v100
    s_mov_b32 s96, s58
    s_mov_b32 s97, s59
    s_mov_b32 s98, 1835008
    s_mov_b32 s99, 0x00020000
    buffer_load_dwordx4 v[224:227], v108, s[96:99], s100 offen
    v_add_f32 v101, v101, v101
    v_sin_f32 v80, v80
    v_sin_f32 v81, v81
    v_sin_f32 v82, v82
    v_sin_f32 v83, v83
    v_sin_f32 v84, v84
    v_sin_f32 v85, v85
    buffer_load_dwordx4 v[224:227], v108, s[96:99], s101 offen
    v_sin_f32 v86, v86
    v_sin_f32 v87, v87
    v_sin_f32 v88, v88
    v_sin_f32 v89, v89
    v_sin_f32 v90, v90
    v_sin_f32 v91, v91
    s_waitcnt lgkmcnt(0)
    s_mov_b32 s96, s4
    s_mov_b32 s97, s5
    s_mov_b32 s98, 1835008
    s_mov_b32 s99, 0x00020000
    buffer_load_dwordx4 v[224:227], v108, s[96:99], s100 offen
    v_sin_f32 v92, v92
    v_sin_f32 v93, v93
    v_sin_f32 v94, v94
    v_sin_f32 v95, v95
    v_add_u32 v102, s53, v2
    v_add_u32 v102, 147456, v102
    v_cvt_pk_bf16_f32 v128, v80, v81
    buffer_load_dwordx4 v[224:227], v108, s[96:99], s101 offen
    v_cvt_pk_bf16_f32 v129, v82, v83
    v_cvt_pk_bf16_f32 v130, v84, v85
    v_cvt_pk_bf16_f32 v131, v86, v87
    ds_write_b128 v102, v[128:131] offset:0
    v_cvt_pk_bf16_f32 v132, v88, v89
    v_cvt_pk_bf16_f32 v133, v90, v91
    v_cvt_pk_bf16_f32 v134, v92, v93
    s_add_u32 m0, s53, 32768
    s_add_u32 s55, s54, 256
    buffer_load_dwordx4 v20, s[36:39], s55 offen offset:0 lds
    v_cvt_pk_bf16_f32 v135, v94, v95
    ds_write_b128 v102, v[132:135] offset:1024
    v_pk_fma_f32 v[80:81], v[100:101], v[88:89], v[80:81] op_sel:[1,0,0] op_sel_hi:[1,1,1] neg_lo:[0,0,1] neg_hi:[0,0,1]
    v_pk_fma_f32 v[82:83], v[100:101], v[90:91], v[82:83] op_sel:[1,0,0] op_sel_hi:[1,1,1] neg_lo:[0,0,1] neg_hi:[0,0,1]
    v_pk_fma_f32 v[84:85], v[100:101], v[92:93], v[84:85] op_sel:[1,0,0] op_sel_hi:[1,1,1] neg_lo:[0,0,1] neg_hi:[0,0,1]
    v_pk_fma_f32 v[86:87], v[100:101], v[94:95], v[86:87] op_sel:[1,0,0] op_sel_hi:[1,1,1] neg_lo:[0,0,1] neg_hi:[0,0,1]
    v_cvt_pk_bf16_f32 v136, v80, v81
    buffer_load_dwordx4 v21, s[36:39], s55 offen offset:1024 lds
    v_cvt_pk_bf16_f32 v137, v82, v83
    v_cvt_pk_bf16_f32 v138, v84, v85
    v_cvt_pk_bf16_f32 v139, v86, v87
    ds_write_b128 v102, v[136:139] offset:2048
    v_pk_fma_f32 v[88:89], v[100:101], v[80:81], v[88:89] op_sel:[1,0,0] op_sel_hi:[1,1,1] neg_lo:[0,0,1] neg_hi:[0,0,1]
    v_pk_fma_f32 v[90:91], v[100:101], v[82:83], v[90:91] op_sel:[1,0,0] op_sel_hi:[1,1,1] neg_lo:[0,0,1] neg_hi:[0,0,1]
    v_pk_fma_f32 v[92:93], v[100:101], v[84:85], v[92:93] op_sel:[1,0,0] op_sel_hi:[1,1,1] neg_lo:[0,0,1] neg_hi:[0,0,1]
    buffer_load_dwordx4 v22, s[36:39], s55 offen offset:2048 lds
    v_pk_fma_f32 v[94:95], v[100:101], v[86:87], v[94:95] op_sel:[1,0,0] op_sel_hi:[1,1,1] neg_lo:[0,0,1] neg_hi:[0,0,1]
    v_cvt_pk_bf16_f32 v140, v88, v89
    v_cvt_pk_bf16_f32 v141, v90, v91
    v_cvt_pk_bf16_f32 v142, v92, v93
    v_cvt_pk_bf16_f32 v143, v94, v95
    ds_write_b128 v102, v[140:143] offset:3072
    v_bfe_u32 v99, v1, 1, 3
    buffer_load_dwordx4 v23, s[36:39], s55 offen offset:3072 lds
    v_xor_b32 v99, v99, v15
    v_lshl_add_u32 v100, v14, 7, s53
    v_xor_b32 v101, 0, v99
    v_lshl_add_u32 v24, v101, 4, v100
    v_add_u32 v28, 0x10000, v24
    v_xor_b32 v32, 0x1000, v24
    v_xor_b32 v36, 0x1000, v28
    v_xor_b32 v101, 2, v99
    v_lshl_add_u32 v25, v101, 4, v100
    v_add_u32 v29, 0x10000, v25
    v_xor_b32 v33, 0x1000, v25
    v_xor_b32 v37, 0x1000, v29
    s_add_u32 m0, s53, 49152
    s_add_u32 s55, s54, 384
    buffer_load_dwordx4 v20, s[36:39], s55 offen offset:0 lds
    v_xor_b32 v101, 4, v99
    v_lshl_add_u32 v26, v101, 4, v100
    v_add_u32 v30, 0x10000, v26
    v_xor_b32 v34, 0x1000, v26
    v_xor_b32 v38, 0x1000, v30
    v_xor_b32 v101, 6, v99
    v_lshl_add_u32 v27, v101, 4, v100
    v_add_u32 v31, 0x10000, v27
    v_xor_b32 v35, 0x1000, v27
    v_xor_b32 v39, 0x1000, v31
    v_mov_b32 v208, 0x3f803f80
    v_mov_b32 v209, 0x3f803f80
    buffer_load_dwordx4 v21, s[36:39], s55 offen offset:1024 lds
    v_add_u32 v102, 147456, v2
    s_mov_b32 s28, s12
    s_mov_b32 s29, s13
    s_mov_b32 s30, 1835008
    s_mov_b32 s31, 0x00020000
    s_sub_u32 s32, s58, 2048
    s_subb_u32 s33, s59, 0
    s_mov_b32 s34, 1837056
    s_mov_b32 s35, 0x00020000
    v_and_b32 v97, 7, v1
    v_mul_u32_u24 v99, 3584, v96
    v_and_b32 v98, 2, v96
    buffer_load_dwordx4 v22, s[36:39], s55 offen offset:2048 lds
    v_xor_b32 v97, v97, v98
    v_lshl_add_u32 v16, v97, 4, v99
    v_xor_b32 v18, 64, v16
    v_add_u32 v17, 27648, v16
    v_add_u32 v19, 27648, v18
    s_mul_i32 s52, s18, 57344
    s_lshl_b32 s56, s20, 8
    s_add_u32 s52, s52, s56
    s_waitcnt lgkmcnt(0)
    s_barrier
    ds_read_b128 v[128:131], v102 offset:0
    ds_read_b128 v[132:135], v102 offset:1024
    ds_read_b128 v[136:139], v102 offset:2048
    buffer_load_dwordx4 v23, s[36:39], s55 offen offset:3072 lds
    ds_read_b128 v[140:143], v102 offset:3072
    ds_read_b128 v[144:147], v102 offset:4096
    ds_read_b128 v[148:151], v102 offset:5120
    ds_read_b128 v[152:155], v102 offset:6144
    ds_read_b128 v[156:159], v102 offset:7168
    ds_read_b128 v[160:163], v102 offset:8192
    ds_read_b128 v[164:167], v102 offset:9216
    ds_read_b128 v[168:171], v102 offset:10240
    ds_read_b128 v[172:175], v102 offset:11264
    ds_read_b128 v[176:179], v102 offset:12288
    ds_read_b128 v[180:183], v102 offset:13312
    ds_read_b128 v[184:187], v102 offset:14336
    s_add_u32 m0, s53, 65536
    s_add_u32 s55, s54, 512
    buffer_load_dwordx4 v20, s[36:39], s55 offen offset:0 lds
    s_waitcnt lgkmcnt(14)
    ds_read_b128 v[188:191], v102 offset:15360
    v_bfe_u32 v99, v1, 2, 1
    buffer_load_dwordx4 v21, s[36:39], s55 offen offset:1024 lds
    v_bfe_u32 v100, v1, 3, 2
    v_lshlrev_b32 v100, 2, v100
    v_lshl_add_u32 v99, v99, 4, v100
    v_and_or_b32 v99, v1, 3, v99
    v_cvt_f32_u32 v99, v99
    v_lshl_add_u32 v100, v15, 8, s19
    v_cvt_f32_u32 v100, v100
    v_mul_f32 v100, 0x3c800000, v100
    v_mul_f32 v99, 0x3d000000, v99
    v_mul_f32 v81, v100, v99
    v_mul_f32 v101, 0x41000000, v99
    buffer_load_dwordx4 v22, s[36:39], s55 offen offset:2048 lds
    v_add_f32 v83, v81, v99
    v_add_f32 v89, v81, v101
    v_add_f32 v91, v83, v101
    v_cos_f32 v100, v99
    v_cos_f32 v101, v101
    v_cos_f32 v80, v81
    v_sin_f32 v81, v81
    v_cos_f32 v82, v83
    buffer_load_dwordx4 v23, s[36:39], s55 offen offset:3072 lds
    v_sin_f32 v83, v83
    v_cos_f32 v88, v89
    v_sin_f32 v89, v89
    v_cos_f32 v90, v91
    v_sin_f32 v91, v91
    v_pk_add_f32 v[100:101], v[100:101], v[100:101]
    s_add_u32 m0, s53, 81920
    s_add_u32 s55, s54, 640
    buffer_load_dwordx4 v20, s[36:39], s55 offen offset:0 lds
    v_pk_fma_f32 v[84:85], v[100:101], v[82:83], v[80:81] op_sel_hi:[0,1,1] neg_lo:[0,0,1] neg_hi:[0,0,1]
    v_pk_fma_f32 v[92:93], v[100:101], v[90:91], v[88:89] op_sel_hi:[0,1,1] neg_lo:[0,0,1] neg_hi:[0,0,1]
    v_pk_fma_f32 v[86:87], v[100:101], v[84:85], v[82:83] op_sel_hi:[0,1,1] neg_lo:[0,0,1] neg_hi:[0,0,1]
    v_pk_fma_f32 v[94:95], v[100:101], v[92:93], v[90:91] op_sel_hi:[0,1,1] neg_lo:[0,0,1] neg_hi:[0,0,1]
    v_cvt_pk_bf16_f32 v112, v80, v82
    v_cvt_pk_bf16_f32 v113, v84, v86
    v_cvt_pk_bf16_f32 v114, v88, v90
    v_cvt_pk_bf16_f32 v115, v92, v94
    v_cvt_pk_bf16_f32 v120, v81, v83
    v_cvt_pk_bf16_f32 v121, v85, v87
    v_cvt_pk_bf16_f32 v122, v89, v91
    v_cvt_pk_bf16_f32 v123, v93, v95
    buffer_load_dwordx4 v21, s[36:39], s55 offen offset:1024 lds
    v_pk_fma_f32 v[80:81], v[100:101], v[88:89], v[80:81] op_sel:[1,0,0] op_sel_hi:[1,1,1] neg_lo:[0,0,1] neg_hi:[0,0,1]
    v_pk_fma_f32 v[82:83], v[100:101], v[90:91], v[82:83] op_sel:[1,0,0] op_sel_hi:[1,1,1] neg_lo:[0,0,1] neg_hi:[0,0,1]
    v_pk_fma_f32 v[84:85], v[100:101], v[92:93], v[84:85] op_sel:[1,0,0] op_sel_hi:[1,1,1] neg_lo:[0,0,1] neg_hi:[0,0,1]
    v_pk_fma_f32 v[86:87], v[100:101], v[94:95], v[86:87] op_sel:[1,0,0] op_sel_hi:[1,1,1] neg_lo:[0,0,1] neg_hi:[0,0,1]
    v_pk_fma_f32 v[88:89], v[100:101], v[80:81], v[88:89] op_sel:[1,0,0] op_sel_hi:[1,1,1] neg_lo:[0,0,1] neg_hi:[0,0,1]
    v_pk_fma_f32 v[90:91], v[100:101], v[82:83], v[90:91] op_sel:[1,0,0] op_sel_hi:[1,1,1] neg_lo:[0,0,1] neg_hi:[0,0,1]
    v_pk_fma_f32 v[92:93], v[100:101], v[84:85], v[92:93] op_sel:[1,0,0] op_sel_hi:[1,1,1] neg_lo:[0,0,1] neg_hi:[0,0,1]
    v_pk_fma_f32 v[94:95], v[100:101], v[86:87], v[94:95] op_sel:[1,0,0] op_sel_hi:[1,1,1] neg_lo:[0,0,1] neg_hi:[0,0,1]
    v_cvt_pk_bf16_f32 v116, v80, v82
    v_cvt_pk_bf16_f32 v117, v84, v86
    v_cvt_pk_bf16_f32 v118, v88, v90
    v_cvt_pk_bf16_f32 v119, v92, v94
    buffer_load_dwordx4 v22, s[36:39], s55 offen offset:2048 lds
    v_cvt_pk_bf16_f32 v124, v81, v83
    v_cvt_pk_bf16_f32 v125, v85, v87
    v_cvt_pk_bf16_f32 v126, v89, v91
    v_cvt_pk_bf16_f32 v127, v93, v95
    v_bfe_u32 v99, v1, 2, 2
    v_bfe_u32 v101, v1, 4, 1
    v_lshl_add_u32 v103, v15, 3, v99
    v_lshlrev_b32 v103, 7, v103
    v_lshl_add_u32 v103, v101, 11, v103
    v_and_b32 v98, 1, v1
    v_and_or_b32 v98, v99, 2, v98
    v_lshl_add_u32 v98, v101, 2, v98
    buffer_load_dwordx4 v23, s[36:39], s55 offen offset:3072 lds
    v_lshl_add_u32 v103, v98, 4, v103
    v_bfe_u32 v100, v1, 1, 1
    v_lshl_add_u32 v103, v100, 3, v103
    s_brev_b32 s63, s18
    s_lshr_b32 s63, s63, 25
    v_xor_b32 v8, s63, v103
    v_xor_b32 v9, 32, v8
    v_add_u32 v10, 0x10000, v8
    v_add_u32 v12, 0x20000, v8
    v_add_u32 v11, 0x10000, v9
    v_add_u32 v13, 0x20000, v9
    s_mov_b32 s40, s8
    s_add_u32 m0, s53, 98304
    s_add_u32 s55, s54, 768
    buffer_load_dwordx4 v20, s[36:39], s55 offen offset:0 lds
    s_mov_b32 s41, s9
    s_mov_b32 s42, 1052672
    s_mov_b32 s43, 0x00020000
    s_mov_b32 s44, s10
    s_mov_b32 s45, s11
    s_mov_b32 s46, 1052672
    s_mov_b32 s47, 0x00020000
    s_lshr_b32 s61, s17, 4
    s_lshl_b32 s61, s61, 2
    s_add_u32 s61, s61, s18
    v_lshrrev_b32 v231, 4, v1
    v_mul_u32_u24 v230, 514, v231
    buffer_load_dwordx4 v21, s[36:39], s55 offen offset:1024 lds
    v_and_b32 v232, 15, v1
    v_lshl_add_u32 v230, v232, 2, v230
    s_bfe_u32 s60, s17, 0x10003
    s_lshl_b32 s8, s16, 1
    s_add_u32 s60, s60, s8
    s_and_b32 s8, s17, 7
    s_lshl_b32 s60, s60, 3
    s_add_u32 s8, s8, s60
    s_lshl_b32 s23, s8, 6
    s_lshl_b32 s9, s61, 18
    s_add_u32 s23, s23, s9
    s_add_u32 s23, s23, 4194304
    buffer_load_dwordx4 v22, s[36:39], s55 offen offset:2048 lds
    s_mul_i32 s60, s60, 3
    s_add_u32 s8, s8, s60
    s_mul_i32 s8, s8, 2056
    s_lshl_b32 s61, s61, 6
    s_add_u32 s8, s8, s61
    s_waitcnt vmcnt(30)
    s_barrier
    s_waitcnt lgkmcnt(14)
    ds_read_b128 a[0:3], v24 offset:0
    s_waitcnt lgkmcnt(14)
    ds_read_b128 a[4:7], v25 offset:0
    s_waitcnt lgkmcnt(14)
    ds_read_b128 a[8:11], v26 offset:0
    s_waitcnt lgkmcnt(14)
    ds_read_b128 a[12:15], v27 offset:0
    s_waitcnt lgkmcnt(14)
    ds_read_b128 a[128:131], v32 offset:0
    s_waitcnt lgkmcnt(14)
    ds_read_b128 a[132:135], v33 offset:0
    s_waitcnt lgkmcnt(14)
    ds_read_b128 a[136:139], v34 offset:0
    s_waitcnt lgkmcnt(14)
    ds_read_b128 a[140:143], v35 offset:0
    s_waitcnt lgkmcnt(4)
    s_waitcnt lgkmcnt(0)
    s_waitcnt vmcnt(26)
    s_barrier
    v_mfma_f32_32x32x16_bf16 v[80:95], a[0:3], v[128:131], 0
    ds_read_b128 a[16:19], v24 offset:16384
    ds_read_b128 a[20:23], v25 offset:16384
    buffer_load_dwordx4 v23, s[36:39], s55 offen offset:3072 lds
    v_mfma_f32_4x4x4_16b_bf16 v[192:195], v[208:209], a[0:1], 0
    v_mfma_f32_4x4x4_16b_bf16 v[200:203], a[0:1], a[0:1], 0
    v_mfma_f32_4x4x4_16b_bf16 v[196:199], v[208:209], a[2:3], 0
    v_mfma_f32_4x4x4_16b_bf16 v[204:207], a[2:3], a[2:3], 0
    v_mfma_f32_32x32x16_bf16 v[80:95], a[4:7], v[132:135], v[80:95]
    ds_read_b128 a[24:27], v26 offset:16384
    ds_read_b128 a[28:31], v27 offset:16384
    s_add_u32 m0, s53, 114688
    s_add_u32 s55, s54, 896
    buffer_load_dwordx4 v20, s[36:39], s55 offen offset:0 lds
    v_mfma_f32_4x4x4_16b_bf16 v[192:195], v[208:209], a[4:5], v[192:195]
    v_mfma_f32_4x4x4_16b_bf16 v[200:203], a[4:5], a[4:5], v[200:203]
    v_mfma_f32_4x4x4_16b_bf16 v[196:199], v[208:209], a[6:7], v[196:199]
    v_mfma_f32_4x4x4_16b_bf16 v[204:207], a[6:7], a[6:7], v[204:207]
    v_mfma_f32_32x32x16_bf16 v[80:95], a[8:11], v[136:139], v[80:95]
    ds_read_b128 a[144:147], v32 offset:16384
    ds_read_b128 a[148:151], v33 offset:16384
    buffer_load_dwordx4 v21, s[36:39], s55 offen offset:1024 lds
    v_mfma_f32_4x4x4_16b_bf16 v[192:195], v[208:209], a[8:9], v[192:195]
    v_mfma_f32_4x4x4_16b_bf16 v[200:203], a[8:9], a[8:9], v[200:203]
    v_mfma_f32_4x4x4_16b_bf16 v[196:199], v[208:209], a[10:11], v[196:199]
    v_mfma_f32_4x4x4_16b_bf16 v[204:207], a[10:11], a[10:11], v[204:207]
    v_mfma_f32_32x32x16_bf16 v[80:95], a[12:15], v[140:143], v[80:95]
    ds_read_b128 a[152:155], v34 offset:16384
    ds_read_b128 a[156:159], v35 offset:16384
    buffer_load_dwordx4 v22, s[36:39], s55 offen offset:2048 lds
    v_mfma_f32_4x4x4_16b_bf16 v[192:195], v[208:209], a[12:13], v[192:195]
    v_mfma_f32_4x4x4_16b_bf16 v[200:203], a[12:13], a[12:13], v[200:203]
    v_mfma_f32_4x4x4_16b_bf16 v[196:199], v[208:209], a[14:15], v[196:199]
    v_mfma_f32_4x4x4_16b_bf16 v[204:207], a[14:15], a[14:15], v[204:207]
    s_waitcnt lgkmcnt(4)
    s_waitcnt lgkmcnt(0)
    s_waitcnt vmcnt(19)
    s_barrier
    v_mfma_f32_32x32x16_bf16 v[80:95], a[16:19], v[144:147], v[80:95]
    ds_read_b128 a[32:35], v24 offset:32768
    ds_read_b128 a[36:39], v25 offset:32768
    buffer_load_dwordx4 v23, s[36:39], s55 offen offset:3072 lds
    v_mfma_f32_4x4x4_16b_bf16 v[192:195], v[208:209], a[16:17], v[192:195]
    v_mfma_f32_4x4x4_16b_bf16 v[200:203], a[16:17], a[16:17], v[200:203]
    v_mfma_f32_4x4x4_16b_bf16 v[196:199], v[208:209], a[18:19], v[196:199]
    v_mfma_f32_4x4x4_16b_bf16 v[204:207], a[18:19], a[18:19], v[204:207]
    v_mfma_f32_32x32x16_bf16 v[80:95], a[20:23], v[148:151], v[80:95]
    ds_read_b128 a[40:43], v26 offset:32768
    ds_read_b128 a[44:47], v27 offset:32768
    s_add_u32 m0, s53, 131072
    s_add_u32 s55, s52, 0
    buffer_load_dwordx4 v16, s[28:31], s55 offen offset:0 lds
    v_mfma_f32_4x4x4_16b_bf16 v[192:195], v[208:209], a[20:21], v[192:195]
    v_mfma_f32_4x4x4_16b_bf16 v[200:203], a[20:21], a[20:21], v[200:203]
    v_mfma_f32_4x4x4_16b_bf16 v[196:199], v[208:209], a[22:23], v[196:199]
    v_mfma_f32_4x4x4_16b_bf16 v[204:207], a[22:23], a[22:23], v[204:207]
    v_mfma_f32_32x32x16_bf16 v[80:95], a[24:27], v[152:155], v[80:95]
    ds_read_b128 a[160:163], v32 offset:32768
    ds_read_b128 a[164:167], v33 offset:32768
    buffer_load_dwordx4 v17, s[28:31], s55 offen offset:1024 lds
    v_mfma_f32_4x4x4_16b_bf16 v[192:195], v[208:209], a[24:25], v[192:195]
    v_mfma_f32_4x4x4_16b_bf16 v[200:203], a[24:25], a[24:25], v[200:203]
    v_mfma_f32_4x4x4_16b_bf16 v[196:199], v[208:209], a[26:27], v[196:199]
    v_mfma_f32_4x4x4_16b_bf16 v[204:207], a[26:27], a[26:27], v[204:207]
    v_mfma_f32_32x32x16_bf16 v[80:95], a[28:31], v[156:159], v[80:95]
    ds_read_b128 a[168:171], v34 offset:32768
    ds_read_b128 a[172:175], v35 offset:32768
    buffer_load_dwordx4 v18, s[32:35], s55 offen offset:2048 lds
    v_mfma_f32_4x4x4_16b_bf16 v[192:195], v[208:209], a[28:29], v[192:195]
    v_mfma_f32_4x4x4_16b_bf16 v[200:203], a[28:29], a[28:29], v[200:203]
    v_mfma_f32_4x4x4_16b_bf16 v[196:199], v[208:209], a[30:31], v[196:199]
    v_mfma_f32_4x4x4_16b_bf16 v[204:207], a[30:31], a[30:31], v[204:207]
    v_mov_b32 v229, 0
    buffer_load_dword v228, v229, s[48:51], 0 offen sc1
    s_waitcnt lgkmcnt(4)
    s_waitcnt lgkmcnt(0)
    s_waitcnt vmcnt(20)
    s_barrier
    v_mfma_f32_32x32x16_bf16 v[80:95], a[32:35], v[160:163], v[80:95]
    ds_read_b128 a[48:51], v24 offset:49152
    ds_read_b128 a[52:55], v25 offset:49152
    buffer_load_dwordx4 v19, s[32:35], s55 offen offset:3072 lds
    v_mfma_f32_4x4x4_16b_bf16 v[192:195], v[208:209], a[32:33], v[192:195]
    v_mfma_f32_4x4x4_16b_bf16 v[200:203], a[32:33], a[32:33], v[200:203]
    v_mfma_f32_4x4x4_16b_bf16 v[196:199], v[208:209], a[34:35], v[196:199]
    v_mfma_f32_4x4x4_16b_bf16 v[204:207], a[34:35], a[34:35], v[204:207]
    v_mfma_f32_32x32x16_bf16 v[80:95], a[36:39], v[164:167], v[80:95]
    ds_read_b128 a[56:59], v26 offset:49152
    ds_read_b128 a[60:63], v27 offset:49152
    s_add_u32 m0, s53, 0
    s_add_u32 s55, s52, 229376
    buffer_load_dwordx4 v16, s[28:31], s55 offen offset:0 lds
    v_mfma_f32_4x4x4_16b_bf16 v[192:195], v[208:209], a[36:37], v[192:195]
    v_mfma_f32_4x4x4_16b_bf16 v[200:203], a[36:37], a[36:37], v[200:203]
    v_mfma_f32_4x4x4_16b_bf16 v[196:199], v[208:209], a[38:39], v[196:199]
    v_mfma_f32_4x4x4_16b_bf16 v[204:207], a[38:39], a[38:39], v[204:207]
    v_mfma_f32_32x32x16_bf16 v[80:95], a[40:43], v[168:171], v[80:95]
    ds_read_b128 a[176:179], v32 offset:49152
    ds_read_b128 a[180:183], v33 offset:49152
    buffer_load_dwordx4 v17, s[28:31], s55 offen offset:1024 lds
    v_mfma_f32_4x4x4_16b_bf16 v[192:195], v[208:209], a[40:41], v[192:195]
    v_mfma_f32_4x4x4_16b_bf16 v[200:203], a[40:41], a[40:41], v[200:203]
    v_mfma_f32_4x4x4_16b_bf16 v[196:199], v[208:209], a[42:43], v[196:199]
    v_mfma_f32_4x4x4_16b_bf16 v[204:207], a[42:43], a[42:43], v[204:207]
    v_mfma_f32_32x32x16_bf16 v[80:95], a[44:47], v[172:175], v[80:95]
    ds_read_b128 a[184:187], v34 offset:49152
    ds_read_b128 a[188:191], v35 offset:49152
    buffer_load_dwordx4 v18, s[32:35], s55 offen offset:2048 lds
    v_mfma_f32_4x4x4_16b_bf16 v[192:195], v[208:209], a[44:45], v[192:195]
    v_mfma_f32_4x4x4_16b_bf16 v[200:203], a[44:45], a[44:45], v[200:203]
    v_mfma_f32_4x4x4_16b_bf16 v[196:199], v[208:209], a[46:47], v[196:199]
    v_mfma_f32_4x4x4_16b_bf16 v[204:207], a[46:47], a[46:47], v[204:207]
    s_waitcnt lgkmcnt(4)
    s_waitcnt lgkmcnt(0)
    s_waitcnt vmcnt(20)
    s_barrier
    v_mfma_f32_32x32x16_bf16 v[80:95], a[48:51], v[176:179], v[80:95]
    ds_read_b128 a[64:67], v28 offset:0
    ds_read_b128 a[68:71], v29 offset:0
    buffer_load_dwordx4 v19, s[32:35], s55 offen offset:3072 lds
    v_mfma_f32_4x4x4_16b_bf16 v[192:195], v[208:209], a[48:49], v[192:195]
    v_mfma_f32_4x4x4_16b_bf16 v[200:203], a[48:49], a[48:49], v[200:203]
    v_mfma_f32_4x4x4_16b_bf16 v[196:199], v[208:209], a[50:51], v[196:199]
    v_mfma_f32_4x4x4_16b_bf16 v[204:207], a[50:51], a[50:51], v[204:207]
    v_mfma_f32_32x32x16_bf16 v[80:95], a[52:55], v[180:183], v[80:95]
    ds_read_b128 a[72:75], v30 offset:0
    ds_read_b128 a[76:79], v31 offset:0
    s_add_u32 m0, s53, 16384
    s_add_u32 s55, s52, 458752
    buffer_load_dwordx4 v16, s[28:31], s55 offen offset:0 lds
    v_mfma_f32_4x4x4_16b_bf16 v[192:195], v[208:209], a[52:53], v[192:195]
    v_mfma_f32_4x4x4_16b_bf16 v[200:203], a[52:53], a[52:53], v[200:203]
    v_mfma_f32_4x4x4_16b_bf16 v[196:199], v[208:209], a[54:55], v[196:199]
    v_mfma_f32_4x4x4_16b_bf16 v[204:207], a[54:55], a[54:55], v[204:207]
    v_mfma_f32_32x32x16_bf16 v[80:95], a[56:59], v[184:187], v[80:95]
    ds_read_b128 a[192:195], v36 offset:0
    ds_read_b128 a[196:199], v37 offset:0
    buffer_load_dwordx4 v17, s[28:31], s55 offen offset:1024 lds
    v_mfma_f32_4x4x4_16b_bf16 v[192:195], v[208:209], a[56:57], v[192:195]
    v_mfma_f32_4x4x4_16b_bf16 v[200:203], a[56:57], a[56:57], v[200:203]
    v_mfma_f32_4x4x4_16b_bf16 v[196:199], v[208:209], a[58:59], v[196:199]
    v_mfma_f32_4x4x4_16b_bf16 v[204:207], a[58:59], a[58:59], v[204:207]
    v_mfma_f32_32x32x16_bf16 v[80:95], a[60:63], v[188:191], v[80:95]
    ds_read_b128 a[200:203], v38 offset:0
    ds_read_b128 a[204:207], v39 offset:0
    buffer_load_dwordx4 v18, s[32:35], s55 offen offset:2048 lds
    v_mfma_f32_4x4x4_16b_bf16 v[192:195], v[208:209], a[60:61], v[192:195]
    v_mfma_f32_4x4x4_16b_bf16 v[200:203], a[60:61], a[60:61], v[200:203]
    v_mfma_f32_4x4x4_16b_bf16 v[196:199], v[208:209], a[62:63], v[196:199]
    v_mfma_f32_4x4x4_16b_bf16 v[204:207], a[62:63], a[62:63], v[204:207]
    s_waitcnt lgkmcnt(4)
    s_waitcnt lgkmcnt(0)
    s_waitcnt vmcnt(20)
    s_barrier
    v_mfma_f32_32x32x16_bf16 v[96:111], a[64:67], v[128:131], 0
    ds_read_b128 a[80:83], v28 offset:16384
    ds_read_b128 a[84:87], v29 offset:16384
    buffer_load_dwordx4 v19, s[32:35], s55 offen offset:3072 lds
    v_mfma_f32_4x4x4_16b_bf16 v[192:195], v[208:209], a[64:65], v[192:195]
    v_mfma_f32_4x4x4_16b_bf16 v[200:203], a[64:65], a[64:65], v[200:203]
    v_mfma_f32_4x4x4_16b_bf16 v[196:199], v[208:209], a[66:67], v[196:199]
    v_mfma_f32_4x4x4_16b_bf16 v[204:207], a[66:67], a[66:67], v[204:207]
    v_mfma_f32_32x32x16_bf16 v[96:111], a[68:71], v[132:135], v[96:111]
    ds_read_b128 a[88:91], v30 offset:16384
    ds_read_b128 a[92:95], v31 offset:16384
    buffer_load_dword v52, v230, s[40:43], s8 offen offset:2
    v_mfma_f32_4x4x4_16b_bf16 v[192:195], v[208:209], a[68:69], v[192:195]
    v_mfma_f32_4x4x4_16b_bf16 v[200:203], a[68:69], a[68:69], v[200:203]
    v_mfma_f32_4x4x4_16b_bf16 v[196:199], v[208:209], a[70:71], v[196:199]
    v_mfma_f32_4x4x4_16b_bf16 v[204:207], a[70:71], a[70:71], v[204:207]
    v_mfma_f32_32x32x16_bf16 v[96:111], a[72:75], v[136:139], v[96:111]
    ds_read_b128 a[208:211], v36 offset:16384
    ds_read_b128 a[212:215], v37 offset:16384
    buffer_load_dword v60, v230, s[44:47], s8 offen offset:2
    v_mfma_f32_4x4x4_16b_bf16 v[192:195], v[208:209], a[72:73], v[192:195]
    v_mfma_f32_4x4x4_16b_bf16 v[200:203], a[72:73], a[72:73], v[200:203]
    v_mfma_f32_4x4x4_16b_bf16 v[196:199], v[208:209], a[74:75], v[196:199]
    v_mfma_f32_4x4x4_16b_bf16 v[204:207], a[74:75], a[74:75], v[204:207]
    v_mfma_f32_32x32x16_bf16 v[96:111], a[76:79], v[140:143], v[96:111]
    ds_read_b128 a[216:219], v38 offset:16384
    ds_read_b128 a[220:223], v39 offset:16384
    s_add_u32 s8, s8, 16448
    buffer_load_dword v53, v230, s[40:43], s8 offen offset:2
    v_mfma_f32_4x4x4_16b_bf16 v[192:195], v[208:209], a[76:77], v[192:195]
    v_mfma_f32_4x4x4_16b_bf16 v[200:203], a[76:77], a[76:77], v[200:203]
    v_mfma_f32_4x4x4_16b_bf16 v[196:199], v[208:209], a[78:79], v[196:199]
    v_mfma_f32_4x4x4_16b_bf16 v[204:207], a[78:79], a[78:79], v[204:207]
    s_waitcnt lgkmcnt(4)
    s_waitcnt lgkmcnt(0)
    s_waitcnt vmcnt(20)
    s_barrier
    v_mfma_f32_32x32x16_bf16 v[96:111], a[80:83], v[144:147], v[96:111]
    ds_read_b128 a[96:99], v28 offset:32768
    ds_read_b128 a[100:103], v29 offset:32768
    buffer_load_dword v61, v230, s[44:47], s8 offen offset:2
    v_mfma_f32_4x4x4_16b_bf16 v[192:195], v[208:209], a[80:81], v[192:195]
    v_mfma_f32_4x4x4_16b_bf16 v[200:203], a[80:81], a[80:81], v[200:203]
    v_mfma_f32_4x4x4_16b_bf16 v[196:199], v[208:209], a[82:83], v[196:199]
    v_mfma_f32_4x4x4_16b_bf16 v[204:207], a[82:83], a[82:83], v[204:207]
    v_mfma_f32_32x32x16_bf16 v[96:111], a[84:87], v[148:151], v[96:111]
    ds_read_b128 a[104:107], v30 offset:32768
    ds_read_b128 a[108:111], v31 offset:32768
    s_add_u32 s8, s8, 16448
    buffer_load_dword v54, v230, s[40:43], s8 offen offset:2
    v_mfma_f32_4x4x4_16b_bf16 v[192:195], v[208:209], a[84:85], v[192:195]
    v_mfma_f32_4x4x4_16b_bf16 v[200:203], a[84:85], a[84:85], v[200:203]
    v_mfma_f32_4x4x4_16b_bf16 v[196:199], v[208:209], a[86:87], v[196:199]
    v_mfma_f32_4x4x4_16b_bf16 v[204:207], a[86:87], a[86:87], v[204:207]
    v_mfma_f32_32x32x16_bf16 v[96:111], a[88:91], v[152:155], v[96:111]
    ds_read_b128 a[224:227], v36 offset:32768
    ds_read_b128 a[228:231], v37 offset:32768
    buffer_load_dword v62, v230, s[44:47], s8 offen offset:2
    v_mfma_f32_4x4x4_16b_bf16 v[192:195], v[208:209], a[88:89], v[192:195]
    v_mfma_f32_4x4x4_16b_bf16 v[200:203], a[88:89], a[88:89], v[200:203]
    v_mfma_f32_4x4x4_16b_bf16 v[196:199], v[208:209], a[90:91], v[196:199]
    v_mfma_f32_4x4x4_16b_bf16 v[204:207], a[90:91], a[90:91], v[204:207]
    v_mfma_f32_32x32x16_bf16 v[96:111], a[92:95], v[156:159], v[96:111]
    ds_read_b128 a[232:235], v38 offset:32768
    ds_read_b128 a[236:239], v39 offset:32768
    s_add_u32 s8, s8, 16448
    buffer_load_dword v55, v230, s[40:43], s8 offen offset:2
    v_mfma_f32_4x4x4_16b_bf16 v[192:195], v[208:209], a[92:93], v[192:195]
    v_mfma_f32_4x4x4_16b_bf16 v[200:203], a[92:93], a[92:93], v[200:203]
    v_mfma_f32_4x4x4_16b_bf16 v[196:199], v[208:209], a[94:95], v[196:199]
    v_mfma_f32_4x4x4_16b_bf16 v[204:207], a[94:95], a[94:95], v[204:207]
    s_waitcnt lgkmcnt(4)
    s_waitcnt lgkmcnt(0)
    s_waitcnt vmcnt(20)
    s_barrier
    v_mfma_f32_32x32x16_bf16 v[96:111], a[96:99], v[160:163], v[96:111]
    ds_read_b128 a[112:115], v28 offset:49152
    ds_read_b128 a[116:119], v29 offset:49152
    buffer_load_dword v63, v230, s[44:47], s8 offen offset:2
    v_mfma_f32_4x4x4_16b_bf16 v[192:195], v[208:209], a[96:97], v[192:195]
    v_mfma_f32_4x4x4_16b_bf16 v[200:203], a[96:97], a[96:97], v[200:203]
    v_mfma_f32_4x4x4_16b_bf16 v[196:199], v[208:209], a[98:99], v[196:199]
    v_mfma_f32_4x4x4_16b_bf16 v[204:207], a[98:99], a[98:99], v[204:207]
    v_mfma_f32_32x32x16_bf16 v[96:111], a[100:103], v[164:167], v[96:111]
    ds_read_b128 a[120:123], v30 offset:49152
    ds_read_b128 a[124:127], v31 offset:49152
    s_add_u32 m0, s53, 32768
    s_add_u32 s55, s52, 688128
    buffer_load_dwordx4 v16, s[28:31], s55 offen offset:0 lds
    v_mfma_f32_4x4x4_16b_bf16 v[192:195], v[208:209], a[100:101], v[192:195]
    v_mfma_f32_4x4x4_16b_bf16 v[200:203], a[100:101], a[100:101], v[200:203]
    v_mfma_f32_4x4x4_16b_bf16 v[196:199], v[208:209], a[102:103], v[196:199]
    v_mfma_f32_4x4x4_16b_bf16 v[204:207], a[102:103], a[102:103], v[204:207]
    v_mfma_f32_32x32x16_bf16 v[96:111], a[104:107], v[168:171], v[96:111]
    ds_read_b128 a[240:243], v36 offset:49152
    ds_read_b128 a[244:247], v37 offset:49152
    buffer_load_dwordx4 v17, s[28:31], s55 offen offset:1024 lds
    v_mfma_f32_4x4x4_16b_bf16 v[192:195], v[208:209], a[104:105], v[192:195]
    v_mfma_f32_4x4x4_16b_bf16 v[200:203], a[104:105], a[104:105], v[200:203]
    v_mfma_f32_4x4x4_16b_bf16 v[196:199], v[208:209], a[106:107], v[196:199]
    v_mfma_f32_4x4x4_16b_bf16 v[204:207], a[106:107], a[106:107], v[204:207]
    v_mfma_f32_32x32x16_bf16 v[96:111], a[108:111], v[172:175], v[96:111]
    ds_read_b128 a[248:251], v38 offset:49152
    ds_read_b128 a[252:255], v39 offset:49152
    buffer_load_dwordx4 v18, s[32:35], s55 offen offset:2048 lds
    v_mfma_f32_4x4x4_16b_bf16 v[192:195], v[208:209], a[108:109], v[192:195]
    v_mfma_f32_4x4x4_16b_bf16 v[200:203], a[108:109], a[108:109], v[200:203]
    v_mfma_f32_4x4x4_16b_bf16 v[196:199], v[208:209], a[110:111], v[196:199]
    v_mfma_f32_4x4x4_16b_bf16 v[204:207], a[110:111], a[110:111], v[204:207]
    s_waitcnt lgkmcnt(4)
    s_waitcnt lgkmcnt(0)
    v_mfma_f32_32x32x16_bf16 v[96:111], a[112:115], v[176:179], v[96:111]
    buffer_load_dwordx4 v19, s[32:35], s55 offen offset:3072 lds
    v_mfma_f32_4x4x4_16b_bf16 v[192:195], v[208:209], a[112:113], v[192:195]
    v_mfma_f32_4x4x4_16b_bf16 v[200:203], a[112:113], a[112:113], v[200:203]
    v_mfma_f32_4x4x4_16b_bf16 v[196:199], v[208:209], a[114:115], v[196:199]
    v_mfma_f32_4x4x4_16b_bf16 v[204:207], a[114:115], a[114:115], v[204:207]
    v_mfma_f32_32x32x16_bf16 v[96:111], a[116:119], v[180:183], v[96:111]
    s_add_u32 m0, s53, 49152
    s_add_u32 s55, s52, 917504
    buffer_load_dwordx4 v16, s[28:31], s55 offen offset:0 lds
    v_mfma_f32_4x4x4_16b_bf16 v[192:195], v[208:209], a[116:117], v[192:195]
    v_mfma_f32_4x4x4_16b_bf16 v[200:203], a[116:117], a[116:117], v[200:203]
    v_mfma_f32_4x4x4_16b_bf16 v[196:199], v[208:209], a[118:119], v[196:199]
    v_mfma_f32_4x4x4_16b_bf16 v[204:207], a[118:119], a[118:119], v[204:207]
    v_mfma_f32_32x32x16_bf16 v[96:111], a[120:123], v[184:187], v[96:111]
    buffer_load_dwordx4 v17, s[28:31], s55 offen offset:1024 lds
    v_mfma_f32_4x4x4_16b_bf16 v[192:195], v[208:209], a[120:121], v[192:195]
    v_mfma_f32_4x4x4_16b_bf16 v[200:203], a[120:121], a[120:121], v[200:203]
    v_mfma_f32_4x4x4_16b_bf16 v[196:199], v[208:209], a[122:123], v[196:199]
    v_mfma_f32_4x4x4_16b_bf16 v[204:207], a[122:123], a[122:123], v[204:207]
    v_mfma_f32_32x32x16_bf16 v[96:111], a[124:127], v[188:191], v[96:111]
    buffer_load_dwordx4 v18, s[32:35], s55 offen offset:2048 lds
    v_mfma_f32_4x4x4_16b_bf16 v[192:195], v[208:209], a[124:125], v[192:195]
    v_mfma_f32_4x4x4_16b_bf16 v[200:203], a[124:125], a[124:125], v[200:203]
    v_mfma_f32_4x4x4_16b_bf16 v[196:199], v[208:209], a[126:127], v[196:199]
    v_mfma_f32_4x4x4_16b_bf16 v[204:207], a[126:127], a[126:127], v[204:207]
    s_waitcnt vmcnt(23)
    s_barrier
    ds_read_b64_tr_b16 v[20:21], v12 offset:0
    ds_read_b64_tr_b16 v[22:23], v12 offset:512
    ds_read_b64_tr_b16 v[24:25], v13 offset:0
    ds_read_b64_tr_b16 v[26:27], v13 offset:512
    ds_read_b64_tr_b16 v[28:29], v12 offset:4096
    ds_read_b64_tr_b16 v[30:31], v12 offset:4608
    ds_read_b64_tr_b16 v[32:33], v13 offset:4096
    ds_read_b64_tr_b16 v[34:35], v13 offset:4608
    v_and_b32 v45, 3, v1
    v_add_f32 v200, v200, v204
    v_add_f32 v201, v201, v205
    v_add_f32 v202, v202, v206
    v_add_f32 v203, v203, v207
    v_add_f32 v44, v192, v196
    v_cmp_eq_u32 vcc, 1, v45
    v_fma_f32 v81, v97, v210, v81
    v_fma_f32 v85, v101, v210, v85
    v_cndmask_b32 v200, v200, v201, vcc
    v_cmp_eq_u32 vcc, 2, v45
    v_fma_f32 v82, v98, v210, v82
    v_fma_f32 v86, v102, v210, v86
    v_cndmask_b32 v200, v200, v202, vcc
    v_cmp_eq_u32 vcc, 3, v45
    v_fma_f32 v83, v99, v210, v83
    v_fma_f32 v87, v103, v210, v87
    v_cndmask_b32 v46, v200, v203, vcc
    v_mov_b32 v45, v44
    v_mov_b32 v47, v46
    s_add_u32 s60, s53, 114688
    v_lshl_add_u32 v68, v14, 2, s60
    v_permlane32_swap_b32 v44, v45
    v_permlane32_swap_b32 v46, v47
    v_add_f32 v44, v44, v45
    v_add_f32 v46, v46, v47
    v_mul_f32 v44, 0x3b000000, v44
    v_mul_f32 v46, 0x3b000000, v46
    v_fma_f32 v46, -v44, v44, v46
    v_max_f32 v46, 0, v46
    v_cvt_pk_bf16_f32 v44, v44, v46
    v_and_b32 v46, 0xffff0000, v44
    v_add_f32 v46, 0x3727c5ac, v46
    v_cvt_pk_bf16_f32 v46, v46, v46
    v_and_b32 v46, 0xffff0000, v46
    v_sqrt_f32 v46, v46
    v_lshl_add_u32 v47, v15, 4, s60
    v_cvt_pk_bf16_f32 v46, v46, v46
    v_and_b32 v7, 0xffff0000, v46
    v_rcp_f32 v6, v7
    v_and_b32 v44, 0xffff, v44
    v_or_b32 v44, v44, v7
    ds_write2_b32 v68, v6, v44 offset0:0 offset1:32
    ds_read_b128 v[192:195], v47 offset:0
    ds_read_b128 v[196:199], v47 offset:32
    ds_read_b128 v[200:203], v47 offset:64
    ds_read_b128 v[204:207], v47 offset:96
    v_fma_f32 v80, v96, v210, v80
    v_fma_f32 v84, v100, v210, v84
    v_fma_f32 v88, v104, v210, v88
    v_fma_f32 v89, v105, v210, v89
    v_fma_f32 v90, v106, v210, v90
    v_fma_f32 v91, v107, v210, v91
    v_fma_f32 v92, v108, v210, v92
    v_fma_f32 v93, v109, v210, v93
    v_fma_f32 v94, v110, v210, v94
    v_fma_f32 v95, v111, v210, v95
    s_waitcnt lgkmcnt(3)
    v_mul_f32 v80, v80, v192
    v_mul_f32 v81, v81, v193
    v_mul_f32 v82, v82, v194
    v_mul_f32 v83, v83, v195
    s_waitcnt lgkmcnt(2)
    v_mul_f32 v84, v84, v196
    v_mul_f32 v85, v85, v197
    v_mul_f32 v86, v86, v198
    v_mul_f32 v87, v87, v199
    s_waitcnt lgkmcnt(1)
    v_mul_f32 v88, v88, v200
    v_mul_f32 v89, v89, v201
    v_mul_f32 v90, v90, v202
    v_mul_f32 v91, v91, v203
    s_waitcnt lgkmcnt(0)
    v_mul_f32 v92, v92, v204
    v_mul_f32 v93, v93, v205
    v_mul_f32 v94, v94, v206
    v_mul_f32 v95, v95, v207
    v_cvt_pk_bf16_f32 v72, v80, v81
    v_cvt_pk_bf16_f32 v73, v82, v83
    v_cvt_pk_bf16_f32 v74, v84, v85
    v_cvt_pk_bf16_f32 v75, v86, v87
    v_cvt_pk_bf16_f32 v76, v88, v89
    v_cvt_pk_bf16_f32 v77, v90, v91
    v_cvt_pk_bf16_f32 v78, v92, v93
    v_cvt_pk_bf16_f32 v79, v94, v95
    v_cmp_eq_u32 vcc, 0, v228
    s_nop 1
    s_cbranch_vccnz G_AW1_SPIN
G_AW1_OK:
    v_readfirstlane_b32 s22, v228
    v_mfma_f32_32x32x16_bf16 v[80:95], v[112:115], v[72:75], 0
    v_mfma_f32_32x32x16_bf16 v[96:111], v[120:123], v[72:75], 0
    v_mfma_f32_32x32x16_bf16 v[80:95], v[116:119], v[76:79], v[80:95]
    v_mfma_f32_32x32x16_bf16 v[96:111], v[124:127], v[76:79], v[96:111]
    v_mov_b32 v114, 0x3f803f80
    v_mov_b32 v115, 0x3f803f80
    v_mov_b32 v4, 0xc0135761
    v_mov_b32 v5, 0xbdd2d3e8
    s_add_u32 s62, s53, 147456
    v_lshlrev_b32 v211, 1, v1
    v_and_b32 v211, 0x70, v211
    v_xor_b32 v211, v211, v2
    v_add_u32 v211, s62, v211
    v_lshlrev_b32 v46, 31, v1
    v_or_b32 v46, 1.0, v46
    v_lshlrev_b32 v69, 6, v14
    v_lshl_add_u32 v69, v15, 5, v69
    v_lshlrev_b32 v70, 3, v1
    v_and_b32 v70, 0x70, v70
    v_xor_b32 v69, v69, v70
    v_add_u32 v69, s62, v69
    v_xor_b32 v70, 16, v69
    s_lshl_b32 s60, s20, 17
    s_lshl_b32 s61, s19, 7
    s_add_u32 s60, s60, s61
    s_add_u32 s60, s60, 2097152
    s_add_u32 s61, s60, 65536
    v_fmac_f32_dpp v80, v96, v46 quad_perm:[1,0,3,2] row_mask:0xf bank_mask:0xf
    v_fmac_f32_dpp v81, v97, v46 quad_perm:[1,0,3,2] row_mask:0xf bank_mask:0xf
    v_fmac_f32_dpp v82, v98, v46 quad_perm:[1,0,3,2] row_mask:0xf bank_mask:0xf
    v_fmac_f32_dpp v83, v99, v46 quad_perm:[1,0,3,2] row_mask:0xf bank_mask:0xf
    v_fmac_f32_dpp v84, v100, v46 quad_perm:[1,0,3,2] row_mask:0xf bank_mask:0xf
    v_fmac_f32_dpp v85, v101, v46 quad_perm:[1,0,3,2] row_mask:0xf bank_mask:0xf
    v_fmac_f32_dpp v86, v102, v46 quad_perm:[1,0,3,2] row_mask:0xf bank_mask:0xf
    v_fmac_f32_dpp v87, v103, v46 quad_perm:[1,0,3,2] row_mask:0xf bank_mask:0xf
    v_cvt_pk_bf16_f32 v72, v80, v81
    v_cvt_pk_bf16_f32 v73, v82, v83
    v_cvt_pk_bf16_f32 v74, v84, v85
    v_cvt_pk_bf16_f32 v75, v86, v87
    ds_write_b128 v69, v[72:75] offset:2048
    v_fmac_f32_dpp v88, v104, v46 quad_perm:[1,0,3,2] row_mask:0xf bank_mask:0xf
    v_fmac_f32_dpp v89, v105, v46 quad_perm:[1,0,3,2] row_mask:0xf bank_mask:0xf
    v_fmac_f32_dpp v90, v106, v46 quad_perm:[1,0,3,2] row_mask:0xf bank_mask:0xf
    v_fmac_f32_dpp v91, v107, v46 quad_perm:[1,0,3,2] row_mask:0xf bank_mask:0xf
    v_fmac_f32_dpp v92, v108, v46 quad_perm:[1,0,3,2] row_mask:0xf bank_mask:0xf
    v_fmac_f32_dpp v93, v109, v46 quad_perm:[1,0,3,2] row_mask:0xf bank_mask:0xf
    v_fmac_f32_dpp v94, v110, v46 quad_perm:[1,0,3,2] row_mask:0xf bank_mask:0xf
    v_fmac_f32_dpp v95, v111, v46 quad_perm:[1,0,3,2] row_mask:0xf bank_mask:0xf
    v_cvt_pk_bf16_f32 v76, v88, v89
    v_cvt_pk_bf16_f32 v77, v90, v91
    v_cvt_pk_bf16_f32 v78, v92, v93
    v_cvt_pk_bf16_f32 v79, v94, v95
    ds_write_b128 v70, v[76:79] offset:2048
    ds_read_b128 v[104:107], v211 offset:2048
    ds_read_b128 v[108:111], v211 offset:3072
    v_lshrrev_b32 v70, 3, v1
    v_lshlrev_b32 v70, 13, v70
    v_and_b32 v47, 7, v1
    v_lshl_add_u32 v70, v47, 4, v70
    s_waitcnt lgkmcnt(1)
    buffer_store_dwordx4 v[104:107], v70, s[24:27], s60 offen sc1
    s_waitcnt lgkmcnt(0)
    buffer_store_dwordx4 v[108:111], v70, s[24:27], s61 offen sc1
    s_add_u32 s9, s53, 147456
    v_lshl_add_u32 v232, v232, 7, s9
    v_and_b32 v230, 7, v1
    v_xor_b32 v231, v231, v230
    v_lshl_add_u32 v231, v231, 4, v232
    v_xor_b32 v232, 64, v231
    v_lshrrev_b32 v3, 2, v1
    v_lshlrev_b32 v3, 13, v3
    v_and_b32 v230, 3, v1
    v_lshl_add_u32 v3, v230, 4, v3
    s_mov_b32 s10, 0x05040100
    s_mov_b32 s11, 0x07060302
    s_add_u32 s9, s23, 131072
    s_waitcnt vmcnt(15)
    v_perm_b32 v48, v60, v52, s10
    s_waitcnt vmcnt(13)
    v_perm_b32 v49, v61, v53, s10
    s_waitcnt vmcnt(11)
    v_perm_b32 v50, v62, v54, s10
    s_waitcnt vmcnt(9)
    v_perm_b32 v51, v63, v55, s10
    ds_write_b128 v231, v[48:51]
    v_perm_b32 v56, v60, v52, s11
    v_perm_b32 v57, v61, v53, s11
    v_perm_b32 v58, v62, v54, s11
    v_perm_b32 v59, v63, v55, s11
    ds_write_b128 v232, v[56:59]
    ds_read_b128 v[48:51], v211
    ds_read_b128 v[56:59], v211 offset:1024
    s_waitcnt lgkmcnt(1)
    buffer_store_dwordx4 v[48:51], v3, s[24:27], s23 offen sc1
    s_waitcnt lgkmcnt(0)
    buffer_store_dwordx4 v[56:59], v3, s[24:27], s9 offen sc1
    v_mfma_f32_32x32x16_bf16 v[128:143], v[20:23], a[0:3], 0
    ds_read_b64_tr_b16 v[36:37], v12 offset:8192
    v_mfma_f32_32x32x16_bf16 v[144:159], v[20:23], a[128:131], 0
    ds_read_b64_tr_b16 v[38:39], v12 offset:8704
    buffer_load_dwordx4 v19, s[32:35], s55 offen offset:3072 lds
    v_mfma_f32_4x4x4_16b_bf16 v[116:119], v[114:115], v[20:21], 0
    v_mfma_f32_4x4x4_16b_bf16 v[120:123], v[114:115], v[22:23], 0
    v_mfma_f32_32x32x16_bf16 v[160:175], v[24:27], a[0:3], 0
    ds_read_b64_tr_b16 v[40:41], v13 offset:8192
    v_mfma_f32_32x32x16_bf16 v[176:191], v[24:27], a[128:131], 0
    ds_read_b64_tr_b16 v[42:43], v13 offset:8704
    s_add_u32 m0, s53, 65536
    s_add_u32 s55, s52, 1146880
    buffer_load_dwordx4 v16, s[28:31], s55 offen offset:0 lds
    v_mfma_f32_32x32x16_bf16 v[128:143], v[28:31], a[4:7], v[128:143]
    ds_read_b64_tr_b16 v[20:21], v12 offset:12288
    v_mfma_f32_32x32x16_bf16 v[144:159], v[28:31], a[132:135], v[144:159]
    ds_read_b64_tr_b16 v[22:23], v12 offset:12800
    buffer_load_dwordx4 v17, s[28:31], s55 offen offset:1024 lds
    v_mfma_f32_4x4x4_16b_bf16 v[116:119], v[114:115], v[28:29], v[116:119]
    v_mfma_f32_4x4x4_16b_bf16 v[120:123], v[114:115], v[30:31], v[120:123]
    v_mfma_f32_32x32x16_bf16 v[160:175], v[32:35], a[4:7], v[160:175]
    ds_read_b64_tr_b16 v[24:25], v13 offset:12288
    v_mfma_f32_32x32x16_bf16 v[176:191], v[32:35], a[132:135], v[176:191]
    ds_read_b64_tr_b16 v[26:27], v13 offset:12800
    buffer_load_dwordx4 v18, s[32:35], s55 offen offset:2048 lds
    s_waitcnt lgkmcnt(4)
    v_mfma_f32_32x32x16_bf16 v[128:143], v[36:39], a[8:11], v[128:143]
    s_barrier
    ds_read_b64_tr_b16 v[28:29], v8 offset:0
    v_mfma_f32_32x32x16_bf16 v[144:159], v[36:39], a[136:139], v[144:159]
    ds_read_b64_tr_b16 v[30:31], v8 offset:512
    buffer_load_dwordx4 v19, s[32:35], s55 offen offset:3072 lds
    v_mfma_f32_4x4x4_16b_bf16 v[116:119], v[114:115], v[36:37], v[116:119]
    v_mfma_f32_4x4x4_16b_bf16 v[120:123], v[114:115], v[38:39], v[120:123]
    v_mfma_f32_32x32x16_bf16 v[160:175], v[40:43], a[8:11], v[160:175]
    ds_read_b64_tr_b16 v[32:33], v9 offset:0
    v_mfma_f32_32x32x16_bf16 v[176:191], v[40:43], a[136:139], v[176:191]
    ds_read_b64_tr_b16 v[34:35], v9 offset:512
    s_add_u32 m0, s53, 81920
    s_add_u32 s55, s52, 1376256
    buffer_load_dwordx4 v16, s[28:31], s55 offen offset:0 lds
    s_waitcnt lgkmcnt(4)
    v_mfma_f32_32x32x16_bf16 v[128:143], v[20:23], a[12:15], v[128:143]
    ds_read_b64_tr_b16 v[36:37], v8 offset:4096
    v_mfma_f32_32x32x16_bf16 v[144:159], v[20:23], a[140:143], v[144:159]
    ds_read_b64_tr_b16 v[38:39], v8 offset:4608
    buffer_load_dwordx4 v17, s[28:31], s55 offen offset:1024 lds
    v_mfma_f32_4x4x4_16b_bf16 v[116:119], v[114:115], v[20:21], v[116:119]
    v_mfma_f32_4x4x4_16b_bf16 v[120:123], v[114:115], v[22:23], v[120:123]
    v_mfma_f32_32x32x16_bf16 v[160:175], v[24:27], a[12:15], v[160:175]
    ds_read_b64_tr_b16 v[40:41], v9 offset:4096
    v_mfma_f32_32x32x16_bf16 v[176:191], v[24:27], a[140:143], v[176:191]
    ds_read_b64_tr_b16 v[42:43], v9 offset:4608
    buffer_load_dwordx4 v18, s[32:35], s55 offen offset:2048 lds
    s_waitcnt lgkmcnt(4)
    v_mfma_f32_32x32x16_bf16 v[128:143], v[28:31], a[16:19], v[128:143]
    ds_read_b64_tr_b16 v[20:21], v8 offset:8192
    v_mfma_f32_32x32x16_bf16 v[144:159], v[28:31], a[144:147], v[144:159]
    ds_read_b64_tr_b16 v[22:23], v8 offset:8704
    s_waitcnt vmcnt(8)
    s_barrier
    s_add_u32 s100, s22, 1
    v_mov_b32 v76, s100
    s_cmp_eq_u32 s18, 0
    s_cselect_b32 s100, 0, 0x7ffffff0
    v_mov_b32 v77, s100
    s_lshl_b32 s100, s2, 7
    s_mov_b64 exec, 1
    buffer_store_dword v76, v77, s[24:27], s100 offen sc1
    s_mov_b64 exec, -1
    v_mfma_f32_4x4x4_16b_bf16 v[116:119], v[114:115], v[28:29], v[116:119]
    v_mfma_f32_4x4x4_16b_bf16 v[120:123], v[114:115], v[30:31], v[120:123]
    v_mfma_f32_32x32x16_bf16 v[160:175], v[32:35], a[16:19], v[160:175]
    ds_read_b64_tr_b16 v[24:25], v9 offset:8192
    v_xor_b32 v68, 0x1000, v68
    ds_read2_b32 v[124:125], v68 offset0:0 offset1:32
    v_cmp_gt_u32 vcc, 32, v1
    v_mov_b32 v90, 0
    v_mfma_f32_32x32x16_bf16 v[176:191], v[32:35], a[144:147], v[176:191]
    ds_read_b64_tr_b16 v[26:27], v9 offset:8704
    buffer_load_dwordx4 v19, s[32:35], s55 offen offset:3072 lds
    s_waitcnt lgkmcnt(5)
    v_mfma_f32_32x32x16_bf16 v[128:143], v[36:39], a[20:23], v[128:143]
    ds_read_b64_tr_b16 v[28:29], v8 offset:12288
    v_mov_b32 v91, 0
    v_and_b32 v88, 0xffff, v44
    v_xor_b32 v88, 0x8000, v88
    v_cndmask_b32 v89, 0, v88, vcc
    v_mfma_f32_32x32x16_bf16 v[144:159], v[36:39], a[148:151], v[144:159]
    ds_read_b64_tr_b16 v[30:31], v8 offset:12800
    s_add_u32 m0, s53, 98304
    s_add_u32 s55, s52, 1605632
    buffer_load_dwordx4 v16, s[28:31], s55 offen offset:0 lds
    v_mfma_f32_4x4x4_16b_bf16 v[116:119], v[114:115], v[36:37], v[116:119]
    v_mfma_f32_4x4x4_16b_bf16 v[120:123], v[114:115], v[38:39], v[120:123]
    v_mfma_f32_32x32x16_bf16 v[160:175], v[40:43], a[20:23], v[160:175]
    ds_read_b64_tr_b16 v[32:33], v9 offset:12288
    v_lshl_or_b32 v88, v89, 16, v89
    v_mfma_f32_32x32x16_bf16 v[176:191], v[40:43], a[148:151], v[176:191]
    ds_read_b64_tr_b16 v[34:35], v9 offset:12800
    buffer_load_dwordx4 v17, s[28:31], s55 offen offset:1024 lds
    s_waitcnt lgkmcnt(4)
    v_mfma_f32_32x32x16_bf16 v[128:143], v[20:23], a[24:27], v[128:143]
    s_barrier
    ds_read_b64_tr_b16 v[36:37], v8 offset:16384
    v_mfma_f32_32x32x16_bf16 v[144:159], v[20:23], a[152:155], v[144:159]
    ds_read_b64_tr_b16 v[38:39], v8 offset:16896
    buffer_load_dwordx4 v18, s[32:35], s55 offen offset:2048 lds
    v_mfma_f32_4x4x4_16b_bf16 v[116:119], v[114:115], v[20:21], v[116:119]
    v_mfma_f32_4x4x4_16b_bf16 v[120:123], v[114:115], v[22:23], v[120:123]
    v_mfma_f32_32x32x16_bf16 v[160:175], v[24:27], a[24:27], v[160:175]
    ds_read_b64_tr_b16 v[40:41], v9 offset:16384
    v_mov_b32 v94, 0
    v_mov_b32 v95, 0
    v_and_b32 v92, 0xffff, v125
    v_xor_b32 v92, 0x8000, v92
    v_mfma_f32_32x32x16_bf16 v[176:191], v[24:27], a[152:155], v[176:191]
    ds_read_b64_tr_b16 v[42:43], v9 offset:16896
    buffer_load_dwordx4 v19, s[32:35], s55 offen offset:3072 lds
    s_waitcnt lgkmcnt(4)
    v_mfma_f32_32x32x16_bf16 v[128:143], v[28:31], a[28:31], v[128:143]
    ds_read_b64_tr_b16 v[20:21], v8 offset:20480
    v_cndmask_b32 v93, 0, v92, vcc
    v_lshl_or_b32 v92, v93, 16, v93
    v_and_b32 v125, 0xffff0000, v125
    s_lshl_b32 s60, s63, 5
    v_mfma_f32_32x32x16_bf16 v[144:159], v[28:31], a[156:159], v[144:159]
    ds_read_b64_tr_b16 v[22:23], v8 offset:20992
    s_add_u32 m0, s53, 131072
    s_add_u32 s55, s52, 229504
    buffer_load_dwordx4 v16, s[28:31], s55 offen offset:0 lds
    v_mfma_f32_4x4x4_16b_bf16 v[116:119], v[114:115], v[28:29], v[116:119]
    v_mfma_f32_4x4x4_16b_bf16 v[120:123], v[114:115], v[30:31], v[120:123]
    v_mfma_f32_32x32x16_bf16 v[160:175], v[32:35], a[28:31], v[160:175]
    ds_read_b64_tr_b16 v[24:25], v9 offset:20480
    v_add_u32 v126, s60, v2
    v_xor_b32 v127, 1024, v126
    s_add_u32 s60, s53, 147456
    v_lshl_add_u32 v112, v14, 2, s60
    v_mfma_f32_32x32x16_bf16 v[176:191], v[32:35], a[156:159], v[176:191]
    ds_read_b64_tr_b16 v[26:27], v9 offset:20992
    buffer_load_dwordx4 v17, s[28:31], s55 offen offset:1024 lds
    s_waitcnt lgkmcnt(4)
    v_mfma_f32_32x32x16_bf16 v[128:143], v[36:39], a[32:35], v[128:143]
    ds_read_b64_tr_b16 v[28:29], v8 offset:24576
    v_xor_b32 v113, 0x2000, v112
    v_mov_b32 v98, 0
    v_mov_b32 v99, 0
    v_mov_b32 v102, 0
    v_mfma_f32_32x32x16_bf16 v[144:159], v[36:39], a[160:163], v[144:159]
    ds_read_b64_tr_b16 v[30:31], v8 offset:25088
    buffer_load_dwordx4 v18, s[32:35], s55 offen offset:2048 lds
    v_mfma_f32_4x4x4_16b_bf16 v[116:119], v[114:115], v[36:37], v[116:119]
    v_mfma_f32_4x4x4_16b_bf16 v[120:123], v[114:115], v[38:39], v[120:123]
    v_mfma_f32_32x32x16_bf16 v[160:175], v[40:43], a[32:35], v[160:175]
    ds_read_b64_tr_b16 v[32:33], v9 offset:24576
    v_mov_b32 v103, 0
    s_xor_b32 s56, s19, 0
    s_mul_i32 s56, s56, 112
    s_lshl_b32 s57, s20, 3
    v_mfma_f32_32x32x16_bf16 v[176:191], v[40:43], a[160:163], v[176:191]
    ds_read_b64_tr_b16 v[34:35], v9 offset:25088
    buffer_load_dwordx4 v19, s[32:35], s55 offen offset:3072 lds
    s_waitcnt lgkmcnt(4)
    v_mfma_f32_32x32x16_bf16 v[128:143], v[20:23], a[36:39], v[128:143]
    ds_read_b64_tr_b16 v[36:37], v8 offset:28672
    s_add_u32 s56, s56, s57
    s_lshl_b32 s56, s56, 10
    s_add_u32 s56, s56, 6291456
    s_add_u32 s57, s56, 4096
    v_mfma_f32_32x32x16_bf16 v[144:159], v[20:23], a[164:167], v[144:159]
    ds_read_b64_tr_b16 v[38:39], v8 offset:29184
    s_xor_b32 s58, s19, 1
    s_mul_i32 s58, s58, 112
    s_lshl_b32 s59, s20, 3
    s_add_u32 s58, s58, s59
    v_mfma_f32_4x4x4_16b_bf16 v[116:119], v[114:115], v[20:21], v[116:119]
    v_mfma_f32_4x4x4_16b_bf16 v[120:123], v[114:115], v[22:23], v[120:123]
    v_mfma_f32_32x32x16_bf16 v[160:175], v[24:27], a[36:39], v[160:175]
    ds_read_b64_tr_b16 v[40:41], v9 offset:28672
    s_lshl_b32 s58, s58, 10
    s_add_u32 s58, s58, 6291456
    s_add_u32 s59, s58, 4096
    v_mfma_f32_32x32x16_bf16 v[176:191], v[24:27], a[164:167], v[176:191]
    ds_read_b64_tr_b16 v[42:43], v9 offset:29184
    s_and_b32 s60, s17, 3
    s_lshl_b32 s61, s16, 3
    s_lshl_b32 s60, s60, 1
    s_add_u32 s49, s60, s61
    s_lshr_b32 s50, s17, 2
    v_lshrrev_b32 v84, 3, v1
    v_and_b32 v85, 7, v1
    v_and_b32 v86, 2, v84
    v_lshlrev_b32 v86, 1, v86
    v_xor_b32 v85, v85, v86
    v_lshlrev_b32 v84, 10, v84
    v_lshl_add_u32 v44, v85, 4, v84
    v_add_u32 v45, 7168, v44
    v_add_u32 v46, 14336, v44
    v_add_u32 v47, 21504, v44
    s_mul_i32 s48, s18, 458752
    s_lshl_b32 s60, s50, 7
    s_add_u32 s48, s48, s60
    s_mov_b32 s40, s4
    s_mov_b32 s41, s5
    s_mov_b32 s42, 1835008
    s_mov_b32 s43, 0x00020000
    s_mov_b32 s44, s6
    s_mov_b32 s45, s7
    s_mov_b32 s46, 2097152
    s_mov_b32 s47, 0x00020000
    s_waitcnt lgkmcnt(4)
    v_mfma_f32_32x32x16_bf16 v[128:143], v[28:31], a[40:43], v[128:143]
    s_barrier
    ds_read_b64_tr_b16 v[20:21], v8 offset:32768
    v_mfma_f32_32x32x16_bf16 v[144:159], v[28:31], a[168:171], v[144:159]
    ds_read_b64_tr_b16 v[22:23], v8 offset:33280
    s_add_u32 m0, s53, 0
    s_add_u32 s55, s52, 458880
    buffer_load_dwordx4 v16, s[28:31], s55 offen offset:0 lds
    v_mfma_f32_4x4x4_16b_bf16 v[116:119], v[114:115], v[28:29], v[116:119]
    v_mfma_f32_4x4x4_16b_bf16 v[120:123], v[114:115], v[30:31], v[120:123]
    v_mfma_f32_32x32x16_bf16 v[160:175], v[32:35], a[40:43], v[160:175]
    ds_read_b64_tr_b16 v[24:25], v9 offset:32768
    v_mfma_f32_32x32x16_bf16 v[176:191], v[32:35], a[168:171], v[176:191]
    ds_read_b64_tr_b16 v[26:27], v9 offset:33280
    buffer_load_dwordx4 v17, s[28:31], s55 offen offset:1024 lds
    s_waitcnt lgkmcnt(4)
    v_mfma_f32_32x32x16_bf16 v[128:143], v[36:39], a[44:47], v[128:143]
    ds_read_b64_tr_b16 v[28:29], v8 offset:36864
    v_mfma_f32_32x32x16_bf16 v[144:159], v[36:39], a[172:175], v[144:159]
    ds_read_b64_tr_b16 v[30:31], v8 offset:37376
    buffer_load_dwordx4 v18, s[32:35], s55 offen offset:2048 lds
    v_mfma_f32_4x4x4_16b_bf16 v[116:119], v[114:115], v[36:37], v[116:119]
    v_mfma_f32_4x4x4_16b_bf16 v[120:123], v[114:115], v[38:39], v[120:123]
    v_mfma_f32_32x32x16_bf16 v[160:175], v[40:43], a[44:47], v[160:175]
    ds_read_b64_tr_b16 v[32:33], v9 offset:36864
    v_mfma_f32_32x32x16_bf16 v[176:191], v[40:43], a[172:175], v[176:191]
    ds_read_b64_tr_b16 v[34:35], v9 offset:37376
    buffer_load_dwordx4 v19, s[32:35], s55 offen offset:3072 lds
    s_waitcnt lgkmcnt(4)
    v_mfma_f32_32x32x16_bf16 v[128:143], v[20:23], a[48:51], v[128:143]
    ds_read_b64_tr_b16 v[36:37], v8 offset:40960
    v_mfma_f32_32x32x16_bf16 v[144:159], v[20:23], a[176:179], v[144:159]
    ds_read_b64_tr_b16 v[38:39], v8 offset:41472
    v_mfma_f32_4x4x4_16b_bf16 v[116:119], v[114:115], v[20:21], v[116:119]
    v_mfma_f32_4x4x4_16b_bf16 v[120:123], v[114:115], v[22:23], v[120:123]
    v_mfma_f32_32x32x16_bf16 v[160:175], v[24:27], a[48:51], v[160:175]
    ds_read_b64_tr_b16 v[40:41], v9 offset:40960
    v_mfma_f32_32x32x16_bf16 v[176:191], v[24:27], a[176:179], v[176:191]
    ds_read_b64_tr_b16 v[42:43], v9 offset:41472
    s_waitcnt lgkmcnt(4)
    v_mfma_f32_32x32x16_bf16 v[128:143], v[28:31], a[52:55], v[128:143]
    ds_read_b64_tr_b16 v[20:21], v8 offset:45056
    v_mfma_f32_32x32x16_bf16 v[144:159], v[28:31], a[180:183], v[144:159]
    ds_read_b64_tr_b16 v[22:23], v8 offset:45568
    v_mfma_f32_4x4x4_16b_bf16 v[116:119], v[114:115], v[28:29], v[116:119]
    v_mfma_f32_4x4x4_16b_bf16 v[120:123], v[114:115], v[30:31], v[120:123]
    v_mfma_f32_32x32x16_bf16 v[160:175], v[32:35], a[52:55], v[160:175]
    ds_read_b64_tr_b16 v[24:25], v9 offset:45056
    v_mfma_f32_32x32x16_bf16 v[176:191], v[32:35], a[180:183], v[176:191]
    ds_read_b64_tr_b16 v[26:27], v9 offset:45568
    s_waitcnt lgkmcnt(4)
    v_mfma_f32_32x32x16_bf16 v[128:143], v[36:39], a[56:59], v[128:143]
    s_waitcnt vmcnt(21)
    s_barrier
    ds_read_b64_tr_b16 v[28:29], v8 offset:49152
    v_mfma_f32_32x32x16_bf16 v[144:159], v[36:39], a[184:187], v[144:159]
    ds_read_b64_tr_b16 v[30:31], v8 offset:49664
    s_add_u32 m0, s53, 16384
    s_add_u32 s55, s52, 688256
    buffer_load_dwordx4 v16, s[28:31], s55 offen offset:0 lds
    v_mfma_f32_4x4x4_16b_bf16 v[116:119], v[114:115], v[36:37], v[116:119]
    v_mfma_f32_4x4x4_16b_bf16 v[120:123], v[114:115], v[38:39], v[120:123]
    v_mfma_f32_32x32x16_bf16 v[160:175], v[40:43], a[56:59], v[160:175]
    ds_read_b64_tr_b16 v[32:33], v9 offset:49152
    v_mfma_f32_32x32x16_bf16 v[176:191], v[40:43], a[184:187], v[176:191]
    ds_read_b64_tr_b16 v[34:35], v9 offset:49664
    buffer_load_dwordx4 v17, s[28:31], s55 offen offset:1024 lds
    s_waitcnt lgkmcnt(4)
    v_mfma_f32_32x32x16_bf16 v[128:143], v[20:23], a[60:63], v[128:143]
    ds_read_b64_tr_b16 v[36:37], v8 offset:53248
    v_mfma_f32_32x32x16_bf16 v[144:159], v[20:23], a[188:191], v[144:159]
    ds_read_b64_tr_b16 v[38:39], v8 offset:53760
    buffer_load_dwordx4 v18, s[32:35], s55 offen offset:2048 lds
    v_mfma_f32_4x4x4_16b_bf16 v[116:119], v[114:115], v[20:21], v[116:119]
    v_mfma_f32_4x4x4_16b_bf16 v[120:123], v[114:115], v[22:23], v[120:123]
    v_mfma_f32_32x32x16_bf16 v[160:175], v[24:27], a[60:63], v[160:175]
    ds_read_b64_tr_b16 v[40:41], v9 offset:53248
    v_mfma_f32_32x32x16_bf16 v[176:191], v[24:27], a[188:191], v[176:191]
    ds_read_b64_tr_b16 v[42:43], v9 offset:53760
    buffer_load_dwordx4 v19, s[32:35], s55 offen offset:3072 lds
    s_waitcnt lgkmcnt(4)
    v_mfma_f32_32x32x16_bf16 v[128:143], v[28:31], a[64:67], v[128:143]
    ds_read_b64_tr_b16 v[20:21], v8 offset:57344
    v_mfma_f32_32x32x16_bf16 v[144:159], v[28:31], a[192:195], v[144:159]
    ds_read_b64_tr_b16 v[22:23], v8 offset:57856
    v_mfma_f32_4x4x4_16b_bf16 v[116:119], v[114:115], v[28:29], v[116:119]
    v_mfma_f32_4x4x4_16b_bf16 v[120:123], v[114:115], v[30:31], v[120:123]
    v_mfma_f32_32x32x16_bf16 v[160:175], v[32:35], a[64:67], v[160:175]
    ds_read_b64_tr_b16 v[24:25], v9 offset:57344
    v_mfma_f32_32x32x16_bf16 v[176:191], v[32:35], a[192:195], v[176:191]
    ds_read_b64_tr_b16 v[26:27], v9 offset:57856
    s_waitcnt lgkmcnt(4)
    v_mfma_f32_32x32x16_bf16 v[128:143], v[36:39], a[68:71], v[128:143]
    ds_read_b64_tr_b16 v[28:29], v8 offset:61440
    v_mfma_f32_32x32x16_bf16 v[144:159], v[36:39], a[196:199], v[144:159]
    ds_read_b64_tr_b16 v[30:31], v8 offset:61952
    v_mfma_f32_4x4x4_16b_bf16 v[116:119], v[114:115], v[36:37], v[116:119]
    v_mfma_f32_4x4x4_16b_bf16 v[120:123], v[114:115], v[38:39], v[120:123]
    v_mfma_f32_32x32x16_bf16 v[160:175], v[40:43], a[68:71], v[160:175]
    ds_read_b64_tr_b16 v[32:33], v9 offset:61440
    v_mfma_f32_32x32x16_bf16 v[176:191], v[40:43], a[196:199], v[176:191]
    ds_read_b64_tr_b16 v[34:35], v9 offset:61952
    s_waitcnt lgkmcnt(4)
    v_mfma_f32_32x32x16_bf16 v[128:143], v[20:23], a[72:75], v[128:143]
    s_waitcnt vmcnt(21)
    s_barrier
    ds_read_b64_tr_b16 v[36:37], v10 offset:0
    v_mfma_f32_32x32x16_bf16 v[144:159], v[20:23], a[200:203], v[144:159]
    ds_read_b64_tr_b16 v[38:39], v10 offset:512
    s_add_u32 m0, s53, 32768
    s_add_u32 s55, s52, 917632
    buffer_load_dwordx4 v16, s[28:31], s55 offen offset:0 lds
    v_mfma_f32_4x4x4_16b_bf16 v[116:119], v[114:115], v[20:21], v[116:119]
    v_mfma_f32_4x4x4_16b_bf16 v[120:123], v[114:115], v[22:23], v[120:123]
    v_mfma_f32_32x32x16_bf16 v[160:175], v[24:27], a[72:75], v[160:175]
    ds_read_b64_tr_b16 v[40:41], v11 offset:0
    v_mfma_f32_32x32x16_bf16 v[176:191], v[24:27], a[200:203], v[176:191]
    ds_read_b64_tr_b16 v[42:43], v11 offset:512
    buffer_load_dwordx4 v17, s[28:31], s55 offen offset:1024 lds
    s_waitcnt lgkmcnt(4)
    v_mfma_f32_32x32x16_bf16 v[128:143], v[28:31], a[76:79], v[128:143]
    ds_read_b64_tr_b16 v[20:21], v10 offset:4096
    v_mfma_f32_32x32x16_bf16 v[144:159], v[28:31], a[204:207], v[144:159]
    ds_read_b64_tr_b16 v[22:23], v10 offset:4608
    buffer_load_dwordx4 v18, s[32:35], s55 offen offset:2048 lds
    v_mfma_f32_4x4x4_16b_bf16 v[116:119], v[114:115], v[28:29], v[116:119]
    v_mfma_f32_4x4x4_16b_bf16 v[120:123], v[114:115], v[30:31], v[120:123]
    v_mfma_f32_32x32x16_bf16 v[160:175], v[32:35], a[76:79], v[160:175]
    ds_read_b64_tr_b16 v[24:25], v11 offset:4096
    v_mfma_f32_32x32x16_bf16 v[176:191], v[32:35], a[204:207], v[176:191]
    ds_read_b64_tr_b16 v[26:27], v11 offset:4608
    buffer_load_dwordx4 v19, s[32:35], s55 offen offset:3072 lds
    s_waitcnt lgkmcnt(4)
    v_mfma_f32_32x32x16_bf16 v[128:143], v[36:39], a[80:83], v[128:143]
    ds_read_b64_tr_b16 v[28:29], v10 offset:8192
    v_mfma_f32_32x32x16_bf16 v[144:159], v[36:39], a[208:211], v[144:159]
    ds_read_b64_tr_b16 v[30:31], v10 offset:8704
    s_add_u32 m0, s53, 114688
    s_add_u32 s55, s52, 128
    buffer_load_dwordx4 v16, s[28:31], s55 offen offset:0 lds
    v_mfma_f32_4x4x4_16b_bf16 v[116:119], v[114:115], v[36:37], v[116:119]
    v_mfma_f32_4x4x4_16b_bf16 v[120:123], v[114:115], v[38:39], v[120:123]
    v_mfma_f32_32x32x16_bf16 v[160:175], v[40:43], a[80:83], v[160:175]
    ds_read_b64_tr_b16 v[32:33], v11 offset:8192
    v_mfma_f32_32x32x16_bf16 v[176:191], v[40:43], a[208:211], v[176:191]
    ds_read_b64_tr_b16 v[34:35], v11 offset:8704
    buffer_load_dwordx4 v17, s[28:31], s55 offen offset:1024 lds
    s_waitcnt lgkmcnt(4)
    v_mfma_f32_32x32x16_bf16 v[128:143], v[20:23], a[84:87], v[128:143]
    ds_read_b64_tr_b16 v[36:37], v10 offset:12288
    v_mfma_f32_32x32x16_bf16 v[144:159], v[20:23], a[212:215], v[144:159]
    ds_read_b64_tr_b16 v[38:39], v10 offset:12800
    buffer_load_dwordx4 v18, s[32:35], s55 offen offset:2048 lds
    v_mfma_f32_4x4x4_16b_bf16 v[116:119], v[114:115], v[20:21], v[116:119]
    v_mfma_f32_4x4x4_16b_bf16 v[120:123], v[114:115], v[22:23], v[120:123]
    v_mfma_f32_32x32x16_bf16 v[160:175], v[24:27], a[84:87], v[160:175]
    ds_read_b64_tr_b16 v[40:41], v11 offset:12288
    v_mfma_f32_32x32x16_bf16 v[176:191], v[24:27], a[212:215], v[176:191]
    ds_read_b64_tr_b16 v[42:43], v11 offset:12800
    buffer_load_dwordx4 v19, s[32:35], s55 offen offset:3072 lds
    s_waitcnt lgkmcnt(4)
    v_mfma_f32_32x32x16_bf16 v[128:143], v[28:31], a[88:91], v[128:143]
    s_waitcnt vmcnt(24)
    s_barrier
    ds_read_b64_tr_b16 v[20:21], v10 offset:16384
    v_mfma_f32_32x32x16_bf16 v[144:159], v[28:31], a[216:219], v[144:159]
    ds_read_b64_tr_b16 v[22:23], v10 offset:16896
    s_add_u32 m0, s53, 49152
    s_add_u32 s55, s52, 1147008
    buffer_load_dwordx4 v16, s[28:31], s55 offen offset:0 lds
    v_mfma_f32_4x4x4_16b_bf16 v[116:119], v[114:115], v[28:29], v[116:119]
    v_mfma_f32_4x4x4_16b_bf16 v[120:123], v[114:115], v[30:31], v[120:123]
    v_mfma_f32_32x32x16_bf16 v[160:175], v[32:35], a[88:91], v[160:175]
    ds_read_b64_tr_b16 v[24:25], v11 offset:16384
    v_mfma_f32_32x32x16_bf16 v[176:191], v[32:35], a[216:219], v[176:191]
    ds_read_b64_tr_b16 v[26:27], v11 offset:16896
    buffer_load_dwordx4 v17, s[28:31], s55 offen offset:1024 lds
    s_waitcnt lgkmcnt(4)
    v_mfma_f32_32x32x16_bf16 v[128:143], v[36:39], a[92:95], v[128:143]
    ds_read_b64_tr_b16 v[28:29], v10 offset:20480
    v_mfma_f32_32x32x16_bf16 v[144:159], v[36:39], a[220:223], v[144:159]
    ds_read_b64_tr_b16 v[30:31], v10 offset:20992
    buffer_load_dwordx4 v18, s[32:35], s55 offen offset:2048 lds
    v_mfma_f32_4x4x4_16b_bf16 v[116:119], v[114:115], v[36:37], v[116:119]
    v_mfma_f32_4x4x4_16b_bf16 v[120:123], v[114:115], v[38:39], v[120:123]
    v_mfma_f32_32x32x16_bf16 v[160:175], v[40:43], a[92:95], v[160:175]
    ds_read_b64_tr_b16 v[32:33], v11 offset:20480
    v_mfma_f32_32x32x16_bf16 v[176:191], v[40:43], a[220:223], v[176:191]
    ds_read_b64_tr_b16 v[34:35], v11 offset:20992
    buffer_load_dwordx4 v19, s[32:35], s55 offen offset:3072 lds
    s_waitcnt lgkmcnt(4)
    v_mfma_f32_32x32x16_bf16 v[128:143], v[20:23], a[96:99], v[128:143]
    ds_read_b64_tr_b16 v[36:37], v10 offset:24576
    v_mfma_f32_32x32x16_bf16 v[144:159], v[20:23], a[224:227], v[144:159]
    ds_read_b64_tr_b16 v[38:39], v10 offset:25088
    v_mfma_f32_4x4x4_16b_bf16 v[116:119], v[114:115], v[20:21], v[116:119]
    v_mfma_f32_4x4x4_16b_bf16 v[120:123], v[114:115], v[22:23], v[120:123]
    v_mfma_f32_32x32x16_bf16 v[160:175], v[24:27], a[96:99], v[160:175]
    ds_read_b64_tr_b16 v[40:41], v11 offset:24576
    v_mfma_f32_32x32x16_bf16 v[176:191], v[24:27], a[224:227], v[176:191]
    ds_read_b64_tr_b16 v[42:43], v11 offset:25088
    s_waitcnt lgkmcnt(4)
    v_mfma_f32_32x32x16_bf16 v[128:143], v[28:31], a[100:103], v[128:143]
    ds_read_b64_tr_b16 v[20:21], v10 offset:28672
    v_mfma_f32_32x32x16_bf16 v[144:159], v[28:31], a[228:231], v[144:159]
    ds_read_b64_tr_b16 v[22:23], v10 offset:29184
    v_mfma_f32_4x4x4_16b_bf16 v[116:119], v[114:115], v[28:29], v[116:119]
    v_mfma_f32_4x4x4_16b_bf16 v[120:123], v[114:115], v[30:31], v[120:123]
    v_mfma_f32_32x32x16_bf16 v[160:175], v[32:35], a[100:103], v[160:175]
    ds_read_b64_tr_b16 v[24:25], v11 offset:28672
    v_mfma_f32_32x32x16_bf16 v[176:191], v[32:35], a[228:231], v[176:191]
    ds_read_b64_tr_b16 v[26:27], v11 offset:29184
    s_waitcnt lgkmcnt(4)
    v_mfma_f32_32x32x16_bf16 v[128:143], v[36:39], a[104:107], v[128:143]
    s_waitcnt vmcnt(24)
    s_barrier
    ds_read_b64_tr_b16 v[28:29], v10 offset:32768
    v_mfma_f32_32x32x16_bf16 v[144:159], v[36:39], a[232:235], v[144:159]
    ds_read_b64_tr_b16 v[30:31], v10 offset:33280
    s_add_u32 m0, s53, 65536
    s_add_u32 s55, s52, 1376384
    buffer_load_dwordx4 v16, s[28:31], s55 offen offset:0 lds
    v_mfma_f32_4x4x4_16b_bf16 v[116:119], v[114:115], v[36:37], v[116:119]
    v_mfma_f32_4x4x4_16b_bf16 v[120:123], v[114:115], v[38:39], v[120:123]
    v_mfma_f32_32x32x16_bf16 v[160:175], v[40:43], a[104:107], v[160:175]
    ds_read_b64_tr_b16 v[32:33], v11 offset:32768
    v_mfma_f32_32x32x16_bf16 v[176:191], v[40:43], a[232:235], v[176:191]
    ds_read_b64_tr_b16 v[34:35], v11 offset:33280
    buffer_load_dwordx4 v17, s[28:31], s55 offen offset:1024 lds
    s_waitcnt lgkmcnt(4)
    v_mfma_f32_32x32x16_bf16 v[128:143], v[20:23], a[108:111], v[128:143]
    ds_read_b64_tr_b16 v[36:37], v10 offset:36864
    v_mfma_f32_32x32x16_bf16 v[144:159], v[20:23], a[236:239], v[144:159]
    ds_read_b64_tr_b16 v[38:39], v10 offset:37376
    buffer_load_dwordx4 v18, s[32:35], s55 offen offset:2048 lds
    v_mfma_f32_4x4x4_16b_bf16 v[116:119], v[114:115], v[20:21], v[116:119]
    v_mfma_f32_4x4x4_16b_bf16 v[120:123], v[114:115], v[22:23], v[120:123]
    v_mfma_f32_32x32x16_bf16 v[160:175], v[24:27], a[108:111], v[160:175]
    ds_read_b64_tr_b16 v[40:41], v11 offset:36864
    v_mfma_f32_32x32x16_bf16 v[176:191], v[24:27], a[236:239], v[176:191]
    ds_read_b64_tr_b16 v[42:43], v11 offset:37376
    buffer_load_dwordx4 v19, s[32:35], s55 offen offset:3072 lds
    s_waitcnt lgkmcnt(4)
    v_mfma_f32_32x32x16_bf16 v[128:143], v[28:31], a[112:115], v[128:143]
    ds_read_b64_tr_b16 v[20:21], v10 offset:40960
    v_mfma_f32_32x32x16_bf16 v[144:159], v[28:31], a[240:243], v[144:159]
    ds_read_b64_tr_b16 v[22:23], v10 offset:41472
    v_mfma_f32_4x4x4_16b_bf16 v[116:119], v[114:115], v[28:29], v[116:119]
    v_mfma_f32_4x4x4_16b_bf16 v[120:123], v[114:115], v[30:31], v[120:123]
    v_mfma_f32_32x32x16_bf16 v[160:175], v[32:35], a[112:115], v[160:175]
    ds_read_b64_tr_b16 v[24:25], v11 offset:40960
    v_mfma_f32_32x32x16_bf16 v[176:191], v[32:35], a[240:243], v[176:191]
    ds_read_b64_tr_b16 v[26:27], v11 offset:41472
    s_waitcnt lgkmcnt(4)
    v_mfma_f32_32x32x16_bf16 v[128:143], v[36:39], a[116:119], v[128:143]
    ds_read_b64_tr_b16 v[28:29], v10 offset:45056
    v_mfma_f32_32x32x16_bf16 v[144:159], v[36:39], a[244:247], v[144:159]
    ds_read_b64_tr_b16 v[30:31], v10 offset:45568
    v_mfma_f32_4x4x4_16b_bf16 v[116:119], v[114:115], v[36:37], v[116:119]
    v_mfma_f32_4x4x4_16b_bf16 v[120:123], v[114:115], v[38:39], v[120:123]
    v_mfma_f32_32x32x16_bf16 v[160:175], v[40:43], a[116:119], v[160:175]
    ds_read_b64_tr_b16 v[32:33], v11 offset:45056
    v_mfma_f32_32x32x16_bf16 v[176:191], v[40:43], a[244:247], v[176:191]
    ds_read_b64_tr_b16 v[34:35], v11 offset:45568
    s_waitcnt lgkmcnt(4)
    v_mfma_f32_32x32x16_bf16 v[128:143], v[20:23], a[120:123], v[128:143]
    s_waitcnt vmcnt(8)
    s_barrier
    ds_read_b64_tr_b16 v[36:37], v10 offset:49152
    v_mfma_f32_32x32x16_bf16 v[144:159], v[20:23], a[248:251], v[144:159]
    ds_read_b64_tr_b16 v[38:39], v10 offset:49664
    s_add_u32 m0, s53, 81920
    s_add_u32 s55, s52, 1605760
    buffer_load_dwordx4 v16, s[28:31], s55 offen offset:0 lds
    v_mfma_f32_4x4x4_16b_bf16 v[116:119], v[114:115], v[20:21], v[116:119]
    v_mfma_f32_4x4x4_16b_bf16 v[120:123], v[114:115], v[22:23], v[120:123]
    v_mfma_f32_32x32x16_bf16 v[160:175], v[24:27], a[120:123], v[160:175]
    ds_read_b64_tr_b16 v[40:41], v11 offset:49152
    v_mfma_f32_32x32x16_bf16 v[176:191], v[24:27], a[248:251], v[176:191]
    ds_read_b64_tr_b16 v[42:43], v11 offset:49664
    buffer_load_dwordx4 v17, s[28:31], s55 offen offset:1024 lds
    s_waitcnt lgkmcnt(4)
    v_mfma_f32_32x32x16_bf16 v[128:143], v[28:31], a[124:127], v[128:143]
    ds_read_b64_tr_b16 v[20:21], v10 offset:53248
    v_mfma_f32_32x32x16_bf16 v[144:159], v[28:31], a[252:255], v[144:159]
    ds_read_b64_tr_b16 v[22:23], v10 offset:53760
    buffer_load_dwordx4 v18, s[32:35], s55 offen offset:2048 lds
    v_mfma_f32_4x4x4_16b_bf16 v[116:119], v[114:115], v[28:29], v[116:119]
    v_mfma_f32_4x4x4_16b_bf16 v[120:123], v[114:115], v[30:31], v[120:123]
    v_mfma_f32_32x32x16_bf16 v[160:175], v[32:35], a[124:127], v[160:175]
    ds_read_b64_tr_b16 v[24:25], v11 offset:53248
    v_mfma_f32_32x32x16_bf16 v[176:191], v[32:35], a[252:255], v[176:191]
    ds_read_b64_tr_b16 v[26:27], v11 offset:53760
    buffer_load_dwordx4 v19, s[32:35], s55 offen offset:3072 lds
    s_waitcnt lgkmcnt(4)
    v_mfma_f32_32x32x16_bf16 v[192:207], v[36:39], a[0:3], 0
    ds_read_b64_tr_b16 v[28:29], v10 offset:57344
    v_add_f32 v104, v116, v120
    v_mov_b32 v105, v104
    s_nop 1
    v_permlane32_swap_b32 v104, v105
    v_mfma_f32_32x32x16_bf16 v[208:223], v[36:39], a[128:131], 0
    ds_read_b64_tr_b16 v[30:31], v10 offset:57856
    v_add_f32 v104, v104, v105
    ds_write_b32 v112, v104 offset:0
    v_and_b32 v96, 0xffff0000, v104
    v_sub_f32 v104, v104, v96
    v_mfma_f32_4x4x4_16b_bf16 v[116:119], v[114:115], v[36:37], 0
    v_mfma_f32_4x4x4_16b_bf16 v[120:123], v[114:115], v[38:39], 0
    v_mfma_f32_32x32x16_bf16 v[224:239], v[40:43], a[0:3], 0
    ds_read_b64_tr_b16 v[32:33], v11 offset:57344
    v_and_b32 v97, 0xffff0000, v104
    v_sub_f32 v104, v104, v97
    v_lshrrev_b32 v96, 16, v96
    v_or_b32 v96, v96, v97
    v_mfma_f32_32x32x16_bf16 v[240:255], v[40:43], a[128:131], 0
    ds_read_b64_tr_b16 v[34:35], v11 offset:57856
    v_lshrrev_b32 v97, 16, v104
    s_nop 1
    v_mfma_f32_32x32x16_bf16 v[128:143], v[96:99], v[88:91], v[128:143]
    v_mfma_f32_32x32x16_bf16 v[144:159], v[96:99], v[92:95], v[144:159]
    s_waitcnt lgkmcnt(5)
    v_mfma_f32_32x32x16_bf16 v[192:207], v[20:23], a[4:7], v[192:207]
    ds_read_b64_tr_b16 v[36:37], v10 offset:61440
    s_nop 7
    v_mul_f32 v128, v128, v6
    v_mul_f32 v129, v129, v6
    v_mul_f32 v130, v130, v6
    v_mul_f32 v131, v131, v6
    v_mfma_f32_32x32x16_bf16 v[208:223], v[20:23], a[132:135], v[208:223]
    ds_read_b64_tr_b16 v[38:39], v10 offset:61952
    v_mul_f32 v132, v132, v6
    v_mul_f32 v133, v133, v6
    v_mul_f32 v134, v134, v6
    v_mul_f32 v135, v135, v6
    v_mfma_f32_4x4x4_16b_bf16 v[116:119], v[114:115], v[20:21], v[116:119]
    v_mfma_f32_4x4x4_16b_bf16 v[120:123], v[114:115], v[22:23], v[120:123]
    v_mfma_f32_32x32x16_bf16 v[224:239], v[24:27], a[4:7], v[224:239]
    ds_read_b64_tr_b16 v[40:41], v11 offset:61440
    v_mul_f32 v64, v128, v128
    v_mul_f32 v65, v129, v129
    v_mul_f32 v66, v130, v130
    v_mul_f32 v67, v131, v131
    v_mfma_f32_32x32x16_bf16 v[240:255], v[24:27], a[132:135], v[240:255]
    ds_read_b64_tr_b16 v[42:43], v11 offset:61952
    v_mul_f32 v68, v132, v132
    v_mul_f32 v69, v133, v133
    v_mul_f32 v70, v134, v134
    s_waitcnt lgkmcnt(4)
    v_mfma_f32_32x32x16_bf16 v[192:207], v[28:31], a[8:11], v[192:207]
    s_barrier
    ds_read_b64_tr_b16 v[20:21], v12 offset:0
    v_mul_f32 v71, v135, v135
    v_fma_f32 v64, v64, v5, v4
    v_fma_f32 v65, v65, v5, v4
    v_mfma_f32_32x32x16_bf16 v[208:223], v[28:31], a[136:139], v[208:223]
    ds_read_b64_tr_b16 v[22:23], v12 offset:512
    s_add_u32 m0, s53, 98304
    s_add_u32 s55, s48, 0
    buffer_load_dwordx4 v44, s[40:43], s55 offen offset:0 lds
    v_mfma_f32_4x4x4_16b_bf16 v[116:119], v[114:115], v[28:29], v[116:119]
    v_mfma_f32_4x4x4_16b_bf16 v[120:123], v[114:115], v[30:31], v[120:123]
    v_mfma_f32_32x32x16_bf16 v[224:239], v[32:35], a[8:11], v[224:239]
    ds_read_b64_tr_b16 v[24:25], v13 offset:0
    v_fma_f32 v66, v66, v5, v4
    v_fma_f32 v67, v67, v5, v4
    v_fma_f32 v68, v68, v5, v4
    v_fma_f32 v69, v69, v5, v4
    v_mfma_f32_32x32x16_bf16 v[240:255], v[32:35], a[136:139], v[240:255]
    ds_read_b64_tr_b16 v[26:27], v13 offset:512
    buffer_load_dwordx4 v45, s[40:43], s55 offen offset:1024 lds
    s_waitcnt lgkmcnt(4)
    v_mfma_f32_32x32x16_bf16 v[192:207], v[36:39], a[12:15], v[192:207]
    ds_read_b64_tr_b16 v[28:29], v12 offset:4096
    v_fma_f32 v70, v70, v5, v4
    v_fma_f32 v71, v71, v5, v4
    v_mul_f32 v64, v64, v128
    v_mul_f32 v65, v65, v129
    v_mfma_f32_32x32x16_bf16 v[208:223], v[36:39], a[140:143], v[208:223]
    ds_read_b64_tr_b16 v[30:31], v12 offset:4608
    buffer_load_dwordx4 v46, s[40:43], s55 offen offset:2048 lds
    v_mfma_f32_4x4x4_16b_bf16 v[116:119], v[114:115], v[36:37], v[116:119]
    v_mfma_f32_4x4x4_16b_bf16 v[120:123], v[114:115], v[38:39], v[120:123]
    v_mfma_f32_32x32x16_bf16 v[224:239], v[40:43], a[12:15], v[224:239]
    ds_read_b64_tr_b16 v[32:33], v13 offset:4096
    v_mul_f32 v66, v66, v130
    v_mul_f32 v67, v67, v131
    v_mul_f32 v68, v68, v132
    v_mul_f32 v69, v69, v133
    v_mfma_f32_32x32x16_bf16 v[240:255], v[40:43], a[140:143], v[240:255]
    ds_read_b64_tr_b16 v[34:35], v13 offset:4608
    buffer_load_dwordx4 v47, s[40:43], s55 offen offset:3072 lds
    s_waitcnt lgkmcnt(4)
    v_mfma_f32_32x32x16_bf16 v[192:207], v[20:23], a[16:19], v[192:207]
    ds_read_b64_tr_b16 v[36:37], v12 offset:8192
    v_mul_f32 v70, v70, v134
    v_mul_f32 v71, v71, v135
    v_exp_f32 v64, v64
    v_mfma_f32_32x32x16_bf16 v[208:223], v[20:23], a[144:147], v[208:223]
    ds_read_b64_tr_b16 v[38:39], v12 offset:8704
    v_mul_f32 v128, v128, v136
    v_exp_f32 v65, v65
    v_mul_f32 v129, v129, v137
    v_mfma_f32_4x4x4_16b_bf16 v[116:119], v[114:115], v[20:21], v[116:119]
    v_mfma_f32_4x4x4_16b_bf16 v[120:123], v[114:115], v[22:23], v[120:123]
    v_mfma_f32_32x32x16_bf16 v[224:239], v[24:27], a[16:19], v[224:239]
    ds_read_b64_tr_b16 v[40:41], v13 offset:8192
    v_exp_f32 v66, v66
    v_mul_f32 v130, v130, v138
    v_mfma_f32_32x32x16_bf16 v[240:255], v[24:27], a[144:147], v[240:255]
    ds_read_b64_tr_b16 v[42:43], v13 offset:8704
    v_exp_f32 v67, v67
    v_mul_f32 v131, v131, v139
    s_waitcnt lgkmcnt(4)
    v_mfma_f32_32x32x16_bf16 v[192:207], v[28:31], a[20:23], v[192:207]
    ds_read_b64_tr_b16 v[20:21], v12 offset:12288
    v_exp_f32 v68, v68
    v_mul_f32 v132, v132, v140
    v_mfma_f32_32x32x16_bf16 v[208:223], v[28:31], a[148:151], v[208:223]
    ds_read_b64_tr_b16 v[22:23], v12 offset:12800
    v_exp_f32 v69, v69
    v_mul_f32 v133, v133, v141
    v_mfma_f32_4x4x4_16b_bf16 v[116:119], v[114:115], v[28:29], v[116:119]
    v_mfma_f32_4x4x4_16b_bf16 v[120:123], v[114:115], v[30:31], v[120:123]
    v_mfma_f32_32x32x16_bf16 v[224:239], v[32:35], a[20:23], v[224:239]
    ds_read_b64_tr_b16 v[24:25], v13 offset:12288
    v_exp_f32 v70, v70
    v_mul_f32 v134, v134, v142
    v_mfma_f32_32x32x16_bf16 v[240:255], v[32:35], a[148:151], v[240:255]
    ds_read_b64_tr_b16 v[26:27], v13 offset:12800
    v_exp_f32 v71, v71
    v_mul_f32 v135, v135, v143
    s_waitcnt lgkmcnt(4)
    v_mfma_f32_32x32x16_bf16 v[192:207], v[36:39], a[24:27], v[192:207]
    s_barrier
    ds_read_b64_tr_b16 v[28:29], v8 offset:0
    v_fma_f32 v64, v64, v7, v7
    v_fma_f32 v65, v65, v7, v7
    v_fma_f32 v66, v66, v7, v7
    v_mfma_f32_32x32x16_bf16 v[208:223], v[36:39], a[152:155], v[208:223]
    ds_read_b64_tr_b16 v[30:31], v8 offset:512
    s_add_u32 m0, s53, 114688
    s_add_u32 s55, s48, 32768
    buffer_load_dwordx4 v44, s[40:43], s55 offen offset:0 lds
    v_mfma_f32_4x4x4_16b_bf16 v[116:119], v[114:115], v[36:37], v[116:119]
    v_mfma_f32_4x4x4_16b_bf16 v[120:123], v[114:115], v[38:39], v[120:123]
    v_mfma_f32_32x32x16_bf16 v[224:239], v[40:43], a[24:27], v[224:239]
    ds_read_b64_tr_b16 v[32:33], v9 offset:0
    v_fma_f32 v67, v67, v7, v7
    v_fma_f32 v68, v68, v7, v7
    v_fma_f32 v69, v69, v7, v7
    v_fma_f32 v70, v70, v7, v7
    v_mfma_f32_32x32x16_bf16 v[240:255], v[40:43], a[152:155], v[240:255]
    ds_read_b64_tr_b16 v[34:35], v9 offset:512
    buffer_load_dwordx4 v45, s[40:43], s55 offen offset:1024 lds
    s_waitcnt lgkmcnt(4)
    v_mfma_f32_32x32x16_bf16 v[192:207], v[20:23], a[28:31], v[192:207]
    ds_read_b64_tr_b16 v[36:37], v8 offset:4096
    v_fma_f32 v71, v71, v7, v7
    v_rcp_f32 v64, v64
    v_mfma_f32_32x32x16_bf16 v[208:223], v[20:23], a[156:159], v[208:223]
    ds_read_b64_tr_b16 v[38:39], v8 offset:4608
    buffer_load_dwordx4 v46, s[40:43], s55 offen offset:2048 lds
    v_mfma_f32_4x4x4_16b_bf16 v[116:119], v[114:115], v[20:21], v[116:119]
    v_mfma_f32_4x4x4_16b_bf16 v[120:123], v[114:115], v[22:23], v[120:123]
    v_mfma_f32_32x32x16_bf16 v[224:239], v[24:27], a[28:31], v[224:239]
    ds_read_b64_tr_b16 v[40:41], v9 offset:4096
    v_rcp_f32 v65, v65
    v_rcp_f32 v66, v66
    v_mfma_f32_32x32x16_bf16 v[240:255], v[24:27], a[156:159], v[240:255]
    ds_read_b64_tr_b16 v[42:43], v9 offset:4608
    buffer_load_dwordx4 v47, s[40:43], s55 offen offset:3072 lds
    s_waitcnt lgkmcnt(4)
    v_mfma_f32_32x32x16_bf16 v[192:207], v[28:31], a[32:35], v[192:207]
    ds_read_b64_tr_b16 v[20:21], v8 offset:8192
    v_rcp_f32 v67, v67
    v_rcp_f32 v68, v68
    v_mfma_f32_32x32x16_bf16 v[208:223], v[28:31], a[160:163], v[208:223]
    ds_read_b64_tr_b16 v[22:23], v8 offset:8704
    v_rcp_f32 v69, v69
    v_rcp_f32 v70, v70
    v_mfma_f32_4x4x4_16b_bf16 v[116:119], v[114:115], v[28:29], v[116:119]
    v_mfma_f32_4x4x4_16b_bf16 v[120:123], v[114:115], v[30:31], v[120:123]
    v_mfma_f32_32x32x16_bf16 v[224:239], v[32:35], a[32:35], v[224:239]
    ds_read_b64_tr_b16 v[24:25], v9 offset:8192
    v_rcp_f32 v71, v71
    v_mul_f32 v128, v128, v64
    v_mul_f32 v129, v129, v65
    v_mfma_f32_32x32x16_bf16 v[240:255], v[32:35], a[160:163], v[240:255]
    ds_read_b64_tr_b16 v[26:27], v9 offset:8704
    v_mul_f32 v130, v130, v66
    v_mul_f32 v131, v131, v67
    v_mul_f32 v132, v132, v68
    s_waitcnt lgkmcnt(4)
    v_mfma_f32_32x32x16_bf16 v[192:207], v[36:39], a[36:39], v[192:207]
    ds_read_b64_tr_b16 v[28:29], v8 offset:12288
    v_mul_f32 v133, v133, v69
    v_mul_f32 v134, v134, v70
    v_mul_f32 v135, v135, v71
    v_cvt_pk_bf16_f32 v80, v128, v129
    v_mfma_f32_32x32x16_bf16 v[208:223], v[36:39], a[164:167], v[208:223]
    ds_read_b64_tr_b16 v[30:31], v8 offset:12800
    v_cvt_pk_bf16_f32 v81, v130, v131
    v_cvt_pk_bf16_f32 v82, v132, v133
    v_cvt_pk_bf16_f32 v83, v134, v135
    v_mfma_f32_4x4x4_16b_bf16 v[116:119], v[114:115], v[36:37], v[116:119]
    v_mfma_f32_4x4x4_16b_bf16 v[120:123], v[114:115], v[38:39], v[120:123]
    v_mfma_f32_32x32x16_bf16 v[224:239], v[40:43], a[36:39], v[224:239]
    ds_read_b64_tr_b16 v[32:33], v9 offset:12288
    buffer_store_dwordx4 v[80:83], v126, s[24:27], s56 offen sc1
    v_mfma_f32_32x32x16_bf16 v[240:255], v[40:43], a[164:167], v[240:255]
    ds_read_b64_tr_b16 v[34:35], v9 offset:12800
    ds_read_b32 v106, v113 offset:0
    s_waitcnt lgkmcnt(5)
    v_mfma_f32_32x32x16_bf16 v[192:207], v[20:23], a[40:43], v[192:207]
    s_barrier
    ds_read_b64_tr_b16 v[36:37], v8 offset:16384
    v_mfma_f32_32x32x16_bf16 v[208:223], v[20:23], a[168:171], v[208:223]
    ds_read_b64_tr_b16 v[38:39], v8 offset:16896
    s_add_u32 m0, s53, 131072
    s_add_u32 s55, s48, 65536
    buffer_load_dwordx4 v44, s[40:43], s55 offen offset:0 lds
    v_mfma_f32_4x4x4_16b_bf16 v[116:119], v[114:115], v[20:21], v[116:119]
    v_mfma_f32_4x4x4_16b_bf16 v[120:123], v[114:115], v[22:23], v[120:123]
    v_mfma_f32_32x32x16_bf16 v[224:239], v[24:27], a[40:43], v[224:239]
    ds_read_b64_tr_b16 v[40:41], v9 offset:16384
    v_mfma_f32_32x32x16_bf16 v[240:255], v[24:27], a[168:171], v[240:255]
    ds_read_b64_tr_b16 v[42:43], v9 offset:16896
    buffer_load_dwordx4 v45, s[40:43], s55 offen offset:1024 lds
    s_waitcnt lgkmcnt(5)
    v_mfma_f32_32x32x16_bf16 v[192:207], v[28:31], a[44:47], v[192:207]
    ds_read_b64_tr_b16 v[20:21], v8 offset:20480
    s_waitcnt lgkmcnt(5)
    v_and_b32 v100, 0xffff0000, v106
    v_sub_f32 v106, v106, v100
    v_and_b32 v101, 0xffff0000, v106
    v_sub_f32 v106, v106, v101
    v_mfma_f32_32x32x16_bf16 v[208:223], v[28:31], a[172:175], v[208:223]
    ds_read_b64_tr_b16 v[22:23], v8 offset:20992
    buffer_load_dwordx4 v46, s[40:43], s55 offen offset:2048 lds
    v_mfma_f32_4x4x4_16b_bf16 v[116:119], v[114:115], v[28:29], v[116:119]
    v_mfma_f32_4x4x4_16b_bf16 v[120:123], v[114:115], v[30:31], v[120:123]
    v_mfma_f32_32x32x16_bf16 v[224:239], v[32:35], a[44:47], v[224:239]
    ds_read_b64_tr_b16 v[24:25], v9 offset:20480
    v_lshrrev_b32 v100, 16, v100
    v_or_b32 v100, v100, v101
    v_lshrrev_b32 v101, 16, v106
    s_nop 1
    v_mfma_f32_32x32x16_bf16 v[160:175], v[100:103], v[88:91], v[160:175]
    v_mfma_f32_32x32x16_bf16 v[176:191], v[100:103], v[92:95], v[176:191]
    v_mfma_f32_32x32x16_bf16 v[240:255], v[32:35], a[172:175], v[240:255]
    ds_read_b64_tr_b16 v[26:27], v9 offset:20992
    buffer_load_dwordx4 v47, s[40:43], s55 offen offset:3072 lds
    s_waitcnt lgkmcnt(4)
    v_mfma_f32_32x32x16_bf16 v[192:207], v[36:39], a[48:51], v[192:207]
    ds_read_b64_tr_b16 v[28:29], v8 offset:24576
    v_mul_f32 v144, v144, v124
    v_mul_f32 v145, v145, v124
    v_mul_f32 v146, v146, v124
    v_mul_f32 v147, v147, v124
    v_mfma_f32_32x32x16_bf16 v[208:223], v[36:39], a[176:179], v[208:223]
    ds_read_b64_tr_b16 v[30:31], v8 offset:25088
    v_mul_f32 v148, v148, v124
    v_mul_f32 v149, v149, v124
    v_mul_f32 v150, v150, v124
    v_mul_f32 v151, v151, v124
    v_mfma_f32_4x4x4_16b_bf16 v[116:119], v[114:115], v[36:37], v[116:119]
    v_mfma_f32_4x4x4_16b_bf16 v[120:123], v[114:115], v[38:39], v[120:123]
    v_mfma_f32_32x32x16_bf16 v[224:239], v[40:43], a[48:51], v[224:239]
    ds_read_b64_tr_b16 v[32:33], v9 offset:24576
    v_mul_f32 v72, v144, v144
    v_mul_f32 v73, v145, v145
    v_mul_f32 v74, v146, v146
    v_mul_f32 v75, v147, v147
    v_mfma_f32_32x32x16_bf16 v[240:255], v[40:43], a[176:179], v[240:255]
    ds_read_b64_tr_b16 v[34:35], v9 offset:25088
    v_mul_f32 v76, v148, v148
    v_mul_f32 v77, v149, v149
    v_mul_f32 v78, v150, v150
    s_waitcnt lgkmcnt(4)
    v_mfma_f32_32x32x16_bf16 v[192:207], v[20:23], a[52:55], v[192:207]
    ds_read_b64_tr_b16 v[36:37], v8 offset:28672
    v_mul_f32 v79, v151, v151
    v_fma_f32 v72, v72, v5, v4
    v_fma_f32 v73, v73, v5, v4
    v_fma_f32 v74, v74, v5, v4
    v_mfma_f32_32x32x16_bf16 v[208:223], v[20:23], a[180:183], v[208:223]
    ds_read_b64_tr_b16 v[38:39], v8 offset:29184
    v_fma_f32 v75, v75, v5, v4
    v_fma_f32 v76, v76, v5, v4
    v_fma_f32 v77, v77, v5, v4
    v_fma_f32 v78, v78, v5, v4
    v_mfma_f32_4x4x4_16b_bf16 v[116:119], v[114:115], v[20:21], v[116:119]
    v_mfma_f32_4x4x4_16b_bf16 v[120:123], v[114:115], v[22:23], v[120:123]
    v_mfma_f32_32x32x16_bf16 v[224:239], v[24:27], a[52:55], v[224:239]
    ds_read_b64_tr_b16 v[40:41], v9 offset:28672
    v_fma_f32 v79, v79, v5, v4
    v_mul_f32 v72, v72, v144
    v_mul_f32 v73, v73, v145
    v_mul_f32 v74, v74, v146
    v_mfma_f32_32x32x16_bf16 v[240:255], v[24:27], a[180:183], v[240:255]
    ds_read_b64_tr_b16 v[42:43], v9 offset:29184
    v_mul_f32 v75, v75, v147
    v_mul_f32 v76, v76, v148
    v_mul_f32 v77, v77, v149
    s_waitcnt lgkmcnt(4)
    v_mfma_f32_32x32x16_bf16 v[192:207], v[28:31], a[56:59], v[192:207]
    s_barrier
    ds_read_b64_tr_b16 v[20:21], v8 offset:32768
    v_mul_f32 v78, v78, v150
    v_mul_f32 v79, v79, v151
    v_mfma_f32_32x32x16_bf16 v[208:223], v[28:31], a[184:187], v[208:223]
    ds_read_b64_tr_b16 v[22:23], v8 offset:33280
    s_add_u32 m0, s53, 0
    s_add_u32 s55, s48, 98304
    buffer_load_dwordx4 v44, s[40:43], s55 offen offset:0 lds
    v_mfma_f32_4x4x4_16b_bf16 v[116:119], v[114:115], v[28:29], v[116:119]
    v_mfma_f32_4x4x4_16b_bf16 v[120:123], v[114:115], v[30:31], v[120:123]
    v_mfma_f32_32x32x16_bf16 v[224:239], v[32:35], a[56:59], v[224:239]
    ds_read_b64_tr_b16 v[24:25], v9 offset:32768
    v_exp_f32 v72, v72
    v_mul_f32 v144, v144, v152
    v_mfma_f32_32x32x16_bf16 v[240:255], v[32:35], a[184:187], v[240:255]
    ds_read_b64_tr_b16 v[26:27], v9 offset:33280
    buffer_load_dwordx4 v45, s[40:43], s55 offen offset:1024 lds
    s_waitcnt lgkmcnt(4)
    v_mfma_f32_32x32x16_bf16 v[192:207], v[36:39], a[60:63], v[192:207]
    ds_read_b64_tr_b16 v[28:29], v8 offset:36864
    v_exp_f32 v73, v73
    v_mul_f32 v145, v145, v153
    v_mfma_f32_32x32x16_bf16 v[208:223], v[36:39], a[188:191], v[208:223]
    ds_read_b64_tr_b16 v[30:31], v8 offset:37376
    buffer_load_dwordx4 v46, s[40:43], s55 offen offset:2048 lds
    v_mfma_f32_4x4x4_16b_bf16 v[116:119], v[114:115], v[36:37], v[116:119]
    v_mfma_f32_4x4x4_16b_bf16 v[120:123], v[114:115], v[38:39], v[120:123]
    v_mfma_f32_32x32x16_bf16 v[224:239], v[40:43], a[60:63], v[224:239]
    ds_read_b64_tr_b16 v[32:33], v9 offset:36864
    v_exp_f32 v74, v74
    v_mul_f32 v146, v146, v154
    v_mfma_f32_32x32x16_bf16 v[240:255], v[40:43], a[188:191], v[240:255]
    ds_read_b64_tr_b16 v[34:35], v9 offset:37376
    buffer_load_dwordx4 v47, s[40:43], s55 offen offset:3072 lds
    s_waitcnt lgkmcnt(4)
    v_mfma_f32_32x32x16_bf16 v[192:207], v[20:23], a[64:67], v[192:207]
    ds_read_b64_tr_b16 v[36:37], v8 offset:40960
    v_exp_f32 v75, v75
    v_mul_f32 v147, v147, v155
    v_mfma_f32_32x32x16_bf16 v[208:223], v[20:23], a[192:195], v[208:223]
    ds_read_b64_tr_b16 v[38:39], v8 offset:41472
    v_exp_f32 v76, v76
    v_mul_f32 v148, v148, v156
    v_mfma_f32_4x4x4_16b_bf16 v[116:119], v[114:115], v[20:21], v[116:119]
    v_mfma_f32_4x4x4_16b_bf16 v[120:123], v[114:115], v[22:23], v[120:123]
    v_mfma_f32_32x32x16_bf16 v[224:239], v[24:27], a[64:67], v[224:239]
    ds_read_b64_tr_b16 v[40:41], v9 offset:40960
    v_exp_f32 v77, v77
    v_mul_f32 v149, v149, v157
    v_mfma_f32_32x32x16_bf16 v[240:255], v[24:27], a[192:195], v[240:255]
    ds_read_b64_tr_b16 v[42:43], v9 offset:41472
    v_exp_f32 v78, v78
    v_mul_f32 v150, v150, v158
    s_waitcnt lgkmcnt(4)
    v_mfma_f32_32x32x16_bf16 v[192:207], v[28:31], a[68:71], v[192:207]
    ds_read_b64_tr_b16 v[20:21], v8 offset:45056
    v_exp_f32 v79, v79
    v_mul_f32 v151, v151, v159
    v_fma_f32 v72, v72, v125, v125
    v_mfma_f32_32x32x16_bf16 v[208:223], v[28:31], a[196:199], v[208:223]
    ds_read_b64_tr_b16 v[22:23], v8 offset:45568
    v_fma_f32 v73, v73, v125, v125
    v_fma_f32 v74, v74, v125, v125
    v_fma_f32 v75, v75, v125, v125
    v_fma_f32 v76, v76, v125, v125
    v_mfma_f32_4x4x4_16b_bf16 v[116:119], v[114:115], v[28:29], v[116:119]
    v_mfma_f32_4x4x4_16b_bf16 v[120:123], v[114:115], v[30:31], v[120:123]
    v_mfma_f32_32x32x16_bf16 v[224:239], v[32:35], a[68:71], v[224:239]
    ds_read_b64_tr_b16 v[24:25], v9 offset:45056
    v_fma_f32 v77, v77, v125, v125
    v_fma_f32 v78, v78, v125, v125
    v_fma_f32 v79, v79, v125, v125
    v_mfma_f32_32x32x16_bf16 v[240:255], v[32:35], a[196:199], v[240:255]
    ds_read_b64_tr_b16 v[26:27], v9 offset:45568
    v_rcp_f32 v72, v72
    s_waitcnt lgkmcnt(4)
    v_mfma_f32_32x32x16_bf16 v[192:207], v[36:39], a[72:75], v[192:207]
    s_waitcnt vmcnt(25)
    s_barrier
    ds_read_b64_tr_b16 v[28:29], v8 offset:49152
    v_rcp_f32 v73, v73
    v_mfma_f32_32x32x16_bf16 v[208:223], v[36:39], a[200:203], v[208:223]
    ds_read_b64_tr_b16 v[30:31], v8 offset:49664
    s_add_u32 m0, s53, 16384
    s_add_u32 s55, s48, 131072
    buffer_load_dwordx4 v44, s[40:43], s55 offen offset:0 lds
    v_mfma_f32_4x4x4_16b_bf16 v[116:119], v[114:115], v[36:37], v[116:119]
    v_mfma_f32_4x4x4_16b_bf16 v[120:123], v[114:115], v[38:39], v[120:123]
    v_mfma_f32_32x32x16_bf16 v[224:239], v[40:43], a[72:75], v[224:239]
    ds_read_b64_tr_b16 v[32:33], v9 offset:49152
    v_rcp_f32 v74, v74
    v_rcp_f32 v75, v75
    v_mfma_f32_32x32x16_bf16 v[240:255], v[40:43], a[200:203], v[240:255]
    ds_read_b64_tr_b16 v[34:35], v9 offset:49664
    buffer_load_dwordx4 v45, s[40:43], s55 offen offset:1024 lds
    s_waitcnt lgkmcnt(4)
    v_mfma_f32_32x32x16_bf16 v[192:207], v[20:23], a[76:79], v[192:207]
    ds_read_b64_tr_b16 v[36:37], v8 offset:53248
    v_rcp_f32 v76, v76
    v_rcp_f32 v77, v77
    v_mfma_f32_32x32x16_bf16 v[208:223], v[20:23], a[204:207], v[208:223]
    ds_read_b64_tr_b16 v[38:39], v8 offset:53760
    buffer_load_dwordx4 v46, s[40:43], s55 offen offset:2048 lds
    v_mfma_f32_4x4x4_16b_bf16 v[116:119], v[114:115], v[20:21], v[116:119]
    v_mfma_f32_4x4x4_16b_bf16 v[120:123], v[114:115], v[22:23], v[120:123]
    v_mfma_f32_32x32x16_bf16 v[224:239], v[24:27], a[76:79], v[224:239]
    ds_read_b64_tr_b16 v[40:41], v9 offset:53248
    v_rcp_f32 v78, v78
    v_rcp_f32 v79, v79
    v_mfma_f32_32x32x16_bf16 v[240:255], v[24:27], a[204:207], v[240:255]
    ds_read_b64_tr_b16 v[42:43], v9 offset:53760
    buffer_load_dwordx4 v47, s[40:43], s55 offen offset:3072 lds
    s_waitcnt lgkmcnt(4)
    v_mfma_f32_32x32x16_bf16 v[192:207], v[28:31], a[80:83], v[192:207]
    ds_read_b64_tr_b16 v[20:21], v8 offset:57344
    v_mul_f32 v144, v144, v72
    v_mul_f32 v145, v145, v73
    v_mul_f32 v146, v146, v74
    v_mul_f32 v147, v147, v75
    v_mfma_f32_32x32x16_bf16 v[208:223], v[28:31], a[208:211], v[208:223]
    ds_read_b64_tr_b16 v[22:23], v8 offset:57856
    v_mul_f32 v148, v148, v76
    v_mul_f32 v149, v149, v77
    v_mul_f32 v150, v150, v78
    v_mul_f32 v151, v151, v79
    v_mfma_f32_4x4x4_16b_bf16 v[116:119], v[114:115], v[28:29], v[116:119]
    v_mfma_f32_4x4x4_16b_bf16 v[120:123], v[114:115], v[30:31], v[120:123]
    v_mfma_f32_32x32x16_bf16 v[224:239], v[32:35], a[80:83], v[224:239]
    ds_read_b64_tr_b16 v[24:25], v9 offset:57344
    v_cvt_pk_bf16_f32 v84, v144, v145
    v_cvt_pk_bf16_f32 v85, v146, v147
    v_cvt_pk_bf16_f32 v86, v148, v149
    v_cvt_pk_bf16_f32 v87, v150, v151
    v_mfma_f32_32x32x16_bf16 v[240:255], v[32:35], a[208:211], v[240:255]
    ds_read_b64_tr_b16 v[26:27], v9 offset:57856
    buffer_store_dwordx4 v[84:87], v126, s[24:27], s58 offen sc1
    s_waitcnt lgkmcnt(4)
    v_mfma_f32_32x32x16_bf16 v[192:207], v[36:39], a[84:87], v[192:207]
    ds_read_b64_tr_b16 v[28:29], v8 offset:61440
    v_mul_f32 v160, v160, v6
    v_mul_f32 v161, v161, v6
    v_mul_f32 v162, v162, v6
    v_mul_f32 v163, v163, v6
    v_mfma_f32_32x32x16_bf16 v[208:223], v[36:39], a[212:215], v[208:223]
    ds_read_b64_tr_b16 v[30:31], v8 offset:61952
    v_mul_f32 v164, v164, v6
    v_mul_f32 v165, v165, v6
    v_mul_f32 v166, v166, v6
    v_mul_f32 v167, v167, v6
    v_mfma_f32_4x4x4_16b_bf16 v[116:119], v[114:115], v[36:37], v[116:119]
    v_mfma_f32_4x4x4_16b_bf16 v[120:123], v[114:115], v[38:39], v[120:123]
    v_mfma_f32_32x32x16_bf16 v[224:239], v[40:43], a[84:87], v[224:239]
    ds_read_b64_tr_b16 v[32:33], v9 offset:61440
    v_mul_f32 v64, v160, v160
    v_mul_f32 v65, v161, v161
    v_mul_f32 v66, v162, v162
    v_mul_f32 v67, v163, v163
    v_mfma_f32_32x32x16_bf16 v[240:255], v[40:43], a[212:215], v[240:255]
    ds_read_b64_tr_b16 v[34:35], v9 offset:61952
    v_mul_f32 v68, v164, v164
    v_mul_f32 v69, v165, v165
    v_mul_f32 v70, v166, v166
    s_waitcnt lgkmcnt(4)
    v_mfma_f32_32x32x16_bf16 v[192:207], v[20:23], a[88:91], v[192:207]
    s_waitcnt vmcnt(26)
    s_barrier
    ds_read_b64_tr_b16 v[36:37], v10 offset:0
    v_mul_f32 v71, v167, v167
    v_fma_f32 v64, v64, v5, v4
    v_fma_f32 v65, v65, v5, v4
    v_mfma_f32_32x32x16_bf16 v[208:223], v[20:23], a[216:219], v[208:223]
    ds_read_b64_tr_b16 v[38:39], v10 offset:512
    s_add_u32 m0, s53, 32768
    s_add_u32 s55, s48, 163840
    buffer_load_dwordx4 v44, s[40:43], s55 offen offset:0 lds
    v_mfma_f32_4x4x4_16b_bf16 v[116:119], v[114:115], v[20:21], v[116:119]
    v_mfma_f32_4x4x4_16b_bf16 v[120:123], v[114:115], v[22:23], v[120:123]
    v_mfma_f32_32x32x16_bf16 v[224:239], v[24:27], a[88:91], v[224:239]
    ds_read_b64_tr_b16 v[40:41], v11 offset:0
    v_fma_f32 v66, v66, v5, v4
    v_fma_f32 v67, v67, v5, v4
    v_fma_f32 v68, v68, v5, v4
    v_fma_f32 v69, v69, v5, v4
    v_mfma_f32_32x32x16_bf16 v[240:255], v[24:27], a[216:219], v[240:255]
    ds_read_b64_tr_b16 v[42:43], v11 offset:512
    buffer_load_dwordx4 v45, s[40:43], s55 offen offset:1024 lds
    s_waitcnt lgkmcnt(4)
    v_mfma_f32_32x32x16_bf16 v[192:207], v[28:31], a[92:95], v[192:207]
    ds_read_b64_tr_b16 v[20:21], v10 offset:4096
    v_fma_f32 v70, v70, v5, v4
    v_fma_f32 v71, v71, v5, v4
    v_mul_f32 v64, v64, v160
    v_mul_f32 v65, v65, v161
    v_mfma_f32_32x32x16_bf16 v[208:223], v[28:31], a[220:223], v[208:223]
    ds_read_b64_tr_b16 v[22:23], v10 offset:4608
    buffer_load_dwordx4 v46, s[40:43], s55 offen offset:2048 lds
    v_mfma_f32_4x4x4_16b_bf16 v[116:119], v[114:115], v[28:29], v[116:119]
    v_mfma_f32_4x4x4_16b_bf16 v[120:123], v[114:115], v[30:31], v[120:123]
    v_mfma_f32_32x32x16_bf16 v[224:239], v[32:35], a[92:95], v[224:239]
    ds_read_b64_tr_b16 v[24:25], v11 offset:4096
    v_mul_f32 v66, v66, v162
    v_mul_f32 v67, v67, v163
    v_mul_f32 v68, v68, v164
    v_mul_f32 v69, v69, v165
    v_mfma_f32_32x32x16_bf16 v[240:255], v[32:35], a[220:223], v[240:255]
    ds_read_b64_tr_b16 v[26:27], v11 offset:4608
    buffer_load_dwordx4 v47, s[40:43], s55 offen offset:3072 lds
    s_waitcnt lgkmcnt(4)
    v_mfma_f32_32x32x16_bf16 v[192:207], v[36:39], a[96:99], v[192:207]
    ds_read_b64_tr_b16 v[28:29], v10 offset:8192
    v_mul_f32 v70, v70, v166
    v_mul_f32 v71, v71, v167
    v_exp_f32 v64, v64
    v_mfma_f32_32x32x16_bf16 v[208:223], v[36:39], a[224:227], v[208:223]
    ds_read_b64_tr_b16 v[30:31], v10 offset:8704
    v_mul_f32 v160, v160, v168
    v_exp_f32 v65, v65
    v_mul_f32 v161, v161, v169
    v_mfma_f32_4x4x4_16b_bf16 v[116:119], v[114:115], v[36:37], v[116:119]
    v_mfma_f32_4x4x4_16b_bf16 v[120:123], v[114:115], v[38:39], v[120:123]
    v_mfma_f32_32x32x16_bf16 v[224:239], v[40:43], a[96:99], v[224:239]
    ds_read_b64_tr_b16 v[32:33], v11 offset:8192
    v_exp_f32 v66, v66
    v_mul_f32 v162, v162, v170
    v_mfma_f32_32x32x16_bf16 v[240:255], v[40:43], a[224:227], v[240:255]
    ds_read_b64_tr_b16 v[34:35], v11 offset:8704
    v_exp_f32 v67, v67
    v_mul_f32 v163, v163, v171
    s_waitcnt lgkmcnt(4)
    v_mfma_f32_32x32x16_bf16 v[192:207], v[20:23], a[100:103], v[192:207]
    ds_read_b64_tr_b16 v[36:37], v10 offset:12288
    v_exp_f32 v68, v68
    v_mul_f32 v164, v164, v172
    v_mfma_f32_32x32x16_bf16 v[208:223], v[20:23], a[228:231], v[208:223]
    ds_read_b64_tr_b16 v[38:39], v10 offset:12800
    v_exp_f32 v69, v69
    v_mul_f32 v165, v165, v173
    v_mfma_f32_4x4x4_16b_bf16 v[116:119], v[114:115], v[20:21], v[116:119]
    v_mfma_f32_4x4x4_16b_bf16 v[120:123], v[114:115], v[22:23], v[120:123]
    v_mfma_f32_32x32x16_bf16 v[224:239], v[24:27], a[100:103], v[224:239]
    ds_read_b64_tr_b16 v[40:41], v11 offset:12288
    v_exp_f32 v70, v70
    v_mul_f32 v166, v166, v174
    v_mfma_f32_32x32x16_bf16 v[240:255], v[24:27], a[228:231], v[240:255]
    ds_read_b64_tr_b16 v[42:43], v11 offset:12800
    v_exp_f32 v71, v71
    v_mul_f32 v167, v167, v175
    s_waitcnt lgkmcnt(4)
    v_mfma_f32_32x32x16_bf16 v[192:207], v[28:31], a[104:107], v[192:207]
    s_waitcnt vmcnt(26)
    s_barrier
    ds_read_b64_tr_b16 v[20:21], v10 offset:16384
    v_fma_f32 v64, v64, v7, v7
    v_fma_f32 v65, v65, v7, v7
    v_fma_f32 v66, v66, v7, v7
    v_mfma_f32_32x32x16_bf16 v[208:223], v[28:31], a[232:235], v[208:223]
    ds_read_b64_tr_b16 v[22:23], v10 offset:16896
    s_add_u32 m0, s53, 49152
    s_add_u32 s55, s48, 196608
    buffer_load_dwordx4 v44, s[40:43], s55 offen offset:0 lds
    v_mfma_f32_4x4x4_16b_bf16 v[116:119], v[114:115], v[28:29], v[116:119]
    v_mfma_f32_4x4x4_16b_bf16 v[120:123], v[114:115], v[30:31], v[120:123]
    v_mfma_f32_32x32x16_bf16 v[224:239], v[32:35], a[104:107], v[224:239]
    ds_read_b64_tr_b16 v[24:25], v11 offset:16384
    v_fma_f32 v67, v67, v7, v7
    v_fma_f32 v68, v68, v7, v7
    v_fma_f32 v69, v69, v7, v7
    v_fma_f32 v70, v70, v7, v7
    v_mfma_f32_32x32x16_bf16 v[240:255], v[32:35], a[232:235], v[240:255]
    ds_read_b64_tr_b16 v[26:27], v11 offset:16896
    buffer_load_dwordx4 v45, s[40:43], s55 offen offset:1024 lds
    s_waitcnt lgkmcnt(4)
    v_mfma_f32_32x32x16_bf16 v[192:207], v[36:39], a[108:111], v[192:207]
    ds_read_b64_tr_b16 v[28:29], v10 offset:20480
    v_fma_f32 v71, v71, v7, v7
    v_rcp_f32 v64, v64
    v_mfma_f32_32x32x16_bf16 v[208:223], v[36:39], a[236:239], v[208:223]
    ds_read_b64_tr_b16 v[30:31], v10 offset:20992
    buffer_load_dwordx4 v46, s[40:43], s55 offen offset:2048 lds
    v_mfma_f32_4x4x4_16b_bf16 v[116:119], v[114:115], v[36:37], v[116:119]
    v_mfma_f32_4x4x4_16b_bf16 v[120:123], v[114:115], v[38:39], v[120:123]
    v_mfma_f32_32x32x16_bf16 v[224:239], v[40:43], a[108:111], v[224:239]
    ds_read_b64_tr_b16 v[32:33], v11 offset:20480
    v_rcp_f32 v65, v65
    v_rcp_f32 v66, v66
    v_mfma_f32_32x32x16_bf16 v[240:255], v[40:43], a[236:239], v[240:255]
    ds_read_b64_tr_b16 v[34:35], v11 offset:20992
    buffer_load_dwordx4 v47, s[40:43], s55 offen offset:3072 lds
    s_waitcnt lgkmcnt(4)
    v_mfma_f32_32x32x16_bf16 v[192:207], v[20:23], a[112:115], v[192:207]
    ds_read_b64_tr_b16 v[36:37], v10 offset:24576
    v_rcp_f32 v67, v67
    v_rcp_f32 v68, v68
    v_mfma_f32_32x32x16_bf16 v[208:223], v[20:23], a[240:243], v[208:223]
    ds_read_b64_tr_b16 v[38:39], v10 offset:25088
    v_rcp_f32 v69, v69
    v_rcp_f32 v70, v70
    v_mfma_f32_4x4x4_16b_bf16 v[116:119], v[114:115], v[20:21], v[116:119]
    v_mfma_f32_4x4x4_16b_bf16 v[120:123], v[114:115], v[22:23], v[120:123]
    v_mfma_f32_32x32x16_bf16 v[224:239], v[24:27], a[112:115], v[224:239]
    ds_read_b64_tr_b16 v[40:41], v11 offset:24576
    v_rcp_f32 v71, v71
    v_mul_f32 v160, v160, v64
    v_mul_f32 v161, v161, v65
    v_mfma_f32_32x32x16_bf16 v[240:255], v[24:27], a[240:243], v[240:255]
    ds_read_b64_tr_b16 v[42:43], v11 offset:25088
    v_mul_f32 v162, v162, v66
    v_mul_f32 v163, v163, v67
    v_mul_f32 v164, v164, v68
    s_waitcnt lgkmcnt(4)
    v_mfma_f32_32x32x16_bf16 v[192:207], v[28:31], a[116:119], v[192:207]
    ds_read_b64_tr_b16 v[20:21], v10 offset:28672
    v_mul_f32 v165, v165, v69
    v_mul_f32 v166, v166, v70
    v_mul_f32 v167, v167, v71
    v_cvt_pk_bf16_f32 v80, v160, v161
    v_mfma_f32_32x32x16_bf16 v[208:223], v[28:31], a[244:247], v[208:223]
    ds_read_b64_tr_b16 v[22:23], v10 offset:29184
    v_cvt_pk_bf16_f32 v81, v162, v163
    v_cvt_pk_bf16_f32 v82, v164, v165
    v_cvt_pk_bf16_f32 v83, v166, v167
    v_mfma_f32_4x4x4_16b_bf16 v[116:119], v[114:115], v[28:29], v[116:119]
    v_mfma_f32_4x4x4_16b_bf16 v[120:123], v[114:115], v[30:31], v[120:123]
    v_mfma_f32_32x32x16_bf16 v[224:239], v[32:35], a[116:119], v[224:239]
    ds_read_b64_tr_b16 v[24:25], v11 offset:28672
    buffer_store_dwordx4 v[80:83], v127, s[24:27], s56 offen sc1
    v_mfma_f32_32x32x16_bf16 v[240:255], v[32:35], a[244:247], v[240:255]
    ds_read_b64_tr_b16 v[26:27], v11 offset:29184
    v_mul_f32 v176, v176, v124
    v_mul_f32 v177, v177, v124
    v_mul_f32 v178, v178, v124
    s_waitcnt lgkmcnt(4)
    v_mfma_f32_32x32x16_bf16 v[192:207], v[36:39], a[120:123], v[192:207]
    v_mul_f32 v179, v179, v124
    v_mul_f32 v180, v180, v124
    v_mul_f32 v181, v181, v124
    v_mul_f32 v182, v182, v124
    v_mul_f32 v183, v183, v124
    v_mfma_f32_32x32x16_bf16 v[208:223], v[36:39], a[248:251], v[208:223]
    v_mul_f32 v72, v176, v176
    v_mul_f32 v73, v177, v177
    v_mul_f32 v74, v178, v178
    v_mul_f32 v75, v179, v179
    v_mul_f32 v76, v180, v180
    v_mfma_f32_4x4x4_16b_bf16 v[116:119], v[114:115], v[36:37], v[116:119]
    v_mfma_f32_4x4x4_16b_bf16 v[120:123], v[114:115], v[38:39], v[120:123]
    v_mfma_f32_32x32x16_bf16 v[224:239], v[40:43], a[120:123], v[224:239]
    v_mul_f32 v77, v181, v181
    v_mul_f32 v78, v182, v182
    v_mul_f32 v79, v183, v183
    v_fma_f32 v72, v72, v5, v4
    v_fma_f32 v73, v73, v5, v4
    v_mfma_f32_32x32x16_bf16 v[240:255], v[40:43], a[248:251], v[240:255]
    v_fma_f32 v74, v74, v5, v4
    v_fma_f32 v75, v75, v5, v4
    v_fma_f32 v76, v76, v5, v4
    v_fma_f32 v77, v77, v5, v4
    s_waitcnt lgkmcnt(0)
    v_mfma_f32_32x32x16_bf16 v[192:207], v[20:23], a[124:127], v[192:207]
    v_fma_f32 v78, v78, v5, v4
    v_fma_f32 v79, v79, v5, v4
    v_mul_f32 v72, v72, v176
    v_mul_f32 v73, v73, v177
    v_mul_f32 v74, v74, v178
    v_mfma_f32_32x32x16_bf16 v[208:223], v[20:23], a[252:255], v[208:223]
    v_mul_f32 v75, v75, v179
    v_mul_f32 v76, v76, v180
    v_mul_f32 v77, v77, v181
    v_mul_f32 v78, v78, v182
    v_mul_f32 v79, v79, v183
    v_mfma_f32_4x4x4_16b_bf16 v[116:119], v[114:115], v[20:21], v[116:119]
    v_mfma_f32_4x4x4_16b_bf16 v[120:123], v[114:115], v[22:23], v[120:123]
    v_mfma_f32_32x32x16_bf16 v[224:239], v[24:27], a[124:127], v[224:239]
    v_exp_f32 v72, v72
    v_mul_f32 v176, v176, v184
    v_exp_f32 v73, v73
    v_mfma_f32_32x32x16_bf16 v[240:255], v[24:27], a[252:255], v[240:255]
    v_mul_f32 v177, v177, v185
    v_exp_f32 v74, v74
    v_mul_f32 v178, v178, v186
    v_add_f32 v108, v116, v120
    v_mov_b32 v109, v108
    s_nop 1
    v_permlane32_swap_b32 v108, v109
    v_add_f32 v108, v108, v109
    ds_write_b32 v112, v108 offset:128
    v_and_b32 v96, 0xffff0000, v108
    v_sub_f32 v108, v108, v96
    v_and_b32 v97, 0xffff0000, v108
    v_sub_f32 v108, v108, v97
    v_lshrrev_b32 v96, 16, v96
    v_or_b32 v96, v96, v97
    v_lshrrev_b32 v97, 16, v108
    s_nop 1
    v_mfma_f32_32x32x16_bf16 v[192:207], v[96:99], v[88:91], v[192:207]
    v_mfma_f32_32x32x16_bf16 v[208:223], v[96:99], v[92:95], v[208:223]
    v_exp_f32 v75, v75
    v_mul_f32 v179, v179, v187
    v_exp_f32 v76, v76
    v_mul_f32 v180, v180, v188
    v_exp_f32 v77, v77
    v_mul_f32 v181, v181, v189
    v_exp_f32 v78, v78
    v_mul_f32 v182, v182, v190
    v_exp_f32 v79, v79
    v_mul_f32 v183, v183, v191
    v_fma_f32 v72, v72, v125, v125
    v_fma_f32 v73, v73, v125, v125
    v_fma_f32 v74, v74, v125, v125
    v_fma_f32 v75, v75, v125, v125
    v_fma_f32 v76, v76, v125, v125
    v_fma_f32 v77, v77, v125, v125
    v_fma_f32 v78, v78, v125, v125
    v_fma_f32 v79, v79, v125, v125
    v_rcp_f32 v72, v72
    v_rcp_f32 v73, v73
    v_rcp_f32 v74, v74
    v_rcp_f32 v75, v75
    v_rcp_f32 v76, v76
    v_rcp_f32 v77, v77
    v_rcp_f32 v78, v78
    v_rcp_f32 v79, v79
    v_mul_f32 v176, v176, v72
    v_mul_f32 v177, v177, v73
    v_mul_f32 v178, v178, v74
    v_mul_f32 v179, v179, v75
    v_mul_f32 v180, v180, v76
    v_mul_f32 v181, v181, v77
    v_mul_f32 v182, v182, v78
    v_mul_f32 v183, v183, v79
    v_cvt_pk_bf16_f32 v84, v176, v177
    v_cvt_pk_bf16_f32 v85, v178, v179
    v_cvt_pk_bf16_f32 v86, v180, v181
    v_cvt_pk_bf16_f32 v87, v182, v183
    buffer_store_dwordx4 v[84:87], v127, s[24:27], s58 offen sc1
    v_pk_mul_f32 v[192:193], v[192:193], v[6:7] op_sel_hi:[1,0]
    v_pk_mul_f32 v[194:195], v[194:195], v[6:7] op_sel_hi:[1,0]
    v_pk_mul_f32 v[196:197], v[196:197], v[6:7] op_sel_hi:[1,0]
    v_pk_mul_f32 v[198:199], v[198:199], v[6:7] op_sel_hi:[1,0]
    v_pk_mul_f32 v[64:65], v[192:193], v[192:193]
    v_pk_mul_f32 v[66:67], v[194:195], v[194:195]
    v_pk_mul_f32 v[68:69], v[196:197], v[196:197]
    v_pk_mul_f32 v[70:71], v[198:199], v[198:199]
    v_pk_fma_f32 v[64:65], v[64:65], v[4:5], v[4:5] op_sel:[0,1,0] op_sel_hi:[1,1,0]
    v_pk_fma_f32 v[66:67], v[66:67], v[4:5], v[4:5] op_sel:[0,1,0] op_sel_hi:[1,1,0]
    v_pk_fma_f32 v[68:69], v[68:69], v[4:5], v[4:5] op_sel:[0,1,0] op_sel_hi:[1,1,0]
    v_pk_fma_f32 v[70:71], v[70:71], v[4:5], v[4:5] op_sel:[0,1,0] op_sel_hi:[1,1,0]
    v_pk_mul_f32 v[64:65], v[64:65], v[192:193]
    v_pk_mul_f32 v[66:67], v[66:67], v[194:195]
    v_pk_mul_f32 v[68:69], v[68:69], v[196:197]
    v_pk_mul_f32 v[70:71], v[70:71], v[198:199]
    v_exp_f32 v64, v64
    v_pk_mul_f32 v[192:193], v[192:193], v[200:201]
    v_exp_f32 v65, v65
    v_exp_f32 v66, v66
    v_pk_mul_f32 v[194:195], v[194:195], v[202:203]
    v_exp_f32 v67, v67
    v_exp_f32 v68, v68
    v_pk_mul_f32 v[196:197], v[196:197], v[204:205]
    v_exp_f32 v69, v69
    v_exp_f32 v70, v70
    v_pk_mul_f32 v[198:199], v[198:199], v[206:207]
    v_exp_f32 v71, v71
    v_pk_fma_f32 v[64:65], v[64:65], v[6:7], v[6:7] op_sel:[0,1,1] op_sel_hi:[1,1,1]
    v_pk_fma_f32 v[66:67], v[66:67], v[6:7], v[6:7] op_sel:[0,1,1] op_sel_hi:[1,1,1]
    v_pk_fma_f32 v[68:69], v[68:69], v[6:7], v[6:7] op_sel:[0,1,1] op_sel_hi:[1,1,1]
    v_pk_fma_f32 v[70:71], v[70:71], v[6:7], v[6:7] op_sel:[0,1,1] op_sel_hi:[1,1,1]
    v_rcp_f32 v64, v64
    v_rcp_f32 v65, v65
    v_rcp_f32 v66, v66
    v_rcp_f32 v67, v67
    v_rcp_f32 v68, v68
    v_rcp_f32 v69, v69
    v_rcp_f32 v70, v70
    v_rcp_f32 v71, v71
    v_pk_mul_f32 v[192:193], v[192:193], v[64:65]
    v_pk_mul_f32 v[194:195], v[194:195], v[66:67]
    v_pk_mul_f32 v[196:197], v[196:197], v[68:69]
    v_pk_mul_f32 v[198:199], v[198:199], v[70:71]
    v_cvt_pk_bf16_f32 v80, v192, v193
    v_cvt_pk_bf16_f32 v81, v194, v195
    v_cvt_pk_bf16_f32 v82, v196, v197
    v_cvt_pk_bf16_f32 v83, v198, v199
    buffer_store_dwordx4 v[80:83], v126, s[24:27], s57 offen sc1
    s_waitcnt lgkmcnt(0)
    s_barrier
    ds_read_b32 v110, v113 offset:128
    v_pk_mul_f32 v[208:209], v[208:209], v[124:125] op_sel_hi:[1,0]
    v_pk_mul_f32 v[210:211], v[210:211], v[124:125] op_sel_hi:[1,0]
    v_pk_mul_f32 v[212:213], v[212:213], v[124:125] op_sel_hi:[1,0]
    v_pk_mul_f32 v[214:215], v[214:215], v[124:125] op_sel_hi:[1,0]
    v_pk_mul_f32 v[72:73], v[208:209], v[208:209]
    v_pk_mul_f32 v[74:75], v[210:211], v[210:211]
    v_pk_mul_f32 v[76:77], v[212:213], v[212:213]
    v_pk_mul_f32 v[78:79], v[214:215], v[214:215]
    v_pk_fma_f32 v[72:73], v[72:73], v[4:5], v[4:5] op_sel:[0,1,0] op_sel_hi:[1,1,0]
    v_pk_fma_f32 v[74:75], v[74:75], v[4:5], v[4:5] op_sel:[0,1,0] op_sel_hi:[1,1,0]
    v_pk_fma_f32 v[76:77], v[76:77], v[4:5], v[4:5] op_sel:[0,1,0] op_sel_hi:[1,1,0]
    v_pk_fma_f32 v[78:79], v[78:79], v[4:5], v[4:5] op_sel:[0,1,0] op_sel_hi:[1,1,0]
    v_pk_mul_f32 v[72:73], v[72:73], v[208:209]
    v_pk_mul_f32 v[74:75], v[74:75], v[210:211]
    v_pk_mul_f32 v[76:77], v[76:77], v[212:213]
    v_pk_mul_f32 v[78:79], v[78:79], v[214:215]
    v_exp_f32 v72, v72
    v_pk_mul_f32 v[208:209], v[208:209], v[216:217]
    v_exp_f32 v73, v73
    v_exp_f32 v74, v74
    v_pk_mul_f32 v[210:211], v[210:211], v[218:219]
    v_exp_f32 v75, v75
    v_exp_f32 v76, v76
    v_pk_mul_f32 v[212:213], v[212:213], v[220:221]
    v_exp_f32 v77, v77
    v_exp_f32 v78, v78
    v_pk_mul_f32 v[214:215], v[214:215], v[222:223]
    v_exp_f32 v79, v79
    v_pk_fma_f32 v[72:73], v[72:73], v[124:125], v[124:125] op_sel:[0,1,1] op_sel_hi:[1,1,1]
    v_pk_fma_f32 v[74:75], v[74:75], v[124:125], v[124:125] op_sel:[0,1,1] op_sel_hi:[1,1,1]
    v_pk_fma_f32 v[76:77], v[76:77], v[124:125], v[124:125] op_sel:[0,1,1] op_sel_hi:[1,1,1]
    v_pk_fma_f32 v[78:79], v[78:79], v[124:125], v[124:125] op_sel:[0,1,1] op_sel_hi:[1,1,1]
    v_rcp_f32 v72, v72
    v_rcp_f32 v73, v73
    v_rcp_f32 v74, v74
    v_rcp_f32 v75, v75
    v_rcp_f32 v76, v76
    v_rcp_f32 v77, v77
    v_rcp_f32 v78, v78
    v_rcp_f32 v79, v79
    v_pk_mul_f32 v[208:209], v[208:209], v[72:73]
    v_pk_mul_f32 v[210:211], v[210:211], v[74:75]
    v_pk_mul_f32 v[212:213], v[212:213], v[76:77]
    v_pk_mul_f32 v[214:215], v[214:215], v[78:79]
    v_cvt_pk_bf16_f32 v84, v208, v209
    v_cvt_pk_bf16_f32 v85, v210, v211
    v_cvt_pk_bf16_f32 v86, v212, v213
    v_cvt_pk_bf16_f32 v87, v214, v215
    buffer_store_dwordx4 v[84:87], v126, s[24:27], s59 offen sc1
    s_waitcnt lgkmcnt(0)
    v_and_b32 v100, 0xffff0000, v110
    v_sub_f32 v110, v110, v100
    v_and_b32 v101, 0xffff0000, v110
    v_sub_f32 v110, v110, v101
    v_lshrrev_b32 v100, 16, v100
    v_or_b32 v100, v100, v101
    v_lshrrev_b32 v101, 16, v110
    s_nop 1
    v_mfma_f32_32x32x16_bf16 v[224:239], v[100:103], v[88:91], v[224:239]
    v_mfma_f32_32x32x16_bf16 v[240:255], v[100:103], v[92:95], v[240:255]
    s_nop 10
    v_pk_mul_f32 v[224:225], v[224:225], v[6:7] op_sel_hi:[1,0]
    v_pk_mul_f32 v[226:227], v[226:227], v[6:7] op_sel_hi:[1,0]
    v_pk_mul_f32 v[228:229], v[228:229], v[6:7] op_sel_hi:[1,0]
    v_pk_mul_f32 v[230:231], v[230:231], v[6:7] op_sel_hi:[1,0]
    v_pk_mul_f32 v[64:65], v[224:225], v[224:225]
    v_pk_mul_f32 v[66:67], v[226:227], v[226:227]
    v_pk_mul_f32 v[68:69], v[228:229], v[228:229]
    v_pk_mul_f32 v[70:71], v[230:231], v[230:231]
    v_pk_fma_f32 v[64:65], v[64:65], v[4:5], v[4:5] op_sel:[0,1,0] op_sel_hi:[1,1,0]
    v_pk_fma_f32 v[66:67], v[66:67], v[4:5], v[4:5] op_sel:[0,1,0] op_sel_hi:[1,1,0]
    v_pk_fma_f32 v[68:69], v[68:69], v[4:5], v[4:5] op_sel:[0,1,0] op_sel_hi:[1,1,0]
    v_pk_fma_f32 v[70:71], v[70:71], v[4:5], v[4:5] op_sel:[0,1,0] op_sel_hi:[1,1,0]
    v_pk_mul_f32 v[64:65], v[64:65], v[224:225]
    v_pk_mul_f32 v[66:67], v[66:67], v[226:227]
    v_pk_mul_f32 v[68:69], v[68:69], v[228:229]
    v_pk_mul_f32 v[70:71], v[70:71], v[230:231]
    v_exp_f32 v64, v64
    v_pk_mul_f32 v[224:225], v[224:225], v[232:233]
    v_exp_f32 v65, v65
    v_exp_f32 v66, v66
    v_pk_mul_f32 v[226:227], v[226:227], v[234:235]
    v_exp_f32 v67, v67
    v_exp_f32 v68, v68
    v_pk_mul_f32 v[228:229], v[228:229], v[236:237]
    v_exp_f32 v69, v69
    v_exp_f32 v70, v70
    v_pk_mul_f32 v[230:231], v[230:231], v[238:239]
    v_exp_f32 v71, v71
    v_pk_fma_f32 v[64:65], v[64:65], v[6:7], v[6:7] op_sel:[0,1,1] op_sel_hi:[1,1,1]
    v_pk_fma_f32 v[66:67], v[66:67], v[6:7], v[6:7] op_sel:[0,1,1] op_sel_hi:[1,1,1]
    v_pk_fma_f32 v[68:69], v[68:69], v[6:7], v[6:7] op_sel:[0,1,1] op_sel_hi:[1,1,1]
    v_pk_fma_f32 v[70:71], v[70:71], v[6:7], v[6:7] op_sel:[0,1,1] op_sel_hi:[1,1,1]
    v_rcp_f32 v64, v64
    v_rcp_f32 v65, v65
    v_rcp_f32 v66, v66
    v_rcp_f32 v67, v67
    v_rcp_f32 v68, v68
    v_rcp_f32 v69, v69
    v_rcp_f32 v70, v70
    v_rcp_f32 v71, v71
    v_pk_mul_f32 v[224:225], v[224:225], v[64:65]
    v_pk_mul_f32 v[226:227], v[226:227], v[66:67]
    v_pk_mul_f32 v[228:229], v[228:229], v[68:69]
    v_pk_mul_f32 v[230:231], v[230:231], v[70:71]
    v_cvt_pk_bf16_f32 v80, v224, v225
    v_cvt_pk_bf16_f32 v81, v226, v227
    v_cvt_pk_bf16_f32 v82, v228, v229
    v_cvt_pk_bf16_f32 v83, v230, v231
    buffer_store_dwordx4 v[80:83], v127, s[24:27], s57 offen sc1
    v_pk_mul_f32 v[240:241], v[240:241], v[124:125] op_sel_hi:[1,0]
    v_pk_mul_f32 v[242:243], v[242:243], v[124:125] op_sel_hi:[1,0]
    v_pk_mul_f32 v[244:245], v[244:245], v[124:125] op_sel_hi:[1,0]
    v_pk_mul_f32 v[246:247], v[246:247], v[124:125] op_sel_hi:[1,0]
    v_pk_mul_f32 v[72:73], v[240:241], v[240:241]
    v_pk_mul_f32 v[74:75], v[242:243], v[242:243]
    v_pk_mul_f32 v[76:77], v[244:245], v[244:245]
    v_pk_mul_f32 v[78:79], v[246:247], v[246:247]
    v_pk_fma_f32 v[72:73], v[72:73], v[4:5], v[4:5] op_sel:[0,1,0] op_sel_hi:[1,1,0]
    v_pk_fma_f32 v[74:75], v[74:75], v[4:5], v[4:5] op_sel:[0,1,0] op_sel_hi:[1,1,0]
    v_pk_fma_f32 v[76:77], v[76:77], v[4:5], v[4:5] op_sel:[0,1,0] op_sel_hi:[1,1,0]
    v_pk_fma_f32 v[78:79], v[78:79], v[4:5], v[4:5] op_sel:[0,1,0] op_sel_hi:[1,1,0]
    v_pk_mul_f32 v[72:73], v[72:73], v[240:241]
    v_pk_mul_f32 v[74:75], v[74:75], v[242:243]
    v_pk_mul_f32 v[76:77], v[76:77], v[244:245]
    v_pk_mul_f32 v[78:79], v[78:79], v[246:247]
    v_exp_f32 v72, v72
    v_pk_mul_f32 v[240:241], v[240:241], v[248:249]
    v_exp_f32 v73, v73
    v_exp_f32 v74, v74
    v_pk_mul_f32 v[242:243], v[242:243], v[250:251]
    v_exp_f32 v75, v75
    v_exp_f32 v76, v76
    v_pk_mul_f32 v[244:245], v[244:245], v[252:253]
    v_exp_f32 v77, v77
    v_exp_f32 v78, v78
    v_pk_mul_f32 v[246:247], v[246:247], v[254:255]
    v_exp_f32 v79, v79
    v_pk_fma_f32 v[72:73], v[72:73], v[124:125], v[124:125] op_sel:[0,1,1] op_sel_hi:[1,1,1]
    v_pk_fma_f32 v[74:75], v[74:75], v[124:125], v[124:125] op_sel:[0,1,1] op_sel_hi:[1,1,1]
    v_pk_fma_f32 v[76:77], v[76:77], v[124:125], v[124:125] op_sel:[0,1,1] op_sel_hi:[1,1,1]
    v_pk_fma_f32 v[78:79], v[78:79], v[124:125], v[124:125] op_sel:[0,1,1] op_sel_hi:[1,1,1]
    v_rcp_f32 v72, v72
    v_rcp_f32 v73, v73
    v_rcp_f32 v74, v74
    v_rcp_f32 v75, v75
    v_rcp_f32 v76, v76
    v_rcp_f32 v77, v77
    v_rcp_f32 v78, v78
    v_rcp_f32 v79, v79
    v_pk_mul_f32 v[240:241], v[240:241], v[72:73]
    v_pk_mul_f32 v[242:243], v[242:243], v[74:75]
    v_pk_mul_f32 v[244:245], v[244:245], v[76:77]
    v_pk_mul_f32 v[246:247], v[246:247], v[78:79]
    v_cvt_pk_bf16_f32 v84, v240, v241
    v_cvt_pk_bf16_f32 v85, v242, v243
    v_cvt_pk_bf16_f32 v86, v244, v245
    v_cvt_pk_bf16_f32 v87, v246, v247
    buffer_store_dwordx4 v[84:87], v127, s[24:27], s59 offen sc1
    s_waitcnt vmcnt(0)
    s_barrier
    s_add_u32 s100, s22, 2
    v_mov_b32 v64, s100
    s_cmp_eq_u32 s18, 0
    s_cselect_b32 s100, 0, 0x7ffffff0
    v_mov_b32 v65, s100
    s_lshl_b32 s100, s2, 7
    s_mov_b64 exec, 1
    buffer_store_dword v64, v65, s[24:27], s100 offen sc1
    s_mov_b64 exec, -1
    v_mov_b32 v12, v44
    v_mov_b32 v13, v45
    v_mov_b32 v14, v46
    v_mov_b32 v15, v47
    v_and_b32 v248, 31, v1
    v_and_b32 v10, 15, v1
    s_add_u32 m0, s53, 65536
    s_add_u32 s55, s48, 229376
    buffer_load_dwordx4 v12, s[40:43], s55 offen offset:0 lds
    v_min_u32 v10, 13, v10
    v_cmp_lt_u32 vcc, 6, v10
    v_subrev_u32 v3, 7, v10
    s_lshr_b32 s58, s49, 2
    v_cndmask_b32 v10, v10, v3, vcc
    v_cndmask_b32 v3, 0, 4, vcc
    v_lshl_add_u32 v10, v10, 5, v3
    s_and_b32 s59, s58, 3
    s_lshl_b32 s59, s59, 3
    s_lshr_b32 s58, s58, 2
    s_add_u32 s58, s58, s59
    v_add_lshl_u32 v10, v10, s58, 7
    buffer_load_dwordx4 v13, s[40:43], s55 offen offset:1024 lds
    v_lshrrev_b32 v249, 5, v1
    v_add_u32 v9, 224, v248
    v_lshlrev_b32 v9, 7, v9
    v_bfe_u32 v96, v1, 2, 2
    v_lshrrev_b32 v97, 5, v1
    v_lshl_add_u32 v97, v97, 3, v96
    v_lshl_add_u32 v97, v97, 7, s53
    v_bfe_u32 v98, v1, 4, 1
    v_lshl_add_u32 v97, v98, 5, v97
    v_and_b32 v98, 3, v1
    v_lshl_add_u32 v97, v98, 3, v97
    v_and_b32 v96, 2, v96
    buffer_load_dwordx4 v14, s[40:43], s55 offen offset:2048 lds
    v_lshlrev_b32 v96, 5, v96
    v_xor_b32 v250, v97, v96
    v_xor_b32 v251, 64, v250
    v_add_u32 v252, 0x10000, v250
    v_add_u32 v254, 0x20000, v250
    v_add_u32 v253, 0x10000, v251
    v_add_u32 v255, 0x20000, v251
    ds_read_b64_tr_b16 a[64:65], v252 offset:32768
    ds_read_b64_tr_b16 a[66:67], v252 offset:33280
    ds_read_b64_tr_b16 a[68:69], v253 offset:32768
    ds_read_b64_tr_b16 a[70:71], v253 offset:33280
    ds_read_b64_tr_b16 a[72:73], v252 offset:34816
    buffer_load_dwordx4 v15, s[40:43], s55 offen offset:3072 lds
    ds_read_b64_tr_b16 a[74:75], v252 offset:35328
    ds_read_b64_tr_b16 a[76:77], v253 offset:34816
    ds_read_b64_tr_b16 a[78:79], v253 offset:35328
    ds_read_b64_tr_b16 a[80:81], v252 offset:49152
    ds_read_b64_tr_b16 a[82:83], v252 offset:49664
    ds_read_b64_tr_b16 a[84:85], v253 offset:49152
    ds_read_b64_tr_b16 a[86:87], v253 offset:49664
    ds_read_b64_tr_b16 a[88:89], v252 offset:51200
    ds_read_b64_tr_b16 a[90:91], v252 offset:51712
    ds_read_b64_tr_b16 a[92:93], v253 offset:51200
    s_waitcnt lgkmcnt(14)
    ds_read_b64_tr_b16 a[94:95], v253 offset:51712
    s_waitcnt lgkmcnt(14)
    ds_read_b64_tr_b16 a[96:97], v254 offset:0
    s_add_u32 m0, s53, 81920
    s_add_u32 s55, s48, 262144
    buffer_load_dwordx4 v12, s[40:43], s55 offen offset:0 lds
    s_waitcnt lgkmcnt(14)
    ds_read_b64_tr_b16 a[98:99], v254 offset:512
    s_waitcnt lgkmcnt(14)
    ds_read_b64_tr_b16 a[100:101], v255 offset:0
    s_waitcnt lgkmcnt(14)
    ds_read_b64_tr_b16 a[102:103], v255 offset:512
    s_waitcnt lgkmcnt(14)
    ds_read_b64_tr_b16 a[104:105], v254 offset:2048
    s_waitcnt lgkmcnt(14)
    ds_read_b64_tr_b16 a[106:107], v254 offset:2560
    s_waitcnt lgkmcnt(14)
    ds_read_b64_tr_b16 a[108:109], v255 offset:2048
    s_waitcnt lgkmcnt(14)
    ds_read_b64_tr_b16 a[110:111], v255 offset:2560
    s_waitcnt lgkmcnt(14)
    ds_read_b64_tr_b16 a[112:113], v250 offset:0
    s_waitcnt lgkmcnt(14)
    ds_read_b64_tr_b16 a[114:115], v250 offset:512
    s_waitcnt lgkmcnt(14)
    ds_read_b64_tr_b16 a[116:117], v251 offset:0
    s_waitcnt lgkmcnt(14)
    ds_read_b64_tr_b16 a[118:119], v251 offset:512
    s_waitcnt lgkmcnt(14)
    ds_read_b64_tr_b16 a[120:121], v250 offset:2048
    buffer_load_dwordx4 v13, s[40:43], s55 offen offset:1024 lds
    s_waitcnt lgkmcnt(14)
    ds_read_b64_tr_b16 a[122:123], v250 offset:2560
    s_waitcnt lgkmcnt(14)
    ds_read_b64_tr_b16 a[124:125], v251 offset:2048
    s_waitcnt lgkmcnt(14)
    ds_read_b64_tr_b16 a[126:127], v251 offset:2560
    v_add_u32 v11, 114688, v2
    s_mul_i32 s56, s49, 112
    s_mul_i32 s57, s18, 28
    s_add_u32 s56, s56, s57
    s_lshl_b32 s56, s56, 10
    s_add_u32 s56, s56, 6291456
    buffer_load_dwordx4 v14, s[40:43], s55 offen offset:2048 lds
    buffer_load_dwordx4 v15, s[40:43], s55 offen offset:3072 lds
    s_add_u32 m0, s53, 147456
    s_add_u32 s55, s48, 294912
    buffer_load_dwordx4 v12, s[40:43], s55 offen offset:0 lds
    buffer_load_dwordx4 v13, s[40:43], s55 offen offset:1024 lds
    buffer_load_dwordx4 v14, s[40:43], s55 offen offset:2048 lds
    buffer_load_dwordx4 v15, s[40:43], s55 offen offset:3072 lds
    s_waitcnt lgkmcnt(0)
    buffer_load_dword v3, v10, s[24:27], 0 offen sc1
    s_add_u32 m0, s53, 98304
    s_add_u32 s55, s48, 327680
    buffer_load_dwordx4 v12, s[40:43], s55 offen offset:0 lds
    buffer_load_dwordx4 v13, s[40:43], s55 offen offset:1024 lds
    buffer_load_dwordx4 v14, s[40:43], s55 offen offset:2048 lds
    buffer_load_dwordx4 v15, s[40:43], s55 offen offset:3072 lds
    s_add_u32 m0, s53, 114688
    s_add_u32 s55, s48, 360448
    buffer_load_dwordx4 v12, s[40:43], s55 offen offset:0 lds
    buffer_load_dwordx4 v13, s[40:43], s55 offen offset:1024 lds
    buffer_load_dwordx4 v14, s[40:43], s55 offen offset:2048 lds
    buffer_load_dwordx4 v15, s[40:43], s55 offen offset:3072 lds
    s_waitcnt vmcnt(8)
    v_subrev_u32 v3, s22, v3
    v_subrev_u32 v3, 2, v3
    v_cmp_lt_u32 vcc, 0, v3
    s_nop 1
    s_cbranch_vccnz G_AW2_SPIN
G_AW2_OK:
    s_add_u32 s59, s56, 0
    buffer_load_dwordx4 a[128:131], v2, s[24:27], s59 offen sc1
    buffer_load_dwordx4 a[132:135], v11, s[24:27], s59 offen sc1
    s_add_u32 s59, s56, 1024
    buffer_load_dwordx4 a[136:139], v2, s[24:27], s59 offen sc1
    buffer_load_dwordx4 a[140:143], v11, s[24:27], s59 offen sc1
    s_add_u32 s59, s56, 2048
    buffer_load_dwordx4 a[144:147], v2, s[24:27], s59 offen sc1
    buffer_load_dwordx4 a[148:151], v11, s[24:27], s59 offen sc1
    s_add_u32 s59, s56, 3072
    buffer_load_dwordx4 a[152:155], v2, s[24:27], s59 offen sc1
    buffer_load_dwordx4 a[156:159], v11, s[24:27], s59 offen sc1
    s_add_u32 s59, s56, 4096
    buffer_load_dwordx4 a[160:163], v2, s[24:27], s59 offen sc1
    buffer_load_dwordx4 a[164:167], v11, s[24:27], s59 offen sc1
    s_add_u32 s59, s56, 5120
    buffer_load_dwordx4 a[168:171], v2, s[24:27], s59 offen sc1
    buffer_load_dwordx4 a[172:175], v11, s[24:27], s59 offen sc1
    s_add_u32 s59, s56, 6144
    buffer_load_dwordx4 a[176:179], v2, s[24:27], s59 offen sc1
    buffer_load_dwordx4 a[180:183], v11, s[24:27], s59 offen sc1
    s_lshl_b32 s57, s49, 15
    s_lshl_b32 s58, s18, 13
    s_add_u32 s57, s57, s58
    s_add_u32 s57, s57, 13631488
    v_lshrrev_b32 v6, 3, v0
    v_and_b32 v7, 7, v0
    v_lshlrev_b32 v8, 16, v6
    v_lshl_add_u32 v8, v7, 4, v8
    s_lshl_b32 s54, s49, 10
    s_lshl_b32 s58, s50, 7
    s_add_u32 s54, s54, s58
    v_and_b32 v128, 31, v1
    s_lshl_b32 s62, s50, 6
    v_add_u32 v128, s62, v128
    v_lshrrev_b32 v129, 5, v1
    s_lshl_b32 s62, s18, 6
    v_lshl_add_u32 v129, v129, 2, s62
    v_add_u32 v129, 1, v129
    s_movk_i32 s62, 0xc5
    v_cmp_eq_u32 s[60:61], s62, v129
    v_cvt_f32_u32 v129, v129
    v_cvt_f32_u32 v130, v128
    v_mul_f32 v130, 0x3b000000, v130
    v_mul_f32 v131, 0x41000000, v130
    v_sub_f32 v132, 0x3e800000, v131
    v_sin_f32 v132, v132
    v_fma_f32 v113, -v129, v130, 0
    v_sub_f32 v115, v113, v130
    v_sub_f32 v117, v115, v130
    v_sub_f32 v119, v117, v130
    v_add_f32 v112, 0x3e800000, v113
    v_add_f32 v114, 0x3e800000, v115
    v_add_f32 v116, 0x3e800000, v117
    v_add_f32 v118, 0x3e800000, v119
    v_sub_f32 v120, v112, v131
    v_sub_f32 v121, v113, v131
    v_sub_f32 v122, v114, v131
    v_sub_f32 v123, v115, v131
    v_sub_f32 v124, v116, v131
    v_sub_f32 v125, v117, v131
    v_sub_f32 v126, v118, v131
    v_sub_f32 v127, v119, v131
    v_add_f32 v132, v132, v132
    v_sin_f32 v112, v112
    v_sin_f32 v113, v113
    v_sin_f32 v114, v114
    v_sin_f32 v115, v115
    v_sin_f32 v116, v116
    v_sin_f32 v117, v117
    v_sin_f32 v118, v118
    v_sin_f32 v119, v119
    v_sin_f32 v120, v120
    v_sin_f32 v121, v121
    v_sin_f32 v122, v122
    v_sin_f32 v123, v123
    v_sin_f32 v124, v124
    v_sin_f32 v125, v125
    v_sin_f32 v126, v126
    v_sin_f32 v127, v127
    v_cvt_pk_bf16_f32 v16, v112, v113
    v_cvt_pk_bf16_f32 v17, v114, v115
    v_cvt_pk_bf16_f32 v18, v116, v117
    v_cvt_pk_bf16_f32 v19, v118, v119
    v_cvt_pk_bf16_f32 v20, v120, v121
    v_cvt_pk_bf16_f32 v21, v122, v123
    v_cvt_pk_bf16_f32 v22, v124, v125
    v_cvt_pk_bf16_f32 v23, v126, v127
    v_fma_f32 v112, v132, v120, -v112
    v_fma_f32 v113, v132, v121, -v113
    v_fma_f32 v114, v132, v122, -v114
    v_fma_f32 v115, v132, v123, -v115
    v_fma_f32 v116, v132, v124, -v116
    v_fma_f32 v117, v132, v125, -v117
    v_fma_f32 v118, v132, v126, -v118
    v_fma_f32 v119, v132, v127, -v119
    v_cvt_pk_bf16_f32 v24, v112, v113
    v_cvt_pk_bf16_f32 v25, v114, v115
    v_cvt_pk_bf16_f32 v26, v116, v117
    v_cvt_pk_bf16_f32 v27, v118, v119
    v_fma_f32 v120, v132, v112, -v120
    v_fma_f32 v121, v132, v113, -v121
    v_fma_f32 v122, v132, v114, -v122
    v_fma_f32 v123, v132, v115, -v123
    v_fma_f32 v124, v132, v116, -v124
    v_fma_f32 v125, v132, v117, -v125
    v_fma_f32 v126, v132, v118, -v126
    v_fma_f32 v127, v132, v119, -v127
    v_cvt_pk_bf16_f32 v28, v120, v121
    v_cvt_pk_bf16_f32 v29, v122, v123
    v_cvt_pk_bf16_f32 v30, v124, v125
    v_cvt_pk_bf16_f32 v31, v126, v127
    v_fma_f32 v112, v132, v120, -v112
    v_fma_f32 v113, v132, v121, -v113
    v_fma_f32 v114, v132, v122, -v114
    v_fma_f32 v115, v132, v123, -v115
    v_fma_f32 v116, v132, v124, -v116
    v_fma_f32 v117, v132, v125, -v117
    v_fma_f32 v118, v132, v126, -v118
    v_fma_f32 v119, v132, v127, -v119
    v_cvt_pk_bf16_f32 v32, v112, v113
    v_cvt_pk_bf16_f32 v33, v114, v115
    v_cvt_pk_bf16_f32 v34, v116, v117
    v_cvt_pk_bf16_f32 v35, v118, v119
    v_fma_f32 v120, v132, v112, -v120
    v_fma_f32 v121, v132, v113, -v121
    v_fma_f32 v122, v132, v114, -v122
    v_fma_f32 v123, v132, v115, -v123
    v_fma_f32 v124, v132, v116, -v124
    v_fma_f32 v125, v132, v117, -v125
    v_fma_f32 v126, v132, v118, -v126
    v_fma_f32 v127, v132, v119, -v127
    v_cvt_pk_bf16_f32 v36, v120, v121
    v_cvt_pk_bf16_f32 v37, v122, v123
    v_cvt_pk_bf16_f32 v38, v124, v125
    v_cvt_pk_bf16_f32 v39, v126, v127
    v_fma_f32 v112, v132, v120, -v112
    v_fma_f32 v113, v132, v121, -v113
    v_fma_f32 v114, v132, v122, -v114
    v_fma_f32 v115, v132, v123, -v115
    v_fma_f32 v116, v132, v124, -v116
    s_waitcnt vmcnt(13)
    v_mfma_f32_32x32x16_bf16 v[176:191], a[64:67], a[128:131], 0
    v_mfma_f32_32x32x16_bf16 v[192:207], a[68:71], a[128:131], 0
    s_add_u32 s59, s56, 7168
    buffer_load_dwordx4 a[184:187], v2, s[24:27], s59 offen sc1
    v_fma_f32 v117, v132, v125, -v117
    s_waitcnt vmcnt(13)
    v_mfma_f32_32x32x16_bf16 v[208:223], a[64:67], a[132:135], 0
    buffer_load_dwordx4 a[188:191], v11, s[24:27], s59 offen sc1
    v_fma_f32 v118, v132, v126, -v118
    v_mfma_f32_32x32x16_bf16 v[224:239], a[68:71], a[132:135], 0
    s_add_u32 s59, s56, 8192
    buffer_load_dwordx4 a[192:195], v2, s[24:27], s59 offen sc1
    v_fma_f32 v119, v132, v127, -v119
    s_waitcnt vmcnt(14)
    v_mfma_f32_32x32x16_bf16 v[176:191], a[72:75], a[136:139], v[176:191]
    v_mfma_f32_32x32x16_bf16 v[192:207], a[76:79], a[136:139], v[192:207]
    buffer_load_dwordx4 a[196:199], v11, s[24:27], s59 offen sc1
    v_cvt_pk_bf16_f32 v40, v112, v113
    s_waitcnt vmcnt(14)
    v_mfma_f32_32x32x16_bf16 v[208:223], a[72:75], a[140:143], v[208:223]
    buffer_load_dword v4, v9, s[24:27], 0 offen sc1
    v_cvt_pk_bf16_f32 v41, v114, v115
    v_mfma_f32_32x32x16_bf16 v[224:239], a[76:79], a[140:143], v[224:239]
    s_add_u32 s59, s56, 9216
    buffer_load_dwordx4 a[200:203], v2, s[24:27], s59 offen sc1
    v_cvt_pk_bf16_f32 v42, v116, v117
    s_waitcnt vmcnt(15)
    v_mfma_f32_32x32x16_bf16 v[176:191], a[80:83], a[144:147], v[176:191]
    v_mfma_f32_32x32x16_bf16 v[192:207], a[84:87], a[144:147], v[192:207]
    buffer_load_dwordx4 a[204:207], v11, s[24:27], s59 offen sc1
    v_cvt_pk_bf16_f32 v43, v118, v119
    s_waitcnt vmcnt(15)
    v_mfma_f32_32x32x16_bf16 v[208:223], a[80:83], a[148:151], v[208:223]
    s_add_u32 s59, s56, 10240
    buffer_load_dwordx4 a[208:211], v2, s[24:27], s59 offen sc1
    v_fma_f32 v120, v132, v112, -v120
    v_mfma_f32_32x32x16_bf16 v[224:239], a[84:87], a[148:151], v[224:239]
    buffer_load_dwordx4 a[212:215], v11, s[24:27], s59 offen sc1
    v_fma_f32 v121, v132, v113, -v121
    s_waitcnt vmcnt(16)
    v_mfma_f32_32x32x16_bf16 v[176:191], a[88:91], a[152:155], v[176:191]
    v_mfma_f32_32x32x16_bf16 v[192:207], a[92:95], a[152:155], v[192:207]
    s_add_u32 s59, s56, 11264
    buffer_load_dwordx4 a[216:219], v2, s[24:27], s59 offen sc1
    v_fma_f32 v122, v132, v114, -v122
    s_waitcnt vmcnt(16)
    v_mfma_f32_32x32x16_bf16 v[208:223], a[88:91], a[156:159], v[208:223]
    buffer_load_dwordx4 a[220:223], v11, s[24:27], s59 offen sc1
    v_fma_f32 v123, v132, v115, -v123
    v_mfma_f32_32x32x16_bf16 v[224:239], a[92:95], a[156:159], v[224:239]
    s_add_u32 s59, s56, 12288
    buffer_load_dwordx4 a[224:227], v2, s[24:27], s59 offen sc1
    v_fma_f32 v124, v132, v116, -v124
    s_waitcnt vmcnt(17)
    v_mfma_f32_32x32x16_bf16 v[176:191], a[96:99], a[160:163], v[176:191]
    v_mfma_f32_32x32x16_bf16 v[192:207], a[100:103], a[160:163], v[192:207]
    buffer_load_dwordx4 a[228:231], v11, s[24:27], s59 offen sc1
    v_fma_f32 v125, v132, v117, -v125
    s_waitcnt vmcnt(17)
    v_mfma_f32_32x32x16_bf16 v[208:223], a[96:99], a[164:167], v[208:223]
    v_fma_f32 v126, v132, v118, -v126
    v_fma_f32 v127, v132, v119, -v127
    v_cvt_pk_bf16_f32 v44, v120, v121
    v_cvt_pk_bf16_f32 v45, v122, v123
    v_cvt_pk_bf16_f32 v46, v124, v125
    v_mfma_f32_32x32x16_bf16 v[224:239], a[100:103], a[164:167], v[224:239]
    s_add_u32 s59, s56, 13312
    buffer_load_dwordx4 a[232:235], v2, s[24:27], s59 offen sc1
    v_cvt_pk_bf16_f32 v47, v126, v127
    s_waitcnt vmcnt(17)
    v_mfma_f32_32x32x16_bf16 v[176:191], a[104:107], a[168:171], v[176:191]
    v_mfma_f32_32x32x16_bf16 v[192:207], a[108:111], a[168:171], v[192:207]
    buffer_load_dwordx4 a[236:239], v11, s[24:27], s59 offen sc1
    v_and_b32 v134, 1, v128
    s_waitcnt vmcnt(17)
    v_mfma_f32_32x32x16_bf16 v[208:223], a[104:107], a[172:175], v[208:223]
    v_lshlrev_b32 v134, 15, v134
    v_or_b32 v134, 16128, v134
    v_cndmask_b32 v47, v47, v134, s[60:61]
    v_add_u32 v128, 32, v128
    v_cvt_f32_u32 v130, v128
    v_mfma_f32_32x32x16_bf16 v[224:239], a[108:111], a[172:175], v[224:239]
    s_add_u32 s59, s56, 14336
    buffer_load_dwordx4 a[240:243], v2, s[24:27], s59 offen sc1
    v_mul_f32 v130, 0x3b000000, v130
    s_waitcnt vmcnt(17)
    v_mfma_f32_32x32x16_bf16 v[176:191], a[112:115], a[176:179], v[176:191]
    v_mfma_f32_32x32x16_bf16 v[192:207], a[116:119], a[176:179], v[192:207]
    buffer_load_dwordx4 a[244:247], v11, s[24:27], s59 offen sc1
    v_mul_f32 v131, 0x41000000, v130
    s_waitcnt vmcnt(17)
    v_mfma_f32_32x32x16_bf16 v[208:223], a[112:115], a[180:183], v[208:223]
    v_sub_f32 v132, 0x3e800000, v131
    v_sin_f32 v132, v132
    v_fma_f32 v113, -v129, v130, 0
    v_sub_f32 v115, v113, v130
    v_mfma_f32_32x32x16_bf16 v[224:239], a[116:119], a[180:183], v[224:239]
    s_add_u32 s59, s56, 15360
    buffer_load_dwordx4 a[248:251], v2, s[24:27], s59 offen sc1
    v_sub_f32 v117, v115, v130
    s_waitcnt vmcnt(17)
    v_mfma_f32_32x32x16_bf16 v[176:191], a[120:123], a[184:187], v[176:191]
    ds_read_b64_tr_b16 v[80:81], v250 offset:16384
    ds_read_b64_tr_b16 v[82:83], v250 offset:16896
    ds_read_b64_tr_b16 v[84:85], v251 offset:16384
    ds_read_b64_tr_b16 v[86:87], v251 offset:16896
    v_mfma_f32_32x32x16_bf16 v[192:207], a[124:127], a[184:187], v[192:207]
    buffer_load_dwordx4 a[252:255], v11, s[24:27], s59 offen sc1
    v_sub_f32 v119, v117, v130
    s_waitcnt vmcnt(17)
    v_mfma_f32_32x32x16_bf16 v[208:223], a[120:123], a[188:191], v[208:223]
    v_add_f32 v112, 0x3e800000, v113
    v_add_f32 v114, 0x3e800000, v115
    v_add_f32 v116, 0x3e800000, v117
    v_add_f32 v118, 0x3e800000, v119
    v_sub_f32 v120, v112, v131
    v_mfma_f32_32x32x16_bf16 v[224:239], a[124:127], a[188:191], v[224:239]
    s_add_u32 s59, s56, 16384
    buffer_load_dwordx4 a[128:131], v2, s[24:27], s59 offen sc1
    v_sub_f32 v121, v113, v131
    s_waitcnt vmcnt(17) lgkmcnt(2)
    v_mfma_f32_32x32x16_bf16 v[176:191], v[80:83], a[192:195], v[176:191]
    ds_read_b64_tr_b16 v[88:89], v250 offset:18432
    ds_read_b64_tr_b16 v[90:91], v250 offset:18944
    ds_read_b64_tr_b16 v[92:93], v251 offset:18432
    ds_read_b64_tr_b16 v[94:95], v251 offset:18944
    s_waitcnt lgkmcnt(4)
    v_mfma_f32_32x32x16_bf16 v[192:207], v[84:87], a[192:195], v[192:207]
    buffer_load_dwordx4 a[132:135], v11, s[24:27], s59 offen sc1
    v_sub_f32 v122, v114, v131
    s_waitcnt vmcnt(17)
    v_mfma_f32_32x32x16_bf16 v[208:223], v[80:83], a[196:199], v[208:223]
    v_sub_f32 v123, v115, v131
    v_sub_f32 v124, v116, v131
    v_sub_f32 v125, v117, v131
    v_sub_f32 v126, v118, v131
    v_sub_f32 v127, v119, v131
    v_mfma_f32_32x32x16_bf16 v[224:239], v[84:87], a[196:199], v[224:239]
    s_add_u32 s59, s56, 17408
    buffer_load_dwordx4 a[136:139], v2, s[24:27], s59 offen sc1
    v_add_f32 v132, v132, v132
    s_waitcnt vmcnt(16) lgkmcnt(2)
    v_mfma_f32_32x32x16_bf16 v[176:191], v[88:91], a[200:203], v[176:191]
    ds_read_b64_tr_b16 v[80:81], v250 offset:32768
    ds_read_b64_tr_b16 v[82:83], v250 offset:33280
    ds_read_b64_tr_b16 v[84:85], v251 offset:32768
    ds_read_b64_tr_b16 v[86:87], v251 offset:33280
    s_waitcnt lgkmcnt(4)
    v_mfma_f32_32x32x16_bf16 v[192:207], v[92:95], a[200:203], v[192:207]
    buffer_load_dwordx4 a[140:143], v11, s[24:27], s59 offen sc1
    s_waitcnt vmcnt(16)
    v_mfma_f32_32x32x16_bf16 v[208:223], v[88:91], a[204:207], v[208:223]
    v_sin_f32 v112, v112
    v_sin_f32 v113, v113
    v_mfma_f32_32x32x16_bf16 v[224:239], v[92:95], a[204:207], v[224:239]
    v_subrev_u32 v4, s22, v4
    v_subrev_u32 v4, 2, v4
    v_cmp_lt_u32 vcc, 0, v4
    s_nop 1
    s_cbranch_vccnz G_AW3_SPIN
G_AW3_OK:
    s_add_u32 s58, s57, 0
    buffer_load_dwordx4 a[0:3], v2, s[24:27], s58 offen sc1
    s_waitcnt vmcnt(16) lgkmcnt(2)
    v_mfma_f32_32x32x16_bf16 v[176:191], v[80:83], a[208:211], v[176:191]
    ds_read_b64_tr_b16 v[88:89], v250 offset:34816
    ds_read_b64_tr_b16 v[90:91], v250 offset:35328
    ds_read_b64_tr_b16 v[92:93], v251 offset:34816
    ds_read_b64_tr_b16 v[94:95], v251 offset:35328
    s_waitcnt lgkmcnt(4)
    v_mfma_f32_32x32x16_bf16 v[192:207], v[84:87], a[208:211], v[192:207]
    s_add_u32 s58, s57, 32768
    buffer_load_dwordx4 a[4:7], v2, s[24:27], s58 offen sc1
    s_waitcnt vmcnt(16)
    v_mfma_f32_32x32x16_bf16 v[208:223], v[80:83], a[212:215], v[208:223]
    v_sin_f32 v114, v114
    v_sin_f32 v115, v115
    v_mfma_f32_32x32x16_bf16 v[224:239], v[84:87], a[212:215], v[224:239]
    s_add_u32 s58, s57, 1024
    buffer_load_dwordx4 a[8:11], v2, s[24:27], s58 offen sc1
    s_waitcnt vmcnt(16) lgkmcnt(2)
    v_mfma_f32_32x32x16_bf16 v[176:191], v[88:91], a[216:219], v[176:191]
    ds_read_b64_tr_b16 v[80:81], v250 offset:49152
    ds_read_b64_tr_b16 v[82:83], v250 offset:49664
    ds_read_b64_tr_b16 v[84:85], v251 offset:49152
    ds_read_b64_tr_b16 v[86:87], v251 offset:49664
    s_waitcnt lgkmcnt(4)
    v_mfma_f32_32x32x16_bf16 v[192:207], v[92:95], a[216:219], v[192:207]
    s_add_u32 s58, s57, 33792
    buffer_load_dwordx4 a[12:15], v2, s[24:27], s58 offen sc1
    s_waitcnt vmcnt(16)
    v_mfma_f32_32x32x16_bf16 v[208:223], v[88:91], a[220:223], v[208:223]
    v_sin_f32 v116, v116
    v_sin_f32 v117, v117
    v_mfma_f32_32x32x16_bf16 v[224:239], v[92:95], a[220:223], v[224:239]
    s_add_u32 s58, s57, 2048
    buffer_load_dwordx4 a[16:19], v2, s[24:27], s58 offen sc1
    s_waitcnt vmcnt(16) lgkmcnt(2)
    v_mfma_f32_32x32x16_bf16 v[176:191], v[80:83], a[224:227], v[176:191]
    ds_read_b64_tr_b16 v[88:89], v250 offset:51200
    ds_read_b64_tr_b16 v[90:91], v250 offset:51712
    ds_read_b64_tr_b16 v[92:93], v251 offset:51200
    ds_read_b64_tr_b16 v[94:95], v251 offset:51712
    s_waitcnt lgkmcnt(4)
    v_mfma_f32_32x32x16_bf16 v[192:207], v[84:87], a[224:227], v[192:207]
    s_add_u32 s58, s57, 34816
    buffer_load_dwordx4 a[20:23], v2, s[24:27], s58 offen sc1
    s_waitcnt vmcnt(16)
    v_mfma_f32_32x32x16_bf16 v[208:223], v[80:83], a[228:231], v[208:223]
    v_sin_f32 v118, v118
    v_sin_f32 v119, v119
    v_mfma_f32_32x32x16_bf16 v[224:239], v[84:87], a[228:231], v[224:239]
    s_add_u32 s58, s57, 3072
    buffer_load_dwordx4 a[24:27], v2, s[24:27], s58 offen sc1
    s_waitcnt vmcnt(16) lgkmcnt(2)
    v_mfma_f32_32x32x16_bf16 v[176:191], v[88:91], a[232:235], v[176:191]
    ds_read_b64_tr_b16 v[80:81], v252 offset:0
    ds_read_b64_tr_b16 v[82:83], v252 offset:512
    ds_read_b64_tr_b16 v[84:85], v253 offset:0
    ds_read_b64_tr_b16 v[86:87], v253 offset:512
    s_waitcnt lgkmcnt(4)
    v_mfma_f32_32x32x16_bf16 v[192:207], v[92:95], a[232:235], v[192:207]
    s_add_u32 s58, s57, 35840
    buffer_load_dwordx4 a[28:31], v2, s[24:27], s58 offen sc1
    s_waitcnt vmcnt(16)
    v_mfma_f32_32x32x16_bf16 v[208:223], v[88:91], a[236:239], v[208:223]
    v_sin_f32 v120, v120
    v_sin_f32 v121, v121
    v_mfma_f32_32x32x16_bf16 v[224:239], v[92:95], a[236:239], v[224:239]
    s_add_u32 s58, s57, 4096
    buffer_load_dwordx4 a[32:35], v2, s[24:27], s58 offen sc1
    s_waitcnt vmcnt(16) lgkmcnt(2)
    v_mfma_f32_32x32x16_bf16 v[176:191], v[80:83], a[240:243], v[176:191]
    ds_read_b64_tr_b16 v[88:89], v252 offset:2048
    ds_read_b64_tr_b16 v[90:91], v252 offset:2560
    ds_read_b64_tr_b16 v[92:93], v253 offset:2048
    ds_read_b64_tr_b16 v[94:95], v253 offset:2560
    s_waitcnt lgkmcnt(4)
    v_mfma_f32_32x32x16_bf16 v[192:207], v[84:87], a[240:243], v[192:207]
    s_add_u32 s58, s57, 36864
    buffer_load_dwordx4 a[36:39], v2, s[24:27], s58 offen sc1
    s_waitcnt vmcnt(16)
    v_mfma_f32_32x32x16_bf16 v[208:223], v[80:83], a[244:247], v[208:223]
    v_sin_f32 v122, v122
    v_sin_f32 v123, v123
    v_mfma_f32_32x32x16_bf16 v[224:239], v[84:87], a[244:247], v[224:239]
    s_add_u32 s58, s57, 5120
    buffer_load_dwordx4 a[40:43], v2, s[24:27], s58 offen sc1
    s_waitcnt vmcnt(16) lgkmcnt(2)
    v_mfma_f32_32x32x16_bf16 v[176:191], v[88:91], a[248:251], v[176:191]
    ds_read_b64_tr_b16 v[80:81], v252 offset:16384
    ds_read_b64_tr_b16 v[82:83], v252 offset:16896
    ds_read_b64_tr_b16 v[84:85], v253 offset:16384
    ds_read_b64_tr_b16 v[86:87], v253 offset:16896
    s_waitcnt lgkmcnt(4)
    v_mfma_f32_32x32x16_bf16 v[192:207], v[92:95], a[248:251], v[192:207]
    s_add_u32 s58, s57, 37888
    buffer_load_dwordx4 a[44:47], v2, s[24:27], s58 offen sc1
    s_waitcnt vmcnt(16)
    v_mfma_f32_32x32x16_bf16 v[208:223], v[88:91], a[252:255], v[208:223]
    v_sin_f32 v124, v124
    v_sin_f32 v125, v125
    v_mfma_f32_32x32x16_bf16 v[224:239], v[92:95], a[252:255], v[224:239]
    s_add_u32 s58, s57, 6144
    buffer_load_dwordx4 a[48:51], v2, s[24:27], s58 offen sc1
    s_waitcnt vmcnt(16) lgkmcnt(2)
    v_mfma_f32_32x32x16_bf16 v[176:191], v[80:83], a[128:131], v[176:191]
    ds_read_b64_tr_b16 v[88:89], v252 offset:18432
    ds_read_b64_tr_b16 v[90:91], v252 offset:18944
    ds_read_b64_tr_b16 v[92:93], v253 offset:18432
    ds_read_b64_tr_b16 v[94:95], v253 offset:18944
    s_waitcnt lgkmcnt(4)
    v_mfma_f32_32x32x16_bf16 v[192:207], v[84:87], a[128:131], v[192:207]
    s_add_u32 s58, s57, 38912
    buffer_load_dwordx4 a[52:55], v2, s[24:27], s58 offen sc1
    s_waitcnt vmcnt(16)
    v_mfma_f32_32x32x16_bf16 v[208:223], v[80:83], a[132:135], v[208:223]
    v_sin_f32 v126, v126
    v_sin_f32 v127, v127
    v_cvt_pk_bf16_f32 v48, v112, v113
    v_mfma_f32_32x32x16_bf16 v[224:239], v[84:87], a[132:135], v[224:239]
    s_add_u32 s58, s57, 7168
    buffer_load_dwordx4 a[56:59], v2, s[24:27], s58 offen sc1
    v_cvt_pk_bf16_f32 v49, v114, v115
    s_waitcnt vmcnt(16) lgkmcnt(2)
    v_mfma_f32_32x32x16_bf16 v[176:191], v[88:91], a[136:139], v[176:191]
    ds_read_b64_tr_b16 v[80:81], v254 offset:16384
    ds_read_b64_tr_b16 v[82:83], v254 offset:16896
    ds_read_b64_tr_b16 v[84:85], v255 offset:16384
    ds_read_b64_tr_b16 v[86:87], v255 offset:16896
    s_waitcnt lgkmcnt(4)
    v_mfma_f32_32x32x16_bf16 v[192:207], v[92:95], a[136:139], v[192:207]
    s_add_u32 s58, s57, 39936
    buffer_load_dwordx4 a[60:63], v2, s[24:27], s58 offen sc1
    v_cvt_pk_bf16_f32 v50, v116, v117
    s_waitcnt vmcnt(16)
    v_mfma_f32_32x32x16_bf16 v[208:223], v[88:91], a[140:143], v[208:223]
    buffer_load_dwordx4 v[240:243], v8, s[36:39], s54 offen offset:0
    v_cvt_pk_bf16_f32 v51, v118, v119
    v_mfma_f32_32x32x16_bf16 v[224:239], v[92:95], a[140:143], v[224:239]
    buffer_load_dwordx4 v[244:247], v8, s[36:39], s54 offen offset:1024
    v_cvt_pk_bf16_f32 v52, v120, v121
    v_cvt_pk_bf16_f32 v53, v122, v123
    v_cvt_pk_bf16_f32 v54, v124, v125
    v_cvt_pk_bf16_f32 v55, v126, v127
    v_fma_f32 v112, v132, v120, -v112
    v_fma_f32 v113, v132, v121, -v113
    v_fma_f32 v114, v132, v122, -v114
    v_fma_f32 v115, v132, v123, -v115
    v_fma_f32 v116, v132, v124, -v116
    v_fma_f32 v117, v132, v125, -v117
    v_fma_f32 v118, v132, v126, -v118
    v_fma_f32 v119, v132, v127, -v119
    v_cvt_pk_bf16_f32 v56, v112, v113
    v_cvt_pk_bf16_f32 v57, v114, v115
    v_cvt_pk_bf16_f32 v58, v116, v117
    v_cvt_pk_bf16_f32 v59, v118, v119
    v_fma_f32 v120, v132, v112, -v120
    v_fma_f32 v121, v132, v113, -v121
    v_fma_f32 v122, v132, v114, -v122
    v_fma_f32 v123, v132, v115, -v123
    v_fma_f32 v124, v132, v116, -v124
    v_fma_f32 v125, v132, v117, -v125
    v_fma_f32 v126, v132, v118, -v126
    v_fma_f32 v127, v132, v119, -v127
    v_cvt_pk_bf16_f32 v60, v120, v121
    v_cvt_pk_bf16_f32 v61, v122, v123
    v_cvt_pk_bf16_f32 v62, v124, v125
    v_cvt_pk_bf16_f32 v63, v126, v127
    v_fma_f32 v112, v132, v120, -v112
    v_fma_f32 v113, v132, v121, -v113
    v_fma_f32 v114, v132, v122, -v114
    v_fma_f32 v115, v132, v123, -v115
    v_fma_f32 v116, v132, v124, -v116
    v_fma_f32 v117, v132, v125, -v117
    v_fma_f32 v118, v132, v126, -v118
    v_fma_f32 v119, v132, v127, -v119
    v_cvt_pk_bf16_f32 v64, v112, v113
    v_cvt_pk_bf16_f32 v65, v114, v115
    v_cvt_pk_bf16_f32 v66, v116, v117
    v_cvt_pk_bf16_f32 v67, v118, v119
    v_fma_f32 v120, v132, v112, -v120
    v_fma_f32 v121, v132, v113, -v121
    v_fma_f32 v122, v132, v114, -v122
    v_fma_f32 v123, v132, v115, -v123
    v_fma_f32 v124, v132, v116, -v124
    v_fma_f32 v125, v132, v117, -v125
    v_fma_f32 v126, v132, v118, -v126
    v_fma_f32 v127, v132, v119, -v127
    v_cvt_pk_bf16_f32 v68, v120, v121
    v_cvt_pk_bf16_f32 v69, v122, v123
    v_cvt_pk_bf16_f32 v70, v124, v125
    v_cvt_pk_bf16_f32 v71, v126, v127
    v_fma_f32 v112, v132, v120, -v112
    v_fma_f32 v113, v132, v121, -v113
    v_fma_f32 v114, v132, v122, -v114
    v_fma_f32 v115, v132, v123, -v115
    v_fma_f32 v116, v132, v124, -v116
    v_fma_f32 v117, v132, v125, -v117
    v_fma_f32 v118, v132, v126, -v118
    v_fma_f32 v119, v132, v127, -v119
    v_cvt_pk_bf16_f32 v72, v112, v113
    v_cvt_pk_bf16_f32 v73, v114, v115
    v_cvt_pk_bf16_f32 v74, v116, v117
    v_cvt_pk_bf16_f32 v75, v118, v119
    v_fma_f32 v120, v132, v112, -v120
    v_fma_f32 v121, v132, v113, -v121
    v_fma_f32 v122, v132, v114, -v122
    v_fma_f32 v123, v132, v115, -v123
    v_fma_f32 v124, v132, v116, -v124
    v_fma_f32 v125, v132, v117, -v125
    v_fma_f32 v126, v132, v118, -v126
    v_fma_f32 v127, v132, v119, -v127
    v_cvt_pk_bf16_f32 v76, v120, v121
    v_cvt_pk_bf16_f32 v77, v122, v123
    v_cvt_pk_bf16_f32 v78, v124, v125
    v_cvt_pk_bf16_f32 v79, v126, v127
    v_and_b32 v134, 1, v128
    v_lshlrev_b32 v134, 15, v134
    v_or_b32 v134, 16128, v134
    v_cndmask_b32 v79, v79, v134, s[60:61]
    v_bfe_u32 v110, v1, 1, 2
    v_and_b32 v111, 1, v1
    v_lshl_or_b32 v110, v111, 2, v110
    v_xor_b32 v110, v110, v249
    v_lshl_add_u32 v111, v248, 7, s53
    v_xor_b32 v96, 0, v110
    v_lshl_add_u32 v96, v96, 4, v111
    v_add_u32 v100, 81920, v96
    v_add_u32 v96, 16384, v96
    v_xor_b32 v97, 2, v110
    v_lshl_add_u32 v97, v97, 4, v111
    v_add_u32 v101, 81920, v97
    v_add_u32 v97, 16384, v97
    v_xor_b32 v98, 4, v110
    v_lshl_add_u32 v98, v98, 4, v111
    v_add_u32 v102, 81920, v98
    v_add_u32 v98, 16384, v98
    v_xor_b32 v99, 6, v110
    v_lshl_add_u32 v99, v99, 4, v111
    v_add_u32 v103, 81920, v99
    v_add_u32 v99, 16384, v99
    v_bfe_u32 v110, v6, 1, 2
    v_and_b32 v111, 1, v6
    v_lshl_or_b32 v110, v111, 2, v110
    v_lshrrev_b32 v111, 2, v7
    v_lshlrev_b32 v111, 14, v111
    v_lshl_add_u32 v111, v6, 7, v111
    v_and_b32 v109, 3, v7
    v_lshl_add_u32 v108, v109, 1, 0
    v_xor_b32 v108, v108, v110
    v_lshl_add_u32 v104, v108, 4, v111
    v_add_u32 v106, 81920, v104
    v_add_u32 v104, 16384, v104
    v_lshl_add_u32 v108, v109, 1, 1
    v_xor_b32 v108, v108, v110
    v_lshl_add_u32 v105, v108, 4, v111
    v_add_u32 v107, 81920, v105
    v_add_u32 v105, 16384, v105
    s_waitcnt vmcnt(17)
    v_mfma_f32_32x32x16_bf16 v[112:127], v[16:19], a[0:3], 0
    s_add_u32 s59, s56, 18432
    buffer_load_dwordx4 a[144:147], v2, s[24:27], s59 offen sc1
    v_mfma_f32_32x32x16_bf16 v[128:143], v[48:51], a[0:3], 0
    buffer_load_dwordx4 a[148:151], v11, s[24:27], s59 offen sc1
    s_waitcnt vmcnt(18)
    v_mfma_f32_32x32x16_bf16 v[144:159], v[16:19], a[4:7], 0
    v_mfma_f32_32x32x16_bf16 v[160:175], v[48:51], a[4:7], 0
    s_add_u32 s59, s56, 19456
    buffer_load_dwordx4 a[152:155], v2, s[24:27], s59 offen sc1
    s_waitcnt vmcnt(18)
    v_mfma_f32_32x32x16_bf16 v[112:127], v[20:23], a[8:11], v[112:127]
    buffer_load_dwordx4 a[156:159], v11, s[24:27], s59 offen sc1
    v_mfma_f32_32x32x16_bf16 v[128:143], v[52:55], a[8:11], v[128:143]
    s_add_u32 s59, s56, 20480
    buffer_load_dwordx4 a[160:163], v2, s[24:27], s59 offen sc1
    s_waitcnt vmcnt(19)
    v_mfma_f32_32x32x16_bf16 v[144:159], v[20:23], a[12:15], v[144:159]
    v_mfma_f32_32x32x16_bf16 v[160:175], v[52:55], a[12:15], v[160:175]
    buffer_load_dwordx4 a[164:167], v11, s[24:27], s59 offen sc1
    s_waitcnt vmcnt(19)
    v_mfma_f32_32x32x16_bf16 v[112:127], v[24:27], a[16:19], v[112:127]
    v_mfma_f32_32x32x16_bf16 v[128:143], v[56:59], a[16:19], v[128:143]
    s_add_u32 s59, s56, 21504
    buffer_load_dwordx4 a[168:171], v2, s[24:27], s59 offen sc1
    s_waitcnt vmcnt(19)
    v_mfma_f32_32x32x16_bf16 v[144:159], v[24:27], a[20:23], v[144:159]
    v_mfma_f32_32x32x16_bf16 v[160:175], v[56:59], a[20:23], v[160:175]
    buffer_load_dwordx4 a[172:175], v11, s[24:27], s59 offen sc1
    s_waitcnt vmcnt(19)
    v_mfma_f32_32x32x16_bf16 v[112:127], v[28:31], a[24:27], v[112:127]
    v_mfma_f32_32x32x16_bf16 v[128:143], v[60:63], a[24:27], v[128:143]
    s_add_u32 s59, s56, 22528
    buffer_load_dwordx4 a[176:179], v2, s[24:27], s59 offen sc1
    s_waitcnt vmcnt(19)
    v_mfma_f32_32x32x16_bf16 v[144:159], v[28:31], a[28:31], v[144:159]
    v_mfma_f32_32x32x16_bf16 v[160:175], v[60:63], a[28:31], v[160:175]
    buffer_load_dwordx4 a[180:183], v11, s[24:27], s59 offen sc1
    s_waitcnt vmcnt(19)
    v_mfma_f32_32x32x16_bf16 v[112:127], v[32:35], a[32:35], v[112:127]
    s_add_u32 m0, s53, 131072
    s_add_u32 s55, s48, 393216
    buffer_load_dwordx4 v12, s[40:43], s55 offen offset:0 lds
    v_mfma_f32_32x32x16_bf16 v[128:143], v[64:67], a[32:35], v[128:143]
    buffer_load_dwordx4 v13, s[40:43], s55 offen offset:1024 lds
    s_waitcnt vmcnt(20)
    v_mfma_f32_32x32x16_bf16 v[144:159], v[32:35], a[36:39], v[144:159]
    buffer_load_dwordx4 v14, s[40:43], s55 offen offset:2048 lds
    v_mfma_f32_32x32x16_bf16 v[160:175], v[64:67], a[36:39], v[160:175]
    buffer_load_dwordx4 v15, s[40:43], s55 offen offset:3072 lds
    s_waitcnt vmcnt(21)
    v_mfma_f32_32x32x16_bf16 v[112:127], v[36:39], a[40:43], v[112:127]
    s_add_u32 s59, s56, 23552
    buffer_load_dwordx4 a[184:187], v2, s[24:27], s59 offen sc1
    v_mfma_f32_32x32x16_bf16 v[128:143], v[68:71], a[40:43], v[128:143]
    buffer_load_dwordx4 a[188:191], v11, s[24:27], s59 offen sc1
    s_waitcnt vmcnt(22)
    v_mfma_f32_32x32x16_bf16 v[144:159], v[36:39], a[44:47], v[144:159]
    v_mfma_f32_32x32x16_bf16 v[160:175], v[68:71], a[44:47], v[160:175]
    s_add_u32 s59, s56, 24576
    buffer_load_dwordx4 a[192:195], v2, s[24:27], s59 offen sc1
    s_waitcnt vmcnt(22)
    v_mfma_f32_32x32x16_bf16 v[112:127], v[40:43], a[48:51], v[112:127]
    buffer_load_dwordx4 a[196:199], v11, s[24:27], s59 offen sc1
    v_mfma_f32_32x32x16_bf16 v[128:143], v[72:75], a[48:51], v[128:143]
    s_add_u32 m0, s53, 0
    s_add_u32 s55, s48, 425984
    buffer_load_dwordx4 v12, s[40:43], s55 offen offset:0 lds
    s_waitcnt vmcnt(23)
    v_mfma_f32_32x32x16_bf16 v[144:159], v[40:43], a[52:55], v[144:159]
    buffer_load_dwordx4 v13, s[40:43], s55 offen offset:1024 lds
    v_mfma_f32_32x32x16_bf16 v[160:175], v[72:75], a[52:55], v[160:175]
    buffer_load_dwordx4 v14, s[40:43], s55 offen offset:2048 lds
    s_waitcnt vmcnt(24)
    v_mfma_f32_32x32x16_bf16 v[112:127], v[44:47], a[56:59], v[112:127]
    buffer_load_dwordx4 v15, s[40:43], s55 offen offset:3072 lds
    v_mfma_f32_32x32x16_bf16 v[128:143], v[76:79], a[56:59], v[128:143]
    s_add_u32 s59, s56, 25600
    buffer_load_dwordx4 a[200:203], v2, s[24:27], s59 offen sc1
    s_waitcnt vmcnt(25)
    v_mfma_f32_32x32x16_bf16 v[144:159], v[44:47], a[60:63], v[144:159]
    buffer_load_dwordx4 a[204:207], v11, s[24:27], s59 offen sc1
    v_mfma_f32_32x32x16_bf16 v[160:175], v[76:79], a[60:63], v[160:175]
    s_add_u32 s59, s56, 26624
    buffer_load_dwordx4 a[208:211], v2, s[24:27], s59 offen sc1
    s_waitcnt vmcnt(24) lgkmcnt(2)
    v_mfma_f32_32x32x16_bf16 v[176:191], v[80:83], a[144:147], v[176:191]
    ds_read_b64_tr_b16 v[88:89], v254 offset:18432
    ds_read_b64_tr_b16 v[90:91], v254 offset:18944
    ds_read_b64_tr_b16 v[92:93], v255 offset:18432
    ds_read_b64_tr_b16 v[94:95], v255 offset:18944
    s_waitcnt lgkmcnt(4)
    v_mfma_f32_32x32x16_bf16 v[192:207], v[84:87], a[144:147], v[192:207]
    buffer_load_dwordx4 a[212:215], v11, s[24:27], s59 offen sc1
    s_waitcnt vmcnt(24)
    v_mfma_f32_32x32x16_bf16 v[208:223], v[80:83], a[148:151], v[208:223]
    ds_write_b128 v96, v[112:115] offset:0
    v_mfma_f32_32x32x16_bf16 v[224:239], v[84:87], a[148:151], v[224:239]
    s_add_u32 s59, s56, 27648
    buffer_load_dwordx4 a[216:219], v2, s[24:27], s59 offen sc1
    s_waitcnt vmcnt(24) lgkmcnt(3)
    v_mfma_f32_32x32x16_bf16 v[176:191], v[88:91], a[152:155], v[176:191]
    ds_read_b64_tr_b16 v[80:81], v252 offset:32768
    ds_read_b64_tr_b16 v[82:83], v252 offset:33280
    ds_read_b64_tr_b16 v[84:85], v253 offset:32768
    ds_read_b64_tr_b16 v[86:87], v253 offset:33280
    s_waitcnt lgkmcnt(5)
    v_mfma_f32_32x32x16_bf16 v[192:207], v[92:95], a[152:155], v[192:207]
    buffer_load_dwordx4 a[220:223], v11, s[24:27], s59 offen sc1
    s_waitcnt vmcnt(24)
    v_mfma_f32_32x32x16_bf16 v[208:223], v[88:91], a[156:159], v[208:223]
    ds_write_b128 v97, v[116:119] offset:0
    v_mfma_f32_32x32x16_bf16 v[224:239], v[92:95], a[156:159], v[224:239]
    s_waitcnt vmcnt(23) lgkmcnt(3)
    v_mfma_f32_32x32x16_bf16 v[176:191], v[80:83], a[160:163], v[176:191]
    ds_read_b64_tr_b16 v[88:89], v252 offset:34816
    ds_read_b64_tr_b16 v[90:91], v252 offset:35328
    ds_read_b64_tr_b16 v[92:93], v253 offset:34816
    ds_read_b64_tr_b16 v[94:95], v253 offset:35328
    s_waitcnt lgkmcnt(5)
    v_mfma_f32_32x32x16_bf16 v[192:207], v[84:87], a[160:163], v[192:207]
    s_waitcnt vmcnt(22)
    v_mfma_f32_32x32x16_bf16 v[208:223], v[80:83], a[164:167], v[208:223]
    ds_write_b128 v98, v[120:123] offset:0
    v_mfma_f32_32x32x16_bf16 v[224:239], v[84:87], a[164:167], v[224:239]
    s_waitcnt vmcnt(21) lgkmcnt(3)
    v_mfma_f32_32x32x16_bf16 v[176:191], v[88:91], a[168:171], v[176:191]
    ds_read_b64_tr_b16 v[80:81], v252 offset:49152
    ds_read_b64_tr_b16 v[82:83], v252 offset:49664
    ds_read_b64_tr_b16 v[84:85], v253 offset:49152
    ds_read_b64_tr_b16 v[86:87], v253 offset:49664
    s_waitcnt lgkmcnt(5)
    v_mfma_f32_32x32x16_bf16 v[192:207], v[92:95], a[168:171], v[192:207]
    s_waitcnt vmcnt(20)
    v_mfma_f32_32x32x16_bf16 v[208:223], v[88:91], a[172:175], v[208:223]
    ds_write_b128 v99, v[124:127] offset:0
    v_mfma_f32_32x32x16_bf16 v[224:239], v[92:95], a[172:175], v[224:239]
    s_waitcnt vmcnt(19) lgkmcnt(3)
    v_mfma_f32_32x32x16_bf16 v[176:191], v[80:83], a[176:179], v[176:191]
    ds_read_b64_tr_b16 v[88:89], v252 offset:51200
    ds_read_b64_tr_b16 v[90:91], v252 offset:51712
    ds_read_b64_tr_b16 v[92:93], v253 offset:51200
    ds_read_b64_tr_b16 v[94:95], v253 offset:51712
    s_waitcnt lgkmcnt(5)
    v_mfma_f32_32x32x16_bf16 v[192:207], v[84:87], a[176:179], v[192:207]
    s_waitcnt vmcnt(18)
    v_mfma_f32_32x32x16_bf16 v[208:223], v[80:83], a[180:183], v[208:223]
    ds_write_b128 v96, v[128:131] offset:16384
    v_mfma_f32_32x32x16_bf16 v[224:239], v[84:87], a[180:183], v[224:239]
    s_waitcnt vmcnt(13) lgkmcnt(3)
    v_mfma_f32_32x32x16_bf16 v[176:191], v[88:91], a[184:187], v[176:191]
    ds_read_b64_tr_b16 v[80:81], v254 offset:0
    ds_read_b64_tr_b16 v[82:83], v254 offset:512
    ds_read_b64_tr_b16 v[84:85], v255 offset:0
    ds_read_b64_tr_b16 v[86:87], v255 offset:512
    s_waitcnt lgkmcnt(5)
    v_mfma_f32_32x32x16_bf16 v[192:207], v[92:95], a[184:187], v[192:207]
    s_waitcnt vmcnt(12)
    v_mfma_f32_32x32x16_bf16 v[208:223], v[88:91], a[188:191], v[208:223]
    ds_write_b128 v97, v[132:135] offset:16384
    v_mfma_f32_32x32x16_bf16 v[224:239], v[92:95], a[188:191], v[224:239]
    s_waitcnt vmcnt(11) lgkmcnt(3)
    v_mfma_f32_32x32x16_bf16 v[176:191], v[80:83], a[192:195], v[176:191]
    ds_read_b64_tr_b16 v[88:89], v254 offset:2048
    ds_read_b64_tr_b16 v[90:91], v254 offset:2560
    ds_read_b64_tr_b16 v[92:93], v255 offset:2048
    ds_read_b64_tr_b16 v[94:95], v255 offset:2560
    s_waitcnt lgkmcnt(5)
    v_mfma_f32_32x32x16_bf16 v[192:207], v[84:87], a[192:195], v[192:207]
    s_waitcnt vmcnt(10)
    v_mfma_f32_32x32x16_bf16 v[208:223], v[80:83], a[196:199], v[208:223]
    ds_write_b128 v98, v[136:139] offset:16384
    v_mfma_f32_32x32x16_bf16 v[224:239], v[84:87], a[196:199], v[224:239]
    s_waitcnt vmcnt(5) lgkmcnt(3)
    v_mfma_f32_32x32x16_bf16 v[176:191], v[88:91], a[200:203], v[176:191]
    ds_read_b64_tr_b16 v[80:81], v250 offset:0
    ds_read_b64_tr_b16 v[82:83], v250 offset:512
    ds_read_b64_tr_b16 v[84:85], v251 offset:0
    ds_read_b64_tr_b16 v[86:87], v251 offset:512
    s_waitcnt lgkmcnt(5)
    v_mfma_f32_32x32x16_bf16 v[192:207], v[92:95], a[200:203], v[192:207]
    s_waitcnt vmcnt(4)
    v_mfma_f32_32x32x16_bf16 v[208:223], v[88:91], a[204:207], v[208:223]
    ds_write_b128 v99, v[140:143] offset:16384
    v_mfma_f32_32x32x16_bf16 v[224:239], v[92:95], a[204:207], v[224:239]
    s_waitcnt vmcnt(3) lgkmcnt(3)
    v_mfma_f32_32x32x16_bf16 v[176:191], v[80:83], a[208:211], v[176:191]
    ds_read_b64_tr_b16 v[88:89], v250 offset:2048
    ds_read_b64_tr_b16 v[90:91], v250 offset:2560
    ds_read_b64_tr_b16 v[92:93], v251 offset:2048
    ds_read_b64_tr_b16 v[94:95], v251 offset:2560
    s_waitcnt lgkmcnt(5)
    v_mfma_f32_32x32x16_bf16 v[192:207], v[84:87], a[208:211], v[192:207]
    s_waitcnt vmcnt(2)
    v_mfma_f32_32x32x16_bf16 v[208:223], v[80:83], a[212:215], v[208:223]
    ds_write_b128 v96, v[144:147] offset:32768
    v_mfma_f32_32x32x16_bf16 v[224:239], v[84:87], a[212:215], v[224:239]
    s_waitcnt vmcnt(1) lgkmcnt(3)
    v_mfma_f32_32x32x16_bf16 v[176:191], v[88:91], a[216:219], v[176:191]
    s_waitcnt lgkmcnt(1)
    v_mfma_f32_32x32x16_bf16 v[192:207], v[92:95], a[216:219], v[192:207]
    s_waitcnt vmcnt(0)
    v_mfma_f32_32x32x16_bf16 v[208:223], v[88:91], a[220:223], v[208:223]
    ds_write_b128 v97, v[148:151] offset:32768
    v_mfma_f32_32x32x16_bf16 v[224:239], v[92:95], a[220:223], v[224:239]
    ds_write_b128 v98, v[152:155] offset:32768
    ds_write_b128 v99, v[156:159] offset:32768
    ds_write_b128 v96, v[160:163] offset:49152
    ds_write_b128 v97, v[164:167] offset:49152
    ds_write_b128 v98, v[168:171] offset:49152
    ds_write_b128 v99, v[172:175] offset:49152
    ds_write_b128 v100, v[176:179] offset:0
    v_mov_b32 v248, 0xbfb8aa3b
    ds_write_b128 v101, v[180:183] offset:0
    v_mov_b32 v249, 0x36000000
    ds_write_b128 v102, v[184:187] offset:0
    v_lshlrev_b32 v80, 16, v240
    ds_write_b128 v103, v[188:191] offset:0
    v_and_b32 v81, 0xffff0000, v240
    ds_write_b128 v100, v[192:195] offset:16384
    v_lshlrev_b32 v82, 16, v241
    ds_write_b128 v101, v[196:199] offset:16384
    v_and_b32 v83, 0xffff0000, v241
    ds_write_b128 v102, v[200:203] offset:16384
    v_lshlrev_b32 v84, 16, v242
    s_waitcnt lgkmcnt(14)
    ds_write_b128 v103, v[204:207] offset:16384
    v_and_b32 v85, 0xffff0000, v242
    v_lshlrev_b32 v86, 16, v243
    s_waitcnt lgkmcnt(14)
    ds_write_b128 v100, v[208:211] offset:32768
    v_and_b32 v87, 0xffff0000, v243
    s_waitcnt lgkmcnt(14)
    ds_write_b128 v101, v[212:215] offset:32768
    v_lshlrev_b32 v88, 16, v244
    s_waitcnt lgkmcnt(14)
    ds_write_b128 v102, v[216:219] offset:32768
    v_and_b32 v89, 0xffff0000, v244
    s_waitcnt lgkmcnt(14)
    ds_write_b128 v103, v[220:223] offset:32768
    v_lshlrev_b32 v90, 16, v245
    s_waitcnt lgkmcnt(14)
    ds_write_b128 v100, v[224:227] offset:49152
    v_and_b32 v91, 0xffff0000, v245
    s_waitcnt lgkmcnt(14)
    ds_write_b128 v101, v[228:231] offset:49152
    v_lshlrev_b32 v92, 16, v246
    s_waitcnt lgkmcnt(14)
    ds_write_b128 v102, v[232:235] offset:49152
    v_and_b32 v93, 0xffff0000, v246
    s_waitcnt lgkmcnt(14)
    ds_write_b128 v103, v[236:239] offset:49152
    v_lshlrev_b32 v94, 16, v247
    v_and_b32 v95, 0xffff0000, v247
    s_waitcnt lgkmcnt(0)
    s_barrier
    ds_read_b128 v[112:115], v106 offset:0
    ds_read_b128 v[116:119], v107 offset:0
    ds_read_b128 v[120:123], v106 offset:32768
    ds_read_b128 v[124:127], v107 offset:32768
    ds_read_b128 v[128:131], v106 offset:4096
    ds_read_b128 v[132:135], v107 offset:4096
    ds_read_b128 v[136:139], v106 offset:36864
    ds_read_b128 v[140:143], v107 offset:36864
    ds_read_b128 v[144:147], v106 offset:8192
    ds_read_b128 v[148:151], v107 offset:8192
    ds_read_b128 v[152:155], v106 offset:40960
    ds_read_b128 v[156:159], v107 offset:40960
    ds_read_b128 v[160:163], v106 offset:12288
    ds_read_b128 v[164:167], v107 offset:12288
    ds_read_b128 v[168:171], v106 offset:45056
    s_waitcnt lgkmcnt(14)
    ds_read_b128 v[172:175], v107 offset:45056
    s_waitcnt lgkmcnt(14)
    ds_read_b128 v[16:19], v104 offset:0
    s_waitcnt lgkmcnt(14)
    ds_read_b128 v[20:23], v105 offset:0
    s_waitcnt lgkmcnt(14)
    ds_read_b128 v[24:27], v104 offset:32768
    s_waitcnt lgkmcnt(14)
    ds_read_b128 v[28:31], v105 offset:32768
    s_waitcnt lgkmcnt(14)
    ds_read_b128 v[32:35], v104 offset:4096
    s_waitcnt lgkmcnt(14)
    ds_read_b128 v[36:39], v105 offset:4096
    v_pk_add_f32 v[112:113], v[112:113], v[128:129]
    v_pk_add_f32 v[114:115], v[114:115], v[130:131]
    v_pk_add_f32 v[116:117], v[116:117], v[132:133]
    v_pk_add_f32 v[118:119], v[118:119], v[134:135]
    v_pk_add_f32 v[120:121], v[120:121], v[136:137]
    v_pk_add_f32 v[122:123], v[122:123], v[138:139]
    s_waitcnt lgkmcnt(14)
    v_pk_add_f32 v[124:125], v[124:125], v[140:141]
    v_pk_add_f32 v[126:127], v[126:127], v[142:143]
    ds_read_b128 v[40:43], v104 offset:36864
    s_waitcnt lgkmcnt(14)
    ds_read_b128 v[44:47], v105 offset:36864
    s_waitcnt lgkmcnt(14)
    ds_read_b128 v[48:51], v104 offset:8192
    s_waitcnt lgkmcnt(14)
    ds_read_b128 v[52:55], v105 offset:8192
    s_waitcnt lgkmcnt(14)
    ds_read_b128 v[56:59], v104 offset:40960
    s_waitcnt lgkmcnt(14)
    ds_read_b128 v[60:63], v105 offset:40960
    s_waitcnt lgkmcnt(14)
    ds_read_b128 v[64:67], v104 offset:12288
    s_waitcnt lgkmcnt(14)
    ds_read_b128 v[68:71], v105 offset:12288
    s_waitcnt lgkmcnt(14)
    ds_read_b128 v[72:75], v104 offset:45056
    s_waitcnt lgkmcnt(14)
    ds_read_b128 v[76:79], v105 offset:45056
    v_pk_add_f32 v[144:145], v[144:145], v[160:161]
    v_pk_add_f32 v[146:147], v[146:147], v[162:163]
    v_pk_add_f32 v[148:149], v[148:149], v[164:165]
    v_pk_add_f32 v[150:151], v[150:151], v[166:167]
    v_pk_add_f32 v[152:153], v[152:153], v[168:169]
    v_pk_add_f32 v[154:155], v[154:155], v[170:171]
    v_pk_add_f32 v[156:157], v[156:157], v[172:173]
    v_pk_add_f32 v[158:159], v[158:159], v[174:175]
    v_pk_add_f32 v[112:113], v[112:113], v[144:145]
    v_pk_add_f32 v[114:115], v[114:115], v[146:147]
    v_pk_add_f32 v[116:117], v[116:117], v[148:149]
    v_pk_add_f32 v[118:119], v[118:119], v[150:151]
    v_pk_add_f32 v[120:121], v[120:121], v[152:153]
    v_pk_add_f32 v[122:123], v[122:123], v[154:155]
    v_pk_add_f32 v[124:125], v[124:125], v[156:157]
    v_pk_add_f32 v[126:127], v[126:127], v[158:159]
    v_pk_mul_f32 v[176:177], v[112:113], v[248:249] op_sel_hi:[1,0]
    v_pk_mul_f32 v[178:179], v[114:115], v[248:249] op_sel_hi:[1,0]
    v_pk_mul_f32 v[180:181], v[116:117], v[248:249] op_sel_hi:[1,0]
    v_pk_mul_f32 v[182:183], v[118:119], v[248:249] op_sel_hi:[1,0]
    v_pk_mul_f32 v[184:185], v[120:121], v[248:249] op_sel_hi:[1,0]
    v_pk_mul_f32 v[186:187], v[122:123], v[248:249] op_sel_hi:[1,0]
    v_pk_mul_f32 v[188:189], v[124:125], v[248:249] op_sel_hi:[1,0]
    v_pk_mul_f32 v[190:191], v[126:127], v[248:249] op_sel_hi:[1,0]
    v_exp_f32 v176, v176
    v_exp_f32 v177, v177
    v_exp_f32 v178, v178
    v_exp_f32 v179, v179
    v_exp_f32 v180, v180
    v_exp_f32 v181, v181
    v_exp_f32 v182, v182
    v_exp_f32 v183, v183
    v_exp_f32 v184, v184
    v_exp_f32 v185, v185
    v_exp_f32 v186, v186
    v_exp_f32 v187, v187
    v_exp_f32 v188, v188
    v_exp_f32 v189, v189
    v_exp_f32 v190, v190
    v_exp_f32 v191, v191
    s_waitcnt lgkmcnt(11)
    v_pk_add_f32 v[16:17], v[16:17], v[32:33]
    v_pk_add_f32 v[18:19], v[18:19], v[34:35]
    s_waitcnt lgkmcnt(10)
    v_pk_add_f32 v[20:21], v[20:21], v[36:37]
    v_pk_add_f32 v[22:23], v[22:23], v[38:39]
    s_waitcnt lgkmcnt(9)
    v_pk_add_f32 v[24:25], v[24:25], v[40:41]
    v_pk_add_f32 v[26:27], v[26:27], v[42:43]
    s_waitcnt lgkmcnt(8)
    v_pk_add_f32 v[28:29], v[28:29], v[44:45]
    v_pk_add_f32 v[30:31], v[30:31], v[46:47]
    s_waitcnt lgkmcnt(3)
    v_pk_add_f32 v[48:49], v[48:49], v[64:65]
    v_pk_add_f32 v[50:51], v[50:51], v[66:67]
    s_waitcnt lgkmcnt(2)
    v_pk_add_f32 v[52:53], v[52:53], v[68:69]
    v_pk_add_f32 v[54:55], v[54:55], v[70:71]
    s_waitcnt lgkmcnt(1)
    v_pk_add_f32 v[56:57], v[56:57], v[72:73]
    v_pk_add_f32 v[58:59], v[58:59], v[74:75]
    s_waitcnt lgkmcnt(0)
    v_pk_add_f32 v[60:61], v[60:61], v[76:77]
    v_pk_add_f32 v[62:63], v[62:63], v[78:79]
    v_pk_add_f32 v[16:17], v[16:17], v[48:49]
    v_pk_add_f32 v[18:19], v[18:19], v[50:51]
    v_pk_add_f32 v[20:21], v[20:21], v[52:53]
    v_pk_add_f32 v[22:23], v[22:23], v[54:55]
    v_pk_add_f32 v[24:25], v[24:25], v[56:57]
    v_pk_add_f32 v[26:27], v[26:27], v[58:59]
    v_pk_add_f32 v[28:29], v[28:29], v[60:61]
    v_pk_add_f32 v[30:31], v[30:31], v[62:63]
    v_pk_mul_f32 v[112:113], v[112:113], v[248:249] op_sel:[0,1] op_sel_hi:[1,1]
    v_pk_mul_f32 v[114:115], v[114:115], v[248:249] op_sel:[0,1] op_sel_hi:[1,1]
    v_pk_mul_f32 v[116:117], v[116:117], v[248:249] op_sel:[0,1] op_sel_hi:[1,1]
    v_pk_mul_f32 v[118:119], v[118:119], v[248:249] op_sel:[0,1] op_sel_hi:[1,1]
    v_pk_mul_f32 v[120:121], v[120:121], v[248:249] op_sel:[0,1] op_sel_hi:[1,1]
    v_pk_mul_f32 v[122:123], v[122:123], v[248:249] op_sel:[0,1] op_sel_hi:[1,1]
    v_pk_mul_f32 v[124:125], v[124:125], v[248:249] op_sel:[0,1] op_sel_hi:[1,1]
    v_pk_mul_f32 v[126:127], v[126:127], v[248:249] op_sel:[0,1] op_sel_hi:[1,1]
    v_pk_mul_f32 v[112:113], v[112:113], v[16:17]
    v_pk_mul_f32 v[114:115], v[114:115], v[18:19]
    v_pk_mul_f32 v[116:117], v[116:117], v[20:21]
    v_pk_mul_f32 v[118:119], v[118:119], v[22:23]
    v_pk_mul_f32 v[120:121], v[120:121], v[24:25]
    v_pk_mul_f32 v[122:123], v[122:123], v[26:27]
    v_pk_mul_f32 v[124:125], v[124:125], v[28:29]
    v_pk_mul_f32 v[126:127], v[126:127], v[30:31]
    v_pk_add_f32 v[176:177], v[176:177], 1.0 op_sel_hi:[1,0]
    v_pk_add_f32 v[178:179], v[178:179], 1.0 op_sel_hi:[1,0]
    v_pk_add_f32 v[180:181], v[180:181], 1.0 op_sel_hi:[1,0]
    v_pk_add_f32 v[182:183], v[182:183], 1.0 op_sel_hi:[1,0]
    v_pk_add_f32 v[184:185], v[184:185], 1.0 op_sel_hi:[1,0]
    v_pk_add_f32 v[186:187], v[186:187], 1.0 op_sel_hi:[1,0]
    v_pk_add_f32 v[188:189], v[188:189], 1.0 op_sel_hi:[1,0]
    v_pk_add_f32 v[190:191], v[190:191], 1.0 op_sel_hi:[1,0]
    v_rcp_f32 v176, v176
    v_rcp_f32 v177, v177
    v_rcp_f32 v178, v178
    v_rcp_f32 v179, v179
    v_rcp_f32 v180, v180
    v_rcp_f32 v181, v181
    v_rcp_f32 v182, v182
    v_rcp_f32 v183, v183
    v_pk_fma_f32 v[176:177], v[112:113], v[176:177], v[80:81]
    v_pk_fma_f32 v[178:179], v[114:115], v[178:179], v[82:83]
    v_pk_fma_f32 v[180:181], v[116:117], v[180:181], v[84:85]
    v_pk_fma_f32 v[182:183], v[118:119], v[182:183], v[86:87]
    v_cvt_pk_bf16_f32 v192, v176, v177
    v_cvt_pk_bf16_f32 v193, v178, v179
    v_cvt_pk_bf16_f32 v194, v180, v181
    v_cvt_pk_bf16_f32 v195, v182, v183
    buffer_store_dwordx4 v[192:195], v8, s[44:47], s54 offen offset:0
    v_rcp_f32 v184, v184
    v_rcp_f32 v185, v185
    v_rcp_f32 v186, v186
    v_rcp_f32 v187, v187
    v_rcp_f32 v188, v188
    v_rcp_f32 v189, v189
    v_rcp_f32 v190, v190
    v_rcp_f32 v191, v191
    v_pk_fma_f32 v[184:185], v[120:121], v[184:185], v[88:89]
    v_pk_fma_f32 v[186:187], v[122:123], v[186:187], v[90:91]
    v_pk_fma_f32 v[188:189], v[124:125], v[188:189], v[92:93]
    v_pk_fma_f32 v[190:191], v[126:127], v[190:191], v[94:95]
    v_cvt_pk_bf16_f32 v196, v184, v185
    v_cvt_pk_bf16_f32 v197, v186, v187
    v_cvt_pk_bf16_f32 v198, v188, v189
    v_cvt_pk_bf16_f32 v199, v190, v191
    buffer_store_dwordx4 v[196:199], v8, s[44:47], s54 offen offset:1024
    s_endpgm
G_AW1_SPIN:
    s_mov_b32 s101, 65536
G_AW1_L:
    buffer_load_dword v228, v229, s[48:51], 0 offen sc1
    s_sub_u32 s101, s101, 1
    s_waitcnt vmcnt(0)
    v_cmp_eq_u32 vcc, 0, v228
    s_cmp_eq_u32 s101, 0
    s_cbranch_scc1 G_AW1_OK
    s_nop 1
    s_cbranch_vccnz G_AW1_L
    s_branch G_AW1_OK
G_AW2_SPIN:
    s_mov_b32 s101, 65536
G_AW2_L:
    buffer_load_dword v3, v10, s[24:27], 0 offen sc1
    s_sub_u32 s101, s101, 1
    s_waitcnt vmcnt(0)
    v_subrev_u32 v3, s22, v3
    v_subrev_u32 v3, 2, v3
    v_cmp_lt_u32 vcc, 0, v3
    s_cmp_eq_u32 s101, 0
    s_cbranch_scc1 G_AW2_OK
    s_nop 1
    s_cbranch_vccnz G_AW2_L
    s_branch G_AW2_OK
G_AW3_SPIN:
    s_mov_b32 s101, 65536
G_AW3_L:
    buffer_load_dword v4, v9, s[24:27], 0 offen sc1
    s_sub_u32 s101, s101, 1
    s_waitcnt vmcnt(0)
    v_subrev_u32 v4, s22, v4
    v_subrev_u32 v4, 2, v4
    v_cmp_lt_u32 vcc, 0, v4
    s_cmp_eq_u32 s101, 0
    s_cbranch_scc1 G_AW3_OK
    s_nop 1
    s_cbranch_vccnz G_AW3_L
    s_branch G_AW3_OK
ROLE_F:
    s_nop 4
    s_and_b32 s21, s16, 3
    s_lshl_b32 s21, s21, 2
    s_and_b32 s52, s17, 3
    s_add_u32 s21, s21, s52
    s_lshr_b32 s53, s17, 2
    s_lshr_b32 s20, s16, 2
    s_add_u32 s20, s20, 14
    s_lshl_b32 s19, s21, 2
    s_add_u32 s19, s19, s18
    v_and_b32 v1, 63, v0
    v_lshlrev_b32 v2, 4, v1
    v_lshrrev_b32 v96, 3, v1
    v_and_b32 v97, 7, v1
    v_lshrrev_b32 v98, 4, v1
    v_xor_b32 v97, v97, v98
    v_lshlrev_b32 v99, 16, v96
    v_lshl_add_u32 v20, v97, 4, v99
    v_xor_b32 v97, 4, v97
    v_lshl_add_u32 v21, v97, 4, v99
    v_add_u32 v21, 523264, v21
    v_add_u32 v22, 1046528, v20
    v_add_u32 v23, 1046528, v21
    s_lshl_b32 s53, s18, 12
    s_lshl_b32 s54, s19, 10
    s_waitcnt lgkmcnt(0)
    s_mov_b32 s36, s4
    s_mov_b32 s37, s5
    s_mov_b32 s38, 2097152
    s_mov_b32 s39, 0x00020000
    s_mov_b32 s24, s6
    s_mov_b32 s25, s7
    s_mov_b32 s26, 17825792
    s_mov_b32 s27, 0x00020000
    s_mov_b32 s48, s14
    s_mov_b32 s49, s15
    s_mov_b32 s50, 256
    s_mov_b32 s51, 0x00020000
    s_load_dwordx4 s[4:7], s[0:1], 48
    s_lshl_b32 s57, s2, 2
    s_add_u32 s57, s57, s18
    s_cmp_lg_u32 s57, 896
    s_cbranch_scc1 F_NONCE_A
    v_lshlrev_b32 v100, 7, v1
    s_mov_b32 s56, 0
    buffer_load_dword v212, v100, s[24:27], s56 offen sc1
    s_mov_b32 s56, 8192
    buffer_load_dword v213, v100, s[24:27], s56 offen sc1
    s_mov_b32 s56, 16384
    buffer_load_dword v214, v100, s[24:27], s56 offen sc1
    s_mov_b32 s56, 24576
    buffer_load_dword v215, v100, s[24:27], s56 offen sc1
F_NONCE_A:
    s_add_u32 m0, s53, 0
    s_add_u32 s55, s54, 0
    buffer_load_dwordx4 v20, s[36:39], s55 offen offset:0 lds
    buffer_load_dwordx4 v21, s[36:39], s55 offen offset:1024 lds
    buffer_load_dwordx4 v22, s[36:39], s55 offen offset:2048 lds
    buffer_load_dwordx4 v23, s[36:39], s55 offen offset:3072 lds
    s_add_u32 m0, s53, 16384
    s_add_u32 s55, s54, 128
    buffer_load_dwordx4 v20, s[36:39], s55 offen offset:0 lds
    buffer_load_dwordx4 v21, s[36:39], s55 offen offset:1024 lds
    buffer_load_dwordx4 v22, s[36:39], s55 offen offset:2048 lds
    buffer_load_dwordx4 v23, s[36:39], s55 offen offset:3072 lds
    v_and_b32 v14, 31, v1
    s_getpc_b64 s[96:97]
F_PC:
    s_sub_u32 s96, s96, F_PC-recurrent_scan__spectral_gfnet__glu_gated_geglu__prompt_kernel
    s_subb_u32 s97, s97, 0
    s_mov_b32 s98, CODE_END-recurrent_scan__spectral_gfnet__glu_gated_geglu__prompt_kernel
    s_mov_b32 s99, 0x00020000
    s_lshl_b32 s100, s17, 12
    v_lshlrev_b32 v108, 4, v0
    buffer_load_dwordx4 v[224:227], v108, s[96:99], s100 offen
    v_lshrrev_b32 v15, 5, v1
    v_and_b32 v98, 1, v1
    v_lshrrev_b32 v99, 1, v14
    s_lshl_b32 s62, s20, 4
    v_add3_u32 v99, s62, v99, 1
    v_lshlrev_b32 v210, 31, v99
    v_or_b32 v210, 1.0, v210
    v_cvt_f32_u32 v101, v98
    v_cvt_f32_u32 v99, v99
    v_mul_f32 v99, 0x3b000000, v99
    v_mul_f32 v101, 0xbe800000, v101
    s_mul_i32 s100, s2, 7168
    s_add_u32 s101, s100, 4096
    v_lshlrev_b32 v108, 4, v0
    s_mov_b32 s96, s12
    s_mov_b32 s97, s13
    s_mov_b32 s98, 1835008
    s_mov_b32 s99, 0x00020000
    buffer_load_dwordx4 v[224:227], v108, s[96:99], s100 offen
    v_add_f32 v101, 0x3e800000, v101
    s_lshl_b32 s62, s18, 6
    v_lshl_add_u32 v100, v15, 3, s62
    v_cvt_f32_u32 v100, v100
    v_fma_f32 v80, -v100, v99, v101
    v_mul_f32 v100, 0x41800000, v99
    v_sub_f32 v101, 0x3e800000, v100
    v_sin_f32 v101, v101
    v_sub_f32 v81, v80, v99
    v_sub_f32 v82, v81, v99
    v_sub_f32 v83, v82, v99
    buffer_load_dwordx4 v[224:227], v108, s[96:99], s101 offen
    v_sub_f32 v84, v83, v99
    v_sub_f32 v85, v84, v99
    v_sub_f32 v86, v85, v99
    v_sub_f32 v87, v86, v99
    v_sub_f32 v88, v80, v100
    v_sub_f32 v89, v81, v100
    v_sub_f32 v90, v82, v100
    v_sub_f32 v91, v83, v100
    v_sub_f32 v92, v84, v100
    v_sub_f32 v93, v85, v100
    v_sub_f32 v94, v86, v100
    v_sub_f32 v95, v87, v100
    s_mov_b32 s96, s58
    s_mov_b32 s97, s59
    s_mov_b32 s98, 1835008
    s_mov_b32 s99, 0x00020000
    buffer_load_dwordx4 v[224:227], v108, s[96:99], s100 offen
    v_add_f32 v101, v101, v101
    v_sin_f32 v80, v80
    v_sin_f32 v81, v81
    v_sin_f32 v82, v82
    v_sin_f32 v83, v83
    v_sin_f32 v84, v84
    v_sin_f32 v85, v85
    buffer_load_dwordx4 v[224:227], v108, s[96:99], s101 offen
    v_sin_f32 v86, v86
    v_sin_f32 v87, v87
    v_sin_f32 v88, v88
    v_sin_f32 v89, v89
    v_sin_f32 v90, v90
    v_sin_f32 v91, v91
    s_waitcnt lgkmcnt(0)
    s_mov_b32 s96, s4
    s_mov_b32 s97, s5
    s_mov_b32 s98, 1835008
    s_mov_b32 s99, 0x00020000
    buffer_load_dwordx4 v[224:227], v108, s[96:99], s100 offen
    v_sin_f32 v92, v92
    v_sin_f32 v93, v93
    v_sin_f32 v94, v94
    v_sin_f32 v95, v95
    v_add_u32 v102, s53, v2
    v_add_u32 v102, 147456, v102
    v_cvt_pk_bf16_f32 v128, v80, v81
    buffer_load_dwordx4 v[224:227], v108, s[96:99], s101 offen
    v_cvt_pk_bf16_f32 v129, v82, v83
    v_cvt_pk_bf16_f32 v130, v84, v85
    v_cvt_pk_bf16_f32 v131, v86, v87
    ds_write_b128 v102, v[128:131] offset:0
    v_cvt_pk_bf16_f32 v132, v88, v89
    v_cvt_pk_bf16_f32 v133, v90, v91
    v_cvt_pk_bf16_f32 v134, v92, v93
    s_add_u32 m0, s53, 32768
    s_add_u32 s55, s54, 256
    buffer_load_dwordx4 v20, s[36:39], s55 offen offset:0 lds
    v_cvt_pk_bf16_f32 v135, v94, v95
    ds_write_b128 v102, v[132:135] offset:1024
    v_pk_fma_f32 v[80:81], v[100:101], v[88:89], v[80:81] op_sel:[1,0,0] op_sel_hi:[1,1,1] neg_lo:[0,0,1] neg_hi:[0,0,1]
    v_pk_fma_f32 v[82:83], v[100:101], v[90:91], v[82:83] op_sel:[1,0,0] op_sel_hi:[1,1,1] neg_lo:[0,0,1] neg_hi:[0,0,1]
    v_pk_fma_f32 v[84:85], v[100:101], v[92:93], v[84:85] op_sel:[1,0,0] op_sel_hi:[1,1,1] neg_lo:[0,0,1] neg_hi:[0,0,1]
    v_pk_fma_f32 v[86:87], v[100:101], v[94:95], v[86:87] op_sel:[1,0,0] op_sel_hi:[1,1,1] neg_lo:[0,0,1] neg_hi:[0,0,1]
    v_cvt_pk_bf16_f32 v136, v80, v81
    buffer_load_dwordx4 v21, s[36:39], s55 offen offset:1024 lds
    v_cvt_pk_bf16_f32 v137, v82, v83
    v_cvt_pk_bf16_f32 v138, v84, v85
    v_cvt_pk_bf16_f32 v139, v86, v87
    ds_write_b128 v102, v[136:139] offset:2048
    v_pk_fma_f32 v[88:89], v[100:101], v[80:81], v[88:89] op_sel:[1,0,0] op_sel_hi:[1,1,1] neg_lo:[0,0,1] neg_hi:[0,0,1]
    v_pk_fma_f32 v[90:91], v[100:101], v[82:83], v[90:91] op_sel:[1,0,0] op_sel_hi:[1,1,1] neg_lo:[0,0,1] neg_hi:[0,0,1]
    v_pk_fma_f32 v[92:93], v[100:101], v[84:85], v[92:93] op_sel:[1,0,0] op_sel_hi:[1,1,1] neg_lo:[0,0,1] neg_hi:[0,0,1]
    buffer_load_dwordx4 v22, s[36:39], s55 offen offset:2048 lds
    v_pk_fma_f32 v[94:95], v[100:101], v[86:87], v[94:95] op_sel:[1,0,0] op_sel_hi:[1,1,1] neg_lo:[0,0,1] neg_hi:[0,0,1]
    v_cvt_pk_bf16_f32 v140, v88, v89
    v_cvt_pk_bf16_f32 v141, v90, v91
    v_cvt_pk_bf16_f32 v142, v92, v93
    v_cvt_pk_bf16_f32 v143, v94, v95
    ds_write_b128 v102, v[140:143] offset:3072
    v_bfe_u32 v99, v1, 1, 3
    buffer_load_dwordx4 v23, s[36:39], s55 offen offset:3072 lds
    v_xor_b32 v99, v99, v15
    v_lshl_add_u32 v100, v14, 7, s53
    v_xor_b32 v101, 0, v99
    v_lshl_add_u32 v24, v101, 4, v100
    v_add_u32 v28, 0x10000, v24
    v_xor_b32 v101, 2, v99
    v_lshl_add_u32 v25, v101, 4, v100
    v_add_u32 v29, 0x10000, v25
    v_xor_b32 v101, 4, v99
    v_lshl_add_u32 v26, v101, 4, v100
    v_add_u32 v30, 0x10000, v26
    v_xor_b32 v101, 6, v99
    s_add_u32 m0, s53, 49152
    s_add_u32 s55, s54, 384
    buffer_load_dwordx4 v20, s[36:39], s55 offen offset:0 lds
    v_lshl_add_u32 v27, v101, 4, v100
    v_add_u32 v31, 0x10000, v27
    v_mov_b32 v208, 0x3f803f80
    v_mov_b32 v209, 0x3f803f80
    v_add_u32 v102, 147456, v2
    s_waitcnt lgkmcnt(0)
    s_barrier
    ds_read_b128 v[128:131], v102 offset:0
    ds_read_b128 v[132:135], v102 offset:1024
    ds_read_b128 v[136:139], v102 offset:2048
    ds_read_b128 v[140:143], v102 offset:3072
    ds_read_b128 v[144:147], v102 offset:4096
    ds_read_b128 v[148:151], v102 offset:5120
    buffer_load_dwordx4 v21, s[36:39], s55 offen offset:1024 lds
    ds_read_b128 v[152:155], v102 offset:6144
    ds_read_b128 v[156:159], v102 offset:7168
    ds_read_b128 v[160:163], v102 offset:8192
    ds_read_b128 v[164:167], v102 offset:9216
    ds_read_b128 v[168:171], v102 offset:10240
    ds_read_b128 v[172:175], v102 offset:11264
    ds_read_b128 v[176:179], v102 offset:12288
    ds_read_b128 v[180:183], v102 offset:13312
    ds_read_b128 v[184:187], v102 offset:14336
    s_waitcnt lgkmcnt(14)
    ds_read_b128 v[188:191], v102 offset:15360
    s_cmp_lg_u32 s57, 896
    s_cbranch_scc1 F_NONCE_B
    s_waitcnt vmcnt(21)
    s_mov_b32 s56, -3
F_NONCE_L:
    s_add_u32 s56, s56, 4
    v_subrev_u32 v216, s56, v212
    v_subrev_u32 v217, s56, v213
    v_subrev_u32 v218, s56, v214
    v_subrev_u32 v219, s56, v215
    v_min_u32 v216, v216, v217
    v_min3_u32 v216, v216, v218, v219
    v_cmp_ge_u32 vcc, 3, v216
    s_nop 1
    s_cbranch_vccnz F_NONCE_L
    v_mov_b32 v220, s56
    v_mov_b32 v221, 0
    s_mov_b64 exec, 1
    buffer_store_dword v220, v221, s[48:51], 0 offen sc1
    s_mov_b64 exec, -1
    s_nop 1
F_NONCE_B:
    v_bfe_u32 v99, v1, 2, 1
    buffer_load_dwordx4 v22, s[36:39], s55 offen offset:2048 lds
    v_bfe_u32 v100, v1, 3, 2
    v_lshlrev_b32 v100, 2, v100
    v_lshl_add_u32 v99, v99, 4, v100
    v_and_or_b32 v99, v1, 3, v99
    v_cvt_f32_u32 v99, v99
    v_lshl_add_u32 v100, v15, 8, s19
    v_cvt_f32_u32 v100, v100
    v_mul_f32 v100, 0x3c800000, v100
    v_mul_f32 v99, 0x3d000000, v99
    v_mul_f32 v81, v100, v99
    v_mul_f32 v101, 0x41000000, v99
    buffer_load_dwordx4 v23, s[36:39], s55 offen offset:3072 lds
    v_add_f32 v83, v81, v99
    v_add_f32 v89, v81, v101
    v_add_f32 v91, v83, v101
    v_cos_f32 v100, v99
    v_cos_f32 v101, v101
    v_cos_f32 v80, v81
    v_sin_f32 v81, v81
    v_cos_f32 v82, v83
    s_add_u32 m0, s53, 65536
    s_add_u32 s55, s54, 512
    buffer_load_dwordx4 v20, s[36:39], s55 offen offset:0 lds
    v_sin_f32 v83, v83
    v_cos_f32 v88, v89
    v_sin_f32 v89, v89
    v_cos_f32 v90, v91
    v_sin_f32 v91, v91
    v_pk_add_f32 v[100:101], v[100:101], v[100:101]
    buffer_load_dwordx4 v21, s[36:39], s55 offen offset:1024 lds
    v_pk_fma_f32 v[84:85], v[100:101], v[82:83], v[80:81] op_sel_hi:[0,1,1] neg_lo:[0,0,1] neg_hi:[0,0,1]
    v_pk_fma_f32 v[92:93], v[100:101], v[90:91], v[88:89] op_sel_hi:[0,1,1] neg_lo:[0,0,1] neg_hi:[0,0,1]
    v_pk_fma_f32 v[86:87], v[100:101], v[84:85], v[82:83] op_sel_hi:[0,1,1] neg_lo:[0,0,1] neg_hi:[0,0,1]
    v_pk_fma_f32 v[94:95], v[100:101], v[92:93], v[90:91] op_sel_hi:[0,1,1] neg_lo:[0,0,1] neg_hi:[0,0,1]
    v_cvt_pk_bf16_f32 v112, v80, v82
    v_cvt_pk_bf16_f32 v113, v84, v86
    v_cvt_pk_bf16_f32 v114, v88, v90
    v_cvt_pk_bf16_f32 v115, v92, v94
    v_cvt_pk_bf16_f32 v120, v81, v83
    v_cvt_pk_bf16_f32 v121, v85, v87
    v_cvt_pk_bf16_f32 v122, v89, v91
    v_cvt_pk_bf16_f32 v123, v93, v95
    buffer_load_dwordx4 v22, s[36:39], s55 offen offset:2048 lds
    v_pk_fma_f32 v[80:81], v[100:101], v[88:89], v[80:81] op_sel:[1,0,0] op_sel_hi:[1,1,1] neg_lo:[0,0,1] neg_hi:[0,0,1]
    v_pk_fma_f32 v[82:83], v[100:101], v[90:91], v[82:83] op_sel:[1,0,0] op_sel_hi:[1,1,1] neg_lo:[0,0,1] neg_hi:[0,0,1]
    v_pk_fma_f32 v[84:85], v[100:101], v[92:93], v[84:85] op_sel:[1,0,0] op_sel_hi:[1,1,1] neg_lo:[0,0,1] neg_hi:[0,0,1]
    v_pk_fma_f32 v[86:87], v[100:101], v[94:95], v[86:87] op_sel:[1,0,0] op_sel_hi:[1,1,1] neg_lo:[0,0,1] neg_hi:[0,0,1]
    v_pk_fma_f32 v[88:89], v[100:101], v[80:81], v[88:89] op_sel:[1,0,0] op_sel_hi:[1,1,1] neg_lo:[0,0,1] neg_hi:[0,0,1]
    v_pk_fma_f32 v[90:91], v[100:101], v[82:83], v[90:91] op_sel:[1,0,0] op_sel_hi:[1,1,1] neg_lo:[0,0,1] neg_hi:[0,0,1]
    v_pk_fma_f32 v[92:93], v[100:101], v[84:85], v[92:93] op_sel:[1,0,0] op_sel_hi:[1,1,1] neg_lo:[0,0,1] neg_hi:[0,0,1]
    v_pk_fma_f32 v[94:95], v[100:101], v[86:87], v[94:95] op_sel:[1,0,0] op_sel_hi:[1,1,1] neg_lo:[0,0,1] neg_hi:[0,0,1]
    v_cvt_pk_bf16_f32 v116, v80, v82
    v_cvt_pk_bf16_f32 v117, v84, v86
    v_cvt_pk_bf16_f32 v118, v88, v90
    v_cvt_pk_bf16_f32 v119, v92, v94
    buffer_load_dwordx4 v23, s[36:39], s55 offen offset:3072 lds
    v_cvt_pk_bf16_f32 v124, v81, v83
    v_cvt_pk_bf16_f32 v125, v85, v87
    v_cvt_pk_bf16_f32 v126, v89, v91
    v_cvt_pk_bf16_f32 v127, v93, v95
    s_mov_b32 s40, s8
    s_mov_b32 s41, s9
    s_mov_b32 s42, 1052672
    s_mov_b32 s43, 0x00020000
    s_mov_b32 s44, s10
    s_mov_b32 s45, s11
    s_mov_b32 s46, 1052672
    s_mov_b32 s47, 0x00020000
    s_add_u32 m0, s53, 81920
    s_add_u32 s55, s54, 640
    buffer_load_dwordx4 v20, s[36:39], s55 offen offset:0 lds
    s_lshr_b32 s61, s17, 4
    s_lshl_b32 s61, s61, 2
    s_add_u32 s61, s61, s18
    v_lshrrev_b32 v231, 4, v1
    v_mul_u32_u24 v230, 514, v231
    v_and_b32 v232, 15, v1
    v_lshl_add_u32 v230, v232, 2, v230
    s_bfe_u32 s60, s17, 0x10003
    s_lshl_b32 s8, s16, 1
    s_add_u32 s60, s60, s8
    s_and_b32 s8, s17, 7
    s_lshl_b32 s60, s60, 3
    buffer_load_dwordx4 v21, s[36:39], s55 offen offset:1024 lds
    s_add_u32 s8, s8, s60
    s_lshl_b32 s23, s8, 6
    s_lshl_b32 s9, s61, 18
    s_add_u32 s23, s23, s9
    s_add_u32 s23, s23, 4194304
    s_mul_i32 s60, s60, 3
    s_add_u32 s8, s8, s60
    s_mul_i32 s8, s8, 2056
    s_lshl_b32 s61, s61, 6
    s_add_u32 s8, s8, s61
    s_waitcnt vmcnt(25)
    s_waitcnt lgkmcnt(14)
    ds_read_b128 a[0:3], v24 offset:0
    s_waitcnt lgkmcnt(14)
    ds_read_b128 a[4:7], v25 offset:0
    s_waitcnt lgkmcnt(14)
    ds_read_b128 a[8:11], v26 offset:0
    s_waitcnt lgkmcnt(14)
    ds_read_b128 a[12:15], v27 offset:0
    s_waitcnt lgkmcnt(0)
    s_waitcnt vmcnt(21)
    v_mfma_f32_32x32x16_bf16 v[80:95], a[0:3], v[128:131], 0
    ds_read_b128 a[16:19], v24 offset:16384
    buffer_load_dwordx4 v22, s[36:39], s55 offen offset:2048 lds
    v_mfma_f32_4x4x4_16b_bf16 v[192:195], v[208:209], a[0:1], 0
    v_mfma_f32_4x4x4_16b_bf16 v[200:203], a[0:1], a[0:1], 0
    v_mfma_f32_4x4x4_16b_bf16 v[196:199], v[208:209], a[2:3], 0
    v_mfma_f32_4x4x4_16b_bf16 v[204:207], a[2:3], a[2:3], 0
    v_mfma_f32_32x32x16_bf16 v[80:95], a[4:7], v[132:135], v[80:95]
    ds_read_b128 a[20:23], v25 offset:16384
    buffer_load_dwordx4 v23, s[36:39], s55 offen offset:3072 lds
    v_mfma_f32_4x4x4_16b_bf16 v[192:195], v[208:209], a[4:5], v[192:195]
    v_mfma_f32_4x4x4_16b_bf16 v[200:203], a[4:5], a[4:5], v[200:203]
    v_mfma_f32_4x4x4_16b_bf16 v[196:199], v[208:209], a[6:7], v[196:199]
    v_mfma_f32_4x4x4_16b_bf16 v[204:207], a[6:7], a[6:7], v[204:207]
    v_mfma_f32_32x32x16_bf16 v[80:95], a[8:11], v[136:139], v[80:95]
    ds_read_b128 a[24:27], v26 offset:16384
    s_add_u32 m0, s53, 98304
    s_add_u32 s55, s54, 768
    buffer_load_dwordx4 v20, s[36:39], s55 offen offset:0 lds
    v_mfma_f32_4x4x4_16b_bf16 v[192:195], v[208:209], a[8:9], v[192:195]
    v_mfma_f32_4x4x4_16b_bf16 v[200:203], a[8:9], a[8:9], v[200:203]
    v_mfma_f32_4x4x4_16b_bf16 v[196:199], v[208:209], a[10:11], v[196:199]
    v_mfma_f32_4x4x4_16b_bf16 v[204:207], a[10:11], a[10:11], v[204:207]
    v_mfma_f32_32x32x16_bf16 v[80:95], a[12:15], v[140:143], v[80:95]
    ds_read_b128 a[28:31], v27 offset:16384
    buffer_load_dwordx4 v21, s[36:39], s55 offen offset:1024 lds
    v_mfma_f32_4x4x4_16b_bf16 v[192:195], v[208:209], a[12:13], v[192:195]
    v_mfma_f32_4x4x4_16b_bf16 v[200:203], a[12:13], a[12:13], v[200:203]
    v_mfma_f32_4x4x4_16b_bf16 v[196:199], v[208:209], a[14:15], v[196:199]
    v_mfma_f32_4x4x4_16b_bf16 v[204:207], a[14:15], a[14:15], v[204:207]
    s_waitcnt lgkmcnt(0)
    s_waitcnt vmcnt(14)
    v_mfma_f32_32x32x16_bf16 v[80:95], a[16:19], v[144:147], v[80:95]
    ds_read_b128 a[32:35], v24 offset:32768
    buffer_load_dwordx4 v22, s[36:39], s55 offen offset:2048 lds
    v_mfma_f32_4x4x4_16b_bf16 v[192:195], v[208:209], a[16:17], v[192:195]
    v_mfma_f32_4x4x4_16b_bf16 v[200:203], a[16:17], a[16:17], v[200:203]
    v_mfma_f32_4x4x4_16b_bf16 v[196:199], v[208:209], a[18:19], v[196:199]
    v_mfma_f32_4x4x4_16b_bf16 v[204:207], a[18:19], a[18:19], v[204:207]
    v_mfma_f32_32x32x16_bf16 v[80:95], a[20:23], v[148:151], v[80:95]
    ds_read_b128 a[36:39], v25 offset:32768
    buffer_load_dwordx4 v23, s[36:39], s55 offen offset:3072 lds
    v_mfma_f32_4x4x4_16b_bf16 v[192:195], v[208:209], a[20:21], v[192:195]
    v_mfma_f32_4x4x4_16b_bf16 v[200:203], a[20:21], a[20:21], v[200:203]
    v_mfma_f32_4x4x4_16b_bf16 v[196:199], v[208:209], a[22:23], v[196:199]
    v_mfma_f32_4x4x4_16b_bf16 v[204:207], a[22:23], a[22:23], v[204:207]
    v_mfma_f32_32x32x16_bf16 v[80:95], a[24:27], v[152:155], v[80:95]
    ds_read_b128 a[40:43], v26 offset:32768
    s_add_u32 m0, s53, 114688
    s_add_u32 s55, s54, 896
    buffer_load_dwordx4 v20, s[36:39], s55 offen offset:0 lds
    v_mfma_f32_4x4x4_16b_bf16 v[192:195], v[208:209], a[24:25], v[192:195]
    v_mfma_f32_4x4x4_16b_bf16 v[200:203], a[24:25], a[24:25], v[200:203]
    v_mfma_f32_4x4x4_16b_bf16 v[196:199], v[208:209], a[26:27], v[196:199]
    v_mfma_f32_4x4x4_16b_bf16 v[204:207], a[26:27], a[26:27], v[204:207]
    v_mfma_f32_32x32x16_bf16 v[80:95], a[28:31], v[156:159], v[80:95]
    ds_read_b128 a[44:47], v27 offset:32768
    buffer_load_dwordx4 v21, s[36:39], s55 offen offset:1024 lds
    v_mfma_f32_4x4x4_16b_bf16 v[192:195], v[208:209], a[28:29], v[192:195]
    v_mfma_f32_4x4x4_16b_bf16 v[200:203], a[28:29], a[28:29], v[200:203]
    v_mfma_f32_4x4x4_16b_bf16 v[196:199], v[208:209], a[30:31], v[196:199]
    v_mfma_f32_4x4x4_16b_bf16 v[204:207], a[30:31], a[30:31], v[204:207]
    v_mov_b32 v229, 0
    buffer_load_dword v228, v229, s[48:51], 0 offen sc1
    s_waitcnt lgkmcnt(0)
    s_waitcnt vmcnt(15)
    v_mfma_f32_32x32x16_bf16 v[80:95], a[32:35], v[160:163], v[80:95]
    ds_read_b128 a[48:51], v24 offset:49152
    buffer_load_dwordx4 v22, s[36:39], s55 offen offset:2048 lds
    v_mfma_f32_4x4x4_16b_bf16 v[192:195], v[208:209], a[32:33], v[192:195]
    v_mfma_f32_4x4x4_16b_bf16 v[200:203], a[32:33], a[32:33], v[200:203]
    v_mfma_f32_4x4x4_16b_bf16 v[196:199], v[208:209], a[34:35], v[196:199]
    v_mfma_f32_4x4x4_16b_bf16 v[204:207], a[34:35], a[34:35], v[204:207]
    v_mfma_f32_32x32x16_bf16 v[80:95], a[36:39], v[164:167], v[80:95]
    ds_read_b128 a[52:55], v25 offset:49152
    buffer_load_dwordx4 v23, s[36:39], s55 offen offset:3072 lds
    v_mfma_f32_4x4x4_16b_bf16 v[192:195], v[208:209], a[36:37], v[192:195]
    v_mfma_f32_4x4x4_16b_bf16 v[200:203], a[36:37], a[36:37], v[200:203]
    v_mfma_f32_4x4x4_16b_bf16 v[196:199], v[208:209], a[38:39], v[196:199]
    v_mfma_f32_4x4x4_16b_bf16 v[204:207], a[38:39], a[38:39], v[204:207]
    v_mfma_f32_32x32x16_bf16 v[80:95], a[40:43], v[168:171], v[80:95]
    ds_read_b128 a[56:59], v26 offset:49152
    buffer_load_dword v52, v230, s[40:43], s8 offen offset:2
    v_mfma_f32_4x4x4_16b_bf16 v[192:195], v[208:209], a[40:41], v[192:195]
    v_mfma_f32_4x4x4_16b_bf16 v[200:203], a[40:41], a[40:41], v[200:203]
    v_mfma_f32_4x4x4_16b_bf16 v[196:199], v[208:209], a[42:43], v[196:199]
    v_mfma_f32_4x4x4_16b_bf16 v[204:207], a[42:43], a[42:43], v[204:207]
    v_mfma_f32_32x32x16_bf16 v[80:95], a[44:47], v[172:175], v[80:95]
    ds_read_b128 a[60:63], v27 offset:49152
    buffer_load_dword v60, v230, s[44:47], s8 offen offset:2
    v_mfma_f32_4x4x4_16b_bf16 v[192:195], v[208:209], a[44:45], v[192:195]
    v_mfma_f32_4x4x4_16b_bf16 v[200:203], a[44:45], a[44:45], v[200:203]
    v_mfma_f32_4x4x4_16b_bf16 v[196:199], v[208:209], a[46:47], v[196:199]
    v_mfma_f32_4x4x4_16b_bf16 v[204:207], a[46:47], a[46:47], v[204:207]
    s_waitcnt lgkmcnt(0)
    s_waitcnt vmcnt(15)
    v_mfma_f32_32x32x16_bf16 v[80:95], a[48:51], v[176:179], v[80:95]
    ds_read_b128 a[64:67], v28 offset:0
    s_add_u32 s8, s8, 16448
    buffer_load_dword v53, v230, s[40:43], s8 offen offset:2
    v_mfma_f32_4x4x4_16b_bf16 v[192:195], v[208:209], a[48:49], v[192:195]
    v_mfma_f32_4x4x4_16b_bf16 v[200:203], a[48:49], a[48:49], v[200:203]
    v_mfma_f32_4x4x4_16b_bf16 v[196:199], v[208:209], a[50:51], v[196:199]
    v_mfma_f32_4x4x4_16b_bf16 v[204:207], a[50:51], a[50:51], v[204:207]
    v_mfma_f32_32x32x16_bf16 v[80:95], a[52:55], v[180:183], v[80:95]
    ds_read_b128 a[68:71], v29 offset:0
    buffer_load_dword v61, v230, s[44:47], s8 offen offset:2
    v_mfma_f32_4x4x4_16b_bf16 v[192:195], v[208:209], a[52:53], v[192:195]
    v_mfma_f32_4x4x4_16b_bf16 v[200:203], a[52:53], a[52:53], v[200:203]
    v_mfma_f32_4x4x4_16b_bf16 v[196:199], v[208:209], a[54:55], v[196:199]
    v_mfma_f32_4x4x4_16b_bf16 v[204:207], a[54:55], a[54:55], v[204:207]
    v_mfma_f32_32x32x16_bf16 v[80:95], a[56:59], v[184:187], v[80:95]
    ds_read_b128 a[72:75], v30 offset:0
    s_add_u32 s8, s8, 16448
    buffer_load_dword v54, v230, s[40:43], s8 offen offset:2
    v_mfma_f32_4x4x4_16b_bf16 v[192:195], v[208:209], a[56:57], v[192:195]
    v_mfma_f32_4x4x4_16b_bf16 v[200:203], a[56:57], a[56:57], v[200:203]
    v_mfma_f32_4x4x4_16b_bf16 v[196:199], v[208:209], a[58:59], v[196:199]
    v_mfma_f32_4x4x4_16b_bf16 v[204:207], a[58:59], a[58:59], v[204:207]
    v_mfma_f32_32x32x16_bf16 v[80:95], a[60:63], v[188:191], v[80:95]
    ds_read_b128 a[76:79], v31 offset:0
    buffer_load_dword v62, v230, s[44:47], s8 offen offset:2
    v_mfma_f32_4x4x4_16b_bf16 v[192:195], v[208:209], a[60:61], v[192:195]
    v_mfma_f32_4x4x4_16b_bf16 v[200:203], a[60:61], a[60:61], v[200:203]
    v_mfma_f32_4x4x4_16b_bf16 v[196:199], v[208:209], a[62:63], v[196:199]
    v_mfma_f32_4x4x4_16b_bf16 v[204:207], a[62:63], a[62:63], v[204:207]
    s_waitcnt lgkmcnt(0)
    s_waitcnt vmcnt(15)
    v_mfma_f32_32x32x16_bf16 v[96:111], a[64:67], v[128:131], 0
    ds_read_b128 a[80:83], v28 offset:16384
    s_add_u32 s8, s8, 16448
    buffer_load_dword v55, v230, s[40:43], s8 offen offset:2
    v_mfma_f32_4x4x4_16b_bf16 v[192:195], v[208:209], a[64:65], v[192:195]
    v_mfma_f32_4x4x4_16b_bf16 v[200:203], a[64:65], a[64:65], v[200:203]
    v_mfma_f32_4x4x4_16b_bf16 v[196:199], v[208:209], a[66:67], v[196:199]
    v_mfma_f32_4x4x4_16b_bf16 v[204:207], a[66:67], a[66:67], v[204:207]
    v_mfma_f32_32x32x16_bf16 v[96:111], a[68:71], v[132:135], v[96:111]
    ds_read_b128 a[84:87], v29 offset:16384
    buffer_load_dword v63, v230, s[44:47], s8 offen offset:2
    v_mfma_f32_4x4x4_16b_bf16 v[192:195], v[208:209], a[68:69], v[192:195]
    v_mfma_f32_4x4x4_16b_bf16 v[200:203], a[68:69], a[68:69], v[200:203]
    v_mfma_f32_4x4x4_16b_bf16 v[196:199], v[208:209], a[70:71], v[196:199]
    v_mfma_f32_4x4x4_16b_bf16 v[204:207], a[70:71], a[70:71], v[204:207]
    v_mfma_f32_32x32x16_bf16 v[96:111], a[72:75], v[136:139], v[96:111]
    ds_read_b128 a[88:91], v30 offset:16384
    v_mfma_f32_4x4x4_16b_bf16 v[192:195], v[208:209], a[72:73], v[192:195]
    v_mfma_f32_4x4x4_16b_bf16 v[200:203], a[72:73], a[72:73], v[200:203]
    v_mfma_f32_4x4x4_16b_bf16 v[196:199], v[208:209], a[74:75], v[196:199]
    v_mfma_f32_4x4x4_16b_bf16 v[204:207], a[74:75], a[74:75], v[204:207]
    v_mfma_f32_32x32x16_bf16 v[96:111], a[76:79], v[140:143], v[96:111]
    ds_read_b128 a[92:95], v31 offset:16384
    v_mfma_f32_4x4x4_16b_bf16 v[192:195], v[208:209], a[76:77], v[192:195]
    v_mfma_f32_4x4x4_16b_bf16 v[200:203], a[76:77], a[76:77], v[200:203]
    v_mfma_f32_4x4x4_16b_bf16 v[196:199], v[208:209], a[78:79], v[196:199]
    v_mfma_f32_4x4x4_16b_bf16 v[204:207], a[78:79], a[78:79], v[204:207]
    s_waitcnt lgkmcnt(0)
    s_waitcnt vmcnt(13)
    v_mfma_f32_32x32x16_bf16 v[96:111], a[80:83], v[144:147], v[96:111]
    ds_read_b128 a[96:99], v28 offset:32768
    v_mfma_f32_4x4x4_16b_bf16 v[192:195], v[208:209], a[80:81], v[192:195]
    v_mfma_f32_4x4x4_16b_bf16 v[200:203], a[80:81], a[80:81], v[200:203]
    v_mfma_f32_4x4x4_16b_bf16 v[196:199], v[208:209], a[82:83], v[196:199]
    v_mfma_f32_4x4x4_16b_bf16 v[204:207], a[82:83], a[82:83], v[204:207]
    v_mfma_f32_32x32x16_bf16 v[96:111], a[84:87], v[148:151], v[96:111]
    ds_read_b128 a[100:103], v29 offset:32768
    v_mfma_f32_4x4x4_16b_bf16 v[192:195], v[208:209], a[84:85], v[192:195]
    v_mfma_f32_4x4x4_16b_bf16 v[200:203], a[84:85], a[84:85], v[200:203]
    v_mfma_f32_4x4x4_16b_bf16 v[196:199], v[208:209], a[86:87], v[196:199]
    v_mfma_f32_4x4x4_16b_bf16 v[204:207], a[86:87], a[86:87], v[204:207]
    v_mfma_f32_32x32x16_bf16 v[96:111], a[88:91], v[152:155], v[96:111]
    ds_read_b128 a[104:107], v30 offset:32768
    v_mfma_f32_4x4x4_16b_bf16 v[192:195], v[208:209], a[88:89], v[192:195]
    v_mfma_f32_4x4x4_16b_bf16 v[200:203], a[88:89], a[88:89], v[200:203]
    v_mfma_f32_4x4x4_16b_bf16 v[196:199], v[208:209], a[90:91], v[196:199]
    v_mfma_f32_4x4x4_16b_bf16 v[204:207], a[90:91], a[90:91], v[204:207]
    v_mfma_f32_32x32x16_bf16 v[96:111], a[92:95], v[156:159], v[96:111]
    ds_read_b128 a[108:111], v31 offset:32768
    v_mfma_f32_4x4x4_16b_bf16 v[192:195], v[208:209], a[92:93], v[192:195]
    v_mfma_f32_4x4x4_16b_bf16 v[200:203], a[92:93], a[92:93], v[200:203]
    v_mfma_f32_4x4x4_16b_bf16 v[196:199], v[208:209], a[94:95], v[196:199]
    v_mfma_f32_4x4x4_16b_bf16 v[204:207], a[94:95], a[94:95], v[204:207]
    s_waitcnt lgkmcnt(0)
    s_waitcnt vmcnt(8)
    v_mfma_f32_32x32x16_bf16 v[96:111], a[96:99], v[160:163], v[96:111]
    ds_read_b128 a[112:115], v28 offset:49152
    v_mfma_f32_4x4x4_16b_bf16 v[192:195], v[208:209], a[96:97], v[192:195]
    v_mfma_f32_4x4x4_16b_bf16 v[200:203], a[96:97], a[96:97], v[200:203]
    v_mfma_f32_4x4x4_16b_bf16 v[196:199], v[208:209], a[98:99], v[196:199]
    v_mfma_f32_4x4x4_16b_bf16 v[204:207], a[98:99], a[98:99], v[204:207]
    v_mfma_f32_32x32x16_bf16 v[96:111], a[100:103], v[164:167], v[96:111]
    ds_read_b128 a[116:119], v29 offset:49152
    v_mfma_f32_4x4x4_16b_bf16 v[192:195], v[208:209], a[100:101], v[192:195]
    v_mfma_f32_4x4x4_16b_bf16 v[200:203], a[100:101], a[100:101], v[200:203]
    v_mfma_f32_4x4x4_16b_bf16 v[196:199], v[208:209], a[102:103], v[196:199]
    v_mfma_f32_4x4x4_16b_bf16 v[204:207], a[102:103], a[102:103], v[204:207]
    v_mfma_f32_32x32x16_bf16 v[96:111], a[104:107], v[168:171], v[96:111]
    ds_read_b128 a[120:123], v30 offset:49152
    v_mfma_f32_4x4x4_16b_bf16 v[192:195], v[208:209], a[104:105], v[192:195]
    v_mfma_f32_4x4x4_16b_bf16 v[200:203], a[104:105], a[104:105], v[200:203]
    v_mfma_f32_4x4x4_16b_bf16 v[196:199], v[208:209], a[106:107], v[196:199]
    v_mfma_f32_4x4x4_16b_bf16 v[204:207], a[106:107], a[106:107], v[204:207]
    v_mfma_f32_32x32x16_bf16 v[96:111], a[108:111], v[172:175], v[96:111]
    ds_read_b128 a[124:127], v31 offset:49152
    v_mfma_f32_4x4x4_16b_bf16 v[192:195], v[208:209], a[108:109], v[192:195]
    v_mfma_f32_4x4x4_16b_bf16 v[200:203], a[108:109], a[108:109], v[200:203]
    v_mfma_f32_4x4x4_16b_bf16 v[196:199], v[208:209], a[110:111], v[196:199]
    v_mfma_f32_4x4x4_16b_bf16 v[204:207], a[110:111], a[110:111], v[204:207]
    s_waitcnt lgkmcnt(0)
    v_mfma_f32_32x32x16_bf16 v[96:111], a[112:115], v[176:179], v[96:111]
    v_mfma_f32_4x4x4_16b_bf16 v[192:195], v[208:209], a[112:113], v[192:195]
    v_mfma_f32_4x4x4_16b_bf16 v[200:203], a[112:113], a[112:113], v[200:203]
    v_mfma_f32_4x4x4_16b_bf16 v[196:199], v[208:209], a[114:115], v[196:199]
    v_mfma_f32_4x4x4_16b_bf16 v[204:207], a[114:115], a[114:115], v[204:207]
    v_mfma_f32_32x32x16_bf16 v[96:111], a[116:119], v[180:183], v[96:111]
    v_mfma_f32_4x4x4_16b_bf16 v[192:195], v[208:209], a[116:117], v[192:195]
    v_mfma_f32_4x4x4_16b_bf16 v[200:203], a[116:117], a[116:117], v[200:203]
    v_mfma_f32_4x4x4_16b_bf16 v[196:199], v[208:209], a[118:119], v[196:199]
    v_mfma_f32_4x4x4_16b_bf16 v[204:207], a[118:119], a[118:119], v[204:207]
    v_mfma_f32_32x32x16_bf16 v[96:111], a[120:123], v[184:187], v[96:111]
    v_mfma_f32_4x4x4_16b_bf16 v[192:195], v[208:209], a[120:121], v[192:195]
    v_mfma_f32_4x4x4_16b_bf16 v[200:203], a[120:121], a[120:121], v[200:203]
    v_mfma_f32_4x4x4_16b_bf16 v[196:199], v[208:209], a[122:123], v[196:199]
    v_mfma_f32_4x4x4_16b_bf16 v[204:207], a[122:123], a[122:123], v[204:207]
    v_mfma_f32_32x32x16_bf16 v[96:111], a[124:127], v[188:191], v[96:111]
    v_mfma_f32_4x4x4_16b_bf16 v[192:195], v[208:209], a[124:125], v[192:195]
    v_mfma_f32_4x4x4_16b_bf16 v[200:203], a[124:125], a[124:125], v[200:203]
    v_mfma_f32_4x4x4_16b_bf16 v[196:199], v[208:209], a[126:127], v[196:199]
    v_mfma_f32_4x4x4_16b_bf16 v[204:207], a[126:127], a[126:127], v[204:207]
    s_barrier
    s_getpc_b64 s[32:33]
F_TPC:
    s_add_u32 s32, s32, FFT_TBL-F_TPC
    s_addc_u32 s33, s33, 0
    s_mov_b32 s34, 49152
    s_mov_b32 s35, 0x00020000
    v_and_b32 v45, 3, v1
    v_add_f32 v200, v200, v204
    v_add_f32 v201, v201, v205
    v_add_f32 v202, v202, v206
    v_add_f32 v203, v203, v207
    v_add_f32 v44, v192, v196
    v_cmp_eq_u32 vcc, 1, v45
    v_fma_f32 v81, v97, v210, v81
    v_fma_f32 v85, v101, v210, v85
    v_cndmask_b32 v200, v200, v201, vcc
    v_cmp_eq_u32 vcc, 2, v45
    v_fma_f32 v82, v98, v210, v82
    v_fma_f32 v86, v102, v210, v86
    v_cndmask_b32 v200, v200, v202, vcc
    v_cmp_eq_u32 vcc, 3, v45
    v_fma_f32 v83, v99, v210, v83
    v_fma_f32 v87, v103, v210, v87
    v_cndmask_b32 v46, v200, v203, vcc
    v_mov_b32 v45, v44
    v_mov_b32 v47, v46
    s_add_u32 s60, s53, 114688
    v_lshl_add_u32 v68, v14, 2, s60
    v_permlane32_swap_b32 v44, v45
    v_permlane32_swap_b32 v46, v47
    v_add_f32 v44, v44, v45
    v_add_f32 v46, v46, v47
    v_mul_f32 v44, 0x3b000000, v44
    v_mul_f32 v46, 0x3b000000, v46
    v_fma_f32 v46, -v44, v44, v46
    v_max_f32 v46, 0, v46
    v_cvt_pk_bf16_f32 v44, v44, v46
    v_and_b32 v46, 0xffff0000, v44
    v_add_f32 v46, 0x3727c5ac, v46
    v_cvt_pk_bf16_f32 v46, v46, v46
    v_and_b32 v46, 0xffff0000, v46
    v_sqrt_f32 v46, v46
    v_lshl_add_u32 v47, v15, 4, s60
    v_cvt_pk_bf16_f32 v46, v46, v46
    v_and_b32 v7, 0xffff0000, v46
    v_rcp_f32 v6, v7
    v_and_b32 v44, 0xffff, v44
    v_or_b32 v44, v44, v7
    ds_write2_b32 v68, v6, v44 offset0:0 offset1:32
    ds_read_b128 v[192:195], v47 offset:0
    ds_read_b128 v[196:199], v47 offset:32
    ds_read_b128 v[200:203], v47 offset:64
    ds_read_b128 v[204:207], v47 offset:96
    v_fma_f32 v80, v96, v210, v80
    v_fma_f32 v84, v100, v210, v84
    v_fma_f32 v88, v104, v210, v88
    v_fma_f32 v89, v105, v210, v89
    v_fma_f32 v90, v106, v210, v90
    v_fma_f32 v91, v107, v210, v91
    v_fma_f32 v92, v108, v210, v92
    v_fma_f32 v93, v109, v210, v93
    v_fma_f32 v94, v110, v210, v94
    v_fma_f32 v95, v111, v210, v95
    s_waitcnt lgkmcnt(3)
    v_mul_f32 v80, v80, v192
    v_mul_f32 v81, v81, v193
    v_mul_f32 v82, v82, v194
    v_mul_f32 v83, v83, v195
    s_waitcnt lgkmcnt(2)
    v_mul_f32 v84, v84, v196
    v_mul_f32 v85, v85, v197
    v_mul_f32 v86, v86, v198
    v_mul_f32 v87, v87, v199
    s_waitcnt lgkmcnt(1)
    v_mul_f32 v88, v88, v200
    v_mul_f32 v89, v89, v201
    v_mul_f32 v90, v90, v202
    v_mul_f32 v91, v91, v203
    s_waitcnt lgkmcnt(0)
    v_mul_f32 v92, v92, v204
    v_mul_f32 v93, v93, v205
    v_mul_f32 v94, v94, v206
    v_mul_f32 v95, v95, v207
    v_cvt_pk_bf16_f32 v72, v80, v81
    v_cvt_pk_bf16_f32 v73, v82, v83
    v_cvt_pk_bf16_f32 v74, v84, v85
    v_cvt_pk_bf16_f32 v75, v86, v87
    v_cvt_pk_bf16_f32 v76, v88, v89
    v_cvt_pk_bf16_f32 v77, v90, v91
    v_cvt_pk_bf16_f32 v78, v92, v93
    v_cvt_pk_bf16_f32 v79, v94, v95
    v_cmp_eq_u32 vcc, 0, v228
    s_nop 1
    s_cbranch_vccnz F_AW1_SPIN
F_AW1_OK:
    v_readfirstlane_b32 s22, v228
    v_mfma_f32_32x32x16_bf16 v[80:95], v[112:115], v[72:75], 0
    v_mfma_f32_32x32x16_bf16 v[96:111], v[120:123], v[72:75], 0
    v_mfma_f32_32x32x16_bf16 v[80:95], v[116:119], v[76:79], v[80:95]
    v_mfma_f32_32x32x16_bf16 v[96:111], v[124:127], v[76:79], v[96:111]
    s_add_u32 s62, s53, 147456
    v_lshlrev_b32 v211, 1, v1
    v_and_b32 v211, 0x70, v211
    v_xor_b32 v211, v211, v2
    v_add_u32 v211, s62, v211
    v_lshlrev_b32 v46, 31, v1
    v_or_b32 v46, 1.0, v46
    v_lshlrev_b32 v69, 6, v14
    v_lshl_add_u32 v69, v15, 5, v69
    v_lshlrev_b32 v70, 3, v1
    v_and_b32 v70, 0x70, v70
    v_xor_b32 v69, v69, v70
    v_add_u32 v69, s62, v69
    v_xor_b32 v70, 16, v69
    s_lshl_b32 s60, s20, 17
    s_lshl_b32 s61, s19, 7
    s_add_u32 s60, s60, s61
    s_add_u32 s60, s60, 2097152
    s_add_u32 s61, s60, 65536
    v_fmac_f32_dpp v80, v96, v46 quad_perm:[1,0,3,2] row_mask:0xf bank_mask:0xf
    v_fmac_f32_dpp v81, v97, v46 quad_perm:[1,0,3,2] row_mask:0xf bank_mask:0xf
    v_fmac_f32_dpp v82, v98, v46 quad_perm:[1,0,3,2] row_mask:0xf bank_mask:0xf
    v_fmac_f32_dpp v83, v99, v46 quad_perm:[1,0,3,2] row_mask:0xf bank_mask:0xf
    v_fmac_f32_dpp v84, v100, v46 quad_perm:[1,0,3,2] row_mask:0xf bank_mask:0xf
    v_fmac_f32_dpp v85, v101, v46 quad_perm:[1,0,3,2] row_mask:0xf bank_mask:0xf
    v_fmac_f32_dpp v86, v102, v46 quad_perm:[1,0,3,2] row_mask:0xf bank_mask:0xf
    v_fmac_f32_dpp v87, v103, v46 quad_perm:[1,0,3,2] row_mask:0xf bank_mask:0xf
    v_cvt_pk_bf16_f32 v72, v80, v81
    v_cvt_pk_bf16_f32 v73, v82, v83
    v_cvt_pk_bf16_f32 v74, v84, v85
    v_cvt_pk_bf16_f32 v75, v86, v87
    ds_write_b128 v69, v[72:75] offset:2048
    v_fmac_f32_dpp v88, v104, v46 quad_perm:[1,0,3,2] row_mask:0xf bank_mask:0xf
    v_fmac_f32_dpp v89, v105, v46 quad_perm:[1,0,3,2] row_mask:0xf bank_mask:0xf
    v_fmac_f32_dpp v90, v106, v46 quad_perm:[1,0,3,2] row_mask:0xf bank_mask:0xf
    v_fmac_f32_dpp v91, v107, v46 quad_perm:[1,0,3,2] row_mask:0xf bank_mask:0xf
    v_fmac_f32_dpp v92, v108, v46 quad_perm:[1,0,3,2] row_mask:0xf bank_mask:0xf
    v_fmac_f32_dpp v93, v109, v46 quad_perm:[1,0,3,2] row_mask:0xf bank_mask:0xf
    v_fmac_f32_dpp v94, v110, v46 quad_perm:[1,0,3,2] row_mask:0xf bank_mask:0xf
    v_fmac_f32_dpp v95, v111, v46 quad_perm:[1,0,3,2] row_mask:0xf bank_mask:0xf
    v_cvt_pk_bf16_f32 v76, v88, v89
    v_cvt_pk_bf16_f32 v77, v90, v91
    v_cvt_pk_bf16_f32 v78, v92, v93
    v_cvt_pk_bf16_f32 v79, v94, v95
    ds_write_b128 v70, v[76:79] offset:2048
    ds_read_b128 v[104:107], v211 offset:2048
    ds_read_b128 v[108:111], v211 offset:3072
    v_lshrrev_b32 v70, 3, v1
    v_lshlrev_b32 v70, 13, v70
    v_and_b32 v47, 7, v1
    v_lshl_add_u32 v70, v47, 4, v70
    s_waitcnt lgkmcnt(1)
    buffer_store_dwordx4 v[104:107], v70, s[24:27], s60 offen sc1
    s_waitcnt lgkmcnt(0)
    buffer_store_dwordx4 v[108:111], v70, s[24:27], s61 offen sc1
    s_add_u32 s9, s53, 147456
    v_lshl_add_u32 v232, v232, 7, s9
    v_and_b32 v230, 7, v1
    v_xor_b32 v231, v231, v230
    v_lshl_add_u32 v231, v231, 4, v232
    v_xor_b32 v232, 64, v231
    v_lshrrev_b32 v3, 2, v1
    v_lshlrev_b32 v3, 13, v3
    v_and_b32 v230, 3, v1
    v_lshl_add_u32 v3, v230, 4, v3
    s_mov_b32 s10, 0x05040100
    s_mov_b32 s11, 0x07060302
    s_add_u32 s9, s23, 131072
    s_waitcnt vmcnt(8)
    v_perm_b32 v48, v60, v52, s10
    s_waitcnt vmcnt(6)
    v_perm_b32 v49, v61, v53, s10
    s_waitcnt vmcnt(4)
    v_perm_b32 v50, v62, v54, s10
    s_waitcnt vmcnt(2)
    v_perm_b32 v51, v63, v55, s10
    ds_write_b128 v231, v[48:51]
    v_perm_b32 v56, v60, v52, s11
    v_perm_b32 v57, v61, v53, s11
    v_perm_b32 v58, v62, v54, s11
    v_perm_b32 v59, v63, v55, s11
    ds_write_b128 v232, v[56:59]
    ds_read_b128 v[48:51], v211
    ds_read_b128 v[56:59], v211 offset:1024
    s_waitcnt lgkmcnt(1)
    buffer_store_dwordx4 v[48:51], v3, s[24:27], s23 offen sc1
    s_waitcnt lgkmcnt(0)
    buffer_store_dwordx4 v[56:59], v3, s[24:27], s9 offen sc1
    s_and_b32 s60, s17, 3
    s_lshl_b32 s61, s16, 3
    s_lshl_b32 s60, s60, 1
    s_add_u32 s49, s60, s61
    s_lshr_b32 s50, s17, 2
    v_lshrrev_b32 v160, 3, v1
    v_and_b32 v161, 7, v1
    v_and_b32 v162, 2, v160
    v_lshlrev_b32 v162, 1, v162
    v_xor_b32 v161, v161, v162
    v_lshlrev_b32 v160, 10, v160
    v_lshl_add_u32 v252, v161, 4, v160
    v_add_u32 v253, 7168, v252
    v_add_u32 v254, 14336, v252
    v_add_u32 v255, 21504, v252
    s_mul_i32 s48, s18, 458752
    s_lshl_b32 s60, s50, 7
    s_add_u32 s48, s48, s60
    s_mov_b32 s40, s4
    s_mov_b32 s41, s5
    s_mov_b32 s42, 1835008
    s_mov_b32 s43, 0x00020000
    s_mov_b32 s44, s6
    s_mov_b32 s45, s7
    s_mov_b32 s46, 2097152
    s_mov_b32 s47, 0x00020000
    s_add_u32 m0, s53, 0
    s_mov_b32 s55, s53
    buffer_load_dwordx4 v2, s[32:35], s55 offen offset:0 lds
    buffer_load_dwordx4 v2, s[32:35], s55 offen offset:1024 lds
    buffer_load_dwordx4 v2, s[32:35], s55 offen offset:2048 lds
    buffer_load_dwordx4 v2, s[32:35], s55 offen offset:3072 lds
    s_lshl_b32 s55, s18, 13
    s_add_u32 m0, s55, 81920
    s_add_u32 s55, s55, 16384
    buffer_load_dwordx4 v2, s[32:35], s55 offen offset:0 lds
    buffer_load_dwordx4 v2, s[32:35], s55 offen offset:1024 lds
    v_add_u32 v152, 0x10000, v2
    s_lshl_b32 s56, s16, 2
    s_add_u32 s56, s56, s17
    s_sub_u32 s56, s56, 28
    s_lshl_b32 s57, s56, 3
    s_lshl_b32 s58, s18, 1
    s_add_u32 s57, s57, s58
    s_lshl_b32 s57, s57, 13
    s_add_u32 s58, s57, 2097152
    s_add_u32 s59, s57, 4194304
    s_lshl_b32 s54, s18, 14
    s_add_u32 s52, s54, 16384
    s_add_u32 s54, s54, 81920
    v_add_u32 v6, s54, v2
    v_lshlrev_b32 v3, 7, v0
    v_lshrrev_b32 v4, 3, v1
    v_and_b32 v4, 2, v4
    v_lshlrev_b32 v4, 5, v4
    v_xor_b32 v4, v4, v2
    v_bfe_u32 v12, v1, 2, 2
    v_lshl_add_u32 v5, v15, 2, v12
    v_lshlrev_b32 v5, 7, v5
    v_bfe_u32 v11, v1, 4, 1
    v_lshl_add_u32 v5, v11, 5, v5
    v_and_b32 v11, 3, v1
    v_lshl_add_u32 v5, v11, 3, v5
    v_and_b32 v12, 2, v12
    v_lshlrev_b32 v12, 5, v12
    v_xor_b32 v5, v5, v12
    v_add_u32 v5, s52, v5
    v_xor_b32 v12, 64, v5
    v_lshlrev_b32 v7, 2, v14
    v_lshl_add_u32 v8, v15, 8, v7
    v_lshl_add_u32 v7, v15, 11, v7
    s_lshl_b32 s60, s18, 7
    s_add_u32 s60, s60, 16384
    v_add_u32 v7, s60, v7
    s_add_u32 s60, s53, 16384
    v_add_u32 v8, s60, v8
    v_add_u32 v9, 128, v8
    s_waitcnt vmcnt(6)
    s_barrier
    s_add_u32 s100, s22, 1
    v_mov_b32 v76, s100
    s_cmp_eq_u32 s18, 0
    s_cselect_b32 s100, 0, 0x7ffffff0
    v_mov_b32 v77, s100
    s_lshl_b32 s100, s2, 7
    s_mov_b64 exec, 1
    buffer_store_dword v76, v77, s[24:27], s100 offen sc1
    s_mov_b64 exec, -1
    buffer_load_dwordx4 v2, s[32:35], s55 offen offset:2048 lds
    buffer_load_dwordx4 v2, s[32:35], s55 offen offset:3072 lds
    s_lshl_b32 s55, s18, 13
    s_add_u32 m0, s55, 86016
    s_add_u32 s55, s55, 20480
    buffer_load_dwordx4 v2, s[32:35], s55 offen offset:0 lds
    buffer_load_dwordx4 v2, s[32:35], s55 offen offset:1024 lds
    buffer_load_dwordx4 v2, s[32:35], s55 offen offset:2048 lds
    buffer_load_dwordx4 v2, s[32:35], s55 offen offset:3072 lds
    s_add_u32 m0, s53, 16384
    s_add_u32 s55, s48, 0
    buffer_load_dwordx4 v252, s[40:43], s55 offen offset:0 lds
    buffer_load_dwordx4 v253, s[40:43], s55 offen offset:1024 lds
    buffer_load_dwordx4 v254, s[40:43], s55 offen offset:2048 lds
    buffer_load_dwordx4 v255, s[40:43], s55 offen offset:3072 lds
    s_add_u32 m0, s53, 32768
    s_add_u32 s55, s48, 32768
    buffer_load_dwordx4 v252, s[40:43], s55 offen offset:0 lds
    buffer_load_dwordx4 v253, s[40:43], s55 offen offset:1024 lds
    buffer_load_dwordx4 v254, s[40:43], s55 offen offset:2048 lds
    buffer_load_dwordx4 v255, s[40:43], s55 offen offset:3072 lds
    s_add_u32 m0, s53, 49152
    s_add_u32 s55, s48, 65536
    buffer_load_dwordx4 v252, s[40:43], s55 offen offset:0 lds
    buffer_load_dwordx4 v253, s[40:43], s55 offen offset:1024 lds
    buffer_load_dwordx4 v254, s[40:43], s55 offen offset:2048 lds
    buffer_load_dwordx4 v255, s[40:43], s55 offen offset:3072 lds
    s_add_u32 m0, s53, 65536
    s_add_u32 s55, s48, 98304
    buffer_load_dwordx4 v252, s[40:43], s55 offen offset:0 lds
    buffer_load_dwordx4 v253, s[40:43], s55 offen offset:1024 lds
    buffer_load_dwordx4 v254, s[40:43], s55 offen offset:2048 lds
    buffer_load_dwordx4 v255, s[40:43], s55 offen offset:3072 lds
    s_waitcnt vmcnt(16)
    s_barrier
    ds_read_b128 a[24:27], v152 offset:24576
    ds_read_b128 a[28:31], v152 offset:25600
    ds_read_b128 a[32:35], v152 offset:26624
    ds_read_b128 a[36:39], v152 offset:27648
    ds_read_b128 a[40:43], v152 offset:28672
    ds_read_b128 a[44:47], v152 offset:29696
    ds_read_b128 a[48:51], v152 offset:30720
    ds_read_b128 a[52:55], v152 offset:31744
    ds_read_b128 a[56:59], v152 offset:32768
    ds_read_b128 a[60:63], v152 offset:33792
    ds_read_b128 a[64:67], v152 offset:34816
    ds_read_b128 a[68:71], v152 offset:35840
    ds_read_b128 a[72:75], v152 offset:36864
    ds_read_b128 a[76:79], v152 offset:37888
    ds_read_b128 a[80:83], v152 offset:38912
    s_waitcnt lgkmcnt(14)
    ds_read_b128 a[84:87], v152 offset:39936
    s_waitcnt lgkmcnt(14)
    ds_read_b128 a[88:91], v152 offset:40960
    s_waitcnt lgkmcnt(14)
    ds_read_b128 a[92:95], v152 offset:41984
    s_waitcnt lgkmcnt(14)
    ds_read_b128 a[96:99], v152 offset:43008
    s_waitcnt lgkmcnt(14)
    ds_read_b128 a[100:103], v152 offset:44032
    s_waitcnt lgkmcnt(14)
    ds_read_b128 a[104:107], v152 offset:45056
    s_waitcnt lgkmcnt(14)
    ds_read_b128 a[108:111], v152 offset:46080
    s_waitcnt lgkmcnt(14)
    ds_read_b128 a[112:115], v152 offset:47104
    s_waitcnt lgkmcnt(14)
    ds_read_b128 a[116:119], v152 offset:48128
    s_waitcnt lgkmcnt(14)
    ds_read_b128 a[0:3], v152 offset:16384
    s_waitcnt lgkmcnt(14)
    ds_read_b128 a[4:7], v152 offset:17408
    s_waitcnt lgkmcnt(14)
    ds_read_b128 a[8:11], v152 offset:18432
    s_waitcnt lgkmcnt(14)
    ds_read_b128 a[12:15], v152 offset:19456
    s_waitcnt lgkmcnt(14)
    ds_read_b128 a[16:19], v152 offset:20480
    s_waitcnt lgkmcnt(14)
    ds_read_b128 a[20:23], v152 offset:21504
    v_bfe_u32 v164, v1, 2, 2
    v_lshrrev_b32 v165, 5, v1
    v_lshl_add_u32 v165, v165, 3, v164
    v_lshl_add_u32 v165, v165, 7, s53
    v_bfe_u32 v166, v1, 4, 1
    v_lshl_add_u32 v165, v166, 5, v165
    v_and_b32 v166, 3, v1
    v_lshl_add_u32 v165, v166, 3, v165
    v_and_b32 v164, 2, v164
    v_lshlrev_b32 v164, 5, v164
    v_xor_b32 v160, v165, v164
    v_add_u32 v160, 16384, v160
    v_xor_b32 v161, 64, v160
    s_waitcnt vmcnt(0)
    buffer_load_dword v11, v3, s[24:27], 0 offen sc1
    s_waitcnt lgkmcnt(14)
    ds_read_b64_tr_b16 a[128:129], v160 offset:0
    s_waitcnt lgkmcnt(14)
    ds_read_b64_tr_b16 a[130:131], v160 offset:512
    s_waitcnt lgkmcnt(14)
    ds_read_b64_tr_b16 a[132:133], v161 offset:0
    s_waitcnt lgkmcnt(14)
    ds_read_b64_tr_b16 a[134:135], v161 offset:512
    s_waitcnt lgkmcnt(14)
    ds_read_b64_tr_b16 a[136:137], v160 offset:2048
    s_waitcnt lgkmcnt(14)
    ds_read_b64_tr_b16 a[138:139], v160 offset:2560
    s_waitcnt lgkmcnt(14)
    ds_read_b64_tr_b16 a[140:141], v161 offset:2048
    s_waitcnt lgkmcnt(14)
    ds_read_b64_tr_b16 a[142:143], v161 offset:2560
    s_waitcnt lgkmcnt(14)
    ds_read_b64_tr_b16 a[144:145], v160 offset:16384
    s_waitcnt lgkmcnt(14)
    ds_read_b64_tr_b16 a[146:147], v160 offset:16896
    s_waitcnt lgkmcnt(14)
    ds_read_b64_tr_b16 a[148:149], v161 offset:16384
    s_waitcnt lgkmcnt(14)
    ds_read_b64_tr_b16 a[150:151], v161 offset:16896
    s_waitcnt lgkmcnt(14)
    ds_read_b64_tr_b16 a[152:153], v160 offset:18432
    s_waitcnt lgkmcnt(14)
    ds_read_b64_tr_b16 a[154:155], v160 offset:18944
    s_waitcnt lgkmcnt(14)
    ds_read_b64_tr_b16 a[156:157], v161 offset:18432
    s_waitcnt lgkmcnt(14)
    ds_read_b64_tr_b16 a[158:159], v161 offset:18944
    s_waitcnt lgkmcnt(14)
    ds_read_b64_tr_b16 a[160:161], v160 offset:32768
    s_waitcnt lgkmcnt(14)
    ds_read_b64_tr_b16 a[162:163], v160 offset:33280
    s_waitcnt lgkmcnt(14)
    ds_read_b64_tr_b16 a[164:165], v161 offset:32768
    s_waitcnt lgkmcnt(14)
    ds_read_b64_tr_b16 a[166:167], v161 offset:33280
    s_waitcnt lgkmcnt(14)
    ds_read_b64_tr_b16 a[168:169], v160 offset:34816
    s_waitcnt lgkmcnt(14)
    ds_read_b64_tr_b16 a[170:171], v160 offset:35328
    s_waitcnt lgkmcnt(14)
    ds_read_b64_tr_b16 a[172:173], v161 offset:34816
    s_waitcnt lgkmcnt(14)
    ds_read_b64_tr_b16 a[174:175], v161 offset:35328
    s_waitcnt lgkmcnt(14)
    ds_read_b64_tr_b16 a[176:177], v160 offset:49152
    s_waitcnt lgkmcnt(14)
    ds_read_b64_tr_b16 a[178:179], v160 offset:49664
    s_waitcnt lgkmcnt(14)
    ds_read_b64_tr_b16 a[180:181], v161 offset:49152
    s_waitcnt lgkmcnt(14)
    ds_read_b64_tr_b16 a[182:183], v161 offset:49664
    s_waitcnt lgkmcnt(14)
    ds_read_b64_tr_b16 a[184:185], v160 offset:51200
    s_waitcnt lgkmcnt(14)
    ds_read_b64_tr_b16 a[186:187], v160 offset:51712
    s_waitcnt lgkmcnt(14)
    ds_read_b64_tr_b16 a[188:189], v161 offset:51200
    s_waitcnt lgkmcnt(14)
    ds_read_b64_tr_b16 a[190:191], v161 offset:51712
    s_waitcnt lgkmcnt(0)
    s_waitcnt vmcnt(0)
    v_subrev_u32 v11, s22, v11
    v_subrev_u32 v11, 1, v11
    v_cmp_lt_u32 vcc, 1, v11
    s_nop 1
    s_cbranch_vccnz F_AW2_SPIN
F_AW2_OK:
    s_barrier
    s_add_u32 m0, s52, 0
    s_add_u32 s55, s58, 0
    buffer_load_dwordx4 v4, s[24:27], s55 offen offset:0 sc1 lds
    buffer_load_dwordx4 v4, s[24:27], s55 offen offset:1024 sc1 lds
    buffer_load_dwordx4 v4, s[24:27], s55 offen offset:2048 sc1 lds
    buffer_load_dwordx4 v4, s[24:27], s55 offen offset:3072 sc1 lds
    s_add_u32 m0, s52, 4096
    s_add_u32 s55, s58, 4096
    buffer_load_dwordx4 v4, s[24:27], s55 offen offset:0 sc1 lds
    buffer_load_dwordx4 v4, s[24:27], s55 offen offset:1024 sc1 lds
    buffer_load_dwordx4 v4, s[24:27], s55 offen offset:2048 sc1 lds
    buffer_load_dwordx4 v4, s[24:27], s55 offen offset:3072 sc1 lds
    s_add_u32 m0, s52, 8192
    s_add_u32 s55, s58, 8192
    buffer_load_dwordx4 v4, s[24:27], s55 offen offset:0 sc1 lds
    buffer_load_dwordx4 v4, s[24:27], s55 offen offset:1024 sc1 lds
    buffer_load_dwordx4 v4, s[24:27], s55 offen offset:2048 sc1 lds
    buffer_load_dwordx4 v4, s[24:27], s55 offen offset:3072 sc1 lds
    s_waitcnt vmcnt(10)
    s_add_u32 m0, s52, 12288
    s_add_u32 s55, s58, 12288
    buffer_load_dwordx4 v4, s[24:27], s55 offen offset:0 sc1 lds
    ds_read_b64_tr_b16 v[80:81], v5 offset:0
    ds_read_b64_tr_b16 v[82:83], v5 offset:1024
    ds_read_b64_tr_b16 v[96:97], v12 offset:0
    ds_read_b64_tr_b16 v[98:99], v12 offset:1024
    s_waitcnt vmcnt(9)
    ds_read_b64_tr_b16 v[84:85], v5 offset:2048
    ds_read_b64_tr_b16 v[86:87], v5 offset:3072
    ds_read_b64_tr_b16 v[100:101], v12 offset:2048
    ds_read_b64_tr_b16 v[102:103], v12 offset:3072
    s_waitcnt lgkmcnt(6)
    v_mfma_f32_32x32x16_bf16 v[16:31], a[24:27], v[80:83], 0
    buffer_load_dwordx4 v4, s[24:27], s55 offen offset:1024 sc1 lds
    s_waitcnt lgkmcnt(4)
    v_mfma_f32_32x32x16_bf16 v[48:63], a[24:27], v[96:99], 0
    buffer_load_dwordx4 v4, s[24:27], s55 offen offset:2048 sc1 lds
    v_mfma_f32_32x32x16_bf16 v[16:31], a[56:59], v[96:99], v[16:31]
    buffer_load_dwordx4 v4, s[24:27], s55 offen offset:3072 sc1 lds
    v_mfma_f32_32x32x16_bf16 v[48:63], a[88:91], v[80:83], v[48:63]
    s_add_u32 m0, s54, 0
    s_add_u32 s55, s59, 0
    buffer_load_dwordx4 v2, s[24:27], s55 offen offset:0 sc1 lds
    v_mfma_f32_32x32x16_bf16 v[32:47], a[40:43], v[80:83], 0
    v_mfma_f32_32x32x16_bf16 v[64:79], a[40:43], v[96:99], 0
    buffer_load_dwordx4 v2, s[24:27], s55 offen offset:1024 sc1 lds
    v_mfma_f32_32x32x16_bf16 v[32:47], a[72:75], v[96:99], v[32:47]
    buffer_load_dwordx4 v2, s[24:27], s55 offen offset:2048 sc1 lds
    v_mfma_f32_32x32x16_bf16 v[64:79], a[104:107], v[80:83], v[64:79]
    buffer_load_dwordx4 v2, s[24:27], s55 offen offset:3072 sc1 lds
    s_waitcnt vmcnt(14)
    ds_read_b64_tr_b16 v[88:89], v5 offset:4096
    ds_read_b64_tr_b16 v[90:91], v5 offset:5120
    ds_read_b64_tr_b16 v[104:105], v12 offset:4096
    ds_read_b64_tr_b16 v[106:107], v12 offset:5120
    s_waitcnt lgkmcnt(6)
    v_mfma_f32_32x32x16_bf16 v[16:31], a[28:31], v[84:87], v[16:31]
    s_add_u32 m0, s54, 4096
    s_add_u32 s55, s59, 4096
    buffer_load_dwordx4 v2, s[24:27], s55 offen offset:0 sc1 lds
    s_waitcnt lgkmcnt(4)
    v_mfma_f32_32x32x16_bf16 v[48:63], a[28:31], v[100:103], v[48:63]
    buffer_load_dwordx4 v2, s[24:27], s55 offen offset:1024 sc1 lds
    v_mfma_f32_32x32x16_bf16 v[16:31], a[60:63], v[100:103], v[16:31]
    buffer_load_dwordx4 v2, s[24:27], s55 offen offset:2048 sc1 lds
    v_mfma_f32_32x32x16_bf16 v[48:63], a[92:95], v[84:87], v[48:63]
    v_mfma_f32_32x32x16_bf16 v[32:47], a[44:47], v[84:87], v[32:47]
    buffer_load_dwordx4 v2, s[24:27], s55 offen offset:3072 sc1 lds
    v_mfma_f32_32x32x16_bf16 v[64:79], a[44:47], v[100:103], v[64:79]
    s_add_u32 m0, s54, 8192
    s_add_u32 s55, s59, 8192
    buffer_load_dwordx4 v2, s[24:27], s55 offen offset:0 sc1 lds
    v_mfma_f32_32x32x16_bf16 v[32:47], a[76:79], v[100:103], v[32:47]
    buffer_load_dwordx4 v2, s[24:27], s55 offen offset:1024 sc1 lds
    v_mfma_f32_32x32x16_bf16 v[64:79], a[108:111], v[84:87], v[64:79]
    buffer_load_dwordx4 v2, s[24:27], s55 offen offset:2048 sc1 lds
    s_waitcnt vmcnt(19)
    ds_read_b64_tr_b16 v[92:93], v5 offset:6144
    ds_read_b64_tr_b16 v[94:95], v5 offset:7168
    ds_read_b64_tr_b16 v[108:109], v12 offset:6144
    ds_read_b64_tr_b16 v[110:111], v12 offset:7168
    s_waitcnt lgkmcnt(6)
    v_mfma_f32_32x32x16_bf16 v[16:31], a[32:35], v[88:91], v[16:31]
    buffer_load_dwordx4 v2, s[24:27], s55 offen offset:3072 sc1 lds
    s_waitcnt lgkmcnt(4)
    v_mfma_f32_32x32x16_bf16 v[48:63], a[32:35], v[104:107], v[48:63]
    s_add_u32 m0, s54, 12288
    s_add_u32 s55, s59, 12288
    buffer_load_dwordx4 v2, s[24:27], s55 offen offset:0 sc1 lds
    v_mfma_f32_32x32x16_bf16 v[16:31], a[64:67], v[104:107], v[16:31]
    v_mfma_f32_32x32x16_bf16 v[48:63], a[96:99], v[88:91], v[48:63]
    buffer_load_dwordx4 v2, s[24:27], s55 offen offset:1024 sc1 lds
    v_mfma_f32_32x32x16_bf16 v[32:47], a[48:51], v[88:91], v[32:47]
    buffer_load_dwordx4 v2, s[24:27], s55 offen offset:2048 sc1 lds
    v_mfma_f32_32x32x16_bf16 v[64:79], a[48:51], v[104:107], v[64:79]
    buffer_load_dwordx4 v2, s[24:27], s55 offen offset:3072 sc1 lds
    v_mfma_f32_32x32x16_bf16 v[32:47], a[80:83], v[104:107], v[32:47]
    v_mfma_f32_32x32x16_bf16 v[64:79], a[112:115], v[88:91], v[64:79]
    s_waitcnt vmcnt(22)
    ds_read_b64_tr_b16 v[176:177], v5 offset:8192
    ds_read_b64_tr_b16 v[178:179], v5 offset:9216
    ds_read_b64_tr_b16 v[192:193], v12 offset:8192
    ds_read_b64_tr_b16 v[194:195], v12 offset:9216
    s_waitcnt vmcnt(20)
    ds_read_b64_tr_b16 v[180:181], v5 offset:10240
    ds_read_b64_tr_b16 v[182:183], v5 offset:11264
    ds_read_b64_tr_b16 v[196:197], v12 offset:10240
    ds_read_b64_tr_b16 v[198:199], v12 offset:11264
    s_waitcnt lgkmcnt(10)
    v_mfma_f32_32x32x16_bf16 v[16:31], a[36:39], v[92:95], v[16:31]
    s_waitcnt lgkmcnt(8)
    v_mfma_f32_32x32x16_bf16 v[48:63], a[36:39], v[108:111], v[48:63]
    v_mfma_f32_32x32x16_bf16 v[16:31], a[68:71], v[108:111], v[16:31]
    v_mfma_f32_32x32x16_bf16 v[48:63], a[100:103], v[92:95], v[48:63]
    v_mfma_f32_32x32x16_bf16 v[32:47], a[52:55], v[92:95], v[32:47]
    v_mfma_f32_32x32x16_bf16 v[64:79], a[52:55], v[108:111], v[64:79]
    v_mfma_f32_32x32x16_bf16 v[32:47], a[84:87], v[108:111], v[32:47]
    v_mfma_f32_32x32x16_bf16 v[64:79], a[116:119], v[92:95], v[64:79]
    s_waitcnt vmcnt(18)
    ds_read_b64_tr_b16 v[184:185], v5 offset:12288
    ds_read_b64_tr_b16 v[186:187], v5 offset:13312
    ds_read_b64_tr_b16 v[200:201], v12 offset:12288
    ds_read_b64_tr_b16 v[202:203], v12 offset:13312
    s_waitcnt vmcnt(16)
    ds_read_b64_tr_b16 v[188:189], v5 offset:14336
    ds_read_b64_tr_b16 v[190:191], v5 offset:15360
    ds_read_b64_tr_b16 v[204:205], v12 offset:14336
    s_waitcnt lgkmcnt(14)
    ds_read_b64_tr_b16 v[206:207], v12 offset:15360
    s_waitcnt vmcnt(8)
    s_waitcnt lgkmcnt(14)
    v_mfma_f32_32x32x16_bf16 v[112:127], a[24:27], v[176:179], 0
    ds_read_b128 v[208:211], v6 offset:0
    s_waitcnt lgkmcnt(14)
    ds_read_b128 v[216:219], v6 offset:1024
    s_waitcnt lgkmcnt(1)
    v_lshlrev_b32 v240, 16, v208
    v_and_b32 v244, 0xffff0000, v208
    v_lshlrev_b32 v241, 16, v209
    v_and_b32 v245, 0xffff0000, v209
    v_lshlrev_b32 v242, 16, v210
    v_and_b32 v246, 0xffff0000, v210
    v_mfma_f32_32x32x16_bf16 v[144:159], a[24:27], v[192:195], 0
    v_lshlrev_b32 v243, 16, v211
    v_and_b32 v247, 0xffff0000, v211
    v_mul_f32 v224, v16, v240
    v_mul_f32 v228, v48, v240
    v_mul_f32 v225, v17, v241
    v_mul_f32 v229, v49, v241
    v_mul_f32 v226, v18, v242
    v_mul_f32 v230, v50, v242
    v_mfma_f32_32x32x16_bf16 v[112:127], a[56:59], v[192:195], v[112:127]
    v_mul_f32 v227, v19, v243
    v_mul_f32 v231, v51, v243
    v_fma_f32 v224, -v48, v244, v224
    v_fma_f32 v228, v16, v244, v228
    v_fma_f32 v225, -v49, v245, v225
    v_fma_f32 v229, v17, v245, v229
    v_fma_f32 v226, -v50, v246, v226
    v_fma_f32 v230, v18, v246, v230
    v_mfma_f32_32x32x16_bf16 v[144:159], a[88:91], v[176:179], v[144:159]
    v_fma_f32 v227, -v51, v247, v227
    v_fma_f32 v231, v19, v247, v231
    v_cvt_pk_bf16_f32 v80, v224, v225
    v_cvt_pk_bf16_f32 v81, v226, v227
    v_cvt_pk_bf16_f32 v96, v228, v229
    v_cvt_pk_bf16_f32 v97, v230, v231
    ds_read_b128 v[208:211], v6 offset:2048
    s_waitcnt lgkmcnt(1)
    v_lshlrev_b32 v240, 16, v216
    v_mfma_f32_32x32x16_bf16 v[128:143], a[40:43], v[176:179], 0
    v_and_b32 v244, 0xffff0000, v216
    v_lshlrev_b32 v241, 16, v217
    v_and_b32 v245, 0xffff0000, v217
    v_lshlrev_b32 v242, 16, v218
    v_and_b32 v246, 0xffff0000, v218
    v_lshlrev_b32 v243, 16, v219
    v_and_b32 v247, 0xffff0000, v219
    v_mul_f32 v232, v20, v240
    v_mfma_f32_32x32x16_bf16 v[160:175], a[40:43], v[192:195], 0
    v_mul_f32 v236, v52, v240
    v_mul_f32 v233, v21, v241
    v_mul_f32 v237, v53, v241
    v_mul_f32 v234, v22, v242
    v_mul_f32 v238, v54, v242
    v_mul_f32 v235, v23, v243
    v_mul_f32 v239, v55, v243
    v_fma_f32 v232, -v52, v244, v232
    v_mfma_f32_32x32x16_bf16 v[128:143], a[72:75], v[192:195], v[128:143]
    v_fma_f32 v236, v20, v244, v236
    v_fma_f32 v233, -v53, v245, v233
    v_fma_f32 v237, v21, v245, v237
    v_fma_f32 v234, -v54, v246, v234
    v_fma_f32 v238, v22, v246, v238
    v_fma_f32 v235, -v55, v247, v235
    v_fma_f32 v239, v23, v247, v239
    v_cvt_pk_bf16_f32 v82, v232, v233
    v_mfma_f32_32x32x16_bf16 v[160:175], a[104:107], v[176:179], v[160:175]
    v_cvt_pk_bf16_f32 v83, v234, v235
    v_cvt_pk_bf16_f32 v98, v236, v237
    v_cvt_pk_bf16_f32 v99, v238, v239
    ds_read_b128 v[216:219], v6 offset:3072
    s_waitcnt lgkmcnt(1)
    v_lshlrev_b32 v240, 16, v208
    v_and_b32 v244, 0xffff0000, v208
    v_lshlrev_b32 v241, 16, v209
    v_and_b32 v245, 0xffff0000, v209
    v_mfma_f32_32x32x16_bf16 v[112:127], a[28:31], v[180:183], v[112:127]
    v_lshlrev_b32 v242, 16, v210
    v_and_b32 v246, 0xffff0000, v210
    v_lshlrev_b32 v243, 16, v211
    v_and_b32 v247, 0xffff0000, v211
    v_mul_f32 v224, v24, v240
    v_mul_f32 v228, v56, v240
    v_mul_f32 v225, v25, v241
    v_mul_f32 v229, v57, v241
    v_mfma_f32_32x32x16_bf16 v[144:159], a[28:31], v[196:199], v[144:159]
    v_mul_f32 v226, v26, v242
    v_mul_f32 v230, v58, v242
    v_mul_f32 v227, v27, v243
    v_mul_f32 v231, v59, v243
    v_fma_f32 v224, -v56, v244, v224
    v_fma_f32 v228, v24, v244, v228
    v_fma_f32 v225, -v57, v245, v225
    v_fma_f32 v229, v25, v245, v229
    v_mfma_f32_32x32x16_bf16 v[112:127], a[60:63], v[196:199], v[112:127]
    v_fma_f32 v226, -v58, v246, v226
    v_fma_f32 v230, v26, v246, v230
    v_fma_f32 v227, -v59, v247, v227
    v_fma_f32 v231, v27, v247, v231
    v_cvt_pk_bf16_f32 v84, v224, v225
    v_cvt_pk_bf16_f32 v85, v226, v227
    v_cvt_pk_bf16_f32 v100, v228, v229
    v_cvt_pk_bf16_f32 v101, v230, v231
    v_mfma_f32_32x32x16_bf16 v[144:159], a[92:95], v[180:183], v[144:159]
    ds_read_b128 v[208:211], v6 offset:4096
    s_waitcnt lgkmcnt(1)
    v_lshlrev_b32 v240, 16, v216
    v_and_b32 v244, 0xffff0000, v216
    v_lshlrev_b32 v241, 16, v217
    v_and_b32 v245, 0xffff0000, v217
    v_lshlrev_b32 v242, 16, v218
    v_and_b32 v246, 0xffff0000, v218
    v_lshlrev_b32 v243, 16, v219
    v_mfma_f32_32x32x16_bf16 v[128:143], a[44:47], v[180:183], v[128:143]
    v_and_b32 v247, 0xffff0000, v219
    v_mul_f32 v232, v28, v240
    v_mul_f32 v236, v60, v240
    v_mul_f32 v233, v29, v241
    v_mul_f32 v237, v61, v241
    v_mul_f32 v234, v30, v242
    v_mul_f32 v238, v62, v242
    v_mul_f32 v235, v31, v243
    v_mfma_f32_32x32x16_bf16 v[160:175], a[44:47], v[196:199], v[160:175]
    v_mul_f32 v239, v63, v243
    v_fma_f32 v232, -v60, v244, v232
    v_fma_f32 v236, v28, v244, v236
    v_fma_f32 v233, -v61, v245, v233
    v_fma_f32 v237, v29, v245, v237
    v_fma_f32 v234, -v62, v246, v234
    v_fma_f32 v238, v30, v246, v238
    v_fma_f32 v235, -v63, v247, v235
    v_mfma_f32_32x32x16_bf16 v[128:143], a[76:79], v[196:199], v[128:143]
    v_fma_f32 v239, v31, v247, v239
    v_cvt_pk_bf16_f32 v86, v232, v233
    v_cvt_pk_bf16_f32 v87, v234, v235
    v_cvt_pk_bf16_f32 v102, v236, v237
    v_cvt_pk_bf16_f32 v103, v238, v239
    ds_read_b128 v[216:219], v6 offset:5120
    s_waitcnt lgkmcnt(1)
    v_lshlrev_b32 v240, 16, v208
    v_and_b32 v244, 0xffff0000, v208
    v_mfma_f32_32x32x16_bf16 v[160:175], a[108:111], v[180:183], v[160:175]
    v_lshlrev_b32 v241, 16, v209
    v_and_b32 v245, 0xffff0000, v209
    v_lshlrev_b32 v242, 16, v210
    v_and_b32 v246, 0xffff0000, v210
    v_lshlrev_b32 v243, 16, v211
    v_and_b32 v247, 0xffff0000, v211
    v_mul_f32 v224, v32, v240
    v_mul_f32 v228, v64, v240
    v_mfma_f32_32x32x16_bf16 v[112:127], a[32:35], v[184:187], v[112:127]
    v_mul_f32 v225, v33, v241
    v_mul_f32 v229, v65, v241
    v_mul_f32 v226, v34, v242
    v_mul_f32 v230, v66, v242
    v_mul_f32 v227, v35, v243
    v_mul_f32 v231, v67, v243
    v_fma_f32 v224, -v64, v244, v224
    v_fma_f32 v228, v32, v244, v228
    v_mfma_f32_32x32x16_bf16 v[144:159], a[32:35], v[200:203], v[144:159]
    v_fma_f32 v225, -v65, v245, v225
    v_fma_f32 v229, v33, v245, v229
    v_fma_f32 v226, -v66, v246, v226
    v_fma_f32 v230, v34, v246, v230
    v_fma_f32 v227, -v67, v247, v227
    v_fma_f32 v231, v35, v247, v231
    v_cvt_pk_bf16_f32 v88, v224, v225
    v_cvt_pk_bf16_f32 v89, v226, v227
    v_mfma_f32_32x32x16_bf16 v[112:127], a[64:67], v[200:203], v[112:127]
    v_cvt_pk_bf16_f32 v104, v228, v229
    v_cvt_pk_bf16_f32 v105, v230, v231
    ds_read_b128 v[208:211], v6 offset:6144
    s_waitcnt lgkmcnt(1)
    v_lshlrev_b32 v240, 16, v216
    v_and_b32 v244, 0xffff0000, v216
    v_lshlrev_b32 v241, 16, v217
    v_and_b32 v245, 0xffff0000, v217
    v_lshlrev_b32 v242, 16, v218
    v_mfma_f32_32x32x16_bf16 v[144:159], a[96:99], v[184:187], v[144:159]
    v_and_b32 v246, 0xffff0000, v218
    v_lshlrev_b32 v243, 16, v219
    v_and_b32 v247, 0xffff0000, v219
    v_mul_f32 v232, v36, v240
    v_mul_f32 v236, v68, v240
    v_mul_f32 v233, v37, v241
    v_mul_f32 v237, v69, v241
    v_mul_f32 v234, v38, v242
    v_mfma_f32_32x32x16_bf16 v[128:143], a[48:51], v[184:187], v[128:143]
    v_mul_f32 v238, v70, v242
    v_mul_f32 v235, v39, v243
    v_mul_f32 v239, v71, v243
    v_fma_f32 v232, -v68, v244, v232
    v_fma_f32 v236, v36, v244, v236
    v_fma_f32 v233, -v69, v245, v233
    v_fma_f32 v237, v37, v245, v237
    v_fma_f32 v234, -v70, v246, v234
    v_mfma_f32_32x32x16_bf16 v[160:175], a[48:51], v[200:203], v[160:175]
    v_fma_f32 v238, v38, v246, v238
    v_fma_f32 v235, -v71, v247, v235
    v_fma_f32 v239, v39, v247, v239
    v_cvt_pk_bf16_f32 v90, v232, v233
    v_cvt_pk_bf16_f32 v91, v234, v235
    v_cvt_pk_bf16_f32 v106, v236, v237
    v_cvt_pk_bf16_f32 v107, v238, v239
    ds_read_b128 v[216:219], v6 offset:7168
    v_mfma_f32_32x32x16_bf16 v[128:143], a[80:83], v[200:203], v[128:143]
    s_waitcnt lgkmcnt(1)
    v_lshlrev_b32 v240, 16, v208
    v_and_b32 v244, 0xffff0000, v208
    v_lshlrev_b32 v241, 16, v209
    v_and_b32 v245, 0xffff0000, v209
    v_lshlrev_b32 v242, 16, v210
    v_and_b32 v246, 0xffff0000, v210
    v_lshlrev_b32 v243, 16, v211
    v_and_b32 v247, 0xffff0000, v211
    v_mfma_f32_32x32x16_bf16 v[160:175], a[112:115], v[184:187], v[160:175]
    v_mul_f32 v224, v40, v240
    v_mul_f32 v228, v72, v240
    v_mul_f32 v225, v41, v241
    v_mul_f32 v229, v73, v241
    v_mul_f32 v226, v42, v242
    v_mul_f32 v230, v74, v242
    v_mul_f32 v227, v43, v243
    v_mul_f32 v231, v75, v243
    v_mfma_f32_32x32x16_bf16 v[112:127], a[36:39], v[188:191], v[112:127]
    v_fma_f32 v224, -v72, v244, v224
    v_fma_f32 v228, v40, v244, v228
    v_fma_f32 v225, -v73, v245, v225
    v_fma_f32 v229, v41, v245, v229
    v_fma_f32 v226, -v74, v246, v226
    v_fma_f32 v230, v42, v246, v230
    v_fma_f32 v227, -v75, v247, v227
    v_fma_f32 v231, v43, v247, v231
    v_mfma_f32_32x32x16_bf16 v[144:159], a[36:39], v[204:207], v[144:159]
    v_cvt_pk_bf16_f32 v92, v224, v225
    v_cvt_pk_bf16_f32 v93, v226, v227
    v_cvt_pk_bf16_f32 v108, v228, v229
    v_cvt_pk_bf16_f32 v109, v230, v231
    s_waitcnt lgkmcnt(0)
    v_lshlrev_b32 v240, 16, v216
    v_and_b32 v244, 0xffff0000, v216
    v_lshlrev_b32 v241, 16, v217
    v_and_b32 v245, 0xffff0000, v217
    v_mfma_f32_32x32x16_bf16 v[112:127], a[68:71], v[204:207], v[112:127]
    v_lshlrev_b32 v242, 16, v218
    v_and_b32 v246, 0xffff0000, v218
    v_lshlrev_b32 v243, 16, v219
    v_and_b32 v247, 0xffff0000, v219
    v_mul_f32 v232, v44, v240
    v_mul_f32 v236, v76, v240
    v_mul_f32 v233, v45, v241
    v_mul_f32 v237, v77, v241
    v_mfma_f32_32x32x16_bf16 v[144:159], a[100:103], v[188:191], v[144:159]
    v_mul_f32 v234, v46, v242
    v_mul_f32 v238, v78, v242
    v_mul_f32 v235, v47, v243
    v_mul_f32 v239, v79, v243
    v_fma_f32 v232, -v76, v244, v232
    v_fma_f32 v236, v44, v244, v236
    v_fma_f32 v233, -v77, v245, v233
    v_fma_f32 v237, v45, v245, v237
    v_mfma_f32_32x32x16_bf16 v[128:143], a[52:55], v[188:191], v[128:143]
    v_fma_f32 v234, -v78, v246, v234
    v_fma_f32 v238, v46, v246, v238
    v_fma_f32 v235, -v79, v247, v235
    v_fma_f32 v239, v47, v247, v239
    v_cvt_pk_bf16_f32 v94, v232, v233
    v_cvt_pk_bf16_f32 v95, v234, v235
    v_cvt_pk_bf16_f32 v110, v236, v237
    v_cvt_pk_bf16_f32 v111, v238, v239
    v_mfma_f32_32x32x16_bf16 v[160:175], a[52:55], v[204:207], v[160:175]
    v_mfma_f32_32x32x16_bf16 v[128:143], a[84:87], v[204:207], v[128:143]
    v_mfma_f32_32x32x16_bf16 v[160:175], a[116:119], v[188:191], v[160:175]
    s_waitcnt vmcnt(0)
    v_mfma_f32_32x32x16_bf16 v[16:31], v[80:83], a[24:27], 0
    ds_read_b128 v[208:211], v6 offset:8192
    ds_read_b128 v[216:219], v6 offset:9216
    s_waitcnt lgkmcnt(1)
    v_lshlrev_b32 v240, 16, v208
    v_and_b32 v244, 0xffff0000, v208
    v_lshlrev_b32 v241, 16, v209
    v_and_b32 v245, 0xffff0000, v209
    v_lshlrev_b32 v242, 16, v210
    v_and_b32 v246, 0xffff0000, v210
    v_mfma_f32_32x32x16_bf16 v[48:63], v[96:99], a[24:27], 0
    v_lshlrev_b32 v243, 16, v211
    v_and_b32 v247, 0xffff0000, v211
    v_mul_f32 v224, v112, v240
    v_mul_f32 v228, v144, v240
    v_mul_f32 v225, v113, v241
    v_mul_f32 v229, v145, v241
    v_mul_f32 v226, v114, v242
    v_mul_f32 v230, v146, v242
    v_mfma_f32_32x32x16_bf16 v[16:31], v[96:99], a[88:91], v[16:31]
    v_mul_f32 v227, v115, v243
    v_mul_f32 v231, v147, v243
    v_fma_f32 v224, -v144, v244, v224
    v_fma_f32 v228, v112, v244, v228
    v_fma_f32 v225, -v145, v245, v225
    v_fma_f32 v229, v113, v245, v229
    v_fma_f32 v226, -v146, v246, v226
    v_fma_f32 v230, v114, v246, v230
    v_mfma_f32_32x32x16_bf16 v[48:63], v[80:83], a[56:59], v[48:63]
    v_fma_f32 v227, -v147, v247, v227
    v_fma_f32 v231, v115, v247, v231
    v_cvt_pk_bf16_f32 v176, v224, v225
    v_cvt_pk_bf16_f32 v177, v226, v227
    v_cvt_pk_bf16_f32 v192, v228, v229
    v_cvt_pk_bf16_f32 v193, v230, v231
    ds_read_b128 v[208:211], v6 offset:10240
    s_waitcnt lgkmcnt(1)
    v_lshlrev_b32 v240, 16, v216
    v_mfma_f32_32x32x16_bf16 v[32:47], v[80:83], a[40:43], 0
    v_and_b32 v244, 0xffff0000, v216
    v_lshlrev_b32 v241, 16, v217
    v_and_b32 v245, 0xffff0000, v217
    v_lshlrev_b32 v242, 16, v218
    v_and_b32 v246, 0xffff0000, v218
    v_lshlrev_b32 v243, 16, v219
    v_and_b32 v247, 0xffff0000, v219
    v_mul_f32 v232, v116, v240
    v_mfma_f32_32x32x16_bf16 v[64:79], v[96:99], a[40:43], 0
    v_mul_f32 v236, v148, v240
    v_mul_f32 v233, v117, v241
    v_mul_f32 v237, v149, v241
    v_mul_f32 v234, v118, v242
    v_mul_f32 v238, v150, v242
    v_mul_f32 v235, v119, v243
    v_mul_f32 v239, v151, v243
    v_fma_f32 v232, -v148, v244, v232
    v_mfma_f32_32x32x16_bf16 v[32:47], v[96:99], a[104:107], v[32:47]
    v_fma_f32 v236, v116, v244, v236
    v_fma_f32 v233, -v149, v245, v233
    v_fma_f32 v237, v117, v245, v237
    v_fma_f32 v234, -v150, v246, v234
    v_fma_f32 v238, v118, v246, v238
    v_fma_f32 v235, -v151, v247, v235
    v_fma_f32 v239, v119, v247, v239
    v_cvt_pk_bf16_f32 v178, v232, v233
    v_mfma_f32_32x32x16_bf16 v[64:79], v[80:83], a[72:75], v[64:79]
    v_cvt_pk_bf16_f32 v179, v234, v235
    v_cvt_pk_bf16_f32 v194, v236, v237
    v_cvt_pk_bf16_f32 v195, v238, v239
    ds_read_b128 v[216:219], v6 offset:11264
    s_waitcnt lgkmcnt(1)
    v_lshlrev_b32 v240, 16, v208
    v_and_b32 v244, 0xffff0000, v208
    v_lshlrev_b32 v241, 16, v209
    v_and_b32 v245, 0xffff0000, v209
    v_mfma_f32_32x32x16_bf16 v[16:31], v[84:87], a[28:31], v[16:31]
    v_lshlrev_b32 v242, 16, v210
    v_and_b32 v246, 0xffff0000, v210
    v_lshlrev_b32 v243, 16, v211
    v_and_b32 v247, 0xffff0000, v211
    v_mul_f32 v224, v120, v240
    v_mul_f32 v228, v152, v240
    v_mul_f32 v225, v121, v241
    v_mul_f32 v229, v153, v241
    v_mfma_f32_32x32x16_bf16 v[48:63], v[100:103], a[28:31], v[48:63]
    v_mul_f32 v226, v122, v242
    v_mul_f32 v230, v154, v242
    v_mul_f32 v227, v123, v243
    v_mul_f32 v231, v155, v243
    v_fma_f32 v224, -v152, v244, v224
    v_fma_f32 v228, v120, v244, v228
    v_fma_f32 v225, -v153, v245, v225
    v_fma_f32 v229, v121, v245, v229
    v_mfma_f32_32x32x16_bf16 v[16:31], v[100:103], a[92:95], v[16:31]
    v_fma_f32 v226, -v154, v246, v226
    v_fma_f32 v230, v122, v246, v230
    v_fma_f32 v227, -v155, v247, v227
    v_fma_f32 v231, v123, v247, v231
    v_cvt_pk_bf16_f32 v180, v224, v225
    v_cvt_pk_bf16_f32 v181, v226, v227
    v_cvt_pk_bf16_f32 v196, v228, v229
    v_cvt_pk_bf16_f32 v197, v230, v231
    v_mfma_f32_32x32x16_bf16 v[48:63], v[84:87], a[60:63], v[48:63]
    ds_read_b128 v[208:211], v6 offset:12288
    s_waitcnt lgkmcnt(1)
    v_lshlrev_b32 v240, 16, v216
    v_and_b32 v244, 0xffff0000, v216
    v_lshlrev_b32 v241, 16, v217
    v_and_b32 v245, 0xffff0000, v217
    v_lshlrev_b32 v242, 16, v218
    v_and_b32 v246, 0xffff0000, v218
    v_lshlrev_b32 v243, 16, v219
    v_mfma_f32_32x32x16_bf16 v[32:47], v[84:87], a[44:47], v[32:47]
    v_and_b32 v247, 0xffff0000, v219
    v_mul_f32 v232, v124, v240
    v_mul_f32 v236, v156, v240
    v_mul_f32 v233, v125, v241
    v_mul_f32 v237, v157, v241
    v_mul_f32 v234, v126, v242
    v_mul_f32 v238, v158, v242
    v_mul_f32 v235, v127, v243
    v_mfma_f32_32x32x16_bf16 v[64:79], v[100:103], a[44:47], v[64:79]
    v_mul_f32 v239, v159, v243
    v_fma_f32 v232, -v156, v244, v232
    v_fma_f32 v236, v124, v244, v236
    v_fma_f32 v233, -v157, v245, v233
    v_fma_f32 v237, v125, v245, v237
    v_fma_f32 v234, -v158, v246, v234
    v_fma_f32 v238, v126, v246, v238
    v_fma_f32 v235, -v159, v247, v235
    v_mfma_f32_32x32x16_bf16 v[32:47], v[100:103], a[108:111], v[32:47]
    v_fma_f32 v239, v127, v247, v239
    v_cvt_pk_bf16_f32 v182, v232, v233
    v_cvt_pk_bf16_f32 v183, v234, v235
    v_cvt_pk_bf16_f32 v198, v236, v237
    v_cvt_pk_bf16_f32 v199, v238, v239
    ds_read_b128 v[216:219], v6 offset:13312
    s_waitcnt lgkmcnt(1)
    v_lshlrev_b32 v240, 16, v208
    v_and_b32 v244, 0xffff0000, v208
    v_mfma_f32_32x32x16_bf16 v[64:79], v[84:87], a[76:79], v[64:79]
    v_lshlrev_b32 v241, 16, v209
    v_and_b32 v245, 0xffff0000, v209
    v_lshlrev_b32 v242, 16, v210
    v_and_b32 v246, 0xffff0000, v210
    v_lshlrev_b32 v243, 16, v211
    v_and_b32 v247, 0xffff0000, v211
    v_mul_f32 v224, v128, v240
    v_mul_f32 v228, v160, v240
    v_mfma_f32_32x32x16_bf16 v[16:31], v[88:91], a[32:35], v[16:31]
    v_mul_f32 v225, v129, v241
    v_mul_f32 v229, v161, v241
    v_mul_f32 v226, v130, v242
    v_mul_f32 v230, v162, v242
    v_mul_f32 v227, v131, v243
    v_mul_f32 v231, v163, v243
    v_fma_f32 v224, -v160, v244, v224
    v_fma_f32 v228, v128, v244, v228
    v_mfma_f32_32x32x16_bf16 v[48:63], v[104:107], a[32:35], v[48:63]
    v_fma_f32 v225, -v161, v245, v225
    v_fma_f32 v229, v129, v245, v229
    v_fma_f32 v226, -v162, v246, v226
    v_fma_f32 v230, v130, v246, v230
    v_fma_f32 v227, -v163, v247, v227
    v_fma_f32 v231, v131, v247, v231
    v_cvt_pk_bf16_f32 v184, v224, v225
    v_cvt_pk_bf16_f32 v185, v226, v227
    v_mfma_f32_32x32x16_bf16 v[16:31], v[104:107], a[96:99], v[16:31]
    v_cvt_pk_bf16_f32 v200, v228, v229
    v_cvt_pk_bf16_f32 v201, v230, v231
    ds_read_b128 v[208:211], v6 offset:14336
    s_waitcnt lgkmcnt(1)
    v_lshlrev_b32 v240, 16, v216
    v_and_b32 v244, 0xffff0000, v216
    v_lshlrev_b32 v241, 16, v217
    v_and_b32 v245, 0xffff0000, v217
    v_lshlrev_b32 v242, 16, v218
    v_mfma_f32_32x32x16_bf16 v[48:63], v[88:91], a[64:67], v[48:63]
    v_and_b32 v246, 0xffff0000, v218
    v_lshlrev_b32 v243, 16, v219
    v_and_b32 v247, 0xffff0000, v219
    v_mul_f32 v232, v132, v240
    v_mul_f32 v236, v164, v240
    v_mul_f32 v233, v133, v241
    v_mul_f32 v237, v165, v241
    v_mul_f32 v234, v134, v242
    v_mfma_f32_32x32x16_bf16 v[32:47], v[88:91], a[48:51], v[32:47]
    v_mul_f32 v238, v166, v242
    v_mul_f32 v235, v135, v243
    v_mul_f32 v239, v167, v243
    v_fma_f32 v232, -v164, v244, v232
    v_fma_f32 v236, v132, v244, v236
    v_fma_f32 v233, -v165, v245, v233
    v_fma_f32 v237, v133, v245, v237
    v_fma_f32 v234, -v166, v246, v234
    v_mfma_f32_32x32x16_bf16 v[64:79], v[104:107], a[48:51], v[64:79]
    v_fma_f32 v238, v134, v246, v238
    v_fma_f32 v235, -v167, v247, v235
    v_fma_f32 v239, v135, v247, v239
    v_cvt_pk_bf16_f32 v186, v232, v233
    v_cvt_pk_bf16_f32 v187, v234, v235
    v_cvt_pk_bf16_f32 v202, v236, v237
    v_cvt_pk_bf16_f32 v203, v238, v239
    ds_read_b128 v[216:219], v6 offset:15360
    v_mfma_f32_32x32x16_bf16 v[32:47], v[104:107], a[112:115], v[32:47]
    s_waitcnt lgkmcnt(1)
    v_lshlrev_b32 v240, 16, v208
    v_and_b32 v244, 0xffff0000, v208
    v_lshlrev_b32 v241, 16, v209
    v_and_b32 v245, 0xffff0000, v209
    v_lshlrev_b32 v242, 16, v210
    v_and_b32 v246, 0xffff0000, v210
    v_lshlrev_b32 v243, 16, v211
    v_and_b32 v247, 0xffff0000, v211
    v_mfma_f32_32x32x16_bf16 v[64:79], v[88:91], a[80:83], v[64:79]
    v_mul_f32 v224, v136, v240
    v_mul_f32 v228, v168, v240
    v_mul_f32 v225, v137, v241
    v_mul_f32 v229, v169, v241
    v_mul_f32 v226, v138, v242
    v_mul_f32 v230, v170, v242
    v_mul_f32 v227, v139, v243
    v_mul_f32 v231, v171, v243
    v_mfma_f32_32x32x16_bf16 v[16:31], v[92:95], a[36:39], v[16:31]
    v_fma_f32 v224, -v168, v244, v224
    v_fma_f32 v228, v136, v244, v228
    v_fma_f32 v225, -v169, v245, v225
    v_fma_f32 v229, v137, v245, v229
    v_fma_f32 v226, -v170, v246, v226
    v_fma_f32 v230, v138, v246, v230
    v_fma_f32 v227, -v171, v247, v227
    v_fma_f32 v231, v139, v247, v231
    v_mfma_f32_32x32x16_bf16 v[48:63], v[108:111], a[36:39], v[48:63]
    v_cvt_pk_bf16_f32 v188, v224, v225
    v_cvt_pk_bf16_f32 v189, v226, v227
    v_cvt_pk_bf16_f32 v204, v228, v229
    v_cvt_pk_bf16_f32 v205, v230, v231
    s_waitcnt lgkmcnt(0)
    v_lshlrev_b32 v240, 16, v216
    v_and_b32 v244, 0xffff0000, v216
    v_lshlrev_b32 v241, 16, v217
    v_and_b32 v245, 0xffff0000, v217
    v_mfma_f32_32x32x16_bf16 v[16:31], v[108:111], a[100:103], v[16:31]
    v_lshlrev_b32 v242, 16, v218
    v_and_b32 v246, 0xffff0000, v218
    v_lshlrev_b32 v243, 16, v219
    v_and_b32 v247, 0xffff0000, v219
    v_mul_f32 v232, v140, v240
    v_mul_f32 v236, v172, v240
    v_mul_f32 v233, v141, v241
    v_mul_f32 v237, v173, v241
    v_mfma_f32_32x32x16_bf16 v[48:63], v[92:95], a[68:71], v[48:63]
    v_mul_f32 v234, v142, v242
    v_mul_f32 v238, v174, v242
    v_mul_f32 v235, v143, v243
    v_mul_f32 v239, v175, v243
    v_fma_f32 v232, -v172, v244, v232
    v_fma_f32 v236, v140, v244, v236
    v_fma_f32 v233, -v173, v245, v233
    v_fma_f32 v237, v141, v245, v237
    v_mfma_f32_32x32x16_bf16 v[32:47], v[92:95], a[52:55], v[32:47]
    v_fma_f32 v234, -v174, v246, v234
    v_fma_f32 v238, v142, v246, v238
    v_fma_f32 v235, -v175, v247, v235
    v_fma_f32 v239, v143, v247, v239
    v_cvt_pk_bf16_f32 v190, v232, v233
    v_cvt_pk_bf16_f32 v191, v234, v235
    v_cvt_pk_bf16_f32 v206, v236, v237
    v_cvt_pk_bf16_f32 v207, v238, v239
    v_mfma_f32_32x32x16_bf16 v[64:79], v[108:111], a[52:55], v[64:79]
    v_mfma_f32_32x32x16_bf16 v[32:47], v[108:111], a[116:119], v[32:47]
    v_mfma_f32_32x32x16_bf16 v[64:79], v[92:95], a[84:87], v[64:79]
    s_barrier
    v_mfma_f32_32x32x16_bf16 v[112:127], v[176:179], a[24:27], 0
    ds_read_b128 v[208:211], v2 offset:0
    ds_read_b128 v[212:215], v2 offset:1024
    ds_read_b128 v[216:219], v2 offset:2048
    ds_read_b128 v[220:223], v2 offset:3072
    s_waitcnt lgkmcnt(3)
    v_mul_f32 v224, v16, v208
    v_mul_f32 v228, v48, v208
    v_mfma_f32_32x32x16_bf16 v[144:159], v[192:195], a[24:27], 0
    v_mul_f32 v225, v17, v209
    v_mul_f32 v229, v49, v209
    v_mul_f32 v226, v18, v210
    v_mul_f32 v230, v50, v210
    v_mul_f32 v227, v19, v211
    v_mul_f32 v231, v51, v211
    v_mfma_f32_32x32x16_bf16 v[112:127], v[192:195], a[88:91], v[112:127]
    s_waitcnt lgkmcnt(2)
    v_fma_f32 v224, -v48, v212, v224
    v_fma_f32 v228, v16, v212, v228
    v_fma_f32 v225, -v49, v213, v225
    v_fma_f32 v229, v17, v213, v229
    v_fma_f32 v226, -v50, v214, v226
    v_fma_f32 v230, v18, v214, v230
    v_mfma_f32_32x32x16_bf16 v[144:159], v[176:179], a[56:59], v[144:159]
    v_fma_f32 v227, -v51, v215, v227
    v_fma_f32 v231, v19, v215, v231
    v_cvt_pk_bf16_f32 v80, v224, v225
    v_cvt_pk_bf16_f32 v81, v226, v227
    v_cvt_pk_bf16_f32 v96, v228, v229
    v_cvt_pk_bf16_f32 v97, v230, v231
    v_mfma_f32_32x32x16_bf16 v[128:143], v[176:179], a[40:43], 0
    ds_read_b128 v[208:211], v2 offset:4096
    ds_read_b128 v[212:215], v2 offset:5120
    s_waitcnt lgkmcnt(3)
    v_mul_f32 v232, v20, v216
    v_mul_f32 v236, v52, v216
    v_mul_f32 v233, v21, v217
    v_mul_f32 v237, v53, v217
    v_mfma_f32_32x32x16_bf16 v[160:175], v[192:195], a[40:43], 0
    v_mul_f32 v234, v22, v218
    v_mul_f32 v238, v54, v218
    v_mul_f32 v235, v23, v219
    v_mul_f32 v239, v55, v219
    s_waitcnt lgkmcnt(2)
    v_fma_f32 v232, -v52, v220, v232
    v_fma_f32 v236, v20, v220, v236
    v_mfma_f32_32x32x16_bf16 v[128:143], v[192:195], a[104:107], v[128:143]
    v_fma_f32 v233, -v53, v221, v233
    v_fma_f32 v237, v21, v221, v237
    v_fma_f32 v234, -v54, v222, v234
    v_fma_f32 v238, v22, v222, v238
    v_fma_f32 v235, -v55, v223, v235
    v_fma_f32 v239, v23, v223, v239
    v_mfma_f32_32x32x16_bf16 v[160:175], v[176:179], a[72:75], v[160:175]
    v_cvt_pk_bf16_f32 v82, v232, v233
    v_cvt_pk_bf16_f32 v83, v234, v235
    v_cvt_pk_bf16_f32 v98, v236, v237
    v_cvt_pk_bf16_f32 v99, v238, v239
    ds_read_b128 v[216:219], v2 offset:6144
    ds_read_b128 v[220:223], v2 offset:7168
    v_mfma_f32_32x32x16_bf16 v[112:127], v[180:183], a[28:31], v[112:127]
    s_waitcnt lgkmcnt(3)
    v_mul_f32 v224, v24, v208
    v_mul_f32 v228, v56, v208
    v_mul_f32 v225, v25, v209
    v_mul_f32 v229, v57, v209
    v_mul_f32 v226, v26, v210
    v_mul_f32 v230, v58, v210
    v_mfma_f32_32x32x16_bf16 v[144:159], v[196:199], a[28:31], v[144:159]
    v_mul_f32 v227, v27, v211
    v_mul_f32 v231, v59, v211
    s_waitcnt lgkmcnt(2)
    v_fma_f32 v224, -v56, v212, v224
    v_fma_f32 v228, v24, v212, v228
    v_fma_f32 v225, -v57, v213, v225
    v_fma_f32 v229, v25, v213, v229
    v_mfma_f32_32x32x16_bf16 v[112:127], v[196:199], a[92:95], v[112:127]
    v_fma_f32 v226, -v58, v214, v226
    v_fma_f32 v230, v26, v214, v230
    v_fma_f32 v227, -v59, v215, v227
    v_fma_f32 v231, v27, v215, v231
    v_cvt_pk_bf16_f32 v84, v224, v225
    v_cvt_pk_bf16_f32 v85, v226, v227
    v_mfma_f32_32x32x16_bf16 v[144:159], v[180:183], a[60:63], v[144:159]
    v_cvt_pk_bf16_f32 v100, v228, v229
    v_cvt_pk_bf16_f32 v101, v230, v231
    ds_read_b128 v[208:211], v2 offset:8192
    ds_read_b128 v[212:215], v2 offset:9216
    s_waitcnt lgkmcnt(3)
    v_mul_f32 v232, v28, v216
    v_mul_f32 v236, v60, v216
    v_mfma_f32_32x32x16_bf16 v[128:143], v[180:183], a[44:47], v[128:143]
    v_mul_f32 v233, v29, v217
    v_mul_f32 v237, v61, v217
    v_mul_f32 v234, v30, v218
    v_mul_f32 v238, v62, v218
    v_mul_f32 v235, v31, v219
    v_mul_f32 v239, v63, v219
    v_mfma_f32_32x32x16_bf16 v[160:175], v[196:199], a[44:47], v[160:175]
    s_waitcnt lgkmcnt(2)
    v_fma_f32 v232, -v60, v220, v232
    v_fma_f32 v236, v28, v220, v236
    v_fma_f32 v233, -v61, v221, v233
    v_fma_f32 v237, v29, v221, v237
    v_fma_f32 v234, -v62, v222, v234
    v_fma_f32 v238, v30, v222, v238
    v_mfma_f32_32x32x16_bf16 v[128:143], v[196:199], a[108:111], v[128:143]
    v_fma_f32 v235, -v63, v223, v235
    v_fma_f32 v239, v31, v223, v239
    v_cvt_pk_bf16_f32 v86, v232, v233
    v_cvt_pk_bf16_f32 v87, v234, v235
    v_cvt_pk_bf16_f32 v102, v236, v237
    v_cvt_pk_bf16_f32 v103, v238, v239
    v_mfma_f32_32x32x16_bf16 v[160:175], v[180:183], a[76:79], v[160:175]
    ds_read_b128 v[216:219], v2 offset:10240
    ds_read_b128 v[220:223], v2 offset:11264
    s_waitcnt lgkmcnt(3)
    v_mul_f32 v224, v32, v208
    v_mul_f32 v228, v64, v208
    v_mul_f32 v225, v33, v209
    v_mul_f32 v229, v65, v209
    v_mfma_f32_32x32x16_bf16 v[112:127], v[184:187], a[32:35], v[112:127]
    v_mul_f32 v226, v34, v210
    v_mul_f32 v230, v66, v210
    v_mul_f32 v227, v35, v211
    v_mul_f32 v231, v67, v211
    s_waitcnt lgkmcnt(2)
    v_fma_f32 v224, -v64, v212, v224
    v_fma_f32 v228, v32, v212, v228
    v_mfma_f32_32x32x16_bf16 v[144:159], v[200:203], a[32:35], v[144:159]
    v_fma_f32 v225, -v65, v213, v225
    v_fma_f32 v229, v33, v213, v229
    v_fma_f32 v226, -v66, v214, v226
    v_fma_f32 v230, v34, v214, v230
    v_fma_f32 v227, -v67, v215, v227
    v_fma_f32 v231, v35, v215, v231
    v_mfma_f32_32x32x16_bf16 v[112:127], v[200:203], a[96:99], v[112:127]
    v_cvt_pk_bf16_f32 v88, v224, v225
    v_cvt_pk_bf16_f32 v89, v226, v227
    v_cvt_pk_bf16_f32 v104, v228, v229
    v_cvt_pk_bf16_f32 v105, v230, v231
    ds_read_b128 v[208:211], v2 offset:12288
    ds_read_b128 v[212:215], v2 offset:13312
    v_mfma_f32_32x32x16_bf16 v[144:159], v[184:187], a[64:67], v[144:159]
    s_waitcnt lgkmcnt(3)
    v_mul_f32 v232, v36, v216
    v_mul_f32 v236, v68, v216
    v_mul_f32 v233, v37, v217
    v_mul_f32 v237, v69, v217
    v_mul_f32 v234, v38, v218
    v_mul_f32 v238, v70, v218
    v_mfma_f32_32x32x16_bf16 v[128:143], v[184:187], a[48:51], v[128:143]
    v_mul_f32 v235, v39, v219
    v_mul_f32 v239, v71, v219
    s_waitcnt lgkmcnt(2)
    v_fma_f32 v232, -v68, v220, v232
    v_fma_f32 v236, v36, v220, v236
    v_fma_f32 v233, -v69, v221, v233
    v_fma_f32 v237, v37, v221, v237
    v_mfma_f32_32x32x16_bf16 v[160:175], v[200:203], a[48:51], v[160:175]
    v_fma_f32 v234, -v70, v222, v234
    v_fma_f32 v238, v38, v222, v238
    v_fma_f32 v235, -v71, v223, v235
    v_fma_f32 v239, v39, v223, v239
    v_cvt_pk_bf16_f32 v90, v232, v233
    v_cvt_pk_bf16_f32 v91, v234, v235
    v_mfma_f32_32x32x16_bf16 v[128:143], v[200:203], a[112:115], v[128:143]
    v_cvt_pk_bf16_f32 v106, v236, v237
    v_cvt_pk_bf16_f32 v107, v238, v239
    ds_read_b128 v[216:219], v2 offset:14336
    ds_read_b128 v[220:223], v2 offset:15360
    s_waitcnt lgkmcnt(3)
    v_mul_f32 v224, v40, v208
    v_mul_f32 v228, v72, v208
    v_mfma_f32_32x32x16_bf16 v[160:175], v[184:187], a[80:83], v[160:175]
    v_mul_f32 v225, v41, v209
    v_mul_f32 v229, v73, v209
    v_mul_f32 v226, v42, v210
    v_mul_f32 v230, v74, v210
    v_mul_f32 v227, v43, v211
    v_mul_f32 v231, v75, v211
    v_mfma_f32_32x32x16_bf16 v[112:127], v[188:191], a[36:39], v[112:127]
    s_waitcnt lgkmcnt(2)
    v_fma_f32 v224, -v72, v212, v224
    v_fma_f32 v228, v40, v212, v228
    v_fma_f32 v225, -v73, v213, v225
    v_fma_f32 v229, v41, v213, v229
    v_fma_f32 v226, -v74, v214, v226
    v_fma_f32 v230, v42, v214, v230
    v_mfma_f32_32x32x16_bf16 v[144:159], v[204:207], a[36:39], v[144:159]
    v_fma_f32 v227, -v75, v215, v227
    v_fma_f32 v231, v43, v215, v231
    v_cvt_pk_bf16_f32 v92, v224, v225
    v_cvt_pk_bf16_f32 v93, v226, v227
    v_cvt_pk_bf16_f32 v108, v228, v229
    v_cvt_pk_bf16_f32 v109, v230, v231
    v_mfma_f32_32x32x16_bf16 v[112:127], v[204:207], a[100:103], v[112:127]
    s_waitcnt lgkmcnt(1)
    v_mul_f32 v232, v44, v216
    v_mul_f32 v236, v76, v216
    v_mul_f32 v233, v45, v217
    v_mul_f32 v237, v77, v217
    v_mul_f32 v234, v46, v218
    v_mul_f32 v238, v78, v218
    v_mfma_f32_32x32x16_bf16 v[144:159], v[188:191], a[68:71], v[144:159]
    v_mul_f32 v235, v47, v219
    v_mul_f32 v239, v79, v219
    s_waitcnt lgkmcnt(0)
    v_fma_f32 v232, -v76, v220, v232
    v_fma_f32 v236, v44, v220, v236
    v_fma_f32 v233, -v77, v221, v233
    v_fma_f32 v237, v45, v221, v237
    v_mfma_f32_32x32x16_bf16 v[128:143], v[188:191], a[52:55], v[128:143]
    v_fma_f32 v234, -v78, v222, v234
    v_fma_f32 v238, v46, v222, v238
    v_fma_f32 v235, -v79, v223, v235
    v_fma_f32 v239, v47, v223, v239
    v_cvt_pk_bf16_f32 v94, v232, v233
    v_cvt_pk_bf16_f32 v95, v234, v235
    v_mfma_f32_32x32x16_bf16 v[160:175], v[204:207], a[52:55], v[160:175]
    v_cvt_pk_bf16_f32 v110, v236, v237
    v_cvt_pk_bf16_f32 v111, v238, v239
    v_mfma_f32_32x32x16_bf16 v[128:143], v[204:207], a[116:119], v[128:143]
    v_mfma_f32_32x32x16_bf16 v[160:175], v[188:191], a[84:87], v[160:175]
    v_mfma_f32_32x32x16_bf16 v[16:31], v[80:83], a[0:3], 0
    ds_read_b128 v[208:211], v2 offset:0
    ds_read_b128 v[212:215], v2 offset:1024
    ds_read_b128 v[216:219], v2 offset:2048
    ds_read_b128 v[220:223], v2 offset:3072
    s_waitcnt lgkmcnt(3)
    v_mul_f32 v224, v112, v208
    v_mul_f32 v228, v144, v208
    v_mul_f32 v225, v113, v209
    v_mul_f32 v229, v145, v209
    v_mul_f32 v226, v114, v210
    v_mul_f32 v230, v146, v210
    v_mul_f32 v227, v115, v211
    v_mfma_f32_32x32x16_bf16 v[48:63], v[96:99], a[0:3], 0
    v_mul_f32 v231, v147, v211
    s_waitcnt lgkmcnt(2)
    v_fma_f32 v224, -v144, v212, v224
    v_fma_f32 v228, v112, v212, v228
    v_fma_f32 v225, -v145, v213, v225
    v_fma_f32 v229, v113, v213, v229
    v_fma_f32 v226, -v146, v214, v226
    v_fma_f32 v230, v114, v214, v230
    v_fma_f32 v227, -v147, v215, v227
    v_fma_f32 v231, v115, v215, v231
    v_cvt_pk_bf16_f32 v176, v224, v225
    v_cvt_pk_bf16_f32 v177, v226, v227
    v_mfma_f32_32x32x16_bf16 v[16:31], v[96:99], a[16:19], v[16:31]
    v_cvt_pk_bf16_f32 v192, v228, v229
    v_cvt_pk_bf16_f32 v193, v230, v231
    ds_read_b128 v[208:211], v2 offset:4096
    ds_read_b128 v[212:215], v2 offset:5120
    s_waitcnt lgkmcnt(3)
    v_mul_f32 v232, v116, v216
    v_mul_f32 v236, v148, v216
    v_mul_f32 v233, v117, v217
    v_mul_f32 v237, v149, v217
    v_mul_f32 v234, v118, v218
    v_mul_f32 v238, v150, v218
    v_mul_f32 v235, v119, v219
    v_mfma_f32_32x32x16_bf16 v[48:63], v[80:83], a[8:11], v[48:63]
    v_mul_f32 v239, v151, v219
    s_waitcnt lgkmcnt(2)
    v_fma_f32 v232, -v148, v220, v232
    v_fma_f32 v236, v116, v220, v236
    v_fma_f32 v233, -v149, v221, v233
    v_fma_f32 v237, v117, v221, v237
    v_fma_f32 v234, -v150, v222, v234
    v_fma_f32 v238, v118, v222, v238
    v_fma_f32 v235, -v151, v223, v235
    v_fma_f32 v239, v119, v223, v239
    v_cvt_pk_bf16_f32 v178, v232, v233
    v_cvt_pk_bf16_f32 v179, v234, v235
    v_mfma_f32_32x32x16_bf16 v[16:31], v[84:87], a[4:7], v[16:31]
    v_cvt_pk_bf16_f32 v194, v236, v237
    v_cvt_pk_bf16_f32 v195, v238, v239
    ds_read_b128 v[216:219], v2 offset:6144
    ds_read_b128 v[220:223], v2 offset:7168
    s_waitcnt lgkmcnt(3)
    v_mul_f32 v224, v120, v208
    v_mul_f32 v228, v152, v208
    v_mul_f32 v225, v121, v209
    v_mul_f32 v229, v153, v209
    v_mul_f32 v226, v122, v210
    v_mul_f32 v230, v154, v210
    v_mul_f32 v227, v123, v211
    v_mfma_f32_32x32x16_bf16 v[48:63], v[100:103], a[4:7], v[48:63]
    v_mul_f32 v231, v155, v211
    s_waitcnt lgkmcnt(2)
    v_fma_f32 v224, -v152, v212, v224
    v_fma_f32 v228, v120, v212, v228
    v_fma_f32 v225, -v153, v213, v225
    v_fma_f32 v229, v121, v213, v229
    v_fma_f32 v226, -v154, v214, v226
    v_fma_f32 v230, v122, v214, v230
    v_fma_f32 v227, -v155, v215, v227
    v_fma_f32 v231, v123, v215, v231
    v_cvt_pk_bf16_f32 v180, v224, v225
    v_cvt_pk_bf16_f32 v181, v226, v227
    v_mfma_f32_32x32x16_bf16 v[16:31], v[100:103], a[20:23], v[16:31]
    v_cvt_pk_bf16_f32 v196, v228, v229
    v_cvt_pk_bf16_f32 v197, v230, v231
    ds_read_b128 v[208:211], v2 offset:8192
    ds_read_b128 v[212:215], v2 offset:9216
    s_waitcnt lgkmcnt(3)
    v_mul_f32 v232, v124, v216
    v_mul_f32 v236, v156, v216
    v_mul_f32 v233, v125, v217
    v_mul_f32 v237, v157, v217
    v_mul_f32 v234, v126, v218
    v_mul_f32 v238, v158, v218
    v_mul_f32 v235, v127, v219
    v_mfma_f32_32x32x16_bf16 v[48:63], v[84:87], a[12:15], v[48:63]
    v_mul_f32 v239, v159, v219
    s_waitcnt lgkmcnt(2)
    v_fma_f32 v232, -v156, v220, v232
    v_fma_f32 v236, v124, v220, v236
    v_fma_f32 v233, -v157, v221, v233
    v_fma_f32 v237, v125, v221, v237
    v_fma_f32 v234, -v158, v222, v234
    v_fma_f32 v238, v126, v222, v238
    v_fma_f32 v235, -v159, v223, v235
    v_fma_f32 v239, v127, v223, v239
    v_cvt_pk_bf16_f32 v182, v232, v233
    v_cvt_pk_bf16_f32 v183, v234, v235
    v_mfma_f32_32x32x16_bf16 v[32:47], v[88:91], a[0:3], 0
    v_cvt_pk_bf16_f32 v198, v236, v237
    v_cvt_pk_bf16_f32 v199, v238, v239
    ds_read_b128 v[216:219], v2 offset:10240
    ds_read_b128 v[220:223], v2 offset:11264
    s_waitcnt lgkmcnt(3)
    v_mul_f32 v224, v128, v208
    v_mul_f32 v228, v160, v208
    v_mul_f32 v225, v129, v209
    v_mul_f32 v229, v161, v209
    v_mul_f32 v226, v130, v210
    v_mul_f32 v230, v162, v210
    v_mul_f32 v227, v131, v211
    v_mfma_f32_32x32x16_bf16 v[64:79], v[104:107], a[0:3], 0
    v_mul_f32 v231, v163, v211
    s_waitcnt lgkmcnt(2)
    v_fma_f32 v224, -v160, v212, v224
    v_fma_f32 v228, v128, v212, v228
    v_fma_f32 v225, -v161, v213, v225
    v_fma_f32 v229, v129, v213, v229
    v_fma_f32 v226, -v162, v214, v226
    v_fma_f32 v230, v130, v214, v230
    v_fma_f32 v227, -v163, v215, v227
    v_fma_f32 v231, v131, v215, v231
    v_cvt_pk_bf16_f32 v184, v224, v225
    v_cvt_pk_bf16_f32 v185, v226, v227
    v_mfma_f32_32x32x16_bf16 v[32:47], v[104:107], a[16:19], v[32:47]
    v_cvt_pk_bf16_f32 v200, v228, v229
    v_cvt_pk_bf16_f32 v201, v230, v231
    ds_read_b128 v[208:211], v2 offset:12288
    ds_read_b128 v[212:215], v2 offset:13312
    s_waitcnt lgkmcnt(3)
    v_mul_f32 v232, v132, v216
    v_mul_f32 v236, v164, v216
    v_mul_f32 v233, v133, v217
    v_mul_f32 v237, v165, v217
    v_mul_f32 v234, v134, v218
    v_mul_f32 v238, v166, v218
    v_mul_f32 v235, v135, v219
    v_mfma_f32_32x32x16_bf16 v[64:79], v[88:91], a[8:11], v[64:79]
    v_mul_f32 v239, v167, v219
    s_waitcnt lgkmcnt(2)
    v_fma_f32 v232, -v164, v220, v232
    v_fma_f32 v236, v132, v220, v236
    v_fma_f32 v233, -v165, v221, v233
    v_fma_f32 v237, v133, v221, v237
    v_fma_f32 v234, -v166, v222, v234
    v_fma_f32 v238, v134, v222, v238
    v_fma_f32 v235, -v167, v223, v235
    v_fma_f32 v239, v135, v223, v239
    v_cvt_pk_bf16_f32 v186, v232, v233
    v_cvt_pk_bf16_f32 v187, v234, v235
    v_mfma_f32_32x32x16_bf16 v[32:47], v[92:95], a[4:7], v[32:47]
    v_cvt_pk_bf16_f32 v202, v236, v237
    v_cvt_pk_bf16_f32 v203, v238, v239
    ds_read_b128 v[216:219], v2 offset:14336
    ds_read_b128 v[220:223], v2 offset:15360
    s_waitcnt lgkmcnt(3)
    v_mul_f32 v224, v136, v208
    v_mul_f32 v228, v168, v208
    v_mul_f32 v225, v137, v209
    v_mul_f32 v229, v169, v209
    v_mul_f32 v226, v138, v210
    v_mul_f32 v230, v170, v210
    v_mul_f32 v227, v139, v211
    v_mfma_f32_32x32x16_bf16 v[64:79], v[108:111], a[4:7], v[64:79]
    v_mul_f32 v231, v171, v211
    s_waitcnt lgkmcnt(2)
    v_fma_f32 v224, -v168, v212, v224
    v_fma_f32 v228, v136, v212, v228
    v_fma_f32 v225, -v169, v213, v225
    v_fma_f32 v229, v137, v213, v229
    v_fma_f32 v226, -v170, v214, v226
    v_fma_f32 v230, v138, v214, v230
    v_fma_f32 v227, -v171, v215, v227
    v_fma_f32 v231, v139, v215, v231
    v_cvt_pk_bf16_f32 v188, v224, v225
    v_cvt_pk_bf16_f32 v189, v226, v227
    v_mfma_f32_32x32x16_bf16 v[32:47], v[108:111], a[20:23], v[32:47]
    v_cvt_pk_bf16_f32 v204, v228, v229
    v_cvt_pk_bf16_f32 v205, v230, v231
    s_waitcnt lgkmcnt(1)
    v_mul_f32 v232, v140, v216
    v_mul_f32 v236, v172, v216
    v_mul_f32 v233, v141, v217
    v_mul_f32 v237, v173, v217
    v_mul_f32 v234, v142, v218
    v_mul_f32 v238, v174, v218
    v_mul_f32 v235, v143, v219
    v_mul_f32 v239, v175, v219
    s_waitcnt lgkmcnt(0)
    v_fma_f32 v232, -v172, v220, v232
    v_mfma_f32_32x32x16_bf16 v[64:79], v[92:95], a[12:15], v[64:79]
    v_fma_f32 v236, v140, v220, v236
    v_fma_f32 v233, -v173, v221, v233
    v_fma_f32 v237, v141, v221, v237
    v_fma_f32 v234, -v174, v222, v234
    v_fma_f32 v238, v142, v222, v238
    v_fma_f32 v235, -v175, v223, v235
    v_fma_f32 v239, v143, v223, v239
    v_cvt_pk_bf16_f32 v190, v232, v233
    v_cvt_pk_bf16_f32 v191, v234, v235
    v_cvt_pk_bf16_f32 v206, v236, v237
    v_cvt_pk_bf16_f32 v207, v238, v239
    v_mfma_f32_32x32x16_bf16 v[112:127], v[176:179], a[0:3], 0
    v_cvt_pk_bf16_f32 v80, v16, v48
    v_cvt_pk_bf16_f32 v81, v17, v49
    v_cvt_pk_bf16_f32 v82, v18, v50
    ds_write_b32 v7, v80 offset:0
    v_cvt_pk_bf16_f32 v83, v19, v51
    ds_write_b32 v7, v81 offset:512
    v_mfma_f32_32x32x16_bf16 v[144:159], v[192:195], a[0:3], 0
    v_cvt_pk_bf16_f32 v84, v20, v52
    ds_write_b32 v7, v82 offset:1024
    v_cvt_pk_bf16_f32 v85, v21, v53
    ds_write_b32 v7, v83 offset:1536
    v_cvt_pk_bf16_f32 v86, v22, v54
    ds_write_b32 v7, v84 offset:4096
    v_mfma_f32_32x32x16_bf16 v[112:127], v[192:195], a[16:19], v[112:127]
    v_cvt_pk_bf16_f32 v87, v23, v55
    ds_write_b32 v7, v85 offset:4608
    v_cvt_pk_bf16_f32 v88, v24, v56
    ds_write_b32 v7, v86 offset:5120
    v_cvt_pk_bf16_f32 v89, v25, v57
    ds_write_b32 v7, v87 offset:5632
    v_mfma_f32_32x32x16_bf16 v[144:159], v[176:179], a[8:11], v[144:159]
    v_cvt_pk_bf16_f32 v90, v26, v58
    ds_write_b32 v7, v88 offset:8192
    v_cvt_pk_bf16_f32 v91, v27, v59
    ds_write_b32 v7, v89 offset:8704
    v_cvt_pk_bf16_f32 v92, v28, v60
    ds_write_b32 v7, v90 offset:9216
    v_mfma_f32_32x32x16_bf16 v[112:127], v[180:183], a[4:7], v[112:127]
    v_cvt_pk_bf16_f32 v93, v29, v61
    ds_write_b32 v7, v91 offset:9728
    v_cvt_pk_bf16_f32 v94, v30, v62
    ds_write_b32 v7, v92 offset:12288
    v_cvt_pk_bf16_f32 v95, v31, v63
    ds_write_b32 v7, v93 offset:12800
    v_mfma_f32_32x32x16_bf16 v[144:159], v[196:199], a[4:7], v[144:159]
    v_cvt_pk_bf16_f32 v96, v32, v64
    ds_write_b32 v7, v94 offset:13312
    v_cvt_pk_bf16_f32 v97, v33, v65
    s_waitcnt lgkmcnt(14)
    ds_write_b32 v7, v95 offset:13824
    v_cvt_pk_bf16_f32 v98, v34, v66
    s_waitcnt lgkmcnt(14)
    ds_write_b32 v7, v96 offset:16384
    v_mfma_f32_32x32x16_bf16 v[112:127], v[196:199], a[20:23], v[112:127]
    v_cvt_pk_bf16_f32 v99, v35, v67
    s_waitcnt lgkmcnt(14)
    ds_write_b32 v7, v97 offset:16896
    v_cvt_pk_bf16_f32 v100, v36, v68
    s_waitcnt lgkmcnt(14)
    ds_write_b32 v7, v98 offset:17408
    v_cvt_pk_bf16_f32 v101, v37, v69
    s_waitcnt lgkmcnt(14)
    ds_write_b32 v7, v99 offset:17920
    v_mfma_f32_32x32x16_bf16 v[144:159], v[180:183], a[12:15], v[144:159]
    v_cvt_pk_bf16_f32 v102, v38, v70
    s_waitcnt lgkmcnt(14)
    ds_write_b32 v7, v100 offset:20480
    v_cvt_pk_bf16_f32 v103, v39, v71
    s_waitcnt lgkmcnt(14)
    ds_write_b32 v7, v101 offset:20992
    v_cvt_pk_bf16_f32 v104, v40, v72
    s_waitcnt lgkmcnt(14)
    ds_write_b32 v7, v102 offset:21504
    v_mfma_f32_32x32x16_bf16 v[128:143], v[184:187], a[0:3], 0
    v_cvt_pk_bf16_f32 v105, v41, v73
    s_waitcnt lgkmcnt(14)
    ds_write_b32 v7, v103 offset:22016
    v_cvt_pk_bf16_f32 v106, v42, v74
    s_waitcnt lgkmcnt(14)
    ds_write_b32 v7, v104 offset:24576
    v_cvt_pk_bf16_f32 v107, v43, v75
    s_waitcnt lgkmcnt(14)
    ds_write_b32 v7, v105 offset:25088
    v_mfma_f32_32x32x16_bf16 v[160:175], v[200:203], a[0:3], 0
    v_cvt_pk_bf16_f32 v108, v44, v76
    s_waitcnt lgkmcnt(14)
    ds_write_b32 v7, v106 offset:25600
    v_cvt_pk_bf16_f32 v109, v45, v77
    s_waitcnt lgkmcnt(14)
    ds_write_b32 v7, v107 offset:26112
    v_cvt_pk_bf16_f32 v110, v46, v78
    s_waitcnt lgkmcnt(14)
    ds_write_b32 v7, v108 offset:28672
    v_mfma_f32_32x32x16_bf16 v[128:143], v[200:203], a[16:19], v[128:143]
    v_cvt_pk_bf16_f32 v111, v47, v79
    s_waitcnt lgkmcnt(14)
    ds_write_b32 v7, v109 offset:29184
    s_waitcnt lgkmcnt(14)
    ds_write_b32 v7, v110 offset:29696
    s_waitcnt lgkmcnt(14)
    ds_write_b32 v7, v111 offset:30208
    v_mfma_f32_32x32x16_bf16 v[160:175], v[184:187], a[8:11], v[160:175]
    v_mfma_f32_32x32x16_bf16 v[128:143], v[188:191], a[4:7], v[128:143]
    v_mfma_f32_32x32x16_bf16 v[160:175], v[204:207], a[4:7], v[160:175]
    v_mfma_f32_32x32x16_bf16 v[128:143], v[204:207], a[20:23], v[128:143]
    v_mfma_f32_32x32x16_bf16 v[160:175], v[188:191], a[12:15], v[160:175]
    s_lshl_b32 s60, s18, 18
    s_lshl_b32 s61, s56, 10
    s_add_u32 s60, s60, s61
    s_add_u32 s60, s60, 13631488
    v_cvt_pk_bf16_f32 v176, v112, v144
    v_cvt_pk_bf16_f32 v177, v113, v145
    v_cvt_pk_bf16_f32 v178, v114, v146
    s_waitcnt lgkmcnt(14)
    ds_write_b32 v7, v176 offset:32768
    v_cvt_pk_bf16_f32 v179, v115, v147
    s_waitcnt lgkmcnt(14)
    ds_write_b32 v7, v177 offset:33280
    v_cvt_pk_bf16_f32 v180, v116, v148
    s_waitcnt lgkmcnt(14)
    ds_write_b32 v7, v178 offset:33792
    v_cvt_pk_bf16_f32 v181, v117, v149
    s_waitcnt lgkmcnt(14)
    ds_write_b32 v7, v179 offset:34304
    v_cvt_pk_bf16_f32 v182, v118, v150
    s_waitcnt lgkmcnt(14)
    ds_write_b32 v7, v180 offset:36864
    v_cvt_pk_bf16_f32 v183, v119, v151
    s_waitcnt lgkmcnt(14)
    ds_write_b32 v7, v181 offset:37376
    v_cvt_pk_bf16_f32 v184, v120, v152
    s_waitcnt lgkmcnt(14)
    ds_write_b32 v7, v182 offset:37888
    v_cvt_pk_bf16_f32 v185, v121, v153
    s_waitcnt lgkmcnt(14)
    ds_write_b32 v7, v183 offset:38400
    v_cvt_pk_bf16_f32 v186, v122, v154
    s_waitcnt lgkmcnt(14)
    ds_write_b32 v7, v184 offset:40960
    v_cvt_pk_bf16_f32 v187, v123, v155
    s_waitcnt lgkmcnt(14)
    ds_write_b32 v7, v185 offset:41472
    v_cvt_pk_bf16_f32 v188, v124, v156
    s_waitcnt lgkmcnt(14)
    ds_write_b32 v7, v186 offset:41984
    v_cvt_pk_bf16_f32 v189, v125, v157
    s_waitcnt lgkmcnt(14)
    ds_write_b32 v7, v187 offset:42496
    v_cvt_pk_bf16_f32 v190, v126, v158
    s_waitcnt lgkmcnt(14)
    ds_write_b32 v7, v188 offset:45056
    v_cvt_pk_bf16_f32 v191, v127, v159
    s_waitcnt lgkmcnt(14)
    ds_write_b32 v7, v189 offset:45568
    v_cvt_pk_bf16_f32 v192, v128, v160
    s_waitcnt lgkmcnt(14)
    ds_write_b32 v7, v190 offset:46080
    v_cvt_pk_bf16_f32 v193, v129, v161
    s_waitcnt lgkmcnt(14)
    ds_write_b32 v7, v191 offset:46592
    s_waitcnt lgkmcnt(0)
    s_barrier
    ds_read2st64_b32 v[16:17], v8 offset0:0 offset1:128
    ds_read2st64_b32 v[18:19], v9 offset0:0 offset1:128
    ds_read2st64_b32 v[20:21], v8 offset0:2 offset1:130
    ds_read2st64_b32 v[22:23], v9 offset0:2 offset1:130
    ds_read2st64_b32 v[24:25], v8 offset0:4 offset1:132
    ds_read2st64_b32 v[26:27], v9 offset0:4 offset1:132
    ds_read2st64_b32 v[28:29], v8 offset0:6 offset1:134
    ds_read2st64_b32 v[30:31], v9 offset0:6 offset1:134
    ds_read2st64_b32 v[32:33], v8 offset0:8 offset1:136
    ds_read2st64_b32 v[34:35], v9 offset0:8 offset1:136
    ds_read2st64_b32 v[36:37], v8 offset0:10 offset1:138
    ds_read2st64_b32 v[38:39], v9 offset0:10 offset1:138
    ds_read2st64_b32 v[40:41], v8 offset0:12 offset1:140
    ds_read2st64_b32 v[42:43], v9 offset0:12 offset1:140
    ds_read2st64_b32 v[44:45], v8 offset0:14 offset1:142
    s_waitcnt lgkmcnt(14)
    ds_read2st64_b32 v[46:47], v9 offset0:14 offset1:142
    v_cvt_pk_bf16_f32 v194, v130, v162
    s_waitcnt lgkmcnt(14)
    ds_write_b32 v7, v192 offset:49152
    v_cvt_pk_bf16_f32 v195, v131, v163
    s_waitcnt lgkmcnt(14)
    ds_write_b32 v7, v193 offset:49664
    v_cvt_pk_bf16_f32 v196, v132, v164
    s_waitcnt lgkmcnt(14)
    ds_write_b32 v7, v194 offset:50176
    v_cvt_pk_bf16_f32 v197, v133, v165
    s_waitcnt lgkmcnt(14)
    ds_write_b32 v7, v195 offset:50688
    v_cvt_pk_bf16_f32 v198, v134, v166
    s_add_u32 s61, s60, 0
    buffer_store_dwordx4 v[16:19], v2, s[24:27], s61 offen sc1
    s_waitcnt lgkmcnt(14)
    ds_write_b32 v7, v196 offset:53248
    v_cvt_pk_bf16_f32 v199, v135, v167
    s_waitcnt lgkmcnt(14)
    ds_write_b32 v7, v197 offset:53760
    v_cvt_pk_bf16_f32 v200, v136, v168
    s_waitcnt lgkmcnt(14)
    ds_write_b32 v7, v198 offset:54272
    v_cvt_pk_bf16_f32 v201, v137, v169
    s_add_u32 s61, s60, 32768
    buffer_store_dwordx4 v[20:23], v2, s[24:27], s61 offen sc1
    s_waitcnt lgkmcnt(14)
    ds_write_b32 v7, v199 offset:54784
    v_cvt_pk_bf16_f32 v202, v138, v170
    s_waitcnt lgkmcnt(14)
    ds_write_b32 v7, v200 offset:57344
    v_cvt_pk_bf16_f32 v203, v139, v171
    s_waitcnt lgkmcnt(14)
    ds_write_b32 v7, v201 offset:57856
    v_cvt_pk_bf16_f32 v204, v140, v172
    s_add_u32 s61, s60, 65536
    buffer_store_dwordx4 v[24:27], v2, s[24:27], s61 offen sc1
    s_waitcnt lgkmcnt(14)
    ds_write_b32 v7, v202 offset:58368
    v_cvt_pk_bf16_f32 v205, v141, v173
    s_waitcnt lgkmcnt(14)
    ds_write_b32 v7, v203 offset:58880
    v_cvt_pk_bf16_f32 v206, v142, v174
    s_waitcnt lgkmcnt(14)
    ds_write_b32 v7, v204 offset:61440
    v_cvt_pk_bf16_f32 v207, v143, v175
    s_add_u32 s61, s60, 98304
    buffer_store_dwordx4 v[28:31], v2, s[24:27], s61 offen sc1
    s_waitcnt lgkmcnt(14)
    ds_write_b32 v7, v205 offset:61952
    s_waitcnt lgkmcnt(14)
    ds_write_b32 v7, v206 offset:62464
    s_waitcnt lgkmcnt(14)
    ds_write_b32 v7, v207 offset:62976
    s_waitcnt lgkmcnt(0)
    s_barrier
    ds_read2st64_b32 v[48:49], v8 offset0:64 offset1:192
    ds_read2st64_b32 v[50:51], v9 offset0:64 offset1:192
    ds_read2st64_b32 v[52:53], v8 offset0:66 offset1:194
    ds_read2st64_b32 v[54:55], v9 offset0:66 offset1:194
    ds_read2st64_b32 v[56:57], v8 offset0:68 offset1:196
    ds_read2st64_b32 v[58:59], v9 offset0:68 offset1:196
    ds_read2st64_b32 v[60:61], v8 offset0:70 offset1:198
    ds_read2st64_b32 v[62:63], v9 offset0:70 offset1:198
    ds_read2st64_b32 v[64:65], v8 offset0:72 offset1:200
    ds_read2st64_b32 v[66:67], v9 offset0:72 offset1:200
    ds_read2st64_b32 v[68:69], v8 offset0:74 offset1:202
    ds_read2st64_b32 v[70:71], v9 offset0:74 offset1:202
    ds_read2st64_b32 v[72:73], v8 offset0:76 offset1:204
    ds_read2st64_b32 v[74:75], v9 offset0:76 offset1:204
    ds_read2st64_b32 v[76:77], v8 offset0:78 offset1:206
    s_waitcnt lgkmcnt(14)
    ds_read2st64_b32 v[78:79], v9 offset0:78 offset1:206
    s_add_u32 s61, s60, 131072
    buffer_store_dwordx4 v[32:35], v2, s[24:27], s61 offen sc1
    s_add_u32 s61, s60, 163840
    buffer_store_dwordx4 v[36:39], v2, s[24:27], s61 offen sc1
    s_add_u32 s61, s60, 196608
    buffer_store_dwordx4 v[40:43], v2, s[24:27], s61 offen sc1
    s_add_u32 s61, s60, 229376
    buffer_store_dwordx4 v[44:47], v2, s[24:27], s61 offen sc1
    s_add_u32 s61, s60, 1048576
    s_waitcnt lgkmcnt(14)
    buffer_store_dwordx4 v[48:51], v2, s[24:27], s61 offen sc1
    s_add_u32 s61, s60, 1081344
    s_waitcnt lgkmcnt(12)
    buffer_store_dwordx4 v[52:55], v2, s[24:27], s61 offen sc1
    s_add_u32 s61, s60, 1114112
    s_waitcnt lgkmcnt(10)
    buffer_store_dwordx4 v[56:59], v2, s[24:27], s61 offen sc1
    s_add_u32 s61, s60, 1146880
    s_waitcnt lgkmcnt(8)
    buffer_store_dwordx4 v[60:63], v2, s[24:27], s61 offen sc1
    s_add_u32 s61, s60, 1179648
    s_waitcnt lgkmcnt(6)
    buffer_store_dwordx4 v[64:67], v2, s[24:27], s61 offen sc1
    s_add_u32 s61, s60, 1212416
    s_waitcnt lgkmcnt(4)
    buffer_store_dwordx4 v[68:71], v2, s[24:27], s61 offen sc1
    s_add_u32 s61, s60, 1245184
    s_waitcnt lgkmcnt(2)
    buffer_store_dwordx4 v[72:75], v2, s[24:27], s61 offen sc1
    s_add_u32 s61, s60, 1277952
    s_waitcnt lgkmcnt(0)
    buffer_store_dwordx4 v[76:79], v2, s[24:27], s61 offen sc1
    s_add_u32 m0, s53, 147456
    s_add_u32 s55, s48, 131072
    buffer_load_dwordx4 v252, s[40:43], s55 offen offset:0 lds
    buffer_load_dwordx4 v253, s[40:43], s55 offen offset:1024 lds
    buffer_load_dwordx4 v254, s[40:43], s55 offen offset:2048 lds
    buffer_load_dwordx4 v255, s[40:43], s55 offen offset:3072 lds
    s_add_u32 m0, s53, 81920
    s_add_u32 s55, s48, 163840
    buffer_load_dwordx4 v252, s[40:43], s55 offen offset:0 lds
    buffer_load_dwordx4 v253, s[40:43], s55 offen offset:1024 lds
    buffer_load_dwordx4 v254, s[40:43], s55 offen offset:2048 lds
    buffer_load_dwordx4 v255, s[40:43], s55 offen offset:3072 lds
    v_mov_b32 v12, v252
    v_mov_b32 v13, v253
    v_mov_b32 v14, v254
    v_mov_b32 v15, v255
    v_and_b32 v248, 31, v1
    v_and_b32 v10, 15, v1
    v_min_u32 v10, 13, v10
    v_cmp_lt_u32 vcc, 6, v10
    v_subrev_u32 v3, 7, v10
    s_lshr_b32 s58, s49, 2
    v_cndmask_b32 v10, v10, v3, vcc
    v_cndmask_b32 v3, 0, 4, vcc
    v_lshl_add_u32 v10, v10, 5, v3
    s_and_b32 s59, s58, 3
    s_lshl_b32 s59, s59, 3
    s_lshr_b32 s58, s58, 2
    s_add_u32 s58, s58, s59
    v_add_lshl_u32 v10, v10, s58, 7
    buffer_load_dword v3, v10, s[24:27], 0 offen sc1
    v_lshrrev_b32 v249, 5, v1
    v_add_u32 v9, 224, v248
    v_lshlrev_b32 v9, 7, v9
    v_bfe_u32 v96, v1, 2, 2
    v_lshrrev_b32 v97, 5, v1
    v_lshl_add_u32 v97, v97, 3, v96
    v_lshl_add_u32 v97, v97, 7, s53
    v_bfe_u32 v98, v1, 4, 1
    v_lshl_add_u32 v97, v98, 5, v97
    v_and_b32 v98, 3, v1
    v_lshl_add_u32 v97, v98, 3, v97
    v_and_b32 v96, 2, v96
    v_lshlrev_b32 v96, 5, v96
    v_xor_b32 v250, v97, v96
    v_xor_b32 v251, 64, v250
    v_add_u32 v252, 0x10000, v250
    v_add_u32 v254, 0x20000, v250
    v_add_u32 v253, 0x10000, v251
    v_add_u32 v255, 0x20000, v251
    v_add_u32 v11, 114688, v2
    s_mul_i32 s56, s49, 112
    s_mul_i32 s57, s18, 28
    s_add_u32 s56, s56, s57
    s_lshl_b32 s56, s56, 10
    s_add_u32 s56, s56, 6291456
    s_waitcnt vmcnt(9)
    s_barrier
    s_add_u32 s100, s22, 2
    v_mov_b32 v112, s100
    s_cmp_eq_u32 s18, 0
    s_cselect_b32 s100, 0, 0x7ffffff0
    v_mov_b32 v113, s100
    s_lshl_b32 s100, s2, 7
    s_mov_b64 exec, 1
    buffer_store_dword v112, v113, s[24:27], s100 offen sc1
    s_mov_b64 exec, -1
    s_add_u32 m0, s53, 98304
    s_add_u32 s55, s48, 196608
    buffer_load_dwordx4 v12, s[40:43], s55 offen offset:0 lds
    buffer_load_dwordx4 v13, s[40:43], s55 offen offset:1024 lds
    buffer_load_dwordx4 v14, s[40:43], s55 offen offset:2048 lds
    buffer_load_dwordx4 v15, s[40:43], s55 offen offset:3072 lds
    s_add_u32 m0, s53, 114688
    s_add_u32 s55, s48, 229376
    buffer_load_dwordx4 v12, s[40:43], s55 offen offset:0 lds
    buffer_load_dwordx4 v13, s[40:43], s55 offen offset:1024 lds
    buffer_load_dwordx4 v14, s[40:43], s55 offen offset:2048 lds
    buffer_load_dwordx4 v15, s[40:43], s55 offen offset:3072 lds
    s_add_u32 m0, s53, 131072
    s_add_u32 s55, s48, 262144
    buffer_load_dwordx4 v12, s[40:43], s55 offen offset:0 lds
    buffer_load_dwordx4 v13, s[40:43], s55 offen offset:1024 lds
    buffer_load_dwordx4 v14, s[40:43], s55 offen offset:2048 lds
    buffer_load_dwordx4 v15, s[40:43], s55 offen offset:3072 lds
    s_add_u32 m0, s53, 65536
    s_add_u32 s55, s48, 294912
    buffer_load_dwordx4 v12, s[40:43], s55 offen offset:0 lds
    buffer_load_dwordx4 v13, s[40:43], s55 offen offset:1024 lds
    buffer_load_dwordx4 v14, s[40:43], s55 offen offset:2048 lds
    buffer_load_dwordx4 v15, s[40:43], s55 offen offset:3072 lds
    s_waitcnt vmcnt(17)
    v_subrev_u32 v3, s22, v3
    v_subrev_u32 v3, 2, v3
    v_cmp_lt_u32 vcc, 0, v3
    s_nop 1
    s_cbranch_vccnz F_AW3_SPIN
F_AW3_OK:
    s_add_u32 s59, s56, 0
    buffer_load_dwordx4 a[64:67], v2, s[24:27], s59 offen sc1
    buffer_load_dwordx4 a[68:71], v11, s[24:27], s59 offen sc1
    s_add_u32 s59, s56, 1024
    buffer_load_dwordx4 a[72:75], v2, s[24:27], s59 offen sc1
    buffer_load_dwordx4 a[76:79], v11, s[24:27], s59 offen sc1
    s_add_u32 s59, s56, 2048
    buffer_load_dwordx4 a[80:83], v2, s[24:27], s59 offen sc1
    buffer_load_dwordx4 a[84:87], v11, s[24:27], s59 offen sc1
    s_add_u32 s59, s56, 3072
    buffer_load_dwordx4 a[88:91], v2, s[24:27], s59 offen sc1
    buffer_load_dwordx4 a[92:95], v11, s[24:27], s59 offen sc1
    s_add_u32 s59, s56, 4096
    buffer_load_dwordx4 a[96:99], v2, s[24:27], s59 offen sc1
    buffer_load_dwordx4 a[100:103], v11, s[24:27], s59 offen sc1
    s_add_u32 s59, s56, 5120
    buffer_load_dwordx4 a[104:107], v2, s[24:27], s59 offen sc1
    buffer_load_dwordx4 a[108:111], v11, s[24:27], s59 offen sc1
    s_add_u32 s59, s56, 6144
    buffer_load_dwordx4 a[112:115], v2, s[24:27], s59 offen sc1
    buffer_load_dwordx4 a[116:119], v11, s[24:27], s59 offen sc1
    s_lshl_b32 s57, s49, 15
    s_lshl_b32 s58, s18, 13
    s_add_u32 s57, s57, s58
    s_add_u32 s57, s57, 13631488
    v_lshrrev_b32 v6, 3, v0
    v_and_b32 v7, 7, v0
    v_lshlrev_b32 v8, 16, v6
    v_lshl_add_u32 v8, v7, 4, v8
    s_lshl_b32 s54, s49, 10
    s_lshl_b32 s58, s50, 7
    s_add_u32 s54, s54, s58
    v_and_b32 v128, 31, v1
    s_lshl_b32 s62, s50, 6
    v_add_u32 v128, s62, v128
    v_lshrrev_b32 v129, 5, v1
    s_lshl_b32 s62, s18, 6
    v_lshl_add_u32 v129, v129, 2, s62
    v_add_u32 v129, 1, v129
    s_movk_i32 s62, 0xc5
    v_cmp_eq_u32 s[60:61], s62, v129
    v_cvt_f32_u32 v129, v129
    v_cvt_f32_u32 v130, v128
    v_mul_f32 v130, 0x3b000000, v130
    v_mul_f32 v131, 0x41000000, v130
    v_sub_f32 v132, 0x3e800000, v131
    v_sin_f32 v132, v132
    v_fma_f32 v113, -v129, v130, 0
    v_sub_f32 v115, v113, v130
    v_sub_f32 v117, v115, v130
    v_sub_f32 v119, v117, v130
    v_add_f32 v112, 0x3e800000, v113
    v_add_f32 v114, 0x3e800000, v115
    v_add_f32 v116, 0x3e800000, v117
    v_add_f32 v118, 0x3e800000, v119
    v_sub_f32 v120, v112, v131
    v_sub_f32 v121, v113, v131
    v_sub_f32 v122, v114, v131
    v_sub_f32 v123, v115, v131
    v_sub_f32 v124, v116, v131
    v_sub_f32 v125, v117, v131
    v_sub_f32 v126, v118, v131
    v_sub_f32 v127, v119, v131
    v_add_f32 v132, v132, v132
    v_sin_f32 v112, v112
    v_sin_f32 v113, v113
    v_sin_f32 v114, v114
    v_sin_f32 v115, v115
    v_sin_f32 v116, v116
    v_sin_f32 v117, v117
    v_sin_f32 v118, v118
    v_sin_f32 v119, v119
    v_sin_f32 v120, v120
    v_sin_f32 v121, v121
    v_sin_f32 v122, v122
    v_sin_f32 v123, v123
    v_sin_f32 v124, v124
    v_sin_f32 v125, v125
    v_sin_f32 v126, v126
    v_sin_f32 v127, v127
    v_cvt_pk_bf16_f32 v16, v112, v113
    v_cvt_pk_bf16_f32 v17, v114, v115
    v_cvt_pk_bf16_f32 v18, v116, v117
    v_cvt_pk_bf16_f32 v19, v118, v119
    v_cvt_pk_bf16_f32 v20, v120, v121
    v_cvt_pk_bf16_f32 v21, v122, v123
    v_cvt_pk_bf16_f32 v22, v124, v125
    v_cvt_pk_bf16_f32 v23, v126, v127
    v_fma_f32 v112, v132, v120, -v112
    v_fma_f32 v113, v132, v121, -v113
    v_fma_f32 v114, v132, v122, -v114
    v_fma_f32 v115, v132, v123, -v115
    v_fma_f32 v116, v132, v124, -v116
    v_fma_f32 v117, v132, v125, -v117
    v_fma_f32 v118, v132, v126, -v118
    v_fma_f32 v119, v132, v127, -v119
    v_cvt_pk_bf16_f32 v24, v112, v113
    v_cvt_pk_bf16_f32 v25, v114, v115
    v_cvt_pk_bf16_f32 v26, v116, v117
    v_cvt_pk_bf16_f32 v27, v118, v119
    v_fma_f32 v120, v132, v112, -v120
    v_fma_f32 v121, v132, v113, -v121
    v_fma_f32 v122, v132, v114, -v122
    v_fma_f32 v123, v132, v115, -v123
    v_fma_f32 v124, v132, v116, -v124
    v_fma_f32 v125, v132, v117, -v125
    v_fma_f32 v126, v132, v118, -v126
    v_fma_f32 v127, v132, v119, -v127
    v_cvt_pk_bf16_f32 v28, v120, v121
    v_cvt_pk_bf16_f32 v29, v122, v123
    v_cvt_pk_bf16_f32 v30, v124, v125
    v_cvt_pk_bf16_f32 v31, v126, v127
    v_fma_f32 v112, v132, v120, -v112
    v_fma_f32 v113, v132, v121, -v113
    v_fma_f32 v114, v132, v122, -v114
    v_fma_f32 v115, v132, v123, -v115
    v_fma_f32 v116, v132, v124, -v116
    v_fma_f32 v117, v132, v125, -v117
    v_fma_f32 v118, v132, v126, -v118
    v_fma_f32 v119, v132, v127, -v119
    v_cvt_pk_bf16_f32 v32, v112, v113
    v_cvt_pk_bf16_f32 v33, v114, v115
    v_cvt_pk_bf16_f32 v34, v116, v117
    v_cvt_pk_bf16_f32 v35, v118, v119
    v_fma_f32 v120, v132, v112, -v120
    v_fma_f32 v121, v132, v113, -v121
    v_fma_f32 v122, v132, v114, -v122
    v_fma_f32 v123, v132, v115, -v123
    v_fma_f32 v124, v132, v116, -v124
    v_fma_f32 v125, v132, v117, -v125
    v_fma_f32 v126, v132, v118, -v126
    v_fma_f32 v127, v132, v119, -v127
    v_cvt_pk_bf16_f32 v36, v120, v121
    v_cvt_pk_bf16_f32 v37, v122, v123
    v_cvt_pk_bf16_f32 v38, v124, v125
    v_cvt_pk_bf16_f32 v39, v126, v127
    v_fma_f32 v112, v132, v120, -v112
    v_fma_f32 v113, v132, v121, -v113
    v_fma_f32 v114, v132, v122, -v114
    v_fma_f32 v115, v132, v123, -v115
    v_fma_f32 v116, v132, v124, -v116
    s_waitcnt vmcnt(13)
    v_mfma_f32_32x32x16_bf16 v[176:191], a[128:131], a[64:67], 0
    v_mfma_f32_32x32x16_bf16 v[192:207], a[132:135], a[64:67], 0
    s_add_u32 s59, s56, 7168
    buffer_load_dwordx4 a[120:123], v2, s[24:27], s59 offen sc1
    v_fma_f32 v117, v132, v125, -v117
    s_waitcnt vmcnt(13)
    v_mfma_f32_32x32x16_bf16 v[208:223], a[128:131], a[68:71], 0
    buffer_load_dwordx4 a[124:127], v11, s[24:27], s59 offen sc1
    v_fma_f32 v118, v132, v126, -v118
    v_mfma_f32_32x32x16_bf16 v[224:239], a[132:135], a[68:71], 0
    s_add_u32 s59, s56, 8192
    buffer_load_dwordx4 a[192:195], v2, s[24:27], s59 offen sc1
    v_fma_f32 v119, v132, v127, -v119
    s_waitcnt vmcnt(14)
    v_mfma_f32_32x32x16_bf16 v[176:191], a[136:139], a[72:75], v[176:191]
    v_mfma_f32_32x32x16_bf16 v[192:207], a[140:143], a[72:75], v[192:207]
    buffer_load_dwordx4 a[196:199], v11, s[24:27], s59 offen sc1
    v_cvt_pk_bf16_f32 v40, v112, v113
    s_waitcnt vmcnt(14)
    v_mfma_f32_32x32x16_bf16 v[208:223], a[136:139], a[76:79], v[208:223]
    buffer_load_dword v4, v9, s[24:27], 0 offen sc1
    v_cvt_pk_bf16_f32 v41, v114, v115
    v_mfma_f32_32x32x16_bf16 v[224:239], a[140:143], a[76:79], v[224:239]
    s_add_u32 s59, s56, 9216
    buffer_load_dwordx4 a[200:203], v2, s[24:27], s59 offen sc1
    v_cvt_pk_bf16_f32 v42, v116, v117
    s_waitcnt vmcnt(15)
    v_mfma_f32_32x32x16_bf16 v[176:191], a[144:147], a[80:83], v[176:191]
    v_mfma_f32_32x32x16_bf16 v[192:207], a[148:151], a[80:83], v[192:207]
    buffer_load_dwordx4 a[204:207], v11, s[24:27], s59 offen sc1
    v_cvt_pk_bf16_f32 v43, v118, v119
    s_waitcnt vmcnt(15)
    v_mfma_f32_32x32x16_bf16 v[208:223], a[144:147], a[84:87], v[208:223]
    s_add_u32 s59, s56, 10240
    buffer_load_dwordx4 a[208:211], v2, s[24:27], s59 offen sc1
    v_fma_f32 v120, v132, v112, -v120
    v_mfma_f32_32x32x16_bf16 v[224:239], a[148:151], a[84:87], v[224:239]
    buffer_load_dwordx4 a[212:215], v11, s[24:27], s59 offen sc1
    v_fma_f32 v121, v132, v113, -v121
    s_waitcnt vmcnt(16)
    v_mfma_f32_32x32x16_bf16 v[176:191], a[152:155], a[88:91], v[176:191]
    v_mfma_f32_32x32x16_bf16 v[192:207], a[156:159], a[88:91], v[192:207]
    s_add_u32 s59, s56, 11264
    buffer_load_dwordx4 a[216:219], v2, s[24:27], s59 offen sc1
    v_fma_f32 v122, v132, v114, -v122
    s_waitcnt vmcnt(16)
    v_mfma_f32_32x32x16_bf16 v[208:223], a[152:155], a[92:95], v[208:223]
    buffer_load_dwordx4 a[220:223], v11, s[24:27], s59 offen sc1
    v_fma_f32 v123, v132, v115, -v123
    v_mfma_f32_32x32x16_bf16 v[224:239], a[156:159], a[92:95], v[224:239]
    s_add_u32 s59, s56, 12288
    buffer_load_dwordx4 a[224:227], v2, s[24:27], s59 offen sc1
    v_fma_f32 v124, v132, v116, -v124
    s_waitcnt vmcnt(17)
    v_mfma_f32_32x32x16_bf16 v[176:191], a[160:163], a[96:99], v[176:191]
    v_mfma_f32_32x32x16_bf16 v[192:207], a[164:167], a[96:99], v[192:207]
    buffer_load_dwordx4 a[228:231], v11, s[24:27], s59 offen sc1
    v_fma_f32 v125, v132, v117, -v125
    s_waitcnt vmcnt(17)
    v_mfma_f32_32x32x16_bf16 v[208:223], a[160:163], a[100:103], v[208:223]
    v_fma_f32 v126, v132, v118, -v126
    v_fma_f32 v127, v132, v119, -v127
    v_cvt_pk_bf16_f32 v44, v120, v121
    v_cvt_pk_bf16_f32 v45, v122, v123
    v_cvt_pk_bf16_f32 v46, v124, v125
    v_mfma_f32_32x32x16_bf16 v[224:239], a[164:167], a[100:103], v[224:239]
    s_add_u32 s59, s56, 13312
    buffer_load_dwordx4 a[232:235], v2, s[24:27], s59 offen sc1
    v_cvt_pk_bf16_f32 v47, v126, v127
    s_waitcnt vmcnt(17)
    v_mfma_f32_32x32x16_bf16 v[176:191], a[168:171], a[104:107], v[176:191]
    v_mfma_f32_32x32x16_bf16 v[192:207], a[172:175], a[104:107], v[192:207]
    buffer_load_dwordx4 a[236:239], v11, s[24:27], s59 offen sc1
    v_and_b32 v134, 1, v128
    s_waitcnt vmcnt(17)
    v_mfma_f32_32x32x16_bf16 v[208:223], a[168:171], a[108:111], v[208:223]
    v_lshlrev_b32 v134, 15, v134
    v_or_b32 v134, 16128, v134
    v_cndmask_b32 v47, v47, v134, s[60:61]
    v_add_u32 v128, 32, v128
    v_cvt_f32_u32 v130, v128
    v_mfma_f32_32x32x16_bf16 v[224:239], a[172:175], a[108:111], v[224:239]
    s_add_u32 s59, s56, 14336
    buffer_load_dwordx4 a[240:243], v2, s[24:27], s59 offen sc1
    v_mul_f32 v130, 0x3b000000, v130
    s_waitcnt vmcnt(17)
    v_mfma_f32_32x32x16_bf16 v[176:191], a[176:179], a[112:115], v[176:191]
    v_mfma_f32_32x32x16_bf16 v[192:207], a[180:183], a[112:115], v[192:207]
    buffer_load_dwordx4 a[244:247], v11, s[24:27], s59 offen sc1
    v_mul_f32 v131, 0x41000000, v130
    s_waitcnt vmcnt(17)
    v_mfma_f32_32x32x16_bf16 v[208:223], a[176:179], a[116:119], v[208:223]
    v_sub_f32 v132, 0x3e800000, v131
    v_sin_f32 v132, v132
    v_fma_f32 v113, -v129, v130, 0
    v_sub_f32 v115, v113, v130
    v_mfma_f32_32x32x16_bf16 v[224:239], a[180:183], a[116:119], v[224:239]
    s_add_u32 s59, s56, 15360
    buffer_load_dwordx4 a[248:251], v2, s[24:27], s59 offen sc1
    v_sub_f32 v117, v115, v130
    s_waitcnt vmcnt(17)
    v_mfma_f32_32x32x16_bf16 v[176:191], a[184:187], a[120:123], v[176:191]
    ds_read_b64_tr_b16 v[80:81], v254 offset:16384
    ds_read_b64_tr_b16 v[82:83], v254 offset:16896
    ds_read_b64_tr_b16 v[84:85], v255 offset:16384
    ds_read_b64_tr_b16 v[86:87], v255 offset:16896
    v_mfma_f32_32x32x16_bf16 v[192:207], a[188:191], a[120:123], v[192:207]
    buffer_load_dwordx4 a[252:255], v11, s[24:27], s59 offen sc1
    v_sub_f32 v119, v117, v130
    s_waitcnt vmcnt(17)
    v_mfma_f32_32x32x16_bf16 v[208:223], a[184:187], a[124:127], v[208:223]
    v_add_f32 v112, 0x3e800000, v113
    v_add_f32 v114, 0x3e800000, v115
    v_add_f32 v116, 0x3e800000, v117
    v_add_f32 v118, 0x3e800000, v119
    v_sub_f32 v120, v112, v131
    v_mfma_f32_32x32x16_bf16 v[224:239], a[188:191], a[124:127], v[224:239]
    s_add_u32 s59, s56, 16384
    buffer_load_dwordx4 a[64:67], v2, s[24:27], s59 offen sc1
    v_sub_f32 v121, v113, v131
    s_waitcnt vmcnt(17) lgkmcnt(2)
    v_mfma_f32_32x32x16_bf16 v[176:191], v[80:83], a[192:195], v[176:191]
    ds_read_b64_tr_b16 v[88:89], v254 offset:18432
    ds_read_b64_tr_b16 v[90:91], v254 offset:18944
    ds_read_b64_tr_b16 v[92:93], v255 offset:18432
    ds_read_b64_tr_b16 v[94:95], v255 offset:18944
    s_waitcnt lgkmcnt(4)
    v_mfma_f32_32x32x16_bf16 v[192:207], v[84:87], a[192:195], v[192:207]
    buffer_load_dwordx4 a[68:71], v11, s[24:27], s59 offen sc1
    v_sub_f32 v122, v114, v131
    s_waitcnt vmcnt(17)
    v_mfma_f32_32x32x16_bf16 v[208:223], v[80:83], a[196:199], v[208:223]
    v_sub_f32 v123, v115, v131
    v_sub_f32 v124, v116, v131
    v_sub_f32 v125, v117, v131
    v_sub_f32 v126, v118, v131
    v_sub_f32 v127, v119, v131
    v_mfma_f32_32x32x16_bf16 v[224:239], v[84:87], a[196:199], v[224:239]
    s_add_u32 s59, s56, 17408
    buffer_load_dwordx4 a[72:75], v2, s[24:27], s59 offen sc1
    v_add_f32 v132, v132, v132
    s_waitcnt vmcnt(16) lgkmcnt(2)
    v_mfma_f32_32x32x16_bf16 v[176:191], v[88:91], a[200:203], v[176:191]
    ds_read_b64_tr_b16 v[80:81], v252 offset:16384
    ds_read_b64_tr_b16 v[82:83], v252 offset:16896
    ds_read_b64_tr_b16 v[84:85], v253 offset:16384
    ds_read_b64_tr_b16 v[86:87], v253 offset:16896
    s_waitcnt lgkmcnt(4)
    v_mfma_f32_32x32x16_bf16 v[192:207], v[92:95], a[200:203], v[192:207]
    buffer_load_dwordx4 a[76:79], v11, s[24:27], s59 offen sc1
    s_waitcnt vmcnt(16)
    v_mfma_f32_32x32x16_bf16 v[208:223], v[88:91], a[204:207], v[208:223]
    v_sin_f32 v112, v112
    v_sin_f32 v113, v113
    v_mfma_f32_32x32x16_bf16 v[224:239], v[92:95], a[204:207], v[224:239]
    v_subrev_u32 v4, s22, v4
    v_subrev_u32 v4, 2, v4
    v_cmp_lt_u32 vcc, 0, v4
    s_nop 1
    s_cbranch_vccnz F_AW4_SPIN
F_AW4_OK:
    s_add_u32 s58, s57, 0
    buffer_load_dwordx4 a[0:3], v2, s[24:27], s58 offen sc1
    s_waitcnt vmcnt(16) lgkmcnt(2)
    v_mfma_f32_32x32x16_bf16 v[176:191], v[80:83], a[208:211], v[176:191]
    ds_read_b64_tr_b16 v[88:89], v252 offset:18432
    ds_read_b64_tr_b16 v[90:91], v252 offset:18944
    ds_read_b64_tr_b16 v[92:93], v253 offset:18432
    ds_read_b64_tr_b16 v[94:95], v253 offset:18944
    s_waitcnt lgkmcnt(4)
    v_mfma_f32_32x32x16_bf16 v[192:207], v[84:87], a[208:211], v[192:207]
    s_add_u32 s58, s57, 32768
    buffer_load_dwordx4 a[4:7], v2, s[24:27], s58 offen sc1
    s_waitcnt vmcnt(16)
    v_mfma_f32_32x32x16_bf16 v[208:223], v[80:83], a[212:215], v[208:223]
    v_sin_f32 v114, v114
    v_sin_f32 v115, v115
    v_mfma_f32_32x32x16_bf16 v[224:239], v[84:87], a[212:215], v[224:239]
    s_add_u32 s58, s57, 1024
    buffer_load_dwordx4 a[8:11], v2, s[24:27], s58 offen sc1
    s_waitcnt vmcnt(16) lgkmcnt(2)
    v_mfma_f32_32x32x16_bf16 v[176:191], v[88:91], a[216:219], v[176:191]
    ds_read_b64_tr_b16 v[80:81], v252 offset:32768
    ds_read_b64_tr_b16 v[82:83], v252 offset:33280
    ds_read_b64_tr_b16 v[84:85], v253 offset:32768
    ds_read_b64_tr_b16 v[86:87], v253 offset:33280
    s_waitcnt lgkmcnt(4)
    v_mfma_f32_32x32x16_bf16 v[192:207], v[92:95], a[216:219], v[192:207]
    s_add_u32 s58, s57, 33792
    buffer_load_dwordx4 a[12:15], v2, s[24:27], s58 offen sc1
    s_waitcnt vmcnt(16)
    v_mfma_f32_32x32x16_bf16 v[208:223], v[88:91], a[220:223], v[208:223]
    v_sin_f32 v116, v116
    v_sin_f32 v117, v117
    v_mfma_f32_32x32x16_bf16 v[224:239], v[92:95], a[220:223], v[224:239]
    s_add_u32 s58, s57, 2048
    buffer_load_dwordx4 a[16:19], v2, s[24:27], s58 offen sc1
    s_waitcnt vmcnt(16) lgkmcnt(2)
    v_mfma_f32_32x32x16_bf16 v[176:191], v[80:83], a[224:227], v[176:191]
    ds_read_b64_tr_b16 v[88:89], v252 offset:34816
    ds_read_b64_tr_b16 v[90:91], v252 offset:35328
    ds_read_b64_tr_b16 v[92:93], v253 offset:34816
    ds_read_b64_tr_b16 v[94:95], v253 offset:35328
    s_waitcnt lgkmcnt(4)
    v_mfma_f32_32x32x16_bf16 v[192:207], v[84:87], a[224:227], v[192:207]
    s_add_u32 s58, s57, 34816
    buffer_load_dwordx4 a[20:23], v2, s[24:27], s58 offen sc1
    s_waitcnt vmcnt(16)
    v_mfma_f32_32x32x16_bf16 v[208:223], v[80:83], a[228:231], v[208:223]
    v_sin_f32 v118, v118
    v_sin_f32 v119, v119
    v_mfma_f32_32x32x16_bf16 v[224:239], v[84:87], a[228:231], v[224:239]
    s_add_u32 s58, s57, 3072
    buffer_load_dwordx4 a[24:27], v2, s[24:27], s58 offen sc1
    s_waitcnt vmcnt(16) lgkmcnt(2)
    v_mfma_f32_32x32x16_bf16 v[176:191], v[88:91], a[232:235], v[176:191]
    ds_read_b64_tr_b16 v[80:81], v252 offset:49152
    ds_read_b64_tr_b16 v[82:83], v252 offset:49664
    ds_read_b64_tr_b16 v[84:85], v253 offset:49152
    ds_read_b64_tr_b16 v[86:87], v253 offset:49664
    s_waitcnt lgkmcnt(4)
    v_mfma_f32_32x32x16_bf16 v[192:207], v[92:95], a[232:235], v[192:207]
    s_add_u32 s58, s57, 35840
    buffer_load_dwordx4 a[28:31], v2, s[24:27], s58 offen sc1
    s_waitcnt vmcnt(16)
    v_mfma_f32_32x32x16_bf16 v[208:223], v[88:91], a[236:239], v[208:223]
    v_sin_f32 v120, v120
    v_sin_f32 v121, v121
    v_mfma_f32_32x32x16_bf16 v[224:239], v[92:95], a[236:239], v[224:239]
    s_add_u32 s58, s57, 4096
    buffer_load_dwordx4 a[32:35], v2, s[24:27], s58 offen sc1
    s_waitcnt vmcnt(16) lgkmcnt(2)
    v_mfma_f32_32x32x16_bf16 v[176:191], v[80:83], a[240:243], v[176:191]
    ds_read_b64_tr_b16 v[88:89], v252 offset:51200
    ds_read_b64_tr_b16 v[90:91], v252 offset:51712
    ds_read_b64_tr_b16 v[92:93], v253 offset:51200
    ds_read_b64_tr_b16 v[94:95], v253 offset:51712
    s_waitcnt lgkmcnt(4)
    v_mfma_f32_32x32x16_bf16 v[192:207], v[84:87], a[240:243], v[192:207]
    s_add_u32 s58, s57, 36864
    buffer_load_dwordx4 a[36:39], v2, s[24:27], s58 offen sc1
    s_waitcnt vmcnt(16)
    v_mfma_f32_32x32x16_bf16 v[208:223], v[80:83], a[244:247], v[208:223]
    v_sin_f32 v122, v122
    v_sin_f32 v123, v123
    v_mfma_f32_32x32x16_bf16 v[224:239], v[84:87], a[244:247], v[224:239]
    s_add_u32 s58, s57, 5120
    buffer_load_dwordx4 a[40:43], v2, s[24:27], s58 offen sc1
    s_waitcnt vmcnt(16) lgkmcnt(2)
    v_mfma_f32_32x32x16_bf16 v[176:191], v[88:91], a[248:251], v[176:191]
    ds_read_b64_tr_b16 v[80:81], v254 offset:0
    ds_read_b64_tr_b16 v[82:83], v254 offset:512
    ds_read_b64_tr_b16 v[84:85], v255 offset:0
    ds_read_b64_tr_b16 v[86:87], v255 offset:512
    s_waitcnt lgkmcnt(4)
    v_mfma_f32_32x32x16_bf16 v[192:207], v[92:95], a[248:251], v[192:207]
    s_add_u32 s58, s57, 37888
    buffer_load_dwordx4 a[44:47], v2, s[24:27], s58 offen sc1
    s_waitcnt vmcnt(16)
    v_mfma_f32_32x32x16_bf16 v[208:223], v[88:91], a[252:255], v[208:223]
    v_sin_f32 v124, v124
    v_sin_f32 v125, v125
    v_mfma_f32_32x32x16_bf16 v[224:239], v[92:95], a[252:255], v[224:239]
    s_add_u32 s58, s57, 6144
    buffer_load_dwordx4 a[48:51], v2, s[24:27], s58 offen sc1
    s_waitcnt vmcnt(16) lgkmcnt(2)
    v_mfma_f32_32x32x16_bf16 v[176:191], v[80:83], a[64:67], v[176:191]
    ds_read_b64_tr_b16 v[88:89], v254 offset:2048
    ds_read_b64_tr_b16 v[90:91], v254 offset:2560
    ds_read_b64_tr_b16 v[92:93], v255 offset:2048
    ds_read_b64_tr_b16 v[94:95], v255 offset:2560
    s_waitcnt lgkmcnt(4)
    v_mfma_f32_32x32x16_bf16 v[192:207], v[84:87], a[64:67], v[192:207]
    s_add_u32 s58, s57, 38912
    buffer_load_dwordx4 a[52:55], v2, s[24:27], s58 offen sc1
    s_waitcnt vmcnt(16)
    v_mfma_f32_32x32x16_bf16 v[208:223], v[80:83], a[68:71], v[208:223]
    v_sin_f32 v126, v126
    v_sin_f32 v127, v127
    v_cvt_pk_bf16_f32 v48, v112, v113
    v_mfma_f32_32x32x16_bf16 v[224:239], v[84:87], a[68:71], v[224:239]
    s_add_u32 s58, s57, 7168
    buffer_load_dwordx4 a[56:59], v2, s[24:27], s58 offen sc1
    v_cvt_pk_bf16_f32 v49, v114, v115
    s_waitcnt vmcnt(16) lgkmcnt(2)
    v_mfma_f32_32x32x16_bf16 v[176:191], v[88:91], a[72:75], v[176:191]
    ds_read_b64_tr_b16 v[80:81], v252 offset:0
    ds_read_b64_tr_b16 v[82:83], v252 offset:512
    ds_read_b64_tr_b16 v[84:85], v253 offset:0
    ds_read_b64_tr_b16 v[86:87], v253 offset:512
    s_waitcnt lgkmcnt(4)
    v_mfma_f32_32x32x16_bf16 v[192:207], v[92:95], a[72:75], v[192:207]
    s_add_u32 s58, s57, 39936
    buffer_load_dwordx4 a[60:63], v2, s[24:27], s58 offen sc1
    v_cvt_pk_bf16_f32 v50, v116, v117
    s_waitcnt vmcnt(16)
    v_mfma_f32_32x32x16_bf16 v[208:223], v[88:91], a[76:79], v[208:223]
    buffer_load_dwordx4 v[240:243], v8, s[36:39], s54 offen offset:0
    v_cvt_pk_bf16_f32 v51, v118, v119
    v_mfma_f32_32x32x16_bf16 v[224:239], v[92:95], a[76:79], v[224:239]
    buffer_load_dwordx4 v[244:247], v8, s[36:39], s54 offen offset:1024
    v_cvt_pk_bf16_f32 v52, v120, v121
    v_cvt_pk_bf16_f32 v53, v122, v123
    v_cvt_pk_bf16_f32 v54, v124, v125
    v_cvt_pk_bf16_f32 v55, v126, v127
    v_fma_f32 v112, v132, v120, -v112
    v_fma_f32 v113, v132, v121, -v113
    v_fma_f32 v114, v132, v122, -v114
    v_fma_f32 v115, v132, v123, -v115
    v_fma_f32 v116, v132, v124, -v116
    v_fma_f32 v117, v132, v125, -v117
    v_fma_f32 v118, v132, v126, -v118
    v_fma_f32 v119, v132, v127, -v119
    v_cvt_pk_bf16_f32 v56, v112, v113
    v_cvt_pk_bf16_f32 v57, v114, v115
    v_cvt_pk_bf16_f32 v58, v116, v117
    v_cvt_pk_bf16_f32 v59, v118, v119
    v_fma_f32 v120, v132, v112, -v120
    v_fma_f32 v121, v132, v113, -v121
    v_fma_f32 v122, v132, v114, -v122
    v_fma_f32 v123, v132, v115, -v123
    v_fma_f32 v124, v132, v116, -v124
    v_fma_f32 v125, v132, v117, -v125
    v_fma_f32 v126, v132, v118, -v126
    v_fma_f32 v127, v132, v119, -v127
    v_cvt_pk_bf16_f32 v60, v120, v121
    v_cvt_pk_bf16_f32 v61, v122, v123
    v_cvt_pk_bf16_f32 v62, v124, v125
    v_cvt_pk_bf16_f32 v63, v126, v127
    v_fma_f32 v112, v132, v120, -v112
    v_fma_f32 v113, v132, v121, -v113
    v_fma_f32 v114, v132, v122, -v114
    v_fma_f32 v115, v132, v123, -v115
    v_fma_f32 v116, v132, v124, -v116
    v_fma_f32 v117, v132, v125, -v117
    v_fma_f32 v118, v132, v126, -v118
    v_fma_f32 v119, v132, v127, -v119
    v_cvt_pk_bf16_f32 v64, v112, v113
    v_cvt_pk_bf16_f32 v65, v114, v115
    v_cvt_pk_bf16_f32 v66, v116, v117
    v_cvt_pk_bf16_f32 v67, v118, v119
    v_fma_f32 v120, v132, v112, -v120
    v_fma_f32 v121, v132, v113, -v121
    v_fma_f32 v122, v132, v114, -v122
    v_fma_f32 v123, v132, v115, -v123
    v_fma_f32 v124, v132, v116, -v124
    v_fma_f32 v125, v132, v117, -v125
    v_fma_f32 v126, v132, v118, -v126
    v_fma_f32 v127, v132, v119, -v127
    v_cvt_pk_bf16_f32 v68, v120, v121
    v_cvt_pk_bf16_f32 v69, v122, v123
    v_cvt_pk_bf16_f32 v70, v124, v125
    v_cvt_pk_bf16_f32 v71, v126, v127
    v_fma_f32 v112, v132, v120, -v112
    v_fma_f32 v113, v132, v121, -v113
    v_fma_f32 v114, v132, v122, -v114
    v_fma_f32 v115, v132, v123, -v115
    v_fma_f32 v116, v132, v124, -v116
    v_fma_f32 v117, v132, v125, -v117
    v_fma_f32 v118, v132, v126, -v118
    v_fma_f32 v119, v132, v127, -v119
    v_cvt_pk_bf16_f32 v72, v112, v113
    v_cvt_pk_bf16_f32 v73, v114, v115
    v_cvt_pk_bf16_f32 v74, v116, v117
    v_cvt_pk_bf16_f32 v75, v118, v119
    v_fma_f32 v120, v132, v112, -v120
    v_fma_f32 v121, v132, v113, -v121
    v_fma_f32 v122, v132, v114, -v122
    v_fma_f32 v123, v132, v115, -v123
    v_fma_f32 v124, v132, v116, -v124
    v_fma_f32 v125, v132, v117, -v125
    v_fma_f32 v126, v132, v118, -v126
    v_fma_f32 v127, v132, v119, -v127
    v_cvt_pk_bf16_f32 v76, v120, v121
    v_cvt_pk_bf16_f32 v77, v122, v123
    v_cvt_pk_bf16_f32 v78, v124, v125
    v_cvt_pk_bf16_f32 v79, v126, v127
    v_and_b32 v134, 1, v128
    v_lshlrev_b32 v134, 15, v134
    v_or_b32 v134, 16128, v134
    v_cndmask_b32 v79, v79, v134, s[60:61]
    v_bfe_u32 v110, v1, 1, 2
    v_and_b32 v111, 1, v1
    v_lshl_or_b32 v110, v111, 2, v110
    v_xor_b32 v110, v110, v249
    v_lshl_add_u32 v111, v248, 7, s53
    v_xor_b32 v96, 0, v110
    v_lshl_add_u32 v96, v96, 4, v111
    v_add_u32 v100, 0, v96
    v_add_u32 v96, 81920, v96
    v_xor_b32 v97, 2, v110
    v_lshl_add_u32 v97, v97, 4, v111
    v_add_u32 v101, 0, v97
    v_add_u32 v97, 81920, v97
    v_xor_b32 v98, 4, v110
    v_lshl_add_u32 v98, v98, 4, v111
    v_add_u32 v102, 0, v98
    v_add_u32 v98, 81920, v98
    v_xor_b32 v99, 6, v110
    v_lshl_add_u32 v99, v99, 4, v111
    v_add_u32 v103, 0, v99
    v_add_u32 v99, 81920, v99
    v_bfe_u32 v110, v6, 1, 2
    v_and_b32 v111, 1, v6
    v_lshl_or_b32 v110, v111, 2, v110
    v_lshrrev_b32 v111, 2, v7
    v_lshlrev_b32 v111, 14, v111
    v_lshl_add_u32 v111, v6, 7, v111
    v_and_b32 v109, 3, v7
    v_lshl_add_u32 v108, v109, 1, 0
    v_xor_b32 v108, v108, v110
    v_lshl_add_u32 v104, v108, 4, v111
    v_add_u32 v106, 0, v104
    v_add_u32 v104, 81920, v104
    v_lshl_add_u32 v108, v109, 1, 1
    v_xor_b32 v108, v108, v110
    v_lshl_add_u32 v105, v108, 4, v111
    v_add_u32 v107, 0, v105
    v_add_u32 v105, 81920, v105
    s_waitcnt vmcnt(17)
    v_mfma_f32_32x32x16_bf16 v[112:127], v[16:19], a[0:3], 0
    s_add_u32 s59, s56, 18432
    buffer_load_dwordx4 a[80:83], v2, s[24:27], s59 offen sc1
    v_mfma_f32_32x32x16_bf16 v[128:143], v[48:51], a[0:3], 0
    buffer_load_dwordx4 a[84:87], v11, s[24:27], s59 offen sc1
    s_waitcnt vmcnt(18)
    v_mfma_f32_32x32x16_bf16 v[144:159], v[16:19], a[4:7], 0
    s_add_u32 m0, s53, 0
    s_add_u32 s55, s48, 327680
    buffer_load_dwordx4 v12, s[40:43], s55 offen offset:0 lds
    v_mfma_f32_32x32x16_bf16 v[160:175], v[48:51], a[4:7], 0
    buffer_load_dwordx4 v13, s[40:43], s55 offen offset:1024 lds
    s_waitcnt vmcnt(19)
    v_mfma_f32_32x32x16_bf16 v[112:127], v[20:23], a[8:11], v[112:127]
    buffer_load_dwordx4 v14, s[40:43], s55 offen offset:2048 lds
    v_mfma_f32_32x32x16_bf16 v[128:143], v[52:55], a[8:11], v[128:143]
    buffer_load_dwordx4 v15, s[40:43], s55 offen offset:3072 lds
    s_waitcnt vmcnt(20)
    v_mfma_f32_32x32x16_bf16 v[144:159], v[20:23], a[12:15], v[144:159]
    s_add_u32 s59, s56, 19456
    buffer_load_dwordx4 a[88:91], v2, s[24:27], s59 offen sc1
    v_mfma_f32_32x32x16_bf16 v[160:175], v[52:55], a[12:15], v[160:175]
    buffer_load_dwordx4 a[92:95], v11, s[24:27], s59 offen sc1
    s_waitcnt vmcnt(21)
    v_mfma_f32_32x32x16_bf16 v[112:127], v[24:27], a[16:19], v[112:127]
    s_add_u32 s59, s56, 20480
    buffer_load_dwordx4 a[96:99], v2, s[24:27], s59 offen sc1
    v_mfma_f32_32x32x16_bf16 v[128:143], v[56:59], a[16:19], v[128:143]
    buffer_load_dwordx4 a[100:103], v11, s[24:27], s59 offen sc1
    s_waitcnt vmcnt(22)
    v_mfma_f32_32x32x16_bf16 v[144:159], v[24:27], a[20:23], v[144:159]
    s_add_u32 m0, s53, 16384
    s_add_u32 s55, s48, 360448
    buffer_load_dwordx4 v12, s[40:43], s55 offen offset:0 lds
    v_mfma_f32_32x32x16_bf16 v[160:175], v[56:59], a[20:23], v[160:175]
    buffer_load_dwordx4 v13, s[40:43], s55 offen offset:1024 lds
    s_waitcnt vmcnt(23)
    v_mfma_f32_32x32x16_bf16 v[112:127], v[28:31], a[24:27], v[112:127]
    buffer_load_dwordx4 v14, s[40:43], s55 offen offset:2048 lds
    v_mfma_f32_32x32x16_bf16 v[128:143], v[60:63], a[24:27], v[128:143]
    buffer_load_dwordx4 v15, s[40:43], s55 offen offset:3072 lds
    s_waitcnt vmcnt(24)
    v_mfma_f32_32x32x16_bf16 v[144:159], v[28:31], a[28:31], v[144:159]
    s_add_u32 s59, s56, 21504
    buffer_load_dwordx4 a[104:107], v2, s[24:27], s59 offen sc1
    v_mfma_f32_32x32x16_bf16 v[160:175], v[60:63], a[28:31], v[160:175]
    buffer_load_dwordx4 a[108:111], v11, s[24:27], s59 offen sc1
    s_waitcnt vmcnt(25)
    v_mfma_f32_32x32x16_bf16 v[112:127], v[32:35], a[32:35], v[112:127]
    s_add_u32 s59, s56, 22528
    buffer_load_dwordx4 a[112:115], v2, s[24:27], s59 offen sc1
    v_mfma_f32_32x32x16_bf16 v[128:143], v[64:67], a[32:35], v[128:143]
    buffer_load_dwordx4 a[116:119], v11, s[24:27], s59 offen sc1
    s_waitcnt vmcnt(26)
    v_mfma_f32_32x32x16_bf16 v[144:159], v[32:35], a[36:39], v[144:159]
    s_add_u32 m0, s53, 32768
    s_add_u32 s55, s48, 393216
    buffer_load_dwordx4 v12, s[40:43], s55 offen offset:0 lds
    v_mfma_f32_32x32x16_bf16 v[160:175], v[64:67], a[36:39], v[160:175]
    buffer_load_dwordx4 v13, s[40:43], s55 offen offset:1024 lds
    s_waitcnt vmcnt(27)
    v_mfma_f32_32x32x16_bf16 v[112:127], v[36:39], a[40:43], v[112:127]
    buffer_load_dwordx4 v14, s[40:43], s55 offen offset:2048 lds
    v_mfma_f32_32x32x16_bf16 v[128:143], v[68:71], a[40:43], v[128:143]
    buffer_load_dwordx4 v15, s[40:43], s55 offen offset:3072 lds
    s_waitcnt vmcnt(28)
    v_mfma_f32_32x32x16_bf16 v[144:159], v[36:39], a[44:47], v[144:159]
    s_add_u32 s59, s56, 23552
    buffer_load_dwordx4 a[120:123], v2, s[24:27], s59 offen sc1
    v_mfma_f32_32x32x16_bf16 v[160:175], v[68:71], a[44:47], v[160:175]
    buffer_load_dwordx4 a[124:127], v11, s[24:27], s59 offen sc1
    s_waitcnt vmcnt(29)
    v_mfma_f32_32x32x16_bf16 v[112:127], v[40:43], a[48:51], v[112:127]
    s_add_u32 s59, s56, 24576
    buffer_load_dwordx4 a[192:195], v2, s[24:27], s59 offen sc1
    v_mfma_f32_32x32x16_bf16 v[128:143], v[72:75], a[48:51], v[128:143]
    buffer_load_dwordx4 a[196:199], v11, s[24:27], s59 offen sc1
    s_waitcnt vmcnt(30)
    v_mfma_f32_32x32x16_bf16 v[144:159], v[40:43], a[52:55], v[144:159]
    s_add_u32 m0, s53, 49152
    s_add_u32 s55, s48, 425984
    buffer_load_dwordx4 v12, s[40:43], s55 offen offset:0 lds
    v_mfma_f32_32x32x16_bf16 v[160:175], v[72:75], a[52:55], v[160:175]
    buffer_load_dwordx4 v13, s[40:43], s55 offen offset:1024 lds
    s_waitcnt vmcnt(31)
    v_mfma_f32_32x32x16_bf16 v[112:127], v[44:47], a[56:59], v[112:127]
    buffer_load_dwordx4 v14, s[40:43], s55 offen offset:2048 lds
    v_mfma_f32_32x32x16_bf16 v[128:143], v[76:79], a[56:59], v[128:143]
    buffer_load_dwordx4 v15, s[40:43], s55 offen offset:3072 lds
    s_waitcnt vmcnt(32)
    v_mfma_f32_32x32x16_bf16 v[144:159], v[44:47], a[60:63], v[144:159]
    s_add_u32 s59, s56, 25600
    buffer_load_dwordx4 a[200:203], v2, s[24:27], s59 offen sc1
    v_mfma_f32_32x32x16_bf16 v[160:175], v[76:79], a[60:63], v[160:175]
    buffer_load_dwordx4 a[204:207], v11, s[24:27], s59 offen sc1
    s_waitcnt vmcnt(31) lgkmcnt(2)
    v_mfma_f32_32x32x16_bf16 v[176:191], v[80:83], a[80:83], v[176:191]
    ds_read_b64_tr_b16 v[88:89], v252 offset:2048
    ds_read_b64_tr_b16 v[90:91], v252 offset:2560
    ds_read_b64_tr_b16 v[92:93], v253 offset:2048
    ds_read_b64_tr_b16 v[94:95], v253 offset:2560
    s_waitcnt lgkmcnt(4)
    v_mfma_f32_32x32x16_bf16 v[192:207], v[84:87], a[80:83], v[192:207]
    s_add_u32 s59, s56, 26624
    buffer_load_dwordx4 a[208:211], v2, s[24:27], s59 offen sc1
    s_waitcnt vmcnt(31)
    v_mfma_f32_32x32x16_bf16 v[208:223], v[80:83], a[84:87], v[208:223]
    buffer_load_dwordx4 a[212:215], v11, s[24:27], s59 offen sc1
    v_mfma_f32_32x32x16_bf16 v[224:239], v[84:87], a[84:87], v[224:239]
    s_add_u32 s59, s56, 27648
    buffer_load_dwordx4 a[216:219], v2, s[24:27], s59 offen sc1
    s_waitcnt vmcnt(28) lgkmcnt(2)
    v_mfma_f32_32x32x16_bf16 v[176:191], v[88:91], a[88:91], v[176:191]
    ds_read_b64_tr_b16 v[80:81], v250 offset:0
    ds_read_b64_tr_b16 v[82:83], v250 offset:512
    ds_read_b64_tr_b16 v[84:85], v251 offset:0
    ds_read_b64_tr_b16 v[86:87], v251 offset:512
    s_waitcnt lgkmcnt(4)
    v_mfma_f32_32x32x16_bf16 v[192:207], v[92:95], a[88:91], v[192:207]
    buffer_load_dwordx4 a[220:223], v11, s[24:27], s59 offen sc1
    s_waitcnt vmcnt(28)
    v_mfma_f32_32x32x16_bf16 v[208:223], v[88:91], a[92:95], v[208:223]
    ds_write_b128 v96, v[112:115] offset:0
    v_mfma_f32_32x32x16_bf16 v[224:239], v[92:95], a[92:95], v[224:239]
    s_waitcnt vmcnt(27) lgkmcnt(3)
    v_mfma_f32_32x32x16_bf16 v[176:191], v[80:83], a[96:99], v[176:191]
    ds_read_b64_tr_b16 v[88:89], v250 offset:2048
    ds_read_b64_tr_b16 v[90:91], v250 offset:2560
    ds_read_b64_tr_b16 v[92:93], v251 offset:2048
    ds_read_b64_tr_b16 v[94:95], v251 offset:2560
    s_waitcnt lgkmcnt(5)
    v_mfma_f32_32x32x16_bf16 v[192:207], v[84:87], a[96:99], v[192:207]
    s_waitcnt vmcnt(26)
    v_mfma_f32_32x32x16_bf16 v[208:223], v[80:83], a[100:103], v[208:223]
    ds_write_b128 v97, v[116:119] offset:0
    v_mfma_f32_32x32x16_bf16 v[224:239], v[84:87], a[100:103], v[224:239]
    s_waitcnt vmcnt(21) lgkmcnt(3)
    v_mfma_f32_32x32x16_bf16 v[176:191], v[88:91], a[104:107], v[176:191]
    ds_read_b64_tr_b16 v[80:81], v250 offset:16384
    ds_read_b64_tr_b16 v[82:83], v250 offset:16896
    ds_read_b64_tr_b16 v[84:85], v251 offset:16384
    ds_read_b64_tr_b16 v[86:87], v251 offset:16896
    s_waitcnt lgkmcnt(5)
    v_mfma_f32_32x32x16_bf16 v[192:207], v[92:95], a[104:107], v[192:207]
    s_waitcnt vmcnt(20)
    v_mfma_f32_32x32x16_bf16 v[208:223], v[88:91], a[108:111], v[208:223]
    ds_write_b128 v98, v[120:123] offset:0
    v_mfma_f32_32x32x16_bf16 v[224:239], v[92:95], a[108:111], v[224:239]
    s_waitcnt vmcnt(19) lgkmcnt(3)
    v_mfma_f32_32x32x16_bf16 v[176:191], v[80:83], a[112:115], v[176:191]
    ds_read_b64_tr_b16 v[88:89], v250 offset:18432
    ds_read_b64_tr_b16 v[90:91], v250 offset:18944
    ds_read_b64_tr_b16 v[92:93], v251 offset:18432
    ds_read_b64_tr_b16 v[94:95], v251 offset:18944
    s_waitcnt lgkmcnt(5)
    v_mfma_f32_32x32x16_bf16 v[192:207], v[84:87], a[112:115], v[192:207]
    s_waitcnt vmcnt(18)
    v_mfma_f32_32x32x16_bf16 v[208:223], v[80:83], a[116:119], v[208:223]
    ds_write_b128 v99, v[124:127] offset:0
    v_mfma_f32_32x32x16_bf16 v[224:239], v[84:87], a[116:119], v[224:239]
    s_waitcnt vmcnt(13) lgkmcnt(3)
    v_mfma_f32_32x32x16_bf16 v[176:191], v[88:91], a[120:123], v[176:191]
    ds_read_b64_tr_b16 v[80:81], v250 offset:32768
    ds_read_b64_tr_b16 v[82:83], v250 offset:33280
    ds_read_b64_tr_b16 v[84:85], v251 offset:32768
    ds_read_b64_tr_b16 v[86:87], v251 offset:33280
    s_waitcnt lgkmcnt(5)
    v_mfma_f32_32x32x16_bf16 v[192:207], v[92:95], a[120:123], v[192:207]
    s_waitcnt vmcnt(12)
    v_mfma_f32_32x32x16_bf16 v[208:223], v[88:91], a[124:127], v[208:223]
    ds_write_b128 v96, v[128:131] offset:16384
    v_mfma_f32_32x32x16_bf16 v[224:239], v[92:95], a[124:127], v[224:239]
    s_waitcnt vmcnt(11) lgkmcnt(3)
    v_mfma_f32_32x32x16_bf16 v[176:191], v[80:83], a[192:195], v[176:191]
    ds_read_b64_tr_b16 v[88:89], v250 offset:34816
    ds_read_b64_tr_b16 v[90:91], v250 offset:35328
    ds_read_b64_tr_b16 v[92:93], v251 offset:34816
    ds_read_b64_tr_b16 v[94:95], v251 offset:35328
    s_waitcnt lgkmcnt(5)
    v_mfma_f32_32x32x16_bf16 v[192:207], v[84:87], a[192:195], v[192:207]
    s_waitcnt vmcnt(10)
    v_mfma_f32_32x32x16_bf16 v[208:223], v[80:83], a[196:199], v[208:223]
    ds_write_b128 v97, v[132:135] offset:16384
    v_mfma_f32_32x32x16_bf16 v[224:239], v[84:87], a[196:199], v[224:239]
    s_waitcnt vmcnt(5) lgkmcnt(3)
    v_mfma_f32_32x32x16_bf16 v[176:191], v[88:91], a[200:203], v[176:191]
    ds_read_b64_tr_b16 v[80:81], v250 offset:49152
    ds_read_b64_tr_b16 v[82:83], v250 offset:49664
    ds_read_b64_tr_b16 v[84:85], v251 offset:49152
    ds_read_b64_tr_b16 v[86:87], v251 offset:49664
    s_waitcnt lgkmcnt(5)
    v_mfma_f32_32x32x16_bf16 v[192:207], v[92:95], a[200:203], v[192:207]
    s_waitcnt vmcnt(4)
    v_mfma_f32_32x32x16_bf16 v[208:223], v[88:91], a[204:207], v[208:223]
    ds_write_b128 v98, v[136:139] offset:16384
    v_mfma_f32_32x32x16_bf16 v[224:239], v[92:95], a[204:207], v[224:239]
    s_waitcnt vmcnt(3) lgkmcnt(3)
    v_mfma_f32_32x32x16_bf16 v[176:191], v[80:83], a[208:211], v[176:191]
    ds_read_b64_tr_b16 v[88:89], v250 offset:51200
    ds_read_b64_tr_b16 v[90:91], v250 offset:51712
    ds_read_b64_tr_b16 v[92:93], v251 offset:51200
    ds_read_b64_tr_b16 v[94:95], v251 offset:51712
    s_waitcnt lgkmcnt(5)
    v_mfma_f32_32x32x16_bf16 v[192:207], v[84:87], a[208:211], v[192:207]
    s_waitcnt vmcnt(2)
    v_mfma_f32_32x32x16_bf16 v[208:223], v[80:83], a[212:215], v[208:223]
    ds_write_b128 v99, v[140:143] offset:16384
    v_mfma_f32_32x32x16_bf16 v[224:239], v[84:87], a[212:215], v[224:239]
    s_waitcnt vmcnt(1) lgkmcnt(3)
    v_mfma_f32_32x32x16_bf16 v[176:191], v[88:91], a[216:219], v[176:191]
    s_waitcnt lgkmcnt(1)
    v_mfma_f32_32x32x16_bf16 v[192:207], v[92:95], a[216:219], v[192:207]
    s_waitcnt vmcnt(0)
    v_mfma_f32_32x32x16_bf16 v[208:223], v[88:91], a[220:223], v[208:223]
    ds_write_b128 v96, v[144:147] offset:32768
    v_mfma_f32_32x32x16_bf16 v[224:239], v[92:95], a[220:223], v[224:239]
    ds_write_b128 v97, v[148:151] offset:32768
    ds_write_b128 v98, v[152:155] offset:32768
    ds_write_b128 v99, v[156:159] offset:32768
    ds_write_b128 v96, v[160:163] offset:49152
    ds_write_b128 v97, v[164:167] offset:49152
    ds_write_b128 v98, v[168:171] offset:49152
    ds_write_b128 v99, v[172:175] offset:49152
    ds_write_b128 v100, v[176:179] offset:0
    v_mov_b32 v248, 0xbfb8aa3b
    ds_write_b128 v101, v[180:183] offset:0
    v_mov_b32 v249, 0x36000000
    ds_write_b128 v102, v[184:187] offset:0
    v_lshlrev_b32 v80, 16, v240
    ds_write_b128 v103, v[188:191] offset:0
    v_and_b32 v81, 0xffff0000, v240
    ds_write_b128 v100, v[192:195] offset:16384
    v_lshlrev_b32 v82, 16, v241
    ds_write_b128 v101, v[196:199] offset:16384
    v_and_b32 v83, 0xffff0000, v241
    s_waitcnt lgkmcnt(14)
    ds_write_b128 v102, v[200:203] offset:16384
    v_lshlrev_b32 v84, 16, v242
    s_waitcnt lgkmcnt(14)
    ds_write_b128 v103, v[204:207] offset:16384
    v_and_b32 v85, 0xffff0000, v242
    v_lshlrev_b32 v86, 16, v243
    s_waitcnt lgkmcnt(14)
    ds_write_b128 v100, v[208:211] offset:32768
    v_and_b32 v87, 0xffff0000, v243
    s_waitcnt lgkmcnt(14)
    ds_write_b128 v101, v[212:215] offset:32768
    v_lshlrev_b32 v88, 16, v244
    s_waitcnt lgkmcnt(14)
    ds_write_b128 v102, v[216:219] offset:32768
    v_and_b32 v89, 0xffff0000, v244
    s_waitcnt lgkmcnt(14)
    ds_write_b128 v103, v[220:223] offset:32768
    v_lshlrev_b32 v90, 16, v245
    s_waitcnt lgkmcnt(14)
    ds_write_b128 v100, v[224:227] offset:49152
    v_and_b32 v91, 0xffff0000, v245
    s_waitcnt lgkmcnt(14)
    ds_write_b128 v101, v[228:231] offset:49152
    v_lshlrev_b32 v92, 16, v246
    s_waitcnt lgkmcnt(14)
    ds_write_b128 v102, v[232:235] offset:49152
    v_and_b32 v93, 0xffff0000, v246
    s_waitcnt lgkmcnt(14)
    ds_write_b128 v103, v[236:239] offset:49152
    v_lshlrev_b32 v94, 16, v247
    v_and_b32 v95, 0xffff0000, v247
    s_waitcnt lgkmcnt(0)
    s_barrier
    ds_read_b128 v[112:115], v106 offset:0
    ds_read_b128 v[116:119], v107 offset:0
    ds_read_b128 v[120:123], v106 offset:32768
    ds_read_b128 v[124:127], v107 offset:32768
    ds_read_b128 v[128:131], v106 offset:4096
    ds_read_b128 v[132:135], v107 offset:4096
    ds_read_b128 v[136:139], v106 offset:36864
    ds_read_b128 v[140:143], v107 offset:36864
    ds_read_b128 v[144:147], v106 offset:8192
    ds_read_b128 v[148:151], v107 offset:8192
    ds_read_b128 v[152:155], v106 offset:40960
    ds_read_b128 v[156:159], v107 offset:40960
    ds_read_b128 v[160:163], v106 offset:12288
    ds_read_b128 v[164:167], v107 offset:12288
    ds_read_b128 v[168:171], v106 offset:45056
    s_waitcnt lgkmcnt(14)
    ds_read_b128 v[172:175], v107 offset:45056
    s_waitcnt lgkmcnt(14)
    ds_read_b128 v[16:19], v104 offset:0
    s_waitcnt lgkmcnt(14)
    ds_read_b128 v[20:23], v105 offset:0
    s_waitcnt lgkmcnt(14)
    ds_read_b128 v[24:27], v104 offset:32768
    s_waitcnt lgkmcnt(14)
    ds_read_b128 v[28:31], v105 offset:32768
    s_waitcnt lgkmcnt(14)
    ds_read_b128 v[32:35], v104 offset:4096
    s_waitcnt lgkmcnt(14)
    ds_read_b128 v[36:39], v105 offset:4096
    v_pk_add_f32 v[112:113], v[112:113], v[128:129]
    v_pk_add_f32 v[114:115], v[114:115], v[130:131]
    v_pk_add_f32 v[116:117], v[116:117], v[132:133]
    v_pk_add_f32 v[118:119], v[118:119], v[134:135]
    v_pk_add_f32 v[120:121], v[120:121], v[136:137]
    v_pk_add_f32 v[122:123], v[122:123], v[138:139]
    s_waitcnt lgkmcnt(14)
    v_pk_add_f32 v[124:125], v[124:125], v[140:141]
    v_pk_add_f32 v[126:127], v[126:127], v[142:143]
    ds_read_b128 v[40:43], v104 offset:36864
    s_waitcnt lgkmcnt(14)
    ds_read_b128 v[44:47], v105 offset:36864
    s_waitcnt lgkmcnt(14)
    ds_read_b128 v[48:51], v104 offset:8192
    s_waitcnt lgkmcnt(14)
    ds_read_b128 v[52:55], v105 offset:8192
    s_waitcnt lgkmcnt(14)
    ds_read_b128 v[56:59], v104 offset:40960
    s_waitcnt lgkmcnt(14)
    ds_read_b128 v[60:63], v105 offset:40960
    s_waitcnt lgkmcnt(14)
    ds_read_b128 v[64:67], v104 offset:12288
    s_waitcnt lgkmcnt(14)
    ds_read_b128 v[68:71], v105 offset:12288
    s_waitcnt lgkmcnt(14)
    ds_read_b128 v[72:75], v104 offset:45056
    s_waitcnt lgkmcnt(14)
    ds_read_b128 v[76:79], v105 offset:45056
    v_pk_add_f32 v[144:145], v[144:145], v[160:161]
    v_pk_add_f32 v[146:147], v[146:147], v[162:163]
    v_pk_add_f32 v[148:149], v[148:149], v[164:165]
    v_pk_add_f32 v[150:151], v[150:151], v[166:167]
    v_pk_add_f32 v[152:153], v[152:153], v[168:169]
    v_pk_add_f32 v[154:155], v[154:155], v[170:171]
    v_pk_add_f32 v[156:157], v[156:157], v[172:173]
    v_pk_add_f32 v[158:159], v[158:159], v[174:175]
    v_pk_add_f32 v[112:113], v[112:113], v[144:145]
    v_pk_add_f32 v[114:115], v[114:115], v[146:147]
    v_pk_add_f32 v[116:117], v[116:117], v[148:149]
    v_pk_add_f32 v[118:119], v[118:119], v[150:151]
    v_pk_add_f32 v[120:121], v[120:121], v[152:153]
    v_pk_add_f32 v[122:123], v[122:123], v[154:155]
    v_pk_add_f32 v[124:125], v[124:125], v[156:157]
    v_pk_add_f32 v[126:127], v[126:127], v[158:159]
    v_pk_mul_f32 v[176:177], v[112:113], v[248:249] op_sel_hi:[1,0]
    v_pk_mul_f32 v[178:179], v[114:115], v[248:249] op_sel_hi:[1,0]
    v_pk_mul_f32 v[180:181], v[116:117], v[248:249] op_sel_hi:[1,0]
    v_pk_mul_f32 v[182:183], v[118:119], v[248:249] op_sel_hi:[1,0]
    v_pk_mul_f32 v[184:185], v[120:121], v[248:249] op_sel_hi:[1,0]
    v_pk_mul_f32 v[186:187], v[122:123], v[248:249] op_sel_hi:[1,0]
    v_pk_mul_f32 v[188:189], v[124:125], v[248:249] op_sel_hi:[1,0]
    v_pk_mul_f32 v[190:191], v[126:127], v[248:249] op_sel_hi:[1,0]
    v_exp_f32 v176, v176
    v_exp_f32 v177, v177
    v_exp_f32 v178, v178
    v_exp_f32 v179, v179
    v_exp_f32 v180, v180
    v_exp_f32 v181, v181
    v_exp_f32 v182, v182
    v_exp_f32 v183, v183
    v_exp_f32 v184, v184
    v_exp_f32 v185, v185
    v_exp_f32 v186, v186
    v_exp_f32 v187, v187
    v_exp_f32 v188, v188
    v_exp_f32 v189, v189
    v_exp_f32 v190, v190
    v_exp_f32 v191, v191
    s_waitcnt lgkmcnt(11)
    v_pk_add_f32 v[16:17], v[16:17], v[32:33]
    v_pk_add_f32 v[18:19], v[18:19], v[34:35]
    s_waitcnt lgkmcnt(10)
    v_pk_add_f32 v[20:21], v[20:21], v[36:37]
    v_pk_add_f32 v[22:23], v[22:23], v[38:39]
    s_waitcnt lgkmcnt(9)
    v_pk_add_f32 v[24:25], v[24:25], v[40:41]
    v_pk_add_f32 v[26:27], v[26:27], v[42:43]
    s_waitcnt lgkmcnt(8)
    v_pk_add_f32 v[28:29], v[28:29], v[44:45]
    v_pk_add_f32 v[30:31], v[30:31], v[46:47]
    s_waitcnt lgkmcnt(3)
    v_pk_add_f32 v[48:49], v[48:49], v[64:65]
    v_pk_add_f32 v[50:51], v[50:51], v[66:67]
    s_waitcnt lgkmcnt(2)
    v_pk_add_f32 v[52:53], v[52:53], v[68:69]
    v_pk_add_f32 v[54:55], v[54:55], v[70:71]
    s_waitcnt lgkmcnt(1)
    v_pk_add_f32 v[56:57], v[56:57], v[72:73]
    v_pk_add_f32 v[58:59], v[58:59], v[74:75]
    s_waitcnt lgkmcnt(0)
    v_pk_add_f32 v[60:61], v[60:61], v[76:77]
    v_pk_add_f32 v[62:63], v[62:63], v[78:79]
    v_pk_add_f32 v[16:17], v[16:17], v[48:49]
    v_pk_add_f32 v[18:19], v[18:19], v[50:51]
    v_pk_add_f32 v[20:21], v[20:21], v[52:53]
    v_pk_add_f32 v[22:23], v[22:23], v[54:55]
    v_pk_add_f32 v[24:25], v[24:25], v[56:57]
    v_pk_add_f32 v[26:27], v[26:27], v[58:59]
    v_pk_add_f32 v[28:29], v[28:29], v[60:61]
    v_pk_add_f32 v[30:31], v[30:31], v[62:63]
    v_pk_mul_f32 v[112:113], v[112:113], v[248:249] op_sel:[0,1] op_sel_hi:[1,1]
    v_pk_mul_f32 v[114:115], v[114:115], v[248:249] op_sel:[0,1] op_sel_hi:[1,1]
    v_pk_mul_f32 v[116:117], v[116:117], v[248:249] op_sel:[0,1] op_sel_hi:[1,1]
    v_pk_mul_f32 v[118:119], v[118:119], v[248:249] op_sel:[0,1] op_sel_hi:[1,1]
    v_pk_mul_f32 v[120:121], v[120:121], v[248:249] op_sel:[0,1] op_sel_hi:[1,1]
    v_pk_mul_f32 v[122:123], v[122:123], v[248:249] op_sel:[0,1] op_sel_hi:[1,1]
    v_pk_mul_f32 v[124:125], v[124:125], v[248:249] op_sel:[0,1] op_sel_hi:[1,1]
    v_pk_mul_f32 v[126:127], v[126:127], v[248:249] op_sel:[0,1] op_sel_hi:[1,1]
    v_pk_mul_f32 v[112:113], v[112:113], v[16:17]
    v_pk_mul_f32 v[114:115], v[114:115], v[18:19]
    v_pk_mul_f32 v[116:117], v[116:117], v[20:21]
    v_pk_mul_f32 v[118:119], v[118:119], v[22:23]
    v_pk_mul_f32 v[120:121], v[120:121], v[24:25]
    v_pk_mul_f32 v[122:123], v[122:123], v[26:27]
    v_pk_mul_f32 v[124:125], v[124:125], v[28:29]
    v_pk_mul_f32 v[126:127], v[126:127], v[30:31]
    v_pk_add_f32 v[176:177], v[176:177], 1.0 op_sel_hi:[1,0]
    v_pk_add_f32 v[178:179], v[178:179], 1.0 op_sel_hi:[1,0]
    v_pk_add_f32 v[180:181], v[180:181], 1.0 op_sel_hi:[1,0]
    v_pk_add_f32 v[182:183], v[182:183], 1.0 op_sel_hi:[1,0]
    v_pk_add_f32 v[184:185], v[184:185], 1.0 op_sel_hi:[1,0]
    v_pk_add_f32 v[186:187], v[186:187], 1.0 op_sel_hi:[1,0]
    v_pk_add_f32 v[188:189], v[188:189], 1.0 op_sel_hi:[1,0]
    v_pk_add_f32 v[190:191], v[190:191], 1.0 op_sel_hi:[1,0]
    v_rcp_f32 v176, v176
    v_rcp_f32 v177, v177
    v_rcp_f32 v178, v178
    v_rcp_f32 v179, v179
    v_rcp_f32 v180, v180
    v_rcp_f32 v181, v181
    v_rcp_f32 v182, v182
    v_rcp_f32 v183, v183
    v_pk_fma_f32 v[176:177], v[112:113], v[176:177], v[80:81]
    v_pk_fma_f32 v[178:179], v[114:115], v[178:179], v[82:83]
    v_pk_fma_f32 v[180:181], v[116:117], v[180:181], v[84:85]
    v_pk_fma_f32 v[182:183], v[118:119], v[182:183], v[86:87]
    v_cvt_pk_bf16_f32 v192, v176, v177
    v_cvt_pk_bf16_f32 v193, v178, v179
    v_cvt_pk_bf16_f32 v194, v180, v181
    v_cvt_pk_bf16_f32 v195, v182, v183
    buffer_store_dwordx4 v[192:195], v8, s[44:47], s54 offen offset:0
    v_rcp_f32 v184, v184
    v_rcp_f32 v185, v185
    v_rcp_f32 v186, v186
    v_rcp_f32 v187, v187
    v_rcp_f32 v188, v188
    v_rcp_f32 v189, v189
    v_rcp_f32 v190, v190
    v_rcp_f32 v191, v191
    v_pk_fma_f32 v[184:185], v[120:121], v[184:185], v[88:89]
    v_pk_fma_f32 v[186:187], v[122:123], v[186:187], v[90:91]
    v_pk_fma_f32 v[188:189], v[124:125], v[188:189], v[92:93]
    v_pk_fma_f32 v[190:191], v[126:127], v[190:191], v[94:95]
    v_cvt_pk_bf16_f32 v196, v184, v185
    v_cvt_pk_bf16_f32 v197, v186, v187
    v_cvt_pk_bf16_f32 v198, v188, v189
    v_cvt_pk_bf16_f32 v199, v190, v191
    buffer_store_dwordx4 v[196:199], v8, s[44:47], s54 offen offset:1024
    s_endpgm
F_AW1_SPIN:
    s_mov_b32 s101, 65536
F_AW1_L:
    buffer_load_dword v228, v229, s[48:51], 0 offen sc1
    s_sub_u32 s101, s101, 1
    s_waitcnt vmcnt(0)
    v_cmp_eq_u32 vcc, 0, v228
    s_cmp_eq_u32 s101, 0
    s_cbranch_scc1 F_AW1_OK
    s_nop 1
    s_cbranch_vccnz F_AW1_L
    s_branch F_AW1_OK
F_AW2_SPIN:
    s_mov_b32 s101, 65536
F_AW2_L:
    buffer_load_dword v11, v3, s[24:27], 0 offen sc1
    s_sub_u32 s101, s101, 1
    s_waitcnt vmcnt(0)
    v_subrev_u32 v11, s22, v11
    v_subrev_u32 v11, 1, v11
    v_cmp_lt_u32 vcc, 1, v11
    s_cmp_eq_u32 s101, 0
    s_cbranch_scc1 F_AW2_OK
    s_nop 1
    s_cbranch_vccnz F_AW2_L
    s_branch F_AW2_OK
F_AW3_SPIN:
    s_mov_b32 s101, 65536
F_AW3_L:
    buffer_load_dword v3, v10, s[24:27], 0 offen sc1
    s_sub_u32 s101, s101, 1
    s_waitcnt vmcnt(0)
    v_subrev_u32 v3, s22, v3
    v_subrev_u32 v3, 2, v3
    v_cmp_lt_u32 vcc, 0, v3
    s_cmp_eq_u32 s101, 0
    s_cbranch_scc1 F_AW3_OK
    s_nop 1
    s_cbranch_vccnz F_AW3_L
    s_branch F_AW3_OK
F_AW4_SPIN:
    s_mov_b32 s101, 65536
F_AW4_L:
    buffer_load_dword v4, v9, s[24:27], 0 offen sc1
    s_sub_u32 s101, s101, 1
    s_waitcnt vmcnt(0)
    v_subrev_u32 v4, s22, v4
    v_subrev_u32 v4, 2, v4
    v_cmp_lt_u32 vcc, 0, v4
    s_cmp_eq_u32 s101, 0
    s_cbranch_scc1 F_AW4_OK
    s_nop 1
    s_cbranch_vccnz F_AW4_L
    s_branch F_AW4_OK
.p2align 8
.type FFT_TBL,@object
FFT_TBL:
.long 0x3f800000,0x3f800000,0x3f800000,0x3f800000,0x3f800000,0x3f7fffb1,0x3f7ffec4,0x3f7ffd39
.long 0x3f800000,0x3f7ffec4,0x3f7ffb11,0x3f7ff4e6,0x3f800000,0x3f7ffd39,0x3f7ff4e6,0x3f7fe705
.long 0x3f800000,0x3f7ffb11,0x3f7fec43,0x3f7fd397,0x3f800000,0x3f7ff84a,0x3f7fe129,0x3f7fba9e
.long 0x3f800000,0x3f7ff4e6,0x3f7fd397,0x3f7f9c18,0x3f800000,0x3f7ff0e3,0x3f7fc38f,0x3f7f7808
.long 0x3f800000,0x3f7fec43,0x3f7fb10f,0x3f7f4e6d,0x3f800000,0x3f7fe705,0x3f7f9c18,0x3f7f1f49
.long 0x3f800000,0x3f7fe129,0x3f7f84ab,0x3f7eea9d,0x3f800000,0x3f7fdaaf,0x3f7f6ac7,0x3f7eb069
.long 0x3f800000,0x3f7fd397,0x3f7f4e6d,0x3f7e70b0,0x3f800000,0x3f7fcbe2,0x3f7f2f9d,0x3f7e2b72
.long 0x3f800000,0x3f7fc38f,0x3f7f0e58,0x3f7de0b1,0x3f800000,0x3f7fba9e,0x3f7eea9d,0x3f7d906e
.long 0x3f800000,0x3f7fb10f,0x3f7ec46d,0x3f7d3aac,0x3f800000,0x3f7fa6e3,0x3f7e9bc9,0x3f7cdf6c
.long 0x3f800000,0x3f7f9c18,0x3f7e70b0,0x3f7c7eb0,0x3f800000,0x3f7f90b1,0x3f7e4323,0x3f7c187a
.long 0x3f800000,0x3f7f84ab,0x3f7e1324,0x3f7baccd,0x3f800000,0x3f7f7808,0x3f7de0b1,0x3f7b3bab
.long 0x3f800000,0x3f7f6ac7,0x3f7dabcc,0x3f7ac516,0x3f800000,0x3f7f5ce9,0x3f7d7474,0x3f7a4910
.long 0x3f800000,0x3f7f4e6d,0x3f7d3aac,0x3f79c79d,0x3f800000,0x3f7f3f54,0x3f7cfe73,0x3f7940c0
.long 0x3f800000,0x3f7f2f9d,0x3f7cbfc9,0x3f78b47b,0x3f800000,0x3f7f1f49,0x3f7c7eb0,0x3f7822d1
.long 0x3f800000,0x3f7f0e58,0x3f7c3b28,0x3f778bc5,0x3f800000,0x3f7efcc9,0x3f7bf531,0x3f76ef5b
.long 0x3f800000,0x3f7eea9d,0x3f7baccd,0x3f764d97,0x3f800000,0x3f7ed7d4,0x3f7b61fc,0x3f75a67b
.long 0x3f800000,0x3f800000,0x3f800000,0x3f800000,0x3f7ffb11,0x3f7ff84a,0x3f7ff4e6,0x3f7ff0e3
.long 0x3f7fec43,0x3f7fe129,0x3f7fd397,0x3f7fc38f,0x3f7fd397,0x3f7fba9e,0x3f7f9c18,0x3f7f7808
.long 0x3f7fb10f,0x3f7f84ab,0x3f7f4e6d,0x3f7f0e58,0x3f7f84ab,0x3f7f3f54,0x3f7eea9d,0x3f7e868b
.long 0x3f7f4e6d,0x3f7eea9d,0x3f7e70b0,0x3f7de0b1,0x3f7f0e58,0x3f7e868b,0x3f7de0b1,0x3f7d1cdd
.long 0x3f7ec46d,0x3f7e1324,0x3f7d3aac,0x3f7c3b28,0x3f7e70b0,0x3f7d906e,0x3f7c7eb0,0x3f7b3bab
.long 0x3f7e1324,0x3f7cfe73,0x3f7baccd,0x3f7a1e84,0x3f7dabcc,0x3f7c5d3a,0x3f7ac516,0x3f78e3d6
.long 0x3f7d3aac,0x3f7baccd,0x3f79c79d,0x3f778bc5,0x3f7cbfc9,0x3f7aed37,0x3f78b47b,0x3f76167a
.long 0x3f7c3b28,0x3f7a1e84,0x3f778bc5,0x3f748422,0x3f7baccd,0x3f7940c0,0x3f764d97,0x3f72d4eb
.long 0x3f7b14be,0x3f7853f8,0x3f74fa0b,0x3f710908,0x3f7a7302,0x3f77583a,0x3f73913f,0x3f6f20b0
.long 0x3f79c79d,0x3f764d97,0x3f721352,0x3f6d1c1d,0x3f791298,0x3f75341d,0x3f708066,0x3f6afb8c
.long 0x3f7853f8,0x3f740bdd,0x3f6ed89e,0x3f68bf3c,0x3f778bc5,0x3f72d4eb,0x3f6d1c1d,0x3f666771
.long 0x3f76ba07,0x3f718f57,0x3f6b4b0c,0x3f63f473,0x3f75dec6,0x3f703b37,0x3f696591,0x3f61668a
.long 0x3f74fa0b,0x3f6ed89e,0x3f676bd8,0x3f5ebe05,0x3f740bdd,0x3f6d67a1,0x3f655e0b,0x3f5bfb34
.long 0x3f731447,0x3f6be858,0x3f633c5a,0x3f591e6a,0x3f721352,0x3f6a5ad9,0x3f6106f2,0x3f5627fe
.long 0x3f710908,0x3f68bf3c,0x3f5ebe05,0x3f531849,0x3f6ff573,0x3f671599,0x3f5c61c7,0x3f4fefa8
.long 0x3f6ed89e,0x3f655e0b,0x3f59f26a,0x3f4cae79,0x3f6db293,0x3f6398ac,0x3f577026,0x3f495521
.long 0x0,0x0,0x0,0x0,0x0,0x3b490fc6,0x3bc90f88,0x3c16cb58
.long 0x0,0x3bc90f88,0x3c490e90,0x3c96c9b6,0x0,0x3c16cb58,0x3c96c9b6,0x3ce22a7a
.long 0x0,0x3c490e90,0x3cc90ab0,0x3d16c32c,0x0,0x3c7b514b,0x3cfb49ba,0x3d3c6dd5
.long 0x0,0x3c96c9b6,0x3d16c32c,0x3d621469,0x0,0x3cafea69,0x3d2fe007,0x3d83db0a
.long 0x0,0x3cc90ab0,0x3d48fb30,0x3d96a905,0x0,0x3ce22a7a,0x3d621469,0x3da973ba
.long 0x0,0x3cfb49ba,0x3d7b2b74,0x3dbc3ac3,0x0,0x3d0a342f,0x3d8a200a,0x3dcefdb7
.long 0x0,0x3d16c32c,0x3d96a905,0x3de1bc2e,0x0,0x3d2351cb,0x3da3308c,0x3df475c0
.long 0x0,0x3d2fe007,0x3dafb680,0x3e039502,0x0,0x3d3c6dd5,0x3dbc3ac3,0x3e0cec4a
.long 0x0,0x3d48fb30,0x3dc8bd36,0x3e164083,0x0,0x3d55880e,0x3dd53db9,0x3e1f917b
.long 0x0,0x3d621469,0x3de1bc2e,0x3e28defc,0x0,0x3d6ea038,0x3dee3876,0x3e3228d4
.long 0x0,0x3d7b2b74,0x3dfab273,0x3e3b6ecf,0x0,0x3d83db0a,0x3e039502,0x3e44b0b9
.long 0x0,0x3d8a200a,0x3e09cf86,0x3e4dee60,0x0,0x3d9064b4,0x3e1008b7,0x3e57278f
.long 0x0,0x3d96a905,0x3e164083,0x3e605c13,0x0,0x3d9cecf9,0x3e1c76de,0x3e698bba
.long 0x0,0x3da3308c,0x3e22abb6,0x3e72b651,0x0,0x3da973ba,0x3e28defc,0x3e7bdba4
.long 0x0,0x3dafb680,0x3e2f10a2,0x3e827dc0,0x0,0x3db5f8da,0x3e354098,0x3e870ada
.long 0x0,0x3dbc3ac3,0x3e3b6ecf,0x3e8b9507,0x0,0x3dc27c39,0x3e419b37,0x3e901c2c
.long 0x0,0x0,0x0,0x0,0x3c490e90,0x3c7b514b,0x3c96c9b6,0x3cafea69
.long 0x3cc90ab0,0x3cfb49ba,0x3d16c32c,0x3d2fe007,0x3d16c32c,0x3d3c6dd5,0x3d621469,0x3d83db0a
.long 0x3d48fb30,0x3d7b2b74,0x3d96a905,0x3dafb680,0x3d7b2b74,0x3d9cecf9,0x3dbc3ac3,0x3ddb7d37
.long 0x3d96a905,0x3dbc3ac3,0x3de1bc2e,0x3e039502,0x3dafb680,0x3ddb7d37,0x3e039502,0x3e195be0
.long 0x3dc8bd36,0x3dfab273,0x3e164083,0x3e2f10a2,0x3de1bc2e,0x3e0cec4a,0x3e28defc,0x3e44b0b9
.long 0x3dfab273,0x3e1c76de,0x3e3b6ecf,0x3e5a3997,0x3e09cf86,0x3e2bf804,0x3e4dee60,0x3e6fa8b2
.long 0x3e164083,0x3e3b6ecf,0x3e605c13,0x3e827dc0,0x3e22abb6,0x3e4ada4f,0x3e72b651,0x3e8d17c0
.long 0x3e2f10a2,0x3e5a3997,0x3e827dc0,0x3e97a117,0x3e3b6ecf,0x3e698bba,0x3e8b9507,0x3ea21887
.long 0x3e47c5c2,0x3e78cfcc,0x3e94a031,0x3eac7cd4,0x3e541501,0x3e840270,0x3e9d9e78,0x3eb6ccc3
.long 0x3e605c13,0x3e8b9507,0x3ea68f12,0x3ec1071e,0x3e6c9a7f,0x3e931f35,0x3eaf713a,0x3ecb2aae
.long 0x3e78cfcc,0x3e9aa086,0x3eb8442a,0x3ed53641,0x3e827dc0,0x3ea21887,0x3ec1071e,0x3edf28a9
.long 0x3e888e93,0x3ea986c4,0x3ec9b953,0x3ee900b7,0x3e8e9a22,0x3eb0eacb,0x3ed25a09,0x3ef2bd43
.long 0x3e94a031,0x3eb8442a,0x3edae880,0x3efc5d27,0x3e9aa086,0x3ebf926f,0x3ee363fa,0x3f02ef9f
.long 0x3ea09ae5,0x3ec6d529,0x3eebcbbb,0x3f07a136,0x3ea68f12,0x3ece0bea,0x3ef41f07,0x3f0c42c9
.long 0x3eac7cd4,0x3ed53641,0x3efc5d27,0x3f10d3cd,0x3eb263ef,0x3edc53c1,0x3f0242b1,0x3f1553b7
.long 0x3eb8442a,0x3ee363fa,0x3f064b82,0x3f19c200,0x3ebe1d4a,0x3eea6681,0x3f0a48ad,0x3f1e1e22
.long 0x3f800000,0x3f800000,0x3f800000,0x3f800000,0x3f7fec43,0x3f7fe705,0x3f7fe129,0x3f7fdaaf
.long 0x3f7fb10f,0x3f7f9c18,0x3f7f84ab,0x3f7f6ac7,0x3f7f4e6d,0x3f7f1f49,0x3f7eea9d,0x3f7eb069
.long 0x3f7ec46d,0x3f7e70b0,0x3f7e1324,0x3f7dabcc,0x3f7e1324,0x3f7d906e,0x3f7cfe73,0x3f7c5d3a
.long 0x3f7d3aac,0x3f7c7eb0,0x3f7baccd,0x3f7ac516,0x3f7c3b28,0x3f7b3bab,0x3f7a1e84,0x3f78e3d6
.long 0x3f7b14be,0x3f79c79d,0x3f7853f8,0x3f76ba07,0x3f79c79d,0x3f7822d1,0x3f764d97,0x3f74484b
.long 0x3f7853f8,0x3f764d97,0x3f740bdd,0x3f718f57,0x3f76ba07,0x3f74484b,0x3f718f57,0x3f6e8ff8
.long 0x3f74fa0b,0x3f721352,0x3f6ed89e,0x3f6b4b0c,0x3f731447,0x3f6faf1b,0x3f6be858,0x3f67c187
.long 0x3f710908,0x3f6d1c1d,0x3f68bf3c,0x3f63f473,0x3f6ed89e,0x3f6a5ad9,0x3f655e0b,0x3f5fe4e9
.long 0x3f6c835e,0x3f676bd8,0x3f61c598,0x3f5b941a,0x3f6a09a7,0x3f644fac,0x3f5df6be,0x3f570348
.long 0x3f676bd8,0x3f6106f2,0x3f59f26a,0x3f5233c6,0x3f64aa59,0x3f5d924d,0x3f55b993,0x3f4d26fd
.long 0x3f61c598,0x3f59f26a,0x3f514d3d,0x3f47de65,0x3f5ebe05,0x3f5627fe,0x3f4cae79,0x3f425b89
.long 0x3f5b941a,0x3f5233c6,0x3f47de65,0x3f3ca003,0x3f584853,0x3f4e1689,0x3f42de29,0x3f36ad7f
.long 0x3f54db31,0x3f49d112,0x3f3daef9,0x3f3085bb,0x3f514d3d,0x3f456439,0x3f385216,0x3f2a2a80
.long 0x3f4d9f02,0x3f40d0da,0x3f32c8c9,0x3f239da9,0x3f49d112,0x3f3c17d9,0x3f2d1469,0x3f1ce11f
.long 0x3f45e403,0x3f373a23,0x3f273656,0x3f15f6d9,0x3f41d870,0x3f3238aa,0x3f212ff9,0x3f0ee0db
.long 0x3f3daef9,0x3f2d1469,0x3f1b02c6,0x3f07a136,0x3f396842,0x3f27ce61,0x3f14b039,0x3f003a06
.long 0x3f800000,0x3f800000,0x3f800000,0x3f800000,0x3f7fd397,0x3f7fcbe2,0x3f7fc38f,0x3f7fba9e
.long 0x3f7f4e6d,0x3f7f2f9d,0x3f7f0e58,0x3f7eea9d,0x3f7e70b0,0x3f7e2b72,0x3f7de0b1,0x3f7d906e
.long 0x3f7d3aac,0x3f7cbfc9,0x3f7c3b28,0x3f7baccd,0x3f7baccd,0x3f7aed37,0x3f7a1e84,0x3f7940c0
.long 0x3f79c79d,0x3f78b47b,0x3f778bc5,0x3f764d97,0x3f778bc5,0x3f76167a,0x3f748422,0x3f72d4eb
.long 0x3f74fa0b,0x3f731447,0x3f710908,0x3f6ed89e,0x3f721352,0x3f6faf1b,0x3f6d1c1d,0x3f6a5ad9
.long 0x3f6ed89e,0x3f6be858,0x3f68bf3c,0x3f655e0b,0x3f6b4b0c,0x3f67c187,0x3f63f473,0x3f5fe4e9
.long 0x3f676bd8,0x3f633c5a,0x3f5ebe05,0x3f59f26a,0x3f633c5a,0x3f5e5aa6,0x3f591e6a,0x3f5389c7
.long 0x3f5ebe05,0x3f591e6a,0x3f531849,0x3f4cae79,0x3f59f26a,0x3f5389c7,0x3f4cae79,0x3f456439
.long 0x3f54db31,0x3f4d9f02,0x3f45e403,0x3f3daef9,0x3f4f7a1f,0x3f476085,0x3f3ebc1b,0x3f3592e7
.long 0x3f49d112,0x3f40d0da,0x3f373a23,0x3f2d1469,0x3f43e200,0x3f39f2ac,0x3f2f61a5,0x3f24381a
.long 0x3f3daef9,0x3f32c8c9,0x3f273656,0x3f1b02c6,0x3f373a23,0x3f2b561b,0x3f1ebc12,0x3f11796b
.long 0x3f3085bb,0x3f239da9,0x3f15f6d9,0x3f07a136,0x3f299415,0x3f1ba299,0x3f0cead0,0x3efafef7
.long 0x3f226799,0x3f13682a,0x3f039c3d,0x3ee63375,0x3f1b02c6,0x3f0af1b7,0x3ef41f07,0x3ed0eb2a
.long 0x3f13682a,0x3f0242b1,0x3ee0924f,0x3ebb31a0,0x3f0b9a6b,0x3ef2bd43,0x3ecc9b8b,0x3ea5129f
.long 0x3f039c3d,0x3ee0924f,0x3eb8442a,0x3e8e9a22,0x3ef6e0cb,0x3ece0bea,0x3ea395c5,0x3e6fa8b2
.long 0x3ee63375,0x3ebb31a0,0x3e8e9a22,0x3e419b37,0x3ed53641,0x3ea80b1f,0x3e72b651,0x3e1324ca
.long 0x0,0x0,0x0,0x0,0x3cc90ab0,0x3ce22a7a,0x3cfb49ba,0x3d0a342f
.long 0x3d48fb30,0x3d621469,0x3d7b2b74,0x3d8a200a,0x3d96a905,0x3da973ba,0x3dbc3ac3,0x3dcefdb7
.long 0x3dc8bd36,0x3de1bc2e,0x3dfab273,0x3e09cf86,0x3dfab273,0x3e0cec4a,0x3e1c76de,0x3e2bf804
.long 0x3e164083,0x3e28defc,0x3e3b6ecf,0x3e4dee60,0x3e2f10a2,0x3e44b0b9,0x3e5a3997,0x3e6fa8b2
.long 0x3e47c5c2,0x3e605c13,0x3e78cfcc,0x3e888e93,0x3e605c13,0x3e7bdba4,0x3e8b9507,0x3e9920fe
.long 0x3e78cfcc,0x3e8b9507,0x3e9aa086,0x3ea986c4,0x3e888e93,0x3e9920fe,0x3ea986c4,0x3eb9bb1e
.long 0x3e94a031,0x3ea68f12,0x3eb8442a,0x3ec9b953,0x3ea09ae5,0x3eb3dca5,0x3ec6d529,0x3ed97cb9
.long 0x3eac7cd4,0x3ec1071e,0x3ed53641,0x3ee900b7,0x3eb8442a,0x3ece0bea,0x3ee363fa,0x3ef840c8
.long 0x3ec3ef15,0x3edae880,0x3ef15aea,0x3f039c3d,0x3ecf7bca,0x3ee79a5d,0x3eff17b2,0x3f0af1b7
.long 0x3edae880,0x3ef41f07,0x3f064b82,0x3f121eb0,0x3ee63375,0x3f003a06,0x3f0cead0,0x3f19210f
.long 0x3ef15aea,0x3f064b82,0x3f13682a,0x3f1ff6cb,0x3efc5d27,0x3f0c42c9,0x3f19c200,0x3f269de3
.long 0x3f039c3d,0x3f121eb0,0x3f1ff6cb,0x3f2d1469,0x3f08f59b,0x3f17de12,0x3f26050a,0x3f33587a
.long 0x3f0e39da,0x3f1d7fd1,0x3f2beb4a,0x3f396842,0x3f13682a,0x3f2302d3,0x3f31a81d,0x3f3f41fc
.long 0x3f187fc0,0x3f286605,0x3f373a23,0x3f44e3f5,0x3f1d7fd1,0x3f2da859,0x3f3ca003,0x3f4a4c87
.long 0x3f226799,0x3f32c8c9,0x3f41d870,0x3f4f7a1f,0x3f273656,0x3f37c655,0x3f46e22a,0x3f546b3b
.long 0x3f2beb4a,0x3f3ca003,0x3f4bbbf8,0x3f591e6a,0x3f3085bb,0x3f4154e1,0x3f5064af,0x3f5d924d
.long 0x0,0x0,0x0,0x0,0x3d16c32c,0x3d2351cb,0x3d2fe007,0x3d3c6dd5
.long 0x3d96a905,0x3da3308c,0x3dafb680,0x3dbc3ac3,0x3de1bc2e,0x3df475c0,0x3e039502,0x3e0cec4a
.long 0x3e164083,0x3e22abb6,0x3e2f10a2,0x3e3b6ecf,0x3e3b6ecf,0x3e4ada4f,0x3e5a3997,0x3e698bba
.long 0x3e605c13,0x3e72b651,0x3e827dc0,0x3e8b9507,0x3e827dc0,0x3e8d17c0,0x3e97a117,0x3ea21887
.long 0x3e94a031,0x3ea09ae5,0x3eac7cd4,0x3eb8442a,0x3ea68f12,0x3eb3dca5,0x3ec1071e,0x3ece0bea
.long 0x3eb8442a,0x3ec6d529,0x3ed53641,0x3ee363fa,0x3ec9b953,0x3ed97cb9,0x3ee900b7,0x3ef840c8
.long 0x3edae880,0x3eebcbbb,0x3efc5d27,0x3f064b82,0x3eebcbbb,0x3efdbabb,0x3f07a136,0x3f102dd5
.long 0x3efc5d27,0x3f07a136,0x3f10d3cd,0x3f19c200,0x3f064b82,0x3f102dd5,0x3f19c200,0x3f2302d3
.long 0x3f0e39da,0x3f187fc0,0x3f226799,0x3f2beb4a,0x3f15f6d9,0x3f209393,0x3f2ac082,0x3f34768f
.long 0x3f1d7fd1,0x3f286605,0x3f32c8c9,0x3f3ca003,0x3f24d225,0x3f2ff3e6,0x3f3a7ca4,0x3f446337
.long 0x3f2beb4a,0x3f373a23,0x3f41d870,0x3f4bbbf8,0x3f32c8c9,0x3f3e35c5,0x3f48d8b3,0x3f52a649
.long 0x3f396842,0x3f44e3f5,0x3f4f7a1f,0x3f591e6a,0x3f3fc767,0x3f4b41fa,0x3f55b993,0x3f5f20db
.long 0x3f45e403,0x3f514d3d,0x3f5b941a,0x3f64aa59,0x3f4bbbf8,0x3f570348,0x3f6106f2,0x3f69b7e4
.long 0x3f514d3d,0x3f5c61c7,0x3f660f88,0x3f6e46be,0x3f5695e5,0x3f61668a,0x3f6aab7b,0x3f725470
.long 0x3f5b941a,0x3f660f88,0x3f6ed89e,0x3f75dec6,0x3f604621,0x3f6a5ad9,0x3f7294f8,0x3f78e3d6
.long 0x3f64aa59,0x3f6e46be,0x3f75dec6,0x3f7b61fc,0x3f68bf3c,0x3f71d19f,0x3f78b47b,0x3f7d57de
.long 0x3f800000,0x3f800000,0x3f800000,0x3f800000,0x3f7fb10f,0x3f7fa6e3,0x3f7f9c18,0x3f7f90b1
.long 0x3f7ec46d,0x3f7e9bc9,0x3f7e70b0,0x3f7e4323,0x3f7d3aac,0x3f7cdf6c,0x3f7c7eb0,0x3f7c187a
.long 0x3f7b14be,0x3f7a7302,0x3f79c79d,0x3f791298,0x3f7853f8,0x3f77583a,0x3f764d97,0x3f75341d
.long 0x3f74fa0b,0x3f73913f,0x3f721352,0x3f708066,0x3f710908,0x3f6f20b0,0x3f6d1c1d,0x3f6afb8c
.long 0x3f6c835e,0x3f6a09a7,0x3f676bd8,0x3f64aa59,0x3f676bd8,0x3f644fac,0x3f6106f2,0x3f5d924d
.long 0x3f61c598,0x3f5df6be,0x3f59f26a,0x3f55b993,0x3f5b941a,0x3f570348,0x3f5233c6,0x3f4d26fd
.long 0x3f54db31,0x3f4f7a1f,0x3f49d112,0x3f43e200,0x3f4d9f02,0x3f476085,0x3f40d0da,0x3f39f2ac
.long 0x3f45e403,0x3f3ebc1b,0x3f373a23,0x3f2f61a5,0x3f3daef9,0x3f3592e7,0x3f2d1469,0x3f24381a
.long 0x3f3504f3,0x3f2beb4a,0x3f226799,0x3f187fc0,0x3f2beb4a,0x3f21cbfb,0x3f173c07,0x3f0c42c9
.long 0x3f226799,0x3f173c07,0x3f0b9a6b,0x3eff17b2,0x3f187fc0,0x3f0c42c9,0x3eff17b2,0x3ee4cbfe
.long 0x3f0e39da,0x3f00e7e4,0x3ee63375,0x3ec9b953,0x3f039c3d,0x3eea6681,0x3ecc9b8b,0x3eadf73c
.long 0x3ef15aea,0x3ed25a09,0x3eb263ef,0x3e919ddd,0x3edae880,0x3eb9bb1e,0x3e97a117,0x3e698bba
.long 0x3ec3ef15,0x3ea09ae5,0x3e78cfcc,0x3e2f10a2,0x3eac7cd4,0x3e870ada,0x3e419b37,0x3de7fa9a
.long 0x3e94a031,0x3e5a3997,0x3e09cf86,0x3d621469,0x3e78cfcc,0x3e25c58c,0x3da3308c,0xbb490fc6
.long 0x3e47c5c2,0x3de1bc2e,0x3cc90ab0,0xbd7b2b74,0x3e164083,0x3d6ea038,0xbcfb49ba,0xbdf475c0
.long 0x3dc8bd36,0x3bc90f88,0xbdafb680,0xbe354098,0x3d48fb30,0xbd3c6dd5,0xbe1008b7,0xbe6fa8b2
.long 0x3f800000,0x3f800000,0x3f800000,0x3f800000,0x3f7f84ab,0x3f7f7808,0x3f7f6ac7,0x3f7f5ce9
.long 0x3f7e1324,0x3f7de0b1,0x3f7dabcc,0x3f7d7474,0x3f7baccd,0x3f7b3bab,0x3f7ac516,0x3f7a4910
.long 0x3f7853f8,0x3f778bc5,0x3f76ba07,0x3f75dec6,0x3f740bdd,0x3f72d4eb,0x3f718f57,0x3f703b37
.long 0x3f6ed89e,0x3f6d1c1d,0x3f6b4b0c,0x3f696591,0x3f68bf3c,0x3f666771,0x3f63f473,0x3f61668a
.long 0x3f61c598,0x3f5ebe05,0x3f5b941a,0x3f584853,0x3f59f26a,0x3f5627fe,0x3f5233c6,0x3f4e1689
.long 0x3f514d3d,0x3f4cae79,0x3f47de65,0x3f42de29,0x3f47de65,0x3f425b89,0x3f3ca003,0x3f36ad7f
.long 0x3f3daef9,0x3f373a23,0x3f3085bb,0x3f299415,0x3f32c8c9,0x3f2b561b,0x3f239da9,0x3f1ba299
.long 0x3f273656,0x3f1ebc12,0x3f15f6d9,0x3f0cead0,0x3f1b02c6,0x3f11796b,0x3f07a136,0x3efafef7
.long 0x3f0e39da,0x3f039c3d,0x3ef15aea,0x3edae880,0x3f00e7e4,0x3eea6681,0x3ed25a09,0x3eb9bb1e
.long 0x3ee63375,0x3ecc9b8b,0x3eb263ef,0x3e97a117,0x3ec9b953,0x3eadf73c,0x3e919ddd,0x3e698bba
.long 0x3eac7cd4,0x3e8e9a22,0x3e605c13,0x3e22abb6,0x3e8e9a22,0x3e5d4b1a,0x3e1c76de,0x3db5f8da
.long 0x3e605c13,0x3e1c76de,0x3dafb680,0x3c96c9b6,0x3e22abb6,0x3db5f8da,0x3c96c9b6,0xbd55880e
.long 0x3dc8bd36,0x3cc90ab0,0xbd48fb30,0xbdfab273,0x3d16c32c,0xbd2351cb,0xbdee3876,0xbe44b0b9
.long 0xbcc90ab0,0xbdd53db9,0xbe3b6ecf,0xbe8586ce,0xbdafb680,0xbe2bf804,0xbe7ee6e1,0xbea80b1f
.long 0xbe164083,0xbe6c9a7f,0xbea09ae5,0xbec9b953,0xbe541501,0xbe9620d2,0xbec1071e,0xbeea6681
.long 0xbe888e93,0xbeb554ec,0xbee0924f,0xbf04f484,0xbea68f12,0xbed3c867,0xbeff17b2,0xbf140c5f
.long 0x0,0x0,0x0,0x0,0x3d48fb30,0x3d55880e,0x3d621469,0x3d6ea038
.long 0x3dc8bd36,0x3dd53db9,0x3de1bc2e,0x3dee3876,0x3e164083,0x3e1f917b,0x3e28defc,0x3e3228d4
.long 0x3e47c5c2,0x3e541501,0x3e605c13,0x3e6c9a7f,0x3e78cfcc,0x3e840270,0x3e8b9507,0x3e931f35
.long 0x3e94a031,0x3e9d9e78,0x3ea68f12,0x3eaf713a,0x3eac7cd4,0x3eb6ccc3,0x3ec1071e,0x3ecb2aae
.long 0x3ec3ef15,0x3ecf7bca,0x3edae880,0x3ee63375,0x3edae880,0x3ee79a5d,0x3ef41f07,0x3f003a06
.long 0x3ef15aea,0x3eff17b2,0x3f064b82,0x3f0cead0,0x3f039c3d,0x3f0af1b7,0x3f121eb0,0x3f19210f
.long 0x3f0e39da,0x3f15f6d9,0x3f1d7fd1,0x3f24d225,0x3f187fc0,0x3f209393,0x3f286605,0x3f2ff3e6
.long 0x3f226799,0x3f2ac082,0x3f32c8c9,0x3f3a7ca4,0x3f2beb4a,0x3f34768f,0x3f3ca003,0x3f446337
.long 0x3f3504f3,0x3f3daef9,0x3f45e403,0x3f4d9f02,0x3f3daef9,0x3f466354,0x3f4e8d90,0x3f5627fe
.long 0x3f45e403,0x3f4e8d90,0x3f5695e5,0x3f5df6be,0x3f4d9f02,0x3f5627fe,0x3f5df6be,0x3f650479
.long 0x3f54db31,0x3f5d2d53,0x3f64aa59,0x3f6b4b0c,0x3f5b941a,0x3f6398ac,0x3f6aab7b,0x3f70c501
.long 0x3f61c598,0x3f696591,0x3f6ff573,0x3f756d97,0x3f676bd8,0x3f6e8ff8,0x3f748422,0x3f7940c0
.long 0x3f6c835e,0x3f731447,0x3f7853f8,0x3f7c3b28,0x3f710908,0x3f76ef5b,0x3f7b61fc,0x3f7e5a38
.long 0x3f74fa0b,0x3f7a1e84,0x3f7dabcc,0x3f7f9c18,0x3f7853f8,0x3f7c9f8a,0x3f7f2f9d,0x3f7fffb1
.long 0x3f7b14be,0x3f7e70b0,0x3f7fec43,0x3f7f84ab,0x3f7d3aac,0x3f7f90b1,0x3f7fe129,0x3f7e2b72
.long 0x3f7ec46d,0x3f7ffec4,0x3f7f0e58,0x3f7bf531,0x3f7fb10f,0x3f7fba9e,0x3f7d7474,0x3f78e3d6
.long 0x0,0x0,0x0,0x0,0x3d7b2b74,0x3d83db0a,0x3d8a200a,0x3d9064b4
.long 0x3dfab273,0x3e039502,0x3e09cf86,0x3e1008b7,0x3e3b6ecf,0x3e44b0b9,0x3e4dee60,0x3e57278f
.long 0x3e78cfcc,0x3e827dc0,0x3e888e93,0x3e8e9a22,0x3e9aa086,0x3ea21887,0x3ea986c4,0x3eb0eacb
.long 0x3eb8442a,0x3ec1071e,0x3ec9b953,0x3ed25a09,0x3ed53641,0x3edf28a9,0x3ee900b7,0x3ef2bd43
.long 0x3ef15aea,0x3efc5d27,0x3f039c3d,0x3f08f59b,0x3f064b82,0x3f0c42c9,0x3f121eb0,0x3f17de12
.long 0x3f13682a,0x3f19c200,0x3f1ff6cb,0x3f26050a,0x3f1ff6cb,0x3f269de3,0x3f2d1469,0x3f33587a
.long 0x3f2beb4a,0x3f32c8c9,0x3f396842,0x3f3fc767,0x3f373a23,0x3f3e35c5,0x3f44e3f5,0x3f4b41fa
.long 0x3f41d870,0x3f48d8b3,0x3f4f7a1f,0x3f55b993,0x3f4bbbf8,0x3f52a649,0x3f591e6a,0x3f5f20db
.long 0x3f54db31,0x3f5b941a,0x3f61c598,0x3f676bd8,0x3f5d2d53,0x3f6398ac,0x3f696591,0x3f6e8ff8
.long 0x3f64aa59,0x3f6aab7b,0x3f6ff573,0x3f748422,0x3f6b4b0c,0x3f70c501,0x3f756d97,0x3f7940c0
.long 0x3f710908,0x3f75dec6,0x3f79c79d,0x3f7cbfc9,0x3f75dec6,0x3f79f35e,0x3f7cfe73,0x3f7efcc9
.long 0x3f79c79d,0x3f7cfe73,0x3f7f0e58,0x3f7ff4e6,0x3f7cbfc9,0x3f7efcc9,0x3f7ff4e6,0x3f7fa6e3
.long 0x3f7ec46d,0x3f7fec43,0x3f7fb10f,0x3f7e1324,0x3f7fd397,0x3f7fcbe2,0x3f7e4323,0x3f7b3bab
.long 0x3f7fec43,0x3f7e9bc9,0x3f7baccd,0x3f772417,0x3f7f0e58,0x3f7c5d3a,0x3f77f110,0x3f71d19f
.long 0x3f7d3aac,0x3f791298,0x3f731447,0x3f6b4b0c,0x3f7a7302,0x3f74bf62,0x3f6d1c1d,0x3f6398ac
.long 0x3f76ba07,0x3f6f6830,0x3f660f88,0x3f5ac450,0x3f721352,0x3f6912ae,0x3f5df6be,0x3f50d937
.long 0x3f800000,0x3f800000,0x3f800000,0x3f800000,0x3f7f4e6d,0x3f7f3f54,0x3f7f2f9d,0x3f7f1f49
.long 0x3f7d3aac,0x3f7cfe73,0x3f7cbfc9,0x3f7c7eb0,0x3f79c79d,0x3f7940c0,0x3f78b47b,0x3f7822d1
.long 0x3f74fa0b,0x3f740bdd,0x3f731447,0x3f721352,0x3f6ed89e,0x3f6d67a1,0x3f6be858,0x3f6a5ad9
.long 0x3f676bd8,0x3f655e0b,0x3f633c5a,0x3f6106f2,0x3f5ebe05,0x3f5bfb34,0x3f591e6a,0x3f5627fe
.long 0x3f54db31,0x3f514d3d,0x3f4d9f02,0x3f49d112,0x3f49d112,0x3f456439,0x3f40d0da,0x3f3c17d9
.long 0x3f3daef9,0x3f385216,0x3f32c8c9,0x3f2d1469,0x3f3085bb,0x3f2a2a80,0x3f239da9,0x3f1ce11f
.long 0x3f226799,0x3f1b02c6,0x3f13682a,0x3f0b9a6b,0x3f13682a,0x3f0af1b7,0x3f0242b1,0x3ef2bd43
.long 0x3f039c3d,0x3ef41f07,0x3ee0924f,0x3ecc9b8b,0x3ee63375,0x3ed0eb2a,0x3ebb31a0,0x3ea5129f
.long 0x3ec3ef15,0x3eac7cd4,0x3e94a031,0x3e78cfcc,0x3ea09ae5,0x3e870ada,0x3e5a3997,0x3e25c58c
.long 0x3e78cfcc,0x3e419b37,0x3e09cf86,0x3da3308c,0x3e2f10a2,0x3de7fa9a,0x3d621469,0xbb490fc6
.long 0x3dc8bd36,0x3d16c32c,0xbcc90ab0,0xbdafb680,0x3cc90ab0,0xbd2351cb,0xbdd53db9,0xbe2bf804
.long 0xbd48fb30,0xbdee3876,0xbe3b6ecf,0xbe7ee6e1,0xbdfab273,0xbe44b0b9,0xbe8586ce,0xbea80b1f
.long 0xbe47c5c2,0xbe888e93,0xbeac7cd4,0xbecf7bca,0xbe888e93,0xbeadf73c,0xbed25a09,0xbef58035
.long 0xbeac7cd4,0xbed25a09,0xbef6e0cb,0xbf0cead0,0xbecf7bca,0xbef58035,0xbf0cead0,0xbf1e1e22
.long 0xbef15aea,0xbf0b9a6b,0xbf1d7fd1,0xbf2e3bde,0xbf08f59b,0xbf1ba299,0xbf2d1469,0xbf3d27b8
.long 0xbf187fc0,0xbf2ac082,0xbf3b8f3b,0xbf4ac77f,0xbf273656,0xbf38dd65,0xbf48d8b3,0xbf570348
.long 0x3f800000,0x3f800000,0x3f800000,0x3f800000,0x3f7f0e58,0x3f7efcc9,0x3f7eea9d,0x3f7ed7d4
.long 0x3f7c3b28,0x3f7bf531,0x3f7baccd,0x3f7b61fc,0x3f778bc5,0x3f76ef5b,0x3f764d97,0x3f75a67b
.long 0x3f710908,0x3f6ff573,0x3f6ed89e,0x3f6db293,0x3f68bf3c,0x3f671599,0x3f655e0b,0x3f6398ac
.long 0x3f5ebe05,0x3f5c61c7,0x3f59f26a,0x3f577026,0x3f531849,0x3f4fefa8,0x3f4cae79,0x3f495521
.long 0x3f45e403,0x3f41d870,0x3f3daef9,0x3f396842,0x3f373a23,0x3f3238aa,0x3f2d1469,0x3f27ce61
.long 0x3f273656,0x3f212ff9,0x3f1b02c6,0x3f14b039,0x3f15f6d9,0x3f0ee0db,0x3f07a136,0x3f003a06
.long 0x3f039c3d,0x3ef6e0cb,0x3ee63375,0x3ed53641,0x3ee0924f,0x3ece0bea,0x3ebb31a0,0x3ea80b1f
.long 0x3eb8442a,0x3ea395c5,0x3e8e9a22,0x3e72b651,0x3e8e9a22,0x3e6fa8b2,0x3e419b37,0x3e1324ca
.long 0x3e47c5c2,0x3e164083,0x3dc8bd36,0x3d48fb30,0x3de1bc2e,0x3d6ea038,0x3bc90f88,0xbd3c6dd5
.long 0x3cc90ab0,0xbcfb49ba,0xbdafb680,0xbe1008b7,0xbd7b2b74,0xbdf475c0,0xbe354098,0xbe6fa8b2
.long 0xbe164083,0xbe541501,0xbe888e93,0xbea68f12,0xbe6c9a7f,0xbe9620d2,0xbeb554ec,0xbed3c867
.long 0xbea09ae5,0xbec1071e,0xbee0924f,0xbeff17b2,0xbec9b953,0xbeea6681,0xbf04f484,0xbf140c5f
.long 0xbef15aea,0xbf08f59b,0xbf187fc0,0xbf273656,0xbf0b9a6b,0xbf1ba299,0xbf2ac082,0xbf38dd65
.long 0xbf1d7fd1,0xbf2d1469,0xbf3b8f3b,0xbf48d8b3,0xbf2e3bde,0xbf3d27b8,0xbf4ac77f,0xbf570348
.long 0xbf3daef9,0xbf4bbbf8,0xbf584853,0xbf633c5a,0xbf4bbbf8,0xbf58b3a1,0xbf63f473,0xbf6d67a1
.long 0xbf584853,0xbf63f473,0xbf6db293,0xbf756d97,0xbf633c5a,0xbf6d67a1,0xbf756d97,0xbf7b3bab
.long 0x0,0x0,0x0,0x0,0x3d96a905,0x3d9cecf9,0x3da3308c,0x3da973ba
.long 0x3e164083,0x3e1c76de,0x3e22abb6,0x3e28defc,0x3e605c13,0x3e698bba,0x3e72b651,0x3e7bdba4
.long 0x3e94a031,0x3e9aa086,0x3ea09ae5,0x3ea68f12,0x3eb8442a,0x3ebf926f,0x3ec6d529,0x3ece0bea
.long 0x3edae880,0x3ee363fa,0x3eebcbbb,0x3ef41f07,0x3efc5d27,0x3f02ef9f,0x3f07a136,0x3f0c42c9
.long 0x3f0e39da,0x3f13682a,0x3f187fc0,0x3f1d7fd1,0x3f1d7fd1,0x3f2302d3,0x3f286605,0x3f2da859
.long 0x3f2beb4a,0x3f31a81d,0x3f373a23,0x3f3ca003,0x3f396842,0x3f3f41fc,0x3f44e3f5,0x3f4a4c87
.long 0x3f45e403,0x3f4bbbf8,0x3f514d3d,0x3f5695e5,0x3f514d3d,0x3f570348,0x3f5c61c7,0x3f61668a
.long 0x3f5b941a,0x3f6106f2,0x3f660f88,0x3f6aab7b,0x3f64aa59,0x3f69b7e4,0x3f6e46be,0x3f725470
.long 0x3f6c835e,0x3f710908,0x3f74fa0b,0x3f7853f8,0x3f731447,0x3f76ef5b,0x3f7a1e84,0x3f7c9f8a
.long 0x3f7853f8,0x3f7b61fc,0x3f7dabcc,0x3f7f2f9d,0x3f7c3b28,0x3f7e5a38,0x3f7f9c18,0x3f7fffb1
.long 0x3f7ec46d,0x3f7fd397,0x3f7fec43,0x3f7f0e58,0x3f7fec43,0x3f7fcbe2,0x3f7e9bc9,0x3f7c5d3a
.long 0x3f7fb10f,0x3f7e4323,0x3f7baccd,0x3f77f110,0x3f7e1324,0x3f7b3bab,0x3f772417,0x3f71d19f
.long 0x3f7b14be,0x3f76ba07,0x3f710908,0x3f6a09a7,0x3f76ba07,0x3f70c501,0x3f696591,0x3f60a6cf
.long 0x3f710908,0x3f696591,0x3f604621,0x3f55b993,0x3f6a09a7,0x3f60a6cf,0x3f55b993,0x3f495521
.long 0x3f61c598,0x3f5695e5,0x3f49d112,0x3f3b8f3b,0x3f584853,0x3f4b41fa,0x3f3ca003,0x3f2c800f
.long 0x3f4d9f02,0x3f3ebc1b,0x3f2e3bde,0x3f1c420c,0x3f41d870,0x3f311722,0x3f1ebc12,0x3f0af1b7
.long 0x0,0x0,0x0,0x0,0x3dafb680,0x3db5f8da,0x3dbc3ac3,0x3dc27c39
.long 0x3e2f10a2,0x3e354098,0x3e3b6ecf,0x3e419b37,0x3e827dc0,0x3e870ada,0x3e8b9507,0x3e901c2c
.long 0x3eac7cd4,0x3eb263ef,0x3eb8442a,0x3ebe1d4a,0x3ed53641,0x3edc53c1,0x3ee363fa,0x3eea6681
.long 0x3efc5d27,0x3f0242b1,0x3f064b82,0x3f0a48ad,0x3f10d3cd,0x3f1553b7,0x3f19c200,0x3f1e1e22
.long 0x3f226799,0x3f273656,0x3f2beb4a,0x3f3085bb,0x3f32c8c9,0x3f37c655,0x3f3ca003,0x3f4154e1
.long 0x3f41d870,0x3f46e22a,0x3f4bbbf8,0x3f5064af,0x3f4f7a1f,0x3f546b3b,0x3f591e6a,0x3f5d924d
.long 0x3f5b941a,0x3f604621,0x3f64aa59,0x3f68bf3c,0x3f660f88,0x3f6a5ad9,0x3f6e46be,0x3f71d19f
.long 0x3f6ed89e,0x3f7294f8,0x3f75dec6,0x3f78b47b,0x3f75dec6,0x3f78e3d6,0x3f7b61fc,0x3f7d57de
.long 0x3f7b14be,0x3f7d3aac,0x3f7ec46d,0x3f7fb10f,0x3f7e70b0,0x3f7f90b1,0x3f7ffec4,0x3f7fba9e
.long 0x3f7fec43,0x3f7fe129,0x3f7f0e58,0x3f7d7474,0x3f7f84ab,0x3f7e2b72,0x3f7bf531,0x3f78e3d6
.long 0x3f7d3aac,0x3f7a7302,0x3f76ba07,0x3f721352,0x3f791298,0x3f74bf62,0x3f6f6830,0x3f6912ae
.long 0x3f731447,0x3f6d1c1d,0x3f660f88,0x3f5df6be,0x3f6b4b0c,0x3f6398ac,0x3f5ac450,0x3f50d937
.long 0x3f61c598,0x3f584853,0x3f4d9f02,0x3f41d870,0x3f5695e5,0x3f4b41fa,0x3f3ebc1b,0x3f311722
.long 0x3f49d112,0x3f3ca003,0x3f2e3bde,0x3f1ebc12,0x3f3b8f3b,0x3f2c800f,0x3f1c420c,0x3f0af1b7
.long 0x3f2beb4a,0x3f1b02c6,0x3f08f59b,0x3eebcbbb,0x3f1b02c6,0x3f084b92,0x3ee900b7,0x3ebf926f
.long 0x3f08f59b,0x3ee900b7,0x3ebe1d4a,0x3e919ddd,0x3eebcbbb,0x3ebf926f,0x3e919ddd,0x3e44b0b9
.long 0x3f800000,0x3f7ec46d,0x3f7b14be,0x3f74fa0b,0x3f800000,0x3f7eb069,0x3f7ac516,0x3f74484b
.long 0x3f800000,0x3f7e9bc9,0x3f7a7302,0x3f73913f,0x3f800000,0x3f7e868b,0x3f7a1e84,0x3f72d4eb
.long 0x3f800000,0x3f7e70b0,0x3f79c79d,0x3f721352,0x3f800000,0x3f7e5a38,0x3f796e4e,0x3f714c7a
.long 0x3f800000,0x3f7e4323,0x3f791298,0x3f708066,0x3f800000,0x3f7e2b72,0x3f78b47b,0x3f6faf1b
.long 0x3f800000,0x3f7e1324,0x3f7853f8,0x3f6ed89e,0x3f800000,0x3f7dfa38,0x3f77f110,0x3f6dfcf2
.long 0x3f800000,0x3f7de0b1,0x3f778bc5,0x3f6d1c1d,0x3f800000,0x3f7dc68c,0x3f772417,0x3f6c3624
.long 0x3f800000,0x3f7dabcc,0x3f76ba07,0x3f6b4b0c,0x3f800000,0x3f7d906e,0x3f764d97,0x3f6a5ad9
.long 0x3f800000,0x3f7d7474,0x3f75dec6,0x3f696591,0x3f800000,0x3f7d57de,0x3f756d97,0x3f686b39
.long 0x3f800000,0x3f7d3aac,0x3f74fa0b,0x3f676bd8,0x3f800000,0x3f7d1cdd,0x3f748422,0x3f666771
.long 0x3f800000,0x3f7cfe73,0x3f740bdd,0x3f655e0b,0x3f800000,0x3f7cdf6c,0x3f73913f,0x3f644fac
.long 0x3f800000,0x3f7cbfc9,0x3f731447,0x3f633c5a,0x3f800000,0x3f7c9f8a,0x3f7294f8,0x3f62241a
.long 0x3f800000,0x3f7c7eb0,0x3f721352,0x3f6106f2,0x3f800000,0x3f7c5d3a,0x3f718f57,0x3f5fe4e9
.long 0x3f800000,0x3f7c3b28,0x3f710908,0x3f5ebe05,0x3f800000,0x3f7c187a,0x3f708066,0x3f5d924d
.long 0x3f800000,0x3f7bf531,0x3f6ff573,0x3f5c61c7,0x3f800000,0x3f7bd14d,0x3f6f6830,0x3f5b2c79
.long 0x3f800000,0x3f7baccd,0x3f6ed89e,0x3f59f26a,0x3f800000,0x3f7b87b2,0x3f6e46be,0x3f58b3a1
.long 0x3f800000,0x3f7b61fc,0x3f6db293,0x3f577026,0x3f800000,0x3f7b3bab,0x3f6d1c1d,0x3f5627fe
.long 0x3f6c835e,0x3f61c598,0x3f54db31,0x3f45e403,0x3f6b4b0c,0x3f5fe4e9,0x3f5233c6,0x3f425b89
.long 0x3f6a09a7,0x3f5df6be,0x3f4f7a1f,0x3f3ebc1b,0x3f68bf3c,0x3f5bfb34,0x3f4cae79,0x3f3b0629
.long 0x3f676bd8,0x3f59f26a,0x3f49d112,0x3f373a23,0x3f660f88,0x3f57dc7f,0x3f46e22a,0x3f33587a
.long 0x3f64aa59,0x3f55b993,0x3f43e200,0x3f2f61a5,0x3f633c5a,0x3f5389c7,0x3f40d0da,0x3f2b561b
.long 0x3f61c598,0x3f514d3d,0x3f3daef9,0x3f273656,0x3f604621,0x3f4f0417,0x3f3a7ca4,0x3f2302d3
.long 0x3f5ebe05,0x3f4cae79,0x3f373a23,0x3f1ebc12,0x3f5d2d53,0x3f4a4c87,0x3f33e7bc,0x3f1a6293
.long 0x3f5b941a,0x3f47de65,0x3f3085bb,0x3f15f6d9,0x3f59f26a,0x3f456439,0x3f2d1469,0x3f11796b
.long 0x3f584853,0x3f42de29,0x3f299415,0x3f0cead0,0x3f5695e5,0x3f404c5c,0x3f26050a,0x3f084b92
.long 0x3f54db31,0x3f3daef9,0x3f226799,0x3f039c3d,0x3f531849,0x3f3b0629,0x3f1ebc12,0x3efdbabb
.long 0x3f514d3d,0x3f385216,0x3f1b02c6,0x3ef41f07,0x3f4f7a1f,0x3f3592e7,0x3f173c07,0x3eea6681
.long 0x3f4d9f02,0x3f32c8c9,0x3f13682a,0x3ee0924f,0x3f4bbbf8,0x3f2ff3e6,0x3f0f8784,0x3ed6a399
.long 0x3f49d112,0x3f2d1469,0x3f0b9a6b,0x3ecc9b8b,0x3f47de65,0x3f2a2a80,0x3f07a136,0x3ec27b55
.long 0x3f45e403,0x3f273656,0x3f039c3d,0x3eb8442a,0x3f43e200,0x3f24381a,0x3eff17b2,0x3eadf73c
.long 0x3f41d870,0x3f212ff9,0x3ef6e0cb,0x3ea395c5,0x3f3fc767,0x3f1e1e22,0x3eee9479,0x3e9920fe
.long 0x3f3daef9,0x3f1b02c6,0x3ee63375,0x3e8e9a22,0x3f3b8f3b,0x3f17de12,0x3eddbe79,0x3e840270
.long 0x3f396842,0x3f14b039,0x3ed53641,0x3e72b651,0x3f373a23,0x3f11796b,0x3ecc9b8b,0x3e5d4b1a
.long 0x0,0x3dc8bd36,0x3e47c5c2,0x3e94a031,0x0,0x3dcefdb7,0x3e4dee60,0x3e9920fe
.long 0x0,0x3dd53db9,0x3e541501,0x3e9d9e78,0x0,0x3ddb7d37,0x3e5a3997,0x3ea21887
.long 0x0,0x3de1bc2e,0x3e605c13,0x3ea68f12,0x0,0x3de7fa9a,0x3e667c66,0x3eab0201
.long 0x0,0x3dee3876,0x3e6c9a7f,0x3eaf713a,0x0,0x3df475c0,0x3e72b651,0x3eb3dca5
.long 0x0,0x3dfab273,0x3e78cfcc,0x3eb8442a,0x0,0x3e007745,0x3e7ee6e1,0x3ebca7af
.long 0x0,0x3e039502,0x3e827dc0,0x3ec1071e,0x0,0x3e06b26e,0x3e8586ce,0x3ec5625c
.long 0x0,0x3e09cf86,0x3e888e93,0x3ec9b953,0x0,0x3e0cec4a,0x3e8b9507,0x3ece0bea
.long 0x0,0x3e1008b7,0x3e8e9a22,0x3ed25a09,0x0,0x3e1324ca,0x3e919ddd,0x3ed6a399
.long 0x0,0x3e164083,0x3e94a031,0x3edae880,0x0,0x3e195be0,0x3e97a117,0x3edf28a9
.long 0x0,0x3e1c76de,0x3e9aa086,0x3ee363fa,0x0,0x3e1f917b,0x3e9d9e78,0x3ee79a5d
.long 0x0,0x3e22abb6,0x3ea09ae5,0x3eebcbbb,0x0,0x3e25c58c,0x3ea395c5,0x3eeff7fb
.long 0x0,0x3e28defc,0x3ea68f12,0x3ef41f07,0x0,0x3e2bf804,0x3ea986c4,0x3ef840c8
.long 0x0,0x3e2f10a2,0x3eac7cd4,0x3efc5d27,0x0,0x3e3228d4,0x3eaf713a,0x3f003a06
.long 0x0,0x3e354098,0x3eb263ef,0x3f0242b1,0x0,0x3e3857ec,0x3eb554ec,0x3f044889
.long 0x0,0x3e3b6ecf,0x3eb8442a,0x3f064b82,0x0,0x3e3e853e,0x3ebb31a0,0x3f084b92
.long 0x0,0x3e419b37,0x3ebe1d4a,0x3f0a48ad,0x0,0x3e44b0b9,0x3ec1071e,0x3f0c42c9
.long 0x3ec3ef15,0x3ef15aea,0x3f0e39da,0x3f226799,0x3ec9b953,0x3ef840c8,0x3f121eb0,0x3f269de3
.long 0x3ecf7bca,0x3eff17b2,0x3f15f6d9,0x3f2ac082,0x3ed53641,0x3f02ef9f,0x3f19c200,0x3f2ecef7
.long 0x3edae880,0x3f064b82,0x3f1d7fd1,0x3f32c8c9,0x3ee0924f,0x3f099f4e,0x3f212ff9,0x3f36ad7f
.long 0x3ee63375,0x3f0cead0,0x3f24d225,0x3f3a7ca4,0x3eebcbbb,0x3f102dd5,0x3f286605,0x3f3e35c5
.long 0x3ef15aea,0x3f13682a,0x3f2beb4a,0x3f41d870,0x3ef6e0cb,0x3f16999f,0x3f2f61a5,0x3f456439
.long 0x3efc5d27,0x3f19c200,0x3f32c8c9,0x3f48d8b3,0x3f00e7e4,0x3f1ce11f,0x3f36206c,0x3f4c3578
.long 0x3f039c3d,0x3f1ff6cb,0x3f396842,0x3f4f7a1f,0x3f064b82,0x3f2302d3,0x3f3ca003,0x3f52a649
.long 0x3f08f59b,0x3f26050a,0x3f3fc767,0x3f55b993,0x3f0b9a6b,0x3f28fd41,0x3f42de29,0x3f58b3a1
.long 0x3f0e39da,0x3f2beb4a,0x3f45e403,0x3f5b941a,0x3f10d3cd,0x3f2ecef7,0x3f48d8b3,0x3f5e5aa6
.long 0x3f13682a,0x3f31a81d,0x3f4bbbf8,0x3f6106f2,0x3f15f6d9,0x3f34768f,0x3f4e8d90,0x3f6398ac
.long 0x3f187fc0,0x3f373a23,0x3f514d3d,0x3f660f88,0x3f1b02c6,0x3f39f2ac,0x3f53fac3,0x3f686b39
.long 0x3f1d7fd1,0x3f3ca003,0x3f5695e5,0x3f6aab7b,0x3f1ff6cb,0x3f3f41fc,0x3f591e6a,0x3f6cd007
.long 0x3f226799,0x3f41d870,0x3f5b941a,0x3f6ed89e,0x3f24d225,0x3f446337,0x3f5df6be,0x3f70c501
.long 0x3f273656,0x3f46e22a,0x3f604621,0x3f7294f8,0x3f299415,0x3f495521,0x3f628210,0x3f74484b
.long 0x3f2beb4a,0x3f4bbbf8,0x3f64aa59,0x3f75dec6,0x3f2e3bde,0x3f4e1689,0x3f66becc,0x3f77583a
.long 0x3f3085bb,0x3f5064af,0x3f68bf3c,0x3f78b47b,0x3f32c8c9,0x3f52a649,0x3f6aab7b,0x3f79f35e
.long 0x3f3504f3,0x3f226799,0x3f0e39da,0x3ef15aea,0x3f3085bb,0x3f1ce11f,0x3f07a136,0x3ee1fb6a
.long 0x3f2beb4a,0x3f173c07,0x3f00e7e4,0x3ed25a09,0x3f273656,0x3f11796b,0x3ef41f07,0x3ec27b55
.long 0x3f226799,0x3f0b9a6b,0x3ee63375,0x3eb263ef,0x3f1d7fd1,0x3f05a02c,0x3ed8106b,0x3ea21887
.long 0x3f187fc0,0x3eff17b2,0x3ec9b953,0x3e919ddd,0x3f13682a,0x3ef2bd43,0x3ebb31a0,0x3e80f8c0
.long 0x3f0e39da,0x3ee63375,0x3eac7cd4,0x3e605c13,0x3f08f59b,0x3ed97cb9,0x3e9d9e78,0x3e3e853e
.long 0x3f039c3d,0x3ecc9b8b,0x3e8e9a22,0x3e1c76de,0x3efc5d27,0x3ebf926f,0x3e7ee6e1,0x3df475c0
.long 0x3ef15aea,0x3eb263ef,0x3e605c13,0x3dafb680,0x3ee63375,0x3ea5129f,0x3e419b37,0x3d55880e
.long 0x3edae880,0x3e97a117,0x3e22abb6,0x3c96c9b6,0x3ecf7bca,0x3e8a11f7,0x3e039502,0xbc7b514b
.long 0x3ec3ef15,0x3e78cfcc,0x3dc8bd36,0xbd48fb30,0x3eb8442a,0x3e5d4b1a,0x3d8a200a,0xbda973ba
.long 0x3eac7cd4,0x3e419b37,0x3d16c32c,0xbdee3876,0x3ea09ae5,0x3e25c58c,0x3bc90f88,0xbe195be0
.long 0x3e94a031,0x3e09cf86,0xbcc90ab0,0xbe3b6ecf,0x3e888e93,0x3ddb7d37,0xbd621469,0xbe5d4b1a
.long 0x3e78cfcc,0x3da3308c,0xbdafb680,0xbe7ee6e1,0x3e605c13,0x3d55880e,0xbdee3876,0xbe901c2c
.long 0x3e47c5c2,0x3cc90ab0,0xbe164083,0xbea09ae5,0x3e2f10a2,0xbb490fc6,0xbe354098,0xbeb0eacb
.long 0x3e164083,0xbcfb49ba,0xbe541501,0xbec1071e,0x3dfab273,0xbd6ea038,0xbe72b651,0xbed0eb2a
.long 0x3dc8bd36,0xbdafb680,0xbe888e93,0xbee0924f,0x3d96a905,0xbde7fa9a,0xbe97a117,0xbeeff7fb
.long 0x3d48fb30,0xbe1008b7,0xbea68f12,0xbeff17b2,0x3cc90ab0,0xbe2bf804,0xbeb554ec,0xbf06f686
.long 0x3ec3ef15,0x3e94a031,0x3e47c5c2,0x3dc8bd36,0x3eb263ef,0x3e80f8c0,0x3e1c76de,0x3d55880e
.long 0x3ea09ae5,0x3e5a3997,0x3de1bc2e,0x3bc90f88,0x3e8e9a22,0x3e3228d4,0x3d8a200a,0xbd2351cb
.long 0x3e78cfcc,0x3e09cf86,0x3cc90ab0,0xbdafb680,0x3e541501,0x3dc27c39,0xbc96c9b6,0xbe06b26e
.long 0x3e2f10a2,0x3d621469,0xbd7b2b74,0xbe354098,0x3e09cf86,0x3c7b514b,0xbdd53db9,0xbe636c83
.long 0x3dc8bd36,0xbcc90ab0,0xbe164083,0xbe888e93,0x3d7b2b74,0xbd83db0a,0xbe419b37,0xbe9f1cdf
.long 0x3cc90ab0,0xbdd53db9,0xbe6c9a7f,0xbeb554ec,0xbc490e90,0xbe1324ca,0xbe8b9507,0xbecb2aae
.long 0xbd48fb30,0xbe3b6ecf,0xbea09ae5,0xbee0924f,0xbdafb680,0xbe636c83,0xbeb554ec,0xbef58035
.long 0xbdfab273,0xbe8586ce,0xbec9b953,0xbf04f484,0xbe22abb6,0xbe9920fe,0xbeddbe79,0xbf0ee0db
.long 0xbe47c5c2,0xbeac7cd4,0xbef15aea,0xbf187fc0,0xbe6c9a7f,0xbebf926f,0xbf0242b1,0xbf21cbfb
.long 0xbe888e93,0xbed25a09,0xbf0b9a6b,0xbf2ac082,0xbe9aa086,0xbee4cbfe,0xbf14b039,0xbf33587a
.long 0xbeac7cd4,0xbef6e0cb,0xbf1d7fd1,0xbf3b8f3b,0xbebe1d4a,0xbf044889,0xbf26050a,0xbf436051
.long 0xbecf7bca,0xbf0cead0,0xbf2e3bde,0xbf4ac77f,0xbee0924f,0xbf1553b7,0xbf36206c,0xbf51c0c2
.long 0xbef15aea,0xbf1d7fd1,0xbf3daef9,0xbf584853,0xbf00e7e4,0xbf256bcb,0xbf44e3f5,0xbf5e5aa6
.long 0xbf08f59b,0xbf2d1469,0xbf4bbbf8,0xbf63f473,0xbf10d3cd,0xbf34768f,0xbf5233c6,0xbf6912ae
.long 0xbf187fc0,0xbf3b8f3b,0xbf584853,0xbf6db293,0xbf1ff6cb,0xbf425b89,0xbf5df6be,0xbf71d19f
.long 0xbf273656,0xbf48d8b3,0xbf633c5a,0xbf756d97,0xbf2e3bde,0xbf4f0417,0xbf6816a8,0xbf788486
.long 0x3f3504f3,0x3f45e403,0x3f54db31,0x3f61c598,0x3f396842,0x3f4a4c87,0x3f591e6a,0x3f65b710
.long 0x3f3daef9,0x3f4e8d90,0x3f5d2d53,0x3f696591,0x3f41d870,0x3f52a649,0x3f6106f2,0x3f6cd007
.long 0x3f45e403,0x3f5695e5,0x3f64aa59,0x3f6ff573,0x3f49d112,0x3f5a5ba0,0x3f6816a8,0x3f72d4eb
.long 0x3f4d9f02,0x3f5df6be,0x3f6b4b0c,0x3f756d97,0x3f514d3d,0x3f61668a,0x3f6e46be,0x3f77beb7
.long 0x3f54db31,0x3f64aa59,0x3f710908,0x3f79c79d,0x3f584853,0x3f67c187,0x3f73913f,0x3f7b87b2
.long 0x3f5b941a,0x3f6aab7b,0x3f75dec6,0x3f7cfe73,0x3f5ebe05,0x3f6d67a1,0x3f77f110,0x3f7e2b72
.long 0x3f61c598,0x3f6ff573,0x3f79c79d,0x3f7f0e58,0x3f64aa59,0x3f725470,0x3f7b61fc,0x3f7fa6e3
.long 0x3f676bd8,0x3f748422,0x3f7cbfc9,0x3f7ff4e6,0x3f6a09a7,0x3f76841b,0x3f7de0b1,0x3f7ff84a
.long 0x3f6c835e,0x3f7853f8,0x3f7ec46d,0x3f7fb10f,0x3f6ed89e,0x3f79f35e,0x3f7f6ac7,0x3f7f1f49
.long 0x3f710908,0x3f7b61fc,0x3f7fd397,0x3f7e4323,0x3f731447,0x3f7c9f8a,0x3f7ffec4,0x3f7d1cdd
.long 0x3f74fa0b,0x3f7dabcc,0x3f7fec43,0x3f7baccd,0x3f76ba07,0x3f7e868b,0x3f7f9c18,0x3f79f35e
.long 0x3f7853f8,0x3f7f2f9d,0x3f7f0e58,0x3f77f110,0x3f79c79d,0x3f7fa6e3,0x3f7e4323,0x3f75a67b
.long 0x3f7b14be,0x3f7fec43,0x3f7d3aac,0x3f731447,0x3f7c3b28,0x3f7fffb1,0x3f7bf531,0x3f703b37
.long 0x3f7d3aac,0x3f7fe129,0x3f7a7302,0x3f6d1c1d,0x3f7e1324,0x3f7f90b1,0x3f78b47b,0x3f69b7e4
.long 0x3f7ec46d,0x3f7f0e58,0x3f76ba07,0x3f660f88,0x3f7f4e6d,0x3f7e5a38,0x3f748422,0x3f62241a
.long 0x3f7fb10f,0x3f7d7474,0x3f721352,0x3f5df6be,0x3f7fec43,0x3f7c5d3a,0x3f6f6830,0x3f5988ad
.long 0x3f6c835e,0x3f74fa0b,0x3f7b14be,0x3f7ec46d,0x3f6ff573,0x3f77beb7,0x3f7cfe73,0x3f7fa6e3
.long 0x3f731447,0x3f7a1e84,0x3f7e70b0,0x3f7ffec4,0x3f75dec6,0x3f7c187a,0x3f7f6ac7,0x3f7fcbe2
.long 0x3f7853f8,0x3f7dabcc,0x3f7fec43,0x3f7f0e58,0x3f7a7302,0x3f7ed7d4,0x3f7ff4e6,0x3f7dc68c
.long 0x3f7c3b28,0x3f7f9c18,0x3f7f84ab,0x3f7bf531,0x3f7dabcc,0x3f7ff84a,0x3f7e9bc9,0x3f799b43
.long 0x3f7ec46d,0x3f7fec43,0x3f7d3aac,0x3f76ba07,0x3f7f84ab,0x3f7f7808,0x3f7b61fc,0x3f73530e
.long 0x3f7fec43,0x3f7e9bc9,0x3f791298,0x3f6f6830,0x3f7ffb11,0x3f7d57de,0x3f764d97,0x3f6afb8c
.long 0x3f7fb10f,0x3f7baccd,0x3f731447,0x3f660f88,0x3f7f0e58,0x3f799b43,0x3f6f6830,0x3f60a6cf
.long 0x3f7e1324,0x3f772417,0x3f6b4b0c,0x3f5ac450,0x3f7cbfc9,0x3f74484b,0x3f66becc,0x3f546b3b
.long 0x3f7b14be,0x3f710908,0x3f61c598,0x3f4d9f02,0x3f791298,0x3f6d67a1,0x3f5c61c7,0x3f466354
.long 0x3f76ba07,0x3f696591,0x3f5695e5,0x3f3ebc1b,0x3f740bdd,0x3f650479,0x3f5064af,0x3f36ad7f
.long 0x3f710908,0x3f604621,0x3f49d112,0x3f2e3bde,0x3f6db293,0x3f5b2c79,0x3f42de29,0x3f256bcb
.long 0x3f6a09a7,0x3f55b993,0x3f3b8f3b,0x3f1c420c,0x3f660f88,0x3f4fefa8,0x3f33e7bc,0x3f12c39a
.long 0x3f61c598,0x3f49d112,0x3f2beb4a,0x3f08f59b,0x3f5d2d53,0x3f436051,0x3f239da9,0x3efdbabb
.long 0x3f584853,0x3f3ca003,0x3f1b02c6,0x3ee900b7,0x3f531849,0x3f3592e7,0x3f121eb0,0x3ed3c867
.long 0x3f4d9f02,0x3f2e3bde,0x3f08f59b,0x3ebe1d4a,0x3f47de65,0x3f269de3,0x3eff17b2,0x3ea80b1f
.long 0x3f41d870,0x3f1ebc12,0x3eebcbbb,0x3e919ddd,0x3f3b8f3b,0x3f16999f,0x3ed8106b,0x3e75c35a
.long 0x248d3132,0xbdc8bd36,0xbe47c5c2,0xbe94a031,0xbd48fb30,0xbe195be0,0xbe7ee6e1,0xbeb0eacb
.long 0xbdc8bd36,0xbe4dee60,0xbe9aa086,0xbecc9b8b,0xbe164083,0xbe80f8c0,0xbeb554ec,0xbee79a5d
.long 0xbe47c5c2,0xbe9aa086,0xbecf7bca,0xbf00e7e4,0xbe78cfcc,0xbeb3dca5,0xbee900b7,0xbf0d9281
.long 0xbe94a031,0xbecc9b8b,0xbf00e7e4,0xbf19c200,0xbeac7cd4,0xbee4cbfe,0xbf0cead0,0xbf256bcb
.long 0xbec3ef15,0xbefc5d27,0xbf187fc0,0xbf3085bb,0xbedae880,0xbf099f4e,0xbf239da9,0xbf3b0629
.long 0xbef15aea,0xbf14b039,0xbf2e3bde,0xbf44e3f5,0xbf039c3d,0xbf1f599f,0xbf385216,0xbf4e1689
.long 0xbf0e39da,0xbf299415,0xbf41d870,0xbf5695e5,0xbf187fc0,0xbf33587a,0xbf4ac77f,0xbf5e5aa6
.long 0xbf226799,0xbf3ca003,0xbf531849,0xbf655e0b,0xbf2beb4a,0xbf456439,0xbf5ac450,0xbf6b99fb
.long 0xbf3504f3,0xbf4d9f02,0xbf61c598,0xbf710908,0xbf3daef9,0xbf554aa4,0xbf6816a8,0xbf75a67b
.long 0xbf45e403,0xbf5c61c7,0xbf6db293,0xbf796e4e,0xbf4d9f02,0xbf62df7b,0xbf7294f8,0xbf7c5d3a
.long 0xbf54db31,0xbf68bf3c,0xbf76ba07,0xbf7e70b0,0xbf5b941a,0xbf6dfcf2,0xbf7a1e84,0xbf7fa6e3
.long 0xbf61c598,0xbf7294f8,0xbf7cbfc9,0xbf7ffec4,0xbf676bd8,0xbf76841b,0xbf7e9bc9,0xbf7f7808
.long 0xbf6c835e,0xbf79c79d,0xbf7fb10f,0xbf7e1324,0xbf710908,0xbf7c5d3a,0xbf7ffec4,0xbf7bd14d
.long 0xbf74fa0b,0xbf7e4323,0xbf7f84ab,0xbf78b47b,0xbf7853f8,0xbf7f7808,0xbf7e4323,0xbf74bf62
.long 0xbf7b14be,0xbf7ffb11,0xbf7c3b28,0xbf6ff573,0xbf7d3aac,0xbf7fcbe2,0xbf796e4e,0xbf6a5ad9
.long 0xbf7ec46d,0xbf7eea9d,0xbf75dec6,0xbf63f473,0xbf7fb10f,0xbf7d57de,0xbf718f57,0xbf5cc7d1
.long 0xbec3ef15,0xbef15aea,0xbf0e39da,0xbf226799,0xbee0924f,0xbf06f686,0xbf1c420c,0xbf2ff3e6
.long 0xbefc5d27,0xbf14b039,0xbf299415,0xbf3ca003,0xbf0b9a6b,0xbf21cbfb,0xbf36206c,0xbf485bca
.long 0xbf187fc0,0xbf2e3bde,0xbf41d870,0xbf531849,0xbf24d225,0xbf39f2ac,0xbf4cae79,0xbf5cc7d1
.long 0xbf3085bb,0xbf44e3f5,0xbf5695e5,0xbf655e0b,0xbf3b8f3b,0xbf4f0417,0xbf5f8327,0xbf6cd007
.long 0xbf45e403,0xbf584853,0xbf676bd8,0xbf731447,0xbf4f7a1f,0xbf60a6cf,0xbf6e46be,0xbf7822d1
.long 0xbf584853,0xbf6816a8,0xbf740bdd,0xbf7bf531,0xbf604621,0xbf6e8ff8,0xbf78b47b,0xbf7e868b
.long 0xbf676bd8,0xbf740bdd,0xbf7c3b28,0xbf7fd397,0xbf6db293,0xbf788486,0xbf7e9bc9,0xbf7fdaaf
.long 0xbf731447,0xbf7bf531,0xbf7fd397,0xbf7e9bc9,0xbf778bc5,0xbf7e5a38,0xbf7fe129,0xbf7c187a
.long 0xbf7b14be,0xbf7fb10f,0xbf7ec46d,0xbf7853f8,0xbf7dabcc,0xbf7ff84a,0xbf7c7eb0,0xbf73530e
.long 0xbf7f4e6d,0xbf7f2f9d,0xbf791298,0xbf6d1c1d,0xbf7ffb11,0xbf7d57de,0xbf748422,0xbf65b710
.long 0xbf7fb10f,0xbf7a7302,0xbf6ed89e,0xbf5d2d53,0xbf7e70b0,0xbf76841b,0xbf6816a8,0xbf5389c7
.long 0xbf7c3b28,0xbf718f57,0xbf604621,0xbf48d8b3,0xbf791298,0xbf6b99fb,0xbf577026,0xbf3d27b8
.long 0xbf74fa0b,0xbf64aa59,0xbf4d9f02,0xbf3085bb,0xbf6ff573,0xbf5cc7d1,0xbf42de29,0xbf2302d3
.long 0xbf6a09a7,0xbf53fac3,0xbf373a23,0xbf14b039,0xbf633c5a,0xbf4a4c87,0xbf2ac082,0xbf05a02c
.long 0xbf5b941a,0xbf3fc767,0xbf1d7fd1,0xbeebcbbb,0xbf531849,0xbf34768f,0xbf0f8784,0xbecb2aae
.long 0xbf49d112,0xbf286605,0xbf00e7e4,0xbea986c4,0xbf3fc767,0xbf1ba299,0xbee363fa,0xbe870ada
.long 0x3f800000,0x3f7ec46d,0x3f7b14be,0x3f74fa0b,0x3f7fb10f,0x3f7d1cdd,0x3f77f110,0x3f703b37
.long 0x3f7ec46d,0x3f7ac516,0x3f740bdd,0x3f6aab7b,0x3f7d3aac,0x3f77beb7,0x3f6f6830,0x3f644fac
.long 0x3f7b14be,0x3f740bdd,0x3f6a09a7,0x3f5d2d53,0x3f7853f8,0x3f6faf1b,0x3f63f473,0x3f554aa4
.long 0x3f74fa0b,0x3f6aab7b,0x3f5d2d53,0x3f4cae79,0x3f710908,0x3f650479,0x3f55b993,0x3f436051
.long 0x3f6c835e,0x3f5ebe05,0x3f4d9f02,0x3f396842,0x3f676bd8,0x3f57dc7f,0x3f44e3f5,0x3f2ecef7
.long 0x3f61c598,0x3f5064af,0x3f3b8f3b,0x3f239da9,0x3f5b941a,0x3f485bca,0x3f31a81d,0x3f17de12
.long 0x3f54db31,0x3f3fc767,0x3f273656,0x3f0b9a6b,0x3f4d9f02,0x3f36ad7f,0x3f1c420c,0x3efdbabb
.long 0x3f45e403,0x3f2d1469,0x3f10d3cd,0x3ee363fa,0x3f3daef9,0x3f2302d3,0x3f04f484,0x3ec8477c
.long 0x3f3504f3,0x3f187fc0,0x3ef15aea,0x3eac7cd4,0x3f2beb4a,0x3f0d9281,0x3ed8106b,0x3e901c2c
.long 0x3f226799,0x3f0242b1,0x3ebe1d4a,0x3e667c66,0x3f187fc0,0x3eed3063,0x3ea395c5,0x3e2bf804
.long 0x3f0e39da,0x3ed53641,0x3e888e93,0x3de1bc2e,0x3f039c3d,0x3ebca7af,0x3e5a3997,0x3d55880e
.long 0x3ef15aea,0x3ea395c5,0x3e22abb6,0xbbc90f88,0x3edae880,0x3e8a11f7,0x3dd53db9,0xbd83db0a
.long 0x3ec3ef15,0x3e605c13,0x3d48fb30,0xbdfab273,0x3eac7cd4,0x3e2bf804,0xbbc90f88,0xbe3857ec
.long 0x3e94a031,0x3dee3876,0xbd7b2b74,0xbe72b651,0x3e78cfcc,0x3d83db0a,0xbdee3876,0xbe9620d2
.long 0x3e47c5c2,0x3c490e90,0xbe2f10a2,0xbeb263ef,0x3e164083,0xbd2351cb,0xbe667c66,0xbece0bea
.long 0x3dc8bd36,0xbdbc3ac3,0xbe8e9a22,0xbee900b7,0x3d48fb30,0xbe1324ca,0xbea986c4,0xbf019573
.long 0x3f6c835e,0x3f61c598,0x3f54db31,0x3f45e403,0x3f660f88,0x3f5988ad,0x3f4ac77f,0x3f39f2ac
.long 0x3f5ebe05,0x3f5064af,0x3f3fc767,0x3f2d1469,0x3f5695e5,0x3f466354,0x3f33e7bc,0x3f1f599f
.long 0x3f4d9f02,0x3f3b8f3b,0x3f273656,0x3f10d3cd,0x3f43e200,0x3f2ff3e6,0x3f19c200,0x3f019573
.long 0x3f396842,0x3f239da9,0x3f0b9a6b,0x3ee363fa,0x3f2e3bde,0x3f16999f,0x3ef9a02d,0x3ec27b55
.long 0x3f226799,0x3f08f59b,0x3edae880,0x3ea09ae5,0x3f15f6d9,0x3ef58035,0x3ebb31a0,0x3e7bdba4
.long 0x3f08f59b,0x3ed8106b,0x3e9aa086,0x3e354098,0x3ef6e0cb,0x3eb9bb1e,0x3e72b651,0x3ddb7d37
.long 0x3edae880,0x3e9aa086,0x3e2f10a2,0x3d16c32c,0x3ebe1d4a,0x3e75c35a,0x3dd53db9,0xbd0a342f
.long 0x3ea09ae5,0x3e354098,0x3d16c32c,0xbdd53db9,0x3e827dc0,0x3de7fa9a,0xbcfb49ba,0xbe3228d4
.long 0x3e47c5c2,0x3d48fb30,0xbdc8bd36,0xbe78cfcc,0x3e09cf86,0xbc7b514b,0xbe28defc,0xbe9f1cdf
.long 0x3d96a905,0xbda3308c,0xbe6c9a7f,0xbec1071e,0x3c490e90,0xbe1324ca,0xbe97a117,0xbee1fb6a
.long 0xbd48fb30,0xbe541501,0xbeb8442a,0xbf00e7e4,0xbde1bc2e,0xbe8a11f7,0xbed8106b,0xbf102dd5
.long 0xbe2f10a2,0xbea986c4,0xbef6e0cb,0xbf1ebc12,0xbe6c9a7f,0xbec8477c,0xbf0a48ad,0xbf2c800f
.long 0xbe94a031,0xbee63375,0xbf187fc0,0xbf396842,0xbeb263ef,0xbf019573,0xbf26050a,0xbf456439
.long 0xbecf7bca,0xbf0f8784,0xbf32c8c9,0xbf5064af,0xbeebcbbb,0xbf1ce11f,0xbf3ebc1b,0xbf5a5ba0
.long 0xbf039c3d,0xbf299415,0xbf49d112,0xbf633c5a,0xbf10d3cd,0xbf3592e7,0xbf53fac3,0xbf6afb8c
.long 0xbf1d7fd1,0xbf40d0da,0xbf5d2d53,0xbf718f57,0xbf299415,0xbf4b41fa,0xbf655e0b,0xbf76ef5b
.long 0xbf3504f3,0xbf45e403,0xbf54db31,0xbf61c598,0xbf41d870,0xbf51c0c2,0xbf5f8327,0xbf6afb8c
.long 0xbf4d9f02,0xbf5c61c7,0xbf68bf3c,0xbf7294f8,0xbf584853,0xbf65b710,0xbf708066,0xbf788486
.long 0xbf61c598,0xbf6db293,0xbf76ba07,0xbf7cbfc9,0xbf6a09a7,0xbf74484b,0xbf7b61fc,0xbf7f3f54
.long 0xbf710908,0xbf796e4e,0xbf7e70b0,0xbf7ffec4,0xbf76ba07,0xbf7d1cdd,0xbf7fe129,0xbf7efcc9
.long 0xbf7b14be,0xbf7f4e6d,0xbf7fb10f,0xbf7c3b28,0xbf7e1324,0xbf7fffb1,0xbf7de0b1,0xbf77beb7
.long 0xbf7fb10f,0xbf7f2f9d,0xbf7a7302,0xbf718f57,0xbf7fec43,0xbf7cdf6c,0xbf756d97,0xbf69b7e4
.long 0xbf7ec46d,0xbf791298,0xbf6ed89e,0xbf604621,0xbf7c3b28,0xbf73ced9,0xbf66becc,0xbf554aa4
.long 0xbf7853f8,0xbf6d1c1d,0xbf5d2d53,0xbf48d8b3,0xbf731447,0xbf650479,0xbf5233c6,0xbf3b0629
.long 0xbf6c835e,0xbf5b941a,0xbf45e403,0xbf2beb4a,0xbf64aa59,0xbf50d937,0xbf385216,0xbf1ba299
.long 0xbf5b941a,0xbf44e3f5,0xbf299415,0xbf0a48ad,0xbf514d3d,0xbf37c655,0xbf19c200,0xbeeff7fb
.long 0xbf45e403,0xbf299415,0xbf08f59b,0xbec9b953,0xbf396842,0xbf1a6293,0xbeee9479,0xbea21887
.long 0xbf2beb4a,0xbf0a48ad,0xbec9b953,0xbe72b651,0xbf1d7fd1,0xbef2bd43,0xbea395c5,0xbe1f917b
.long 0xbf0e39da,0xbecf7bca,0xbe78cfcc,0xbd96a905,0xbefc5d27,0xbeab0201,0xbe28defc,0x3c16cb58
.long 0xbedae880,0xbe8586ce,0xbdafb680,0x3dbc3ac3,0xbeb8442a,0xbe3e853e,0xbbc90f88,0x3e3228d4
.long 0xbe94a031,0xbde1bc2e,0x3d96a905,0x3e827dc0,0xbe605c13,0xbd0a342f,0x3e1c76de,0x3eab0201
.long 0xbe164083,0x3d2fe007,0x3e6c9a7f,0x3ed25a09,0xbd96a905,0x3df475c0,0x3e9d9e78,0x3ef840c8
.long 0xbf6c835e,0xbf74fa0b,0xbf7b14be,0xbf7ec46d,0xbf740bdd,0xbf7a9c59,0xbf7e9bc9,0xbf7fffb1
.long 0xbf79c79d,0xbf7e4323,0xbf7ffb11,0xbf7eea9d,0xbf7dabcc,0xbf7fe705,0xbf7f2f9d,0xbf7b87b2
.long 0xbf7fb10f,0xbf7f84ab,0xbf7c3b28,0xbf75dec6,0xbf7fd397,0xbf7d1cdd,0xbf772417,0xbf6dfcf2
.long 0xbf7e1324,0xbf78b47b,0xbf6ff573,0xbf63f473,0xbf7a7302,0xbf725470,0xbf66becc,0xbf57dc7f
.long 0xbf74fa0b,0xbf6a09a7,0xbf5b941a,0xbf49d112,0xbf6db293,0xbf5fe4e9,0xbf4e8d90,0xbf39f2ac
.long 0xbf64aa59,0xbf53fac3,0xbf3fc767,0xbf286605,0xbf59f26a,0xbf466354,0xbf2f61a5,0xbf1553b7
.long 0xbf4d9f02,0xbf373a23,0xbf1d7fd1,0xbf00e7e4,0xbf3fc767,0xbf269de3,0xbf0a48ad,0xbed6a399
.long 0xbf3085bb,0xbf14b039,0xbeebcbbb,0xbea986c4,0xbf1ff6cb,0xbf019573,0xbec1071e,0xbe75c35a
.long 0xbf0e39da,0xbedae880,0xbe94a031,0xbe164083,0xbef6e0cb,0xbeb0eacb,0xbe4dee60,0xbd55880e
.long 0xbecf7bca,0xbe8586ce,0xbde1bc2e,0x3d2fe007,0xbea68f12,0xbe3228d4,0xbc96c9b6,0x3e0cec4a
.long 0xbe78cfcc,0xbdafb680,0x3d96a905,0x3e6c9a7f,0xbe22abb6,0x3b490fc6,0x3e28defc,0x3ea5129f
.long 0xbd96a905,0x3dbc3ac3,0x3e827dc0,0x3ed25a09,0x3c490e90,0x3e3857ec,0x3eaf713a,0x3efdbabb
.long 0x3dc8bd36,0x3e888e93,0x3edae880,0x3f13682a,0x3e3b6ecf,0x3eb3dca5,0x3f0242b1,0x3f269de3
.long 0x3e888e93,0x3eddbe79,0x3f15f6d9,0x3f385216,0x3eb263ef,0x3f02ef9f,0x3f286605,0x3f485bca
.long 0x3edae880,0x3f15f6d9,0x3f396842,0x3f5695e5,0x3f00e7e4,0x3f27ce61,0x3f48d8b3,0x3f62df7b
.long 0x3f13682a,0x3f385216,0x3f5695e5,0x3f6d1c1d,0x3f24d225,0x3f476085,0x3f628210,0x3f75341d
.long 0x3f3504f3,0x3f226799,0x3f0e39da,0x3ef15aea,0x3f273656,0x3f12c39a,0x3ef9a02d,0x3ecb2aae
.long 0x3f187fc0,0x3f0242b1,0x3ed53641,0x3ea395c5,0x3f08f59b,0x3ee1fb6a,0x3eaf713a,0x3e75c35a
.long 0x3ef15aea,0x3ebe1d4a,0x3e888e93,0x3e22abb6,0x3ecf7bca,0x3e9920fe,0x3e419b37,0x3d9cecf9
.long 0x3eac7cd4,0x3e667c66,0x3de1bc2e,0xbbc90f88,0x3e888e93,0x3e195be0,0x3cfb49ba,0xbdb5f8da
.long 0x3e47c5c2,0x3d96a905,0xbd48fb30,0xbe2f10a2,0x3dfab273,0xbb490fc6,0xbe039502,0xbe80f8c0
.long 0x3d48fb30,0xbda3308c,0xbe541501,0xbea986c4,0xbcc90ab0,0xbe1f917b,0xbe919ddd,0xbed0eb2a
.long 0xbdc8bd36,0xbe6c9a7f,0xbeb8442a,0xbef6e0cb,0xbe2f10a2,0xbe9c1faf,0xbeddbe79,0xbf0d9281
.long 0xbe78cfcc,0xbec1071e,0xbf00e7e4,0xbf1ebc12,0xbea09ae5,0xbee4cbfe,0xbf121eb0,0xbf2ecef7
.long 0xbec3ef15,0xbf039c3d,0xbf226799,0xbf3daef9,0xbee63375,0xbf140c5f,0xbf31a81d,0xbf4b41fa
.long 0xbf039c3d,0xbf239da9,0xbf3fc767,0xbf577026,0xbf13682a,0xbf3238aa,0xbf4cae79,0xbf62241a
.long 0xbf226799,0xbf3fc767,0xbf584853,0xbf6b4b0c,0xbf3085bb,0xbf4c3578,0xbf628210,0xbf72d4eb
.long 0xbf3daef9,0xbf577026,0xbf6b4b0c,0xbf78b47b,0xbf49d112,0xbf61668a,0xbf7294f8,0xbf7cdf6c
.long 0xbf54db31,0xbf6a09a7,0xbf7853f8,0xbf7f4e6d,0xbf5ebe05,0xbf714c7a,0xbf7c7eb0,0xbf7ffd39
.long 0xbf676bd8,0xbf772417,0xbf7f0e58,0xbf7eea9d,0xbf6ed89e,0xbf7b87b2,0xbf7ffec4,0xbf7c187a
.long 0xbf74fa0b,0xbf7e70b0,0xbf7f4e6d,0xbf778bc5,0xbf79c79d,0xbf7fdaaf,0xbf7cfe73,0xbf714c7a
.long 0xbf7d3aac,0xbf7fc38f,0xbf791298,0xbf696591,0xbf7f4e6d,0xbf7e2b72,0xbf73913f,0xbf5fe4e9
.long 0x3ec3ef15,0x3e94a031,0x3e47c5c2,0x3dc8bd36,0x3e9aa086,0x3e5101f1,0x3dd53db9,0x3b490fc6
.long 0x3e605c13,0x3dee3876,0x3c490e90,0xbdbc3ac3,0x3e09cf86,0x3ce22a7a,0xbda3308c,0xbe3e853e
.long 0x3d48fb30,0xbd7b2b74,0xbe2f10a2,0xbe8e9a22,0xbd16c32c,0xbe195be0,0xbe8586ce,0xbebca7af
.long 0xbdfab273,0xbe72b651,0xbeb263ef,0xbee900b7,0xbe541501,0xbea5129f,0xbeddbe79,0xbf099f4e
.long 0xbe94a031,0xbecf7bca,0xbf039c3d,0xbf1d7fd1,0xbebe1d4a,0xbef840c8,0xbf173c07,0xbf2ff3e6
.long 0xbee63375,0xbf0f8784,0xbf299415,0xbf40d0da,0xbf064b82,0xbf21cbfb,0xbf3a7ca4,0xbf4fefa8
.long 0xbf187fc0,0xbf32c8c9,0xbf49d112,0xbf5d2d53,0xbf299415,0xbf425b89,0xbf577026,0xbf686b39
.long 0xbf396842,0xbf5064af,0xbf633c5a,0xbf718f57,0xbf47de65,0xbf5cc7d1,0xbf6d1c1d,0xbf788486
.long 0xbf54db31,0xbf676bd8,0xbf74fa0b,0xbf7d3aac,0xbf604621,0xbf703b37,0xbf7ac516,0xbf7fa6e3
.long 0xbf6a09a7,0xbf772417,0xbf7e70b0,0xbf7fc38f,0xbf721352,0xbf7c187a,0xbf7ff4e6,0xbf7d906e
.long 0xbf7853f8,0xbf7f0e58,0xbf7f4e6d,0xbf791298,0xbf7cbfc9,0xbf7fffb1,0xbf7c7eb0,0xbf725470
.long 0xbf7f4e6d,0xbf7eea9d,0xbf778bc5,0xbf696591,0xbf7ffb11,0xbf7bd14d,0xbf708066,0xbf5e5aa6
.long 0xbf7ec46d,0xbf76ba07,0xbf676bd8,0xbf514d3d,0xbf7baccd,0xbf6faf1b,0xbf5c61c7,0xbf425b89
.long 0xbf76ba07,0xbf66becc,0xbf4f7a1f,0xbf31a81d,0xbf6ff573,0xbf5bfb34,0xbf40d0da,0xbf1f599f
.long 0xbf676bd8,0xbf4f7a1f,0xbf3085bb,0xbf0b9a6b,0xbf5d2d53,0xbf4154e1,0xbf1ebc12,0xbeed3063
.long 0xbf514d3d,0xbf31a81d,0xbf0b9a6b,0xbec1071e,0xbf43e200,0xbf209393,0xbeee9479,0xbe931f35
.long 0x3f803f80,0x3f803f80,0x3f803f80,0x3f803f80,0x3f7b3f80,0x3f553f6d,0xbe48248d,0xbf0ebec4
.long 0x3f6d3f80,0x3ec43f35,0xbf6dbf80,0xbec4bf35,0x3f553f80,0xbe483ec4,0x3f0ea554,0x3f7b3f6d
.long 0x3f353f80,0xbf35248d,0x3f353f80,0xbf35248d,0x3f0e3f80,0xbf7bbec4,0xbf55248d,0xbe48bf6d
.long 0x3ec43f80,0xbf6dbf35,0xbec4bf80,0x3f6d3f35,0x3e483f80,0xbf0ebf6d,0x3f7ba554,0xbf553ec4
.long 0x248d3f80,0xa554bf80,0x248d3f80,0xa554bf80,0xbe483f80,0x3f0ebf6d,0xbf7b248d,0x3f553ec4
.long 0xbec43f80,0x3f6dbf35,0x3ec4bf80,0xbf6d3f35,0xbf0e3f80,0x3f7bbec4,0x3f55a554,0x3e48bf6d
.long 0xbf353f80,0x3f35a554,0xbf353f80,0x3f35a554,0xbf553f80,0x3e483ec4,0xbf0e248d,0xbf7b3f6d
.long 0xbf6d3f80,0xbec43f35,0x3f6dbf80,0x3ec4bf35,0xbf7b3f80,0xbf553f6d,0x3e48a554,0x3f0ebec4
.long 0xbf803f80,0xbf803f80,0xbf803f80,0xbf803f80,0xbf7b3f80,0xbf553f6d,0x3e48248d,0x3f0ebec4
.long 0xbf6d3f80,0xbec43f35,0x3f6dbf80,0x3ec4bf35,0xbf553f80,0x3e483ec4,0xbf0ea554,0xbf7b3f6d
.long 0xbf353f80,0x3f35248d,0xbf353f80,0x3f35248d,0xbf0e3f80,0x3f7bbec4,0x3f55248d,0x3e48bf6d
.long 0xbec43f80,0x3f6dbf35,0x3ec4bf80,0xbf6d3f35,0xbe483f80,0x3f0ebf6d,0xbf7ba554,0x3f553ec4
.long 0xa5543f80,0x248dbf80,0xa5543f80,0x248dbf80,0x3e483f80,0xbf0ebf6d,0x3f7b248d,0xbf553ec4
.long 0x3ec43f80,0xbf6dbf35,0xbec4bf80,0x3f6d3f35,0x3f0e3f80,0xbf7bbec4,0xbf55a554,0xbe48bf6d
.long 0x3f353f80,0xbf35a554,0x3f353f80,0xbf35a554,0x3f553f80,0xbe483ec4,0x3f0e248d,0x3f7b3f6d
.long 0x3f6d3f80,0x3ec43f35,0xbf6dbf80,0xbec4bf35,0x3f7b3f80,0x3f553f6d,0xbe48a554,0xbf0ebec4
.long 0x3f803f80,0x3f803f80,0x3f803f80,0x3f803f80,0x3f0e3f35,0x3e483ec4,0xbf55bf35,0xbf7bbf6d
.long 0xbec4248d,0xbf6dbf35,0x3ec4a554,0x3f6d3f35,0xbf7bbf35,0xbf0ebf6d,0x3e483f35,0xbf55bec4
.long 0xbf35bf80,0x3f35a554,0xbf35bf80,0x3f35a554,0x3e48bf35,0x3f553f6d,0x3f7b3f35,0xbf0e3ec4
.long 0x3f6da554,0xbec43f35,0xbf6d248d,0x3ec4bf35,0x3f553f35,0xbf7bbec4,0x3f0ebf35,0xbe483f6d
.long 0x248d3f80,0xa554bf80,0x248d3f80,0xa554bf80,0xbf553f35,0x3f7bbec4,0xbf0ebf35,0x3e483f6d
.long 0xbf6d248d,0x3ec43f35,0x3f6da554,0xbec4bf35,0xbe48bf35,0xbf553f6d,0xbf7b3f35,0x3f0e3ec4
.long 0x3f35bf80,0xbf35248d,0x3f35bf80,0xbf35248d,0x3f7bbf35,0x3f0ebf6d,0xbe483f35,0x3f55bec4
.long 0x3ec4a554,0x3f6dbf35,0xbec4248d,0xbf6d3f35,0xbf0e3f35,0xbe483ec4,0x3f55bf35,0x3f7bbf6d
.long 0xbf803f80,0xbf803f80,0xbf803f80,0xbf803f80,0xbf0e3f35,0xbe483ec4,0x3f55bf35,0x3f7bbf6d
.long 0x3ec4248d,0x3f6dbf35,0xbec4a554,0xbf6d3f35,0x3f7bbf35,0x3f0ebf6d,0xbe483f35,0x3f55bec4
.long 0x3f35bf80,0xbf35a554,0x3f35bf80,0xbf35a554,0xbe48bf35,0xbf553f6d,0xbf7b3f35,0x3f0e3ec4
.long 0xbf6da554,0x3ec43f35,0x3f6d248d,0xbec4bf35,0xbf553f35,0x3f7bbec4,0xbf0ebf35,0x3e483f6d
.long 0xa5543f80,0x248dbf80,0xa5543f80,0x248dbf80,0x3f553f35,0xbf7bbec4,0x3f0ebf35,0xbe483f6d
.long 0x3f6d248d,0xbec43f35,0xbf6da554,0x3ec4bf35,0x3e48bf35,0x3f553f6d,0x3f7b3f35,0xbf0e3ec4
.long 0xbf35bf80,0x3f35248d,0xbf35bf80,0x3f35248d,0xbf7bbf35,0xbf0ebf6d,0x3e483f35,0xbf55bec4
.long 0xbec4a554,0xbf6dbf35,0x3ec4248d,0x3f6d3f35,0x3f0e3f35,0x3e483ec4,0xbf55bf35,0xbf7bbf6d
.long 0x3f803f80,0x3f803f80,0x3f803f80,0x3f803f80,0xbf7bbf80,0xbf55bf6d,0x3e48a554,0x3f0e3ec4
.long 0x3f6d3f80,0x3ec43f35,0xbf6dbf80,0xbec4bf35,0xbf55bf80,0x3e48bec4,0xbf0e248d,0xbf7bbf6d
.long 0x3f353f80,0xbf35248d,0x3f353f80,0xbf35248d,0xbf0ebf80,0x3f7b3ec4,0x3f55a554,0x3e483f6d
.long 0x3ec43f80,0xbf6dbf35,0xbec4bf80,0x3f6d3f35,0xbe48bf80,0x3f0e3f6d,0xbf7b248d,0x3f55bec4
.long 0x248d3f80,0xa554bf80,0x248d3f80,0xa554bf80,0x3e48bf80,0xbf0e3f6d,0x3f7ba554,0xbf55bec4
.long 0xbec43f80,0x3f6dbf35,0x3ec4bf80,0xbf6d3f35,0x3f0ebf80,0xbf7b3ec4,0xbf55248d,0xbe483f6d
.long 0xbf353f80,0x3f35a554,0xbf353f80,0x3f35a554,0x3f55bf80,0xbe48bec4,0x3f0ea554,0x3f7bbf6d
.long 0xbf6d3f80,0xbec43f35,0x3f6dbf80,0x3ec4bf35,0x3f7bbf80,0x3f55bf6d,0xbe48248d,0xbf0e3ec4
.long 0xbf803f80,0xbf803f80,0xbf803f80,0xbf803f80,0x3f7bbf80,0x3f55bf6d,0xbe48a554,0xbf0e3ec4
.long 0xbf6d3f80,0xbec43f35,0x3f6dbf80,0x3ec4bf35,0x3f55bf80,0xbe48bec4,0x3f0e248d,0x3f7bbf6d
.long 0xbf353f80,0x3f35248d,0xbf353f80,0x3f35248d,0x3f0ebf80,0xbf7b3ec4,0xbf55a554,0xbe483f6d
.long 0xbec43f80,0x3f6dbf35,0x3ec4bf80,0xbf6d3f35,0x3e48bf80,0xbf0e3f6d,0x3f7b248d,0xbf55bec4
.long 0xa5543f80,0x248dbf80,0xa5543f80,0x248dbf80,0xbe48bf80,0x3f0e3f6d,0xbf7ba554,0x3f55bec4
.long 0x3ec43f80,0xbf6dbf35,0xbec4bf80,0x3f6d3f35,0xbf0ebf80,0x3f7b3ec4,0x3f55248d,0x3e483f6d
.long 0x3f353f80,0xbf35a554,0x3f353f80,0xbf35a554,0xbf55bf80,0x3e48bec4,0xbf0ea554,0xbf7bbf6d
.long 0x3f6d3f80,0x3ec43f35,0xbf6dbf80,0xbec4bf35,0xbf7bbf80,0xbf55bf6d,0x3e48248d,0x3f0e3ec4
.long 0x3f803f80,0x3f803f80,0x3f803f80,0x3f803f80,0xbf0ebf35,0xbe48bec4,0x3f553f35,0x3f7b3f6d
.long 0xbec4248d,0xbf6dbf35,0x3ec4a554,0x3f6d3f35,0x3f7b3f35,0x3f0e3f6d,0xbe48bf35,0x3f553ec4
.long 0xbf35bf80,0x3f35a554,0xbf35bf80,0x3f35a554,0xbe483f35,0xbf55bf6d,0xbf7bbf35,0x3f0ebec4
.long 0x3f6da554,0xbec43f35,0xbf6d248d,0x3ec4bf35,0xbf55bf35,0x3f7b3ec4,0xbf0e3f35,0x3e48bf6d
.long 0x248d3f80,0xa554bf80,0x248d3f80,0xa554bf80,0x3f55bf35,0xbf7b3ec4,0x3f0e3f35,0xbe48bf6d
.long 0xbf6d248d,0x3ec43f35,0x3f6da554,0xbec4bf35,0x3e483f35,0x3f55bf6d,0x3f7bbf35,0xbf0ebec4
.long 0x3f35bf80,0xbf35248d,0x3f35bf80,0xbf35248d,0xbf7b3f35,0xbf0e3f6d,0x3e48bf35,0xbf553ec4
.long 0x3ec4a554,0x3f6dbf35,0xbec4248d,0xbf6d3f35,0x3f0ebf35,0x3e48bec4,0xbf553f35,0xbf7b3f6d
.long 0xbf803f80,0xbf803f80,0xbf803f80,0xbf803f80,0x3f0ebf35,0x3e48bec4,0xbf553f35,0xbf7b3f6d
.long 0x3ec4248d,0x3f6dbf35,0xbec4a554,0xbf6d3f35,0xbf7b3f35,0xbf0e3f6d,0x3e48bf35,0xbf553ec4
.long 0x3f35bf80,0xbf35a554,0x3f35bf80,0xbf35a554,0x3e483f35,0x3f55bf6d,0x3f7bbf35,0xbf0ebec4
.long 0xbf6da554,0x3ec43f35,0x3f6d248d,0xbec4bf35,0x3f55bf35,0xbf7b3ec4,0x3f0e3f35,0xbe48bf6d
.long 0xa5543f80,0x248dbf80,0xa5543f80,0x248dbf80,0xbf55bf35,0x3f7b3ec4,0xbf0e3f35,0x3e48bf6d
.long 0x3f6d248d,0xbec43f35,0xbf6da554,0x3ec4bf35,0xbe483f35,0xbf55bf6d,0xbf7bbf35,0x3f0ebec4
.long 0xbf35bf80,0x3f35248d,0xbf35bf80,0x3f35248d,0x3f7b3f35,0x3f0e3f6d,0xbe48bf35,0x3f553ec4
.long 0xbec4a554,0xbf6dbf35,0x3ec4248d,0x3f6d3f35,0xbf0ebf35,0xbe48bec4,0x3f553f35,0x3f7b3f6d
.long 0x0,0x0,0x0,0x0,0x3e480000,0x3f0e3ec4,0x3f7b3f80,0x3f553f6d
.long 0x3ec40000,0x3f6d3f35,0xbec4250d,0xbf6dbf35,0x3f0e0000,0x3f7b3f6d,0xbf55bf80,0x3e48bec4
.long 0x3f350000,0x3f353f80,0x3f350000,0x3f353f80,0x3f550000,0x3e483f6d,0x3f0e3f80,0xbf7bbec4
.long 0x3f6d0000,0xbec43f35,0xbf6d250d,0x3ec4bf35,0x3f7b0000,0xbf553ec4,0xbe48bf80,0x3f0e3f6d
.long 0x3f800000,0xbf80250d,0x3f800000,0xbf80250d,0x3f7b0000,0xbf55bec4,0xbe483f80,0x3f0ebf6d
.long 0x3f6d0000,0xbec4bf35,0xbf6d250d,0x3ec43f35,0x3f550000,0x3e48bf6d,0x3f0ebf80,0xbf7b3ec4
.long 0x3f350000,0x3f35bf80,0x3f350000,0x3f35bf80,0x3f0e0000,0x3f7bbf6d,0xbf553f80,0x3e483ec4
.long 0x3ec40000,0x3f6dbf35,0xbec4250d,0xbf6d3f35,0x3e480000,0x3f0ebec4,0x3f7bbf80,0x3f55bf6d
.long 0x250d0000,0x250d0000,0x250d0000,0x250d0000,0xbe480000,0xbf0e3ec4,0xbf7b3f80,0xbf553f6d
.long 0xbec40000,0xbf6d3f35,0x3ec4250d,0x3f6dbf35,0xbf0e0000,0xbf7b3f6d,0x3f55bf80,0xbe48bec4
.long 0xbf350000,0xbf353f80,0xbf350000,0xbf353f80,0xbf550000,0xbe483f6d,0xbf0e3f80,0x3f7bbec4
.long 0xbf6d0000,0x3ec43f35,0x3f6d250d,0xbec4bf35,0xbf7b0000,0x3f553ec4,0x3e48bf80,0xbf0e3f6d
.long 0xbf800000,0x3f80250d,0xbf800000,0x3f80250d,0xbf7b0000,0x3f55bec4,0x3e483f80,0xbf0ebf6d
.long 0xbf6d0000,0x3ec4bf35,0x3f6d250d,0xbec43f35,0xbf550000,0xbe48bf6d,0xbf0ebf80,0x3f7b3ec4
.long 0xbf350000,0xbf35bf80,0xbf350000,0xbf35bf80,0xbf0e0000,0xbf7bbf6d,0x3f553f80,0xbe483ec4
.long 0xbec40000,0xbf6dbf35,0x3ec4250d,0x3f6d3f35,0xbe480000,0xbf0ebec4,0xbf7bbf80,0xbf55bf6d
.long 0x0,0x0,0x0,0x0,0x3f553f35,0x3f7b3f6d,0x3f0e3f35,0x3e483ec4
.long 0x3f6d3f80,0x3ec43f35,0xbf6dbf80,0xbec4bf35,0x3e483f35,0xbf55bec4,0x3f7b3f35,0x3f0e3f6d
.long 0xbf35250d,0xbf35bf80,0xbf35250d,0xbf35bf80,0xbf7bbf35,0x3f0ebec4,0x3e48bf35,0x3f553f6d
.long 0xbec4bf80,0x3f6d3f35,0x3ec43f80,0xbf6dbf35,0x3f0ebf35,0xbe483f6d,0xbf55bf35,0x3f7b3ec4
.long 0x3f800000,0xbf80250d,0x3f800000,0xbf80250d,0x3f0e3f35,0xbe48bf6d,0xbf553f35,0x3f7bbec4
.long 0xbec43f80,0x3f6dbf35,0x3ec4bf80,0xbf6d3f35,0xbf7b3f35,0x3f0e3ec4,0x3e483f35,0x3f55bf6d
.long 0xbf35250d,0xbf353f80,0xbf35250d,0xbf353f80,0x3e48bf35,0xbf553ec4,0x3f7bbf35,0x3f0ebf6d
.long 0x3f6dbf80,0x3ec4bf35,0xbf6d3f80,0xbec43f35,0x3f55bf35,0x3f7bbf6d,0x3f0ebf35,0x3e48bec4
.long 0x250d0000,0x250d0000,0x250d0000,0x250d0000,0xbf553f35,0xbf7b3f6d,0xbf0e3f35,0xbe483ec4
.long 0xbf6d3f80,0xbec43f35,0x3f6dbf80,0x3ec4bf35,0xbe483f35,0x3f55bec4,0xbf7b3f35,0xbf0e3f6d
.long 0x3f35250d,0x3f35bf80,0x3f35250d,0x3f35bf80,0x3f7bbf35,0xbf0ebec4,0xbe48bf35,0xbf553f6d
.long 0x3ec4bf80,0xbf6d3f35,0xbec43f80,0x3f6dbf35,0xbf0ebf35,0x3e483f6d,0x3f55bf35,0xbf7b3ec4
.long 0xbf800000,0x3f80250d,0xbf800000,0x3f80250d,0xbf0e3f35,0x3e48bf6d,0x3f553f35,0xbf7bbec4
.long 0x3ec43f80,0xbf6dbf35,0xbec4bf80,0x3f6d3f35,0x3f7b3f35,0xbf0e3ec4,0xbe483f35,0xbf55bf6d
.long 0x3f35250d,0x3f353f80,0x3f35250d,0x3f353f80,0xbe48bf35,0x3f553ec4,0xbf7bbf35,0xbf0ebf6d
.long 0xbf6dbf80,0xbec4bf35,0x3f6d3f80,0x3ec43f35,0xbf55bf35,0xbf7bbf6d,0xbf0ebf35,0xbe48bec4
.long 0x0,0x0,0x0,0x0,0xbe48250d,0xbf0ebec4,0xbf7bbf80,0xbf55bf6d
.long 0x3ec40000,0x3f6d3f35,0xbec4250d,0xbf6dbf35,0xbf0e250d,0xbf7bbf6d,0x3f553f80,0xbe483ec4
.long 0x3f350000,0x3f353f80,0x3f350000,0x3f353f80,0xbf55250d,0xbe48bf6d,0xbf0ebf80,0x3f7b3ec4
.long 0x3f6d0000,0xbec43f35,0xbf6d250d,0x3ec4bf35,0xbf7b250d,0x3f55bec4,0x3e483f80,0xbf0ebf6d
.long 0x3f800000,0xbf80250d,0x3f800000,0xbf80250d,0xbf7b250d,0x3f553ec4,0x3e48bf80,0xbf0e3f6d
.long 0x3f6d0000,0xbec4bf35,0xbf6d250d,0x3ec43f35,0xbf55250d,0xbe483f6d,0xbf0e3f80,0x3f7bbec4
.long 0x3f350000,0x3f35bf80,0x3f350000,0x3f35bf80,0xbf0e250d,0xbf7b3f6d,0x3f55bf80,0xbe48bec4
.long 0x3ec40000,0x3f6dbf35,0xbec4250d,0xbf6d3f35,0xbe48250d,0xbf0e3ec4,0xbf7b3f80,0xbf553f6d
.long 0x250d0000,0x250d0000,0x250d0000,0x250d0000,0x3e48250d,0x3f0ebec4,0x3f7bbf80,0x3f55bf6d
.long 0xbec40000,0xbf6d3f35,0x3ec4250d,0x3f6dbf35,0x3f0e250d,0x3f7bbf6d,0xbf553f80,0x3e483ec4
.long 0xbf350000,0xbf353f80,0xbf350000,0xbf353f80,0x3f55250d,0x3e48bf6d,0x3f0ebf80,0xbf7b3ec4
.long 0xbf6d0000,0x3ec43f35,0x3f6d250d,0xbec4bf35,0x3f7b250d,0xbf55bec4,0xbe483f80,0x3f0ebf6d
.long 0xbf800000,0x3f80250d,0xbf800000,0x3f80250d,0x3f7b250d,0xbf553ec4,0xbe48bf80,0x3f0e3f6d
.long 0xbf6d0000,0x3ec4bf35,0x3f6d250d,0xbec43f35,0x3f55250d,0x3e483f6d,0x3f0e3f80,0xbf7bbec4
.long 0xbf350000,0xbf35bf80,0xbf350000,0xbf35bf80,0x3f0e250d,0x3f7b3f6d,0xbf55bf80,0x3e48bec4
.long 0xbec40000,0xbf6dbf35,0x3ec4250d,0x3f6d3f35,0x3e48250d,0x3f0e3ec4,0x3f7b3f80,0x3f553f6d
.long 0x0,0x0,0x0,0x0,0xbf55bf35,0xbf7bbf6d,0xbf0ebf35,0xbe48bec4
.long 0x3f6d3f80,0x3ec43f35,0xbf6dbf80,0xbec4bf35,0xbe48bf35,0x3f553ec4,0xbf7bbf35,0xbf0ebf6d
.long 0xbf35250d,0xbf35bf80,0xbf35250d,0xbf35bf80,0x3f7b3f35,0xbf0e3ec4,0xbe483f35,0xbf55bf6d
.long 0xbec4bf80,0x3f6d3f35,0x3ec43f80,0xbf6dbf35,0xbf0e3f35,0x3e48bf6d,0x3f553f35,0xbf7bbec4
.long 0x3f800000,0xbf80250d,0x3f800000,0xbf80250d,0xbf0ebf35,0x3e483f6d,0x3f55bf35,0xbf7b3ec4
.long 0xbec43f80,0x3f6dbf35,0x3ec4bf80,0xbf6d3f35,0x3f7bbf35,0xbf0ebec4,0xbe48bf35,0xbf553f6d
.long 0xbf35250d,0xbf353f80,0xbf35250d,0xbf353f80,0xbe483f35,0x3f55bec4,0xbf7b3f35,0xbf0e3f6d
.long 0x3f6dbf80,0x3ec4bf35,0xbf6d3f80,0xbec43f35,0xbf553f35,0xbf7b3f6d,0xbf0e3f35,0xbe483ec4
.long 0x250d0000,0x250d0000,0x250d0000,0x250d0000,0x3f55bf35,0x3f7bbf6d,0x3f0ebf35,0x3e48bec4
.long 0xbf6d3f80,0xbec43f35,0x3f6dbf80,0x3ec4bf35,0x3e48bf35,0xbf553ec4,0x3f7bbf35,0x3f0ebf6d
.long 0x3f35250d,0x3f35bf80,0x3f35250d,0x3f35bf80,0xbf7b3f35,0x3f0e3ec4,0x3e483f35,0x3f55bf6d
.long 0x3ec4bf80,0xbf6d3f35,0xbec43f80,0x3f6dbf35,0x3f0e3f35,0xbe48bf6d,0xbf553f35,0x3f7bbec4
.long 0xbf800000,0x3f80250d,0xbf800000,0x3f80250d,0x3f0ebf35,0xbe483f6d,0xbf55bf35,0x3f7b3ec4
.long 0x3ec43f80,0xbf6dbf35,0xbec4bf80,0x3f6d3f35,0xbf7bbf35,0x3f0ebec4,0x3e48bf35,0x3f553f6d
.long 0x3f35250d,0x3f353f80,0x3f35250d,0x3f353f80,0x3e483f35,0xbf55bec4,0x3f7b3f35,0x3f0e3f6d
.long 0xbf6dbf80,0xbec4bf35,0x3f6d3f80,0x3ec43f35,0x3f553f35,0x3f7b3f6d,0x3f0e3f35,0x3e483ec4
.long 0x80008000,0x80008000,0x80008000,0x80008000,0xbe488000,0xbf0ebec4,0xbf7bbf80,0xbf55bf6d
.long 0xbec48000,0xbf6dbf35,0x3ec4a50d,0x3f6d3f35,0xbf0e8000,0xbf7bbf6d,0x3f553f80,0xbe483ec4
.long 0xbf358000,0xbf35bf80,0xbf358000,0xbf35bf80,0xbf558000,0xbe48bf6d,0xbf0ebf80,0x3f7b3ec4
.long 0xbf6d8000,0x3ec4bf35,0x3f6da50d,0xbec43f35,0xbf7b8000,0x3f55bec4,0x3e483f80,0xbf0ebf6d
.long 0xbf808000,0x3f80a50d,0xbf808000,0x3f80a50d,0xbf7b8000,0x3f553ec4,0x3e48bf80,0xbf0e3f6d
.long 0xbf6d8000,0x3ec43f35,0x3f6da50d,0xbec4bf35,0xbf558000,0xbe483f6d,0xbf0e3f80,0x3f7bbec4
.long 0xbf358000,0xbf353f80,0xbf358000,0xbf353f80,0xbf0e8000,0xbf7b3f6d,0x3f55bf80,0xbe48bec4
.long 0xbec48000,0xbf6d3f35,0x3ec4a50d,0x3f6dbf35,0xbe488000,0xbf0e3ec4,0xbf7b3f80,0xbf553f6d
.long 0xa50d8000,0xa50d8000,0xa50d8000,0xa50d8000,0x3e488000,0x3f0ebec4,0x3f7bbf80,0x3f55bf6d
.long 0x3ec48000,0x3f6dbf35,0xbec4a50d,0xbf6d3f35,0x3f0e8000,0x3f7bbf6d,0xbf553f80,0x3e483ec4
.long 0x3f358000,0x3f35bf80,0x3f358000,0x3f35bf80,0x3f558000,0x3e48bf6d,0x3f0ebf80,0xbf7b3ec4
.long 0x3f6d8000,0xbec4bf35,0xbf6da50d,0x3ec43f35,0x3f7b8000,0xbf55bec4,0xbe483f80,0x3f0ebf6d
.long 0x3f808000,0xbf80a50d,0x3f808000,0xbf80a50d,0x3f7b8000,0xbf553ec4,0xbe48bf80,0x3f0e3f6d
.long 0x3f6d8000,0xbec43f35,0xbf6da50d,0x3ec4bf35,0x3f558000,0x3e483f6d,0x3f0e3f80,0xbf7bbec4
.long 0x3f358000,0x3f353f80,0x3f358000,0x3f353f80,0x3f0e8000,0x3f7b3f6d,0xbf55bf80,0x3e48bec4
.long 0x3ec48000,0x3f6d3f35,0xbec4a50d,0xbf6dbf35,0x3e488000,0x3f0e3ec4,0x3f7b3f80,0x3f553f6d
.long 0x80008000,0x80008000,0x80008000,0x80008000,0xbf55bf35,0xbf7bbf6d,0xbf0ebf35,0xbe48bec4
.long 0xbf6dbf80,0xbec4bf35,0x3f6d3f80,0x3ec43f35,0xbe48bf35,0x3f553ec4,0xbf7bbf35,0xbf0ebf6d
.long 0x3f35a50d,0x3f353f80,0x3f35a50d,0x3f353f80,0x3f7b3f35,0xbf0e3ec4,0xbe483f35,0xbf55bf6d
.long 0x3ec43f80,0xbf6dbf35,0xbec4bf80,0x3f6d3f35,0xbf0e3f35,0x3e48bf6d,0x3f553f35,0xbf7bbec4
.long 0xbf808000,0x3f80a50d,0xbf808000,0x3f80a50d,0xbf0ebf35,0x3e483f6d,0x3f55bf35,0xbf7b3ec4
.long 0x3ec4bf80,0xbf6d3f35,0xbec43f80,0x3f6dbf35,0x3f7bbf35,0xbf0ebec4,0xbe48bf35,0xbf553f6d
.long 0x3f35a50d,0x3f35bf80,0x3f35a50d,0x3f35bf80,0xbe483f35,0x3f55bec4,0xbf7b3f35,0xbf0e3f6d
.long 0xbf6d3f80,0xbec43f35,0x3f6dbf80,0x3ec4bf35,0xbf553f35,0xbf7b3f6d,0xbf0e3f35,0xbe483ec4
.long 0xa50d8000,0xa50d8000,0xa50d8000,0xa50d8000,0x3f55bf35,0x3f7bbf6d,0x3f0ebf35,0x3e48bec4
.long 0x3f6dbf80,0x3ec4bf35,0xbf6d3f80,0xbec43f35,0x3e48bf35,0xbf553ec4,0x3f7bbf35,0x3f0ebf6d
.long 0xbf35a50d,0xbf353f80,0xbf35a50d,0xbf353f80,0xbf7b3f35,0x3f0e3ec4,0x3e483f35,0x3f55bf6d
.long 0xbec43f80,0x3f6dbf35,0x3ec4bf80,0xbf6d3f35,0x3f0e3f35,0xbe48bf6d,0xbf553f35,0x3f7bbec4
.long 0x3f808000,0xbf80a50d,0x3f808000,0xbf80a50d,0x3f0ebf35,0xbe483f6d,0xbf55bf35,0x3f7b3ec4
.long 0xbec4bf80,0x3f6d3f35,0x3ec43f80,0xbf6dbf35,0xbf7bbf35,0x3f0ebec4,0x3e48bf35,0x3f553f6d
.long 0xbf35a50d,0xbf35bf80,0xbf35a50d,0xbf35bf80,0x3e483f35,0xbf55bec4,0x3f7b3f35,0x3f0e3f6d
.long 0x3f6d3f80,0x3ec43f35,0xbf6dbf80,0xbec4bf35,0x3f553f35,0x3f7b3f6d,0x3f0e3f35,0x3e483ec4
.long 0x80008000,0x80008000,0x80008000,0x80008000,0x3e48a50d,0x3f0e3ec4,0x3f7b3f80,0x3f553f6d
.long 0xbec48000,0xbf6dbf35,0x3ec4a50d,0x3f6d3f35,0x3f0ea50d,0x3f7b3f6d,0xbf55bf80,0x3e48bec4
.long 0xbf358000,0xbf35bf80,0xbf358000,0xbf35bf80,0x3f55a50d,0x3e483f6d,0x3f0e3f80,0xbf7bbec4
.long 0xbf6d8000,0x3ec4bf35,0x3f6da50d,0xbec43f35,0x3f7ba50d,0xbf553ec4,0xbe48bf80,0x3f0e3f6d
.long 0xbf808000,0x3f80a50d,0xbf808000,0x3f80a50d,0x3f7ba50d,0xbf55bec4,0xbe483f80,0x3f0ebf6d
.long 0xbf6d8000,0x3ec43f35,0x3f6da50d,0xbec4bf35,0x3f55a50d,0x3e48bf6d,0x3f0ebf80,0xbf7b3ec4
.long 0xbf358000,0xbf353f80,0xbf358000,0xbf353f80,0x3f0ea50d,0x3f7bbf6d,0xbf553f80,0x3e483ec4
.long 0xbec48000,0xbf6d3f35,0x3ec4a50d,0x3f6dbf35,0x3e48a50d,0x3f0ebec4,0x3f7bbf80,0x3f55bf6d
.long 0xa50d8000,0xa50d8000,0xa50d8000,0xa50d8000,0xbe48a50d,0xbf0e3ec4,0xbf7b3f80,0xbf553f6d
.long 0x3ec48000,0x3f6dbf35,0xbec4a50d,0xbf6d3f35,0xbf0ea50d,0xbf7b3f6d,0x3f55bf80,0xbe48bec4
.long 0x3f358000,0x3f35bf80,0x3f358000,0x3f35bf80,0xbf55a50d,0xbe483f6d,0xbf0e3f80,0x3f7bbec4
.long 0x3f6d8000,0xbec4bf35,0xbf6da50d,0x3ec43f35,0xbf7ba50d,0x3f553ec4,0x3e48bf80,0xbf0e3f6d
.long 0x3f808000,0xbf80a50d,0x3f808000,0xbf80a50d,0xbf7ba50d,0x3f55bec4,0x3e483f80,0xbf0ebf6d
.long 0x3f6d8000,0xbec43f35,0xbf6da50d,0x3ec4bf35,0xbf55a50d,0xbe48bf6d,0xbf0ebf80,0x3f7b3ec4
.long 0x3f358000,0x3f353f80,0x3f358000,0x3f353f80,0xbf0ea50d,0xbf7bbf6d,0x3f553f80,0xbe483ec4
.long 0x3ec48000,0x3f6d3f35,0xbec4a50d,0xbf6dbf35,0xbe48a50d,0xbf0ebec4,0xbf7bbf80,0xbf55bf6d
.long 0x80008000,0x80008000,0x80008000,0x80008000,0x3f553f35,0x3f7b3f6d,0x3f0e3f35,0x3e483ec4
.long 0xbf6dbf80,0xbec4bf35,0x3f6d3f80,0x3ec43f35,0x3e483f35,0xbf55bec4,0x3f7b3f35,0x3f0e3f6d
.long 0x3f35a50d,0x3f353f80,0x3f35a50d,0x3f353f80,0xbf7bbf35,0x3f0ebec4,0x3e48bf35,0x3f553f6d
.long 0x3ec43f80,0xbf6dbf35,0xbec4bf80,0x3f6d3f35,0x3f0ebf35,0xbe483f6d,0xbf55bf35,0x3f7b3ec4
.long 0xbf808000,0x3f80a50d,0xbf808000,0x3f80a50d,0x3f0e3f35,0xbe48bf6d,0xbf553f35,0x3f7bbec4
.long 0x3ec4bf80,0xbf6d3f35,0xbec43f80,0x3f6dbf35,0xbf7b3f35,0x3f0e3ec4,0x3e483f35,0x3f55bf6d
.long 0x3f35a50d,0x3f35bf80,0x3f35a50d,0x3f35bf80,0x3e48bf35,0xbf553ec4,0x3f7bbf35,0x3f0ebf6d
.long 0xbf6d3f80,0xbec43f35,0x3f6dbf80,0x3ec4bf35,0x3f55bf35,0x3f7bbf6d,0x3f0ebf35,0x3e48bec4
.long 0xa50d8000,0xa50d8000,0xa50d8000,0xa50d8000,0xbf553f35,0xbf7b3f6d,0xbf0e3f35,0xbe483ec4
.long 0x3f6dbf80,0x3ec4bf35,0xbf6d3f80,0xbec43f35,0xbe483f35,0x3f55bec4,0xbf7b3f35,0xbf0e3f6d
.long 0xbf35a50d,0xbf353f80,0xbf35a50d,0xbf353f80,0x3f7bbf35,0xbf0ebec4,0xbe48bf35,0xbf553f6d
.long 0xbec43f80,0x3f6dbf35,0x3ec4bf80,0xbf6d3f35,0xbf0ebf35,0x3e483f6d,0x3f55bf35,0xbf7b3ec4
.long 0x3f808000,0xbf80a50d,0x3f808000,0xbf80a50d,0xbf0e3f35,0x3e48bf6d,0x3f553f35,0xbf7bbec4
.long 0xbec4bf80,0x3f6d3f35,0x3ec43f80,0xbf6dbf35,0x3f7b3f35,0xbf0e3ec4,0xbe483f35,0xbf55bf6d
.long 0xbf35a50d,0xbf35bf80,0xbf35a50d,0xbf35bf80,0xbe48bf35,0x3f553ec4,0xbf7bbf35,0xbf0ebf6d
.long 0x3f6d3f80,0x3ec43f35,0xbf6dbf80,0xbec4bf35,0xbf55bf35,0xbf7bbf6d,0xbf0ebf35,0xbe48bec4
.long 0x0,0x0,0x0,0x0,0x0,0x0,0x0,0x0
.long 0x0,0x0,0x0,0x0,0x0,0x0,0x0,0x0
.long 0x0,0x0,0x0,0x0,0x0,0x0,0x0,0x0
.long 0x0,0x0,0x0,0x0,0x0,0x0,0x0,0x0
.long 0x0,0x0,0x0,0x0,0x0,0x0,0x0,0x0
.long 0x0,0x0,0x0,0x0,0x0,0x0,0x0,0x0
.long 0x0,0x0,0x0,0x0,0x0,0x0,0x0,0x0
.long 0x0,0x0,0x0,0x0,0x0,0x0,0x0,0x0
.long 0x0,0x0,0x0,0x0,0x0,0x0,0x0,0x0
.long 0x0,0x0,0x0,0x0,0x0,0x0,0x0,0x0
.long 0x0,0x0,0x0,0x0,0x0,0x0,0x0,0x0
.long 0x0,0x0,0x0,0x0,0x0,0x0,0x0,0x0
.long 0x0,0x0,0x0,0x0,0x0,0x0,0x0,0x0
.long 0x0,0x0,0x0,0x0,0x0,0x0,0x0,0x0
.long 0x0,0x0,0x0,0x0,0x0,0x0,0x0,0x0
.long 0x0,0x0,0x0,0x0,0x0,0x0,0x0,0x0
.long 0x0,0x0,0x0,0x0,0x0,0x0,0x0,0x0
.long 0x0,0x0,0x0,0x0,0x0,0x0,0x0,0x0
.long 0x0,0x0,0x0,0x0,0x0,0x0,0x0,0x0
.long 0x0,0x0,0x0,0x0,0x0,0x0,0x0,0x0
.long 0x0,0x0,0x0,0x0,0x0,0x0,0x0,0x0
.long 0x0,0x0,0x0,0x0,0x0,0x0,0x0,0x0
.long 0x0,0x0,0x0,0x0,0x0,0x0,0x0,0x0
.long 0x0,0x0,0x0,0x0,0x0,0x0,0x0,0x0
.long 0x0,0x0,0x0,0x0,0x0,0x0,0x0,0x0
.long 0x0,0x0,0x0,0x0,0x0,0x0,0x0,0x0
.long 0x0,0x0,0x0,0x0,0x0,0x0,0x0,0x0
.long 0x0,0x0,0x0,0x0,0x0,0x0,0x0,0x0
.long 0x0,0x0,0x0,0x0,0x0,0x0,0x0,0x0
.long 0x0,0x0,0x0,0x0,0x0,0x0,0x0,0x0
.long 0x0,0x0,0x0,0x0,0x0,0x0,0x0,0x0
.long 0x0,0x0,0x0,0x0,0x0,0x0,0x0,0x0
.long 0x0,0x0,0x0,0x0,0x0,0x0,0x0,0x0
.long 0x0,0x0,0x0,0x0,0x0,0x0,0x0,0x0
.long 0x0,0x0,0x0,0x0,0x0,0x0,0x0,0x0
.long 0x0,0x0,0x0,0x0,0x0,0x0,0x0,0x0
.long 0x0,0x0,0x0,0x0,0x0,0x0,0x0,0x0
.long 0x0,0x0,0x0,0x0,0x0,0x0,0x0,0x0
.long 0x0,0x0,0x0,0x0,0x0,0x0,0x0,0x0
.long 0x0,0x0,0x0,0x0,0x0,0x0,0x0,0x0
.long 0x0,0x0,0x0,0x0,0x0,0x0,0x0,0x0
.long 0x0,0x0,0x0,0x0,0x0,0x0,0x0,0x0
.long 0x0,0x0,0x0,0x0,0x0,0x0,0x0,0x0
.long 0x0,0x0,0x0,0x0,0x0,0x0,0x0,0x0
.long 0x0,0x0,0x0,0x0,0x0,0x0,0x0,0x0
.long 0x0,0x0,0x0,0x0,0x0,0x0,0x0,0x0
.long 0x0,0x0,0x0,0x0,0x0,0x0,0x0,0x0
.long 0x0,0x0,0x0,0x0,0x0,0x0,0x0,0x0
.long 0x0,0x0,0x0,0x0,0x0,0x0,0x0,0x0
.long 0x0,0x0,0x0,0x0,0x0,0x0,0x0,0x0
.long 0x0,0x0,0x0,0x0,0x0,0x0,0x0,0x0
.long 0x0,0x0,0x0,0x0,0x0,0x0,0x0,0x0
.long 0x0,0x0,0x0,0x0,0x0,0x0,0x0,0x0
.long 0x0,0x0,0x0,0x0,0x0,0x0,0x0,0x0
.long 0x0,0x0,0x0,0x0,0x0,0x0,0x0,0x0
.long 0x0,0x0,0x0,0x0,0x0,0x0,0x0,0x0
.long 0x0,0x0,0x0,0x0,0x0,0x0,0x0,0x0
.long 0x0,0x0,0x0,0x0,0x0,0x0,0x0,0x0
.long 0x0,0x0,0x0,0x0,0x0,0x0,0x0,0x0
.long 0x0,0x0,0x0,0x0,0x0,0x0,0x0,0x0
.long 0x0,0x0,0x0,0x0,0x0,0x0,0x0,0x0
.long 0x0,0x0,0x0,0x0,0x0,0x0,0x0,0x0
.long 0x0,0x0,0x0,0x0,0x0,0x0,0x0,0x0
.long 0x0,0x0,0x0,0x0,0x0,0x0,0x0,0x0
.long 0x3f803f80,0x3f803f80,0x3f803f80,0x3f803f80,0x3f7f3f80,0x3f753f7b,0x3f223f35,0x3ef13f0e
.long 0x3f7b3f80,0x3f553f6d,0xbe48248d,0xbf0ebec4,0x3f753f80,0x3f223f55,0xbf62bf35,0xbf7fbf7b
.long 0x3f6d3f80,0x3ec43f35,0xbf6dbf80,0xbec4bf35,0x3f623f80,0x3dc93f0e,0xbe95bf35,0x3f223e48
.long 0x3f553f80,0xbe483ec4,0x3f0ea554,0x3f7b3f6d,0x3f463f80,0xbef13e48,0x3f7f3f35,0x3e953f55
.long 0x3f353f80,0xbf35248d,0x3f353f80,0xbf35248d,0x3f223f80,0xbf62be48,0xbdc93f35,0xbf75bf55
.long 0x3f0e3f80,0xbf7bbec4,0xbf55248d,0xbe48bf6d,0x3ef13f80,0xbf7fbf0e,0xbf75bf35,0x3f46be48
.long 0x3ec43f80,0xbf6dbf35,0xbec4bf80,0x3f6d3f35,0x3e953f80,0xbf46bf55,0x3ef1bf35,0x3dc93f7b
.long 0x3e483f80,0xbf0ebf6d,0x3f7ba554,0xbf553ec4,0x3dc93f80,0xbe95bf7b,0x3f463f35,0xbf62bf0e
.long 0x248d3f80,0xa554bf80,0x248d3f80,0xa554bf80,0xbdc93f80,0x3e95bf7b,0xbf463f35,0x3f62bf0e
.long 0xbe483f80,0x3f0ebf6d,0xbf7b248d,0x3f553ec4,0xbe953f80,0x3f46bf55,0xbef1bf35,0xbdc93f7b
.long 0xbec43f80,0x3f6dbf35,0x3ec4bf80,0xbf6d3f35,0xbef13f80,0x3f7fbf0e,0x3f75bf35,0xbf46be48
.long 0xbf0e3f80,0x3f7bbec4,0x3f55a554,0x3e48bf6d,0xbf223f80,0x3f62be48,0x3dc93f35,0x3f75bf55
.long 0xbf353f80,0x3f35a554,0xbf353f80,0x3f35a554,0xbf463f80,0x3ef13e48,0xbf7f3f35,0xbe953f55
.long 0xbf553f80,0x3e483ec4,0xbf0e248d,0xbf7b3f6d,0xbf623f80,0xbdc93f0e,0x3e95bf35,0xbf223e48
.long 0xbf6d3f80,0xbec43f35,0x3f6dbf80,0x3ec4bf35,0xbf753f80,0xbf223f55,0x3f62bf35,0x3f7fbf7b
.long 0xbf7b3f80,0xbf553f6d,0x3e48a554,0x3f0ebec4,0xbf7f3f80,0xbf753f7b,0xbf223f35,0xbef13f0e
.long 0x3f803f80,0x3f803f80,0x3f803f80,0x3f803f80,0x3f623f6d,0x3f463f55,0x3e953ec4,0x3dc93e48
.long 0x3f0e3f35,0x3e483ec4,0xbf55bf35,0xbf7bbf6d,0x3dc93ec4,0xbef1be48,0xbf46bf6d,0xbe95bf0e
.long 0xbec4248d,0xbf6dbf35,0x3ec4a554,0x3f6d3f35,0xbf46bec4,0xbf75bf7b,0x3f7f3f6d,0x3ef13f55
.long 0xbf7bbf35,0xbf0ebf6d,0x3e483f35,0xbf55bec4,0xbf75bf6d,0x3dc9bf0e,0xbf62bec4,0xbf22bf7b
.long 0xbf35bf80,0x3f35a554,0xbf35bf80,0x3f35a554,0xbe95bf6d,0x3f7f3f0e,0x3ef1bec4,0x3f463f7b
.long 0x3e48bf35,0x3f553f6d,0x3f7b3f35,0xbf0e3ec4,0x3f22bec4,0x3e953f7b,0x3dc93f6d,0xbf62bf55
.long 0x3f6da554,0xbec43f35,0xbf6d248d,0x3ec4bf35,0x3f7f3ec4,0xbf623e48,0xbf22bf6d,0x3f753f0e
.long 0x3f553f35,0xbf7bbec4,0x3f0ebf35,0xbe483f6d,0x3ef13f6d,0xbf22bf55,0x3f753ec4,0xbf7fbe48
.long 0x248d3f80,0xa554bf80,0x248d3f80,0xa554bf80,0xbef13f6d,0x3f22bf55,0xbf753ec4,0x3f7fbe48
.long 0xbf553f35,0x3f7bbec4,0xbf0ebf35,0x3e483f6d,0xbf7f3ec4,0x3f623e48,0x3f22bf6d,0xbf753f0e
.long 0xbf6d248d,0x3ec43f35,0x3f6da554,0xbec4bf35,0xbf22bec4,0xbe953f7b,0xbdc93f6d,0x3f62bf55
.long 0xbe48bf35,0xbf553f6d,0xbf7b3f35,0x3f0e3ec4,0x3e95bf6d,0xbf7f3f0e,0xbef1bec4,0xbf463f7b
.long 0x3f35bf80,0xbf35248d,0x3f35bf80,0xbf35248d,0x3f75bf6d,0xbdc9bf0e,0x3f62bec4,0x3f22bf7b
.long 0x3f7bbf35,0x3f0ebf6d,0xbe483f35,0x3f55bec4,0x3f46bec4,0x3f75bf7b,0xbf7f3f6d,0xbef13f55
.long 0x3ec4a554,0x3f6dbf35,0xbec4248d,0xbf6d3f35,0xbdc93ec4,0x3ef1be48,0x3f46bf6d,0x3e95bf0e
.long 0xbf0e3f35,0xbe483ec4,0x3f55bf35,0x3f7bbf6d,0xbf623f6d,0xbf463f55,0xbe953ec4,0xbdc93e48
.long 0x3f803f80,0x3f803f80,0x3f803f80,0x3f803f80,0xbdc9248d,0xbe95be48,0xbf46bf35,0xbf62bf55
.long 0xbf7bbf80,0xbf55bf6d,0x3e48a554,0x3f0e3ec4,0x3e95a554,0x3f463f0e,0x3ef13f35,0xbdc93e48
.long 0x3f6d3f80,0x3ec43f35,0xbf6dbf80,0xbec4bf35,0xbef1248d,0xbf7fbf55,0x3f753f35,0x3f463f7b
.long 0xbf55bf80,0x3e48bec4,0xbf0e248d,0xbf7bbf6d,0x3f22a554,0x3f623f7b,0xbdc9bf35,0x3f753f0e
.long 0x3f353f80,0xbf35248d,0x3f353f80,0xbf35248d,0xbf46248d,0xbef1bf7b,0xbf7fbf35,0x3e95bf0e
.long 0xbf0ebf80,0x3f7b3ec4,0x3f55a554,0x3e483f6d,0x3f62a554,0xbdc93f55,0xbe953f35,0xbf22bf7b
.long 0x3ec43f80,0xbf6dbf35,0xbec4bf80,0x3f6d3f35,0xbf75248d,0x3f22bf0e,0x3f623f35,0xbf7fbe48
.long 0xbe48bf80,0x3f0e3f6d,0xbf7b248d,0x3f55bec4,0x3f7fa554,0xbf753e48,0x3f22bf35,0xbef13f55
.long 0x248d3f80,0xa554bf80,0x248d3f80,0xa554bf80,0xbf7f248d,0x3f753e48,0xbf22bf35,0x3ef13f55
.long 0x3e48bf80,0xbf0e3f6d,0x3f7ba554,0xbf55bec4,0x3f75a554,0xbf22bf0e,0xbf623f35,0x3f7fbe48
.long 0xbec43f80,0x3f6dbf35,0x3ec4bf80,0xbf6d3f35,0xbf62248d,0x3dc93f55,0x3e953f35,0x3f22bf7b
.long 0x3f0ebf80,0xbf7b3ec4,0xbf55248d,0xbe483f6d,0x3f46a554,0x3ef1bf7b,0x3f7fbf35,0xbe95bf0e
.long 0xbf353f80,0x3f35a554,0xbf353f80,0x3f35a554,0xbf22248d,0xbf623f7b,0x3dc9bf35,0xbf753f0e
.long 0x3f55bf80,0xbe48bec4,0x3f0ea554,0x3f7bbf6d,0x3ef1a554,0x3f7fbf55,0xbf753f35,0xbf463f7b
.long 0xbf6d3f80,0xbec43f35,0x3f6dbf80,0x3ec4bf35,0xbe95248d,0xbf463f0e,0xbef13f35,0x3dc93e48
.long 0x3f7bbf80,0x3f55bf6d,0xbe48248d,0xbf0e3ec4,0x3dc9a554,0x3e95be48,0x3f46bf35,0x3f62bf55
.long 0x3f803f80,0x3f803f80,0x3f803f80,0x3f803f80,0xbef1bec4,0xbf22bf0e,0xbf75bf6d,0xbf7fbf7b
.long 0xbf0ebf35,0xbe48bec4,0x3f553f35,0x3f7b3f6d,0x3f7f3f6d,0x3f623f7b,0xbf22bec4,0xbf75bf55
.long 0xbec4248d,0xbf6dbf35,0x3ec4a554,0x3f6d3f35,0xbf22bf6d,0x3e95be48,0xbdc93ec4,0xbf62bf0e
.long 0x3f7b3f35,0x3f0e3f6d,0xbe48bf35,0x3f553ec4,0xbe953ec4,0xbf7fbf55,0x3ef13f6d,0xbf46be48
.long 0xbf35bf80,0x3f35a554,0xbf35bf80,0x3f35a554,0x3f753ec4,0x3dc93f55,0x3f623f6d,0xbf223e48
.long 0xbe483f35,0xbf55bf6d,0xbf7bbf35,0x3f0ebec4,0xbf46bf6d,0x3f753e48,0x3f7f3ec4,0xbef13f0e
.long 0x3f6da554,0xbec43f35,0xbf6d248d,0x3ec4bf35,0xbdc93f6d,0xbef1bf7b,0x3f46bec4,0xbe953f55
.long 0xbf55bf35,0x3f7b3ec4,0xbf0e3f35,0x3e48bf6d,0x3f62bec4,0xbf463f0e,0x3e95bf6d,0xbdc93f7b
.long 0x248d3f80,0xa554bf80,0x248d3f80,0xa554bf80,0xbf62bec4,0x3f463f0e,0xbe95bf6d,0x3dc93f7b
.long 0x3f55bf35,0xbf7b3ec4,0x3f0e3f35,0xbe48bf6d,0x3dc93f6d,0x3ef1bf7b,0xbf46bec4,0x3e953f55
.long 0xbf6d248d,0x3ec43f35,0x3f6da554,0xbec4bf35,0x3f46bf6d,0xbf753e48,0xbf7f3ec4,0x3ef13f0e
.long 0x3e483f35,0x3f55bf6d,0x3f7bbf35,0xbf0ebec4,0xbf753ec4,0xbdc93f55,0xbf623f6d,0x3f223e48
.long 0x3f35bf80,0xbf35248d,0x3f35bf80,0xbf35248d,0x3e953ec4,0x3f7fbf55,0xbef13f6d,0x3f46be48
.long 0xbf7b3f35,0xbf0e3f6d,0x3e48bf35,0xbf553ec4,0x3f22bf6d,0xbe95be48,0x3dc93ec4,0x3f62bf0e
.long 0x3ec4a554,0x3f6dbf35,0xbec4248d,0xbf6d3f35,0xbf7f3f6d,0xbf623f7b,0x3f22bec4,0x3f75bf55
.long 0x3f0ebf35,0x3e48bec4,0xbf553f35,0xbf7b3f6d,0x3ef1bec4,0x3f22bf0e,0x3f75bf6d,0x3f7fbf7b
.long 0x3f803f80,0x3f803f80,0x3f803f80,0x3f803f80,0xbf7fbf80,0xbf75bf7b,0xbf22bf35,0xbef1bf0e
.long 0x3f7b3f80,0x3f553f6d,0xbe48248d,0xbf0ebec4,0xbf75bf80,0xbf22bf55,0x3f623f35,0x3f7f3f7b
.long 0x3f6d3f80,0x3ec43f35,0xbf6dbf80,0xbec4bf35,0xbf62bf80,0xbdc9bf0e,0x3e953f35,0xbf22be48
.long 0x3f553f80,0xbe483ec4,0x3f0ea554,0x3f7b3f6d,0xbf46bf80,0x3ef1be48,0xbf7fbf35,0xbe95bf55
.long 0x3f353f80,0xbf35248d,0x3f353f80,0xbf35248d,0xbf22bf80,0x3f623e48,0x3dc9bf35,0x3f753f55
.long 0x3f0e3f80,0xbf7bbec4,0xbf55248d,0xbe48bf6d,0xbef1bf80,0x3f7f3f0e,0x3f753f35,0xbf463e48
.long 0x3ec43f80,0xbf6dbf35,0xbec4bf80,0x3f6d3f35,0xbe95bf80,0x3f463f55,0xbef13f35,0xbdc9bf7b
.long 0x3e483f80,0xbf0ebf6d,0x3f7ba554,0xbf553ec4,0xbdc9bf80,0x3e953f7b,0xbf46bf35,0x3f623f0e
.long 0x248d3f80,0xa554bf80,0x248d3f80,0xa554bf80,0x3dc9bf80,0xbe953f7b,0x3f46bf35,0xbf623f0e
.long 0xbe483f80,0x3f0ebf6d,0xbf7b248d,0x3f553ec4,0x3e95bf80,0xbf463f55,0x3ef13f35,0x3dc9bf7b
.long 0xbec43f80,0x3f6dbf35,0x3ec4bf80,0xbf6d3f35,0x3ef1bf80,0xbf7f3f0e,0xbf753f35,0x3f463e48
.long 0xbf0e3f80,0x3f7bbec4,0x3f55a554,0x3e48bf6d,0x3f22bf80,0xbf623e48,0xbdc9bf35,0xbf753f55
.long 0xbf353f80,0x3f35a554,0xbf353f80,0x3f35a554,0x3f46bf80,0xbef1be48,0x3f7fbf35,0x3e95bf55
.long 0xbf553f80,0x3e483ec4,0xbf0e248d,0xbf7b3f6d,0x3f62bf80,0x3dc9bf0e,0xbe953f35,0x3f22be48
.long 0xbf6d3f80,0xbec43f35,0x3f6dbf80,0x3ec4bf35,0x3f75bf80,0x3f22bf55,0xbf623f35,0xbf7f3f7b
.long 0xbf7b3f80,0xbf553f6d,0x3e48a554,0x3f0ebec4,0x3f7fbf80,0x3f75bf7b,0x3f22bf35,0x3ef1bf0e
.long 0x3f803f80,0x3f803f80,0x3f803f80,0x3f803f80,0xbf62bf6d,0xbf46bf55,0xbe95bec4,0xbdc9be48
.long 0x3f0e3f35,0x3e483ec4,0xbf55bf35,0xbf7bbf6d,0xbdc9bec4,0x3ef13e48,0x3f463f6d,0x3e953f0e
.long 0xbec4248d,0xbf6dbf35,0x3ec4a554,0x3f6d3f35,0x3f463ec4,0x3f753f7b,0xbf7fbf6d,0xbef1bf55
.long 0xbf7bbf35,0xbf0ebf6d,0x3e483f35,0xbf55bec4,0x3f753f6d,0xbdc93f0e,0x3f623ec4,0x3f223f7b
.long 0xbf35bf80,0x3f35a554,0xbf35bf80,0x3f35a554,0x3e953f6d,0xbf7fbf0e,0xbef13ec4,0xbf46bf7b
.long 0x3e48bf35,0x3f553f6d,0x3f7b3f35,0xbf0e3ec4,0xbf223ec4,0xbe95bf7b,0xbdc9bf6d,0x3f623f55
.long 0x3f6da554,0xbec43f35,0xbf6d248d,0x3ec4bf35,0xbf7fbec4,0x3f62be48,0x3f223f6d,0xbf75bf0e
.long 0x3f553f35,0xbf7bbec4,0x3f0ebf35,0xbe483f6d,0xbef1bf6d,0x3f223f55,0xbf75bec4,0x3f7f3e48
.long 0x248d3f80,0xa554bf80,0x248d3f80,0xa554bf80,0x3ef1bf6d,0xbf223f55,0x3f75bec4,0xbf7f3e48
.long 0xbf553f35,0x3f7bbec4,0xbf0ebf35,0x3e483f6d,0x3f7fbec4,0xbf62be48,0xbf223f6d,0x3f75bf0e
.long 0xbf6d248d,0x3ec43f35,0x3f6da554,0xbec4bf35,0x3f223ec4,0x3e95bf7b,0x3dc9bf6d,0xbf623f55
.long 0xbe48bf35,0xbf553f6d,0xbf7b3f35,0x3f0e3ec4,0xbe953f6d,0x3f7fbf0e,0x3ef13ec4,0x3f46bf7b
.long 0x3f35bf80,0xbf35248d,0x3f35bf80,0xbf35248d,0xbf753f6d,0x3dc93f0e,0xbf623ec4,0xbf223f7b
.long 0x3f7bbf35,0x3f0ebf6d,0xbe483f35,0x3f55bec4,0xbf463ec4,0xbf753f7b,0x3f7fbf6d,0x3ef1bf55
.long 0x3ec4a554,0x3f6dbf35,0xbec4248d,0xbf6d3f35,0x3dc9bec4,0xbef13e48,0xbf463f6d,0xbe953f0e
.long 0xbf0e3f35,0xbe483ec4,0x3f55bf35,0x3f7bbf6d,0x3f62bf6d,0x3f46bf55,0x3e95bec4,0x3dc9be48
.long 0x3f803f80,0x3f803f80,0x3f803f80,0x3f803f80,0x3dc9a554,0x3e953e48,0x3f463f35,0x3f623f55
.long 0xbf7bbf80,0xbf55bf6d,0x3e48a554,0x3f0e3ec4,0xbe95248d,0xbf46bf0e,0xbef1bf35,0x3dc9be48
.long 0x3f6d3f80,0x3ec43f35,0xbf6dbf80,0xbec4bf35,0x3ef1a554,0x3f7f3f55,0xbf75bf35,0xbf46bf7b
.long 0xbf55bf80,0x3e48bec4,0xbf0e248d,0xbf7bbf6d,0xbf22248d,0xbf62bf7b,0x3dc93f35,0xbf75bf0e
.long 0x3f353f80,0xbf35248d,0x3f353f80,0xbf35248d,0x3f46a554,0x3ef13f7b,0x3f7f3f35,0xbe953f0e
.long 0xbf0ebf80,0x3f7b3ec4,0x3f55a554,0x3e483f6d,0xbf62248d,0x3dc9bf55,0x3e95bf35,0x3f223f7b
.long 0x3ec43f80,0xbf6dbf35,0xbec4bf80,0x3f6d3f35,0x3f75a554,0xbf223f0e,0xbf62bf35,0x3f7f3e48
.long 0xbe48bf80,0x3f0e3f6d,0xbf7b248d,0x3f55bec4,0xbf7f248d,0x3f75be48,0xbf223f35,0x3ef1bf55
.long 0x248d3f80,0xa554bf80,0x248d3f80,0xa554bf80,0x3f7fa554,0xbf75be48,0x3f223f35,0xbef1bf55
.long 0x3e48bf80,0xbf0e3f6d,0x3f7ba554,0xbf55bec4,0xbf75248d,0x3f223f0e,0x3f62bf35,0xbf7f3e48
.long 0xbec43f80,0x3f6dbf35,0x3ec4bf80,0xbf6d3f35,0x3f62a554,0xbdc9bf55,0xbe95bf35,0xbf223f7b
.long 0x3f0ebf80,0xbf7b3ec4,0xbf55248d,0xbe483f6d,0xbf46248d,0xbef13f7b,0xbf7f3f35,0x3e953f0e
.long 0xbf353f80,0x3f35a554,0xbf353f80,0x3f35a554,0x3f22a554,0x3f62bf7b,0xbdc93f35,0x3f75bf0e
.long 0x3f55bf80,0xbe48bec4,0x3f0ea554,0x3f7bbf6d,0xbef1248d,0xbf7f3f55,0x3f75bf35,0x3f46bf7b
.long 0xbf6d3f80,0xbec43f35,0x3f6dbf80,0x3ec4bf35,0x3e95a554,0x3f46bf0e,0x3ef1bf35,0xbdc9be48
.long 0x3f7bbf80,0x3f55bf6d,0xbe48248d,0xbf0e3ec4,0xbdc9248d,0xbe953e48,0xbf463f35,0xbf623f55
.long 0x3f803f80,0x3f803f80,0x3f803f80,0x3f803f80,0x3ef13ec4,0x3f223f0e,0x3f753f6d,0x3f7f3f7b
.long 0xbf0ebf35,0xbe48bec4,0x3f553f35,0x3f7b3f6d,0xbf7fbf6d,0xbf62bf7b,0x3f223ec4,0x3f753f55
.long 0xbec4248d,0xbf6dbf35,0x3ec4a554,0x3f6d3f35,0x3f223f6d,0xbe953e48,0x3dc9bec4,0x3f623f0e
.long 0x3f7b3f35,0x3f0e3f6d,0xbe48bf35,0x3f553ec4,0x3e95bec4,0x3f7f3f55,0xbef1bf6d,0x3f463e48
.long 0xbf35bf80,0x3f35a554,0xbf35bf80,0x3f35a554,0xbf75bec4,0xbdc9bf55,0xbf62bf6d,0x3f22be48
.long 0xbe483f35,0xbf55bf6d,0xbf7bbf35,0x3f0ebec4,0x3f463f6d,0xbf75be48,0xbf7fbec4,0x3ef1bf0e
.long 0x3f6da554,0xbec43f35,0xbf6d248d,0x3ec4bf35,0x3dc9bf6d,0x3ef13f7b,0xbf463ec4,0x3e95bf55
.long 0xbf55bf35,0x3f7b3ec4,0xbf0e3f35,0x3e48bf6d,0xbf623ec4,0x3f46bf0e,0xbe953f6d,0x3dc9bf7b
.long 0x248d3f80,0xa554bf80,0x248d3f80,0xa554bf80,0x3f623ec4,0xbf46bf0e,0x3e953f6d,0xbdc9bf7b
.long 0x3f55bf35,0xbf7b3ec4,0x3f0e3f35,0xbe48bf6d,0xbdc9bf6d,0xbef13f7b,0x3f463ec4,0xbe95bf55
.long 0xbf6d248d,0x3ec43f35,0x3f6da554,0xbec4bf35,0xbf463f6d,0x3f75be48,0x3f7fbec4,0xbef1bf0e
.long 0x3e483f35,0x3f55bf6d,0x3f7bbf35,0xbf0ebec4,0x3f75bec4,0x3dc9bf55,0x3f62bf6d,0xbf22be48
.long 0x3f35bf80,0xbf35248d,0x3f35bf80,0xbf35248d,0xbe95bec4,0xbf7f3f55,0x3ef1bf6d,0xbf463e48
.long 0xbf7b3f35,0xbf0e3f6d,0x3e48bf35,0xbf553ec4,0xbf223f6d,0x3e953e48,0xbdc9bec4,0xbf623f0e
.long 0x3ec4a554,0x3f6dbf35,0xbec4248d,0xbf6d3f35,0x3f7fbf6d,0x3f62bf7b,0xbf223ec4,0xbf753f55
.long 0x3f0ebf35,0x3e48bec4,0xbf553f35,0xbf7b3f6d,0xbef13ec4,0xbf223f0e,0xbf753f6d,0xbf7f3f7b
.long 0xbf803f80,0xbf803f80,0xbf803f80,0xbf803f80,0xbf7f3f80,0xbf753f7b,0xbf223f35,0xbef13f0e
.long 0xbf7b3f80,0xbf553f6d,0x3e48248d,0x3f0ebec4,0xbf753f80,0xbf223f55,0x3f62bf35,0x3f7fbf7b
.long 0xbf6d3f80,0xbec43f35,0x3f6dbf80,0x3ec4bf35,0xbf623f80,0xbdc93f0e,0x3e95bf35,0xbf223e48
.long 0xbf553f80,0x3e483ec4,0xbf0ea554,0xbf7b3f6d,0xbf463f80,0x3ef13e48,0xbf7f3f35,0xbe953f55
.long 0xbf353f80,0x3f35248d,0xbf353f80,0x3f35248d,0xbf223f80,0x3f62be48,0x3dc93f35,0x3f75bf55
.long 0xbf0e3f80,0x3f7bbec4,0x3f55248d,0x3e48bf6d,0xbef13f80,0x3f7fbf0e,0x3f75bf35,0xbf46be48
.long 0xbec43f80,0x3f6dbf35,0x3ec4bf80,0xbf6d3f35,0xbe953f80,0x3f46bf55,0xbef1bf35,0xbdc93f7b
.long 0xbe483f80,0x3f0ebf6d,0xbf7ba554,0x3f553ec4,0xbdc93f80,0x3e95bf7b,0xbf463f35,0x3f62bf0e
.long 0xa5543f80,0x248dbf80,0xa5543f80,0x248dbf80,0x3dc93f80,0xbe95bf7b,0x3f463f35,0xbf62bf0e
.long 0x3e483f80,0xbf0ebf6d,0x3f7b248d,0xbf553ec4,0x3e953f80,0xbf46bf55,0x3ef1bf35,0x3dc93f7b
.long 0x3ec43f80,0xbf6dbf35,0xbec4bf80,0x3f6d3f35,0x3ef13f80,0xbf7fbf0e,0xbf75bf35,0x3f46be48
.long 0x3f0e3f80,0xbf7bbec4,0xbf55a554,0xbe48bf6d,0x3f223f80,0xbf62be48,0xbdc93f35,0xbf75bf55
.long 0x3f353f80,0xbf35a554,0x3f353f80,0xbf35a554,0x3f463f80,0xbef13e48,0x3f7f3f35,0x3e953f55
.long 0x3f553f80,0xbe483ec4,0x3f0e248d,0x3f7b3f6d,0x3f623f80,0x3dc93f0e,0xbe95bf35,0x3f223e48
.long 0x3f6d3f80,0x3ec43f35,0xbf6dbf80,0xbec4bf35,0x3f753f80,0x3f223f55,0xbf62bf35,0xbf7fbf7b
.long 0x3f7b3f80,0x3f553f6d,0xbe48a554,0xbf0ebec4,0x3f7f3f80,0x3f753f7b,0x3f223f35,0x3ef13f0e
.long 0xbf803f80,0xbf803f80,0xbf803f80,0xbf803f80,0xbf623f6d,0xbf463f55,0xbe953ec4,0xbdc93e48
.long 0xbf0e3f35,0xbe483ec4,0x3f55bf35,0x3f7bbf6d,0xbdc93ec4,0x3ef1be48,0x3f46bf6d,0x3e95bf0e
.long 0x3ec4248d,0x3f6dbf35,0xbec4a554,0xbf6d3f35,0x3f46bec4,0x3f75bf7b,0xbf7f3f6d,0xbef13f55
.long 0x3f7bbf35,0x3f0ebf6d,0xbe483f35,0x3f55bec4,0x3f75bf6d,0xbdc9bf0e,0x3f62bec4,0x3f22bf7b
.long 0x3f35bf80,0xbf35a554,0x3f35bf80,0xbf35a554,0x3e95bf6d,0xbf7f3f0e,0xbef1bec4,0xbf463f7b
.long 0xbe48bf35,0xbf553f6d,0xbf7b3f35,0x3f0e3ec4,0xbf22bec4,0xbe953f7b,0xbdc93f6d,0x3f62bf55
.long 0xbf6da554,0x3ec43f35,0x3f6d248d,0xbec4bf35,0xbf7f3ec4,0x3f623e48,0x3f22bf6d,0xbf753f0e
.long 0xbf553f35,0x3f7bbec4,0xbf0ebf35,0x3e483f6d,0xbef13f6d,0x3f22bf55,0xbf753ec4,0x3f7fbe48
.long 0xa5543f80,0x248dbf80,0xa5543f80,0x248dbf80,0x3ef13f6d,0xbf22bf55,0x3f753ec4,0xbf7fbe48
.long 0x3f553f35,0xbf7bbec4,0x3f0ebf35,0xbe483f6d,0x3f7f3ec4,0xbf623e48,0xbf22bf6d,0x3f753f0e
.long 0x3f6d248d,0xbec43f35,0xbf6da554,0x3ec4bf35,0x3f22bec4,0x3e953f7b,0x3dc93f6d,0xbf62bf55
.long 0x3e48bf35,0x3f553f6d,0x3f7b3f35,0xbf0e3ec4,0xbe95bf6d,0x3f7f3f0e,0x3ef1bec4,0x3f463f7b
.long 0xbf35bf80,0x3f35248d,0xbf35bf80,0x3f35248d,0xbf75bf6d,0x3dc9bf0e,0xbf62bec4,0xbf22bf7b
.long 0xbf7bbf35,0xbf0ebf6d,0x3e483f35,0xbf55bec4,0xbf46bec4,0xbf75bf7b,0x3f7f3f6d,0x3ef13f55
.long 0xbec4a554,0xbf6dbf35,0x3ec4248d,0x3f6d3f35,0x3dc93ec4,0xbef1be48,0xbf46bf6d,0xbe95bf0e
.long 0x3f0e3f35,0x3e483ec4,0xbf55bf35,0xbf7bbf6d,0x3f623f6d,0x3f463f55,0x3e953ec4,0x3dc93e48
.long 0xbf803f80,0xbf803f80,0xbf803f80,0xbf803f80,0x3dc9248d,0x3e95be48,0x3f46bf35,0x3f62bf55
.long 0x3f7bbf80,0x3f55bf6d,0xbe48a554,0xbf0e3ec4,0xbe95a554,0xbf463f0e,0xbef13f35,0x3dc93e48
.long 0xbf6d3f80,0xbec43f35,0x3f6dbf80,0x3ec4bf35,0x3ef1248d,0x3f7fbf55,0xbf753f35,0xbf463f7b
.long 0x3f55bf80,0xbe48bec4,0x3f0e248d,0x3f7bbf6d,0xbf22a554,0xbf623f7b,0x3dc9bf35,0xbf753f0e
.long 0xbf353f80,0x3f35248d,0xbf353f80,0x3f35248d,0x3f46248d,0x3ef1bf7b,0x3f7fbf35,0xbe95bf0e
.long 0x3f0ebf80,0xbf7b3ec4,0xbf55a554,0xbe483f6d,0xbf62a554,0x3dc93f55,0x3e953f35,0x3f22bf7b
.long 0xbec43f80,0x3f6dbf35,0x3ec4bf80,0xbf6d3f35,0x3f75248d,0xbf22bf0e,0xbf623f35,0x3f7fbe48
.long 0x3e48bf80,0xbf0e3f6d,0x3f7b248d,0xbf55bec4,0xbf7fa554,0x3f753e48,0xbf22bf35,0x3ef13f55
.long 0xa5543f80,0x248dbf80,0xa5543f80,0x248dbf80,0x3f7f248d,0xbf753e48,0x3f22bf35,0xbef13f55
.long 0xbe48bf80,0x3f0e3f6d,0xbf7ba554,0x3f55bec4,0xbf75a554,0x3f22bf0e,0x3f623f35,0xbf7fbe48
.long 0x3ec43f80,0xbf6dbf35,0xbec4bf80,0x3f6d3f35,0x3f62248d,0xbdc93f55,0xbe953f35,0xbf22bf7b
.long 0xbf0ebf80,0x3f7b3ec4,0x3f55248d,0x3e483f6d,0xbf46a554,0xbef1bf7b,0xbf7fbf35,0x3e95bf0e
.long 0x3f353f80,0xbf35a554,0x3f353f80,0xbf35a554,0x3f22248d,0x3f623f7b,0xbdc9bf35,0x3f753f0e
.long 0xbf55bf80,0x3e48bec4,0xbf0ea554,0xbf7bbf6d,0xbef1a554,0xbf7fbf55,0x3f753f35,0x3f463f7b
.long 0x3f6d3f80,0x3ec43f35,0xbf6dbf80,0xbec4bf35,0x3e95248d,0x3f463f0e,0x3ef13f35,0xbdc93e48
.long 0xbf7bbf80,0xbf55bf6d,0x3e48248d,0x3f0e3ec4,0xbdc9a554,0xbe95be48,0xbf46bf35,0xbf62bf55
.long 0xbf803f80,0xbf803f80,0xbf803f80,0xbf803f80,0x3ef1bec4,0x3f22bf0e,0x3f75bf6d,0x3f7fbf7b
.long 0x3f0ebf35,0x3e48bec4,0xbf553f35,0xbf7b3f6d,0xbf7f3f6d,0xbf623f7b,0x3f22bec4,0x3f75bf55
.long 0x3ec4248d,0x3f6dbf35,0xbec4a554,0xbf6d3f35,0x3f22bf6d,0xbe95be48,0x3dc93ec4,0x3f62bf0e
.long 0xbf7b3f35,0xbf0e3f6d,0x3e48bf35,0xbf553ec4,0x3e953ec4,0x3f7fbf55,0xbef13f6d,0x3f46be48
.long 0x3f35bf80,0xbf35a554,0x3f35bf80,0xbf35a554,0xbf753ec4,0xbdc93f55,0xbf623f6d,0x3f223e48
.long 0x3e483f35,0x3f55bf6d,0x3f7bbf35,0xbf0ebec4,0x3f46bf6d,0xbf753e48,0xbf7f3ec4,0x3ef13f0e
.long 0xbf6da554,0x3ec43f35,0x3f6d248d,0xbec4bf35,0x3dc93f6d,0x3ef1bf7b,0xbf46bec4,0x3e953f55
.long 0x3f55bf35,0xbf7b3ec4,0x3f0e3f35,0xbe48bf6d,0xbf62bec4,0x3f463f0e,0xbe95bf6d,0x3dc93f7b
.long 0xa5543f80,0x248dbf80,0xa5543f80,0x248dbf80,0x3f62bec4,0xbf463f0e,0x3e95bf6d,0xbdc93f7b
.long 0xbf55bf35,0x3f7b3ec4,0xbf0e3f35,0x3e48bf6d,0xbdc93f6d,0xbef1bf7b,0x3f46bec4,0xbe953f55
.long 0x3f6d248d,0xbec43f35,0xbf6da554,0x3ec4bf35,0xbf46bf6d,0x3f753e48,0x3f7f3ec4,0xbef13f0e
.long 0xbe483f35,0xbf55bf6d,0xbf7bbf35,0x3f0ebec4,0x3f753ec4,0x3dc93f55,0x3f623f6d,0xbf223e48
.long 0xbf35bf80,0x3f35248d,0xbf35bf80,0x3f35248d,0xbe953ec4,0xbf7fbf55,0x3ef13f6d,0xbf46be48
.long 0x3f7b3f35,0x3f0e3f6d,0xbe48bf35,0x3f553ec4,0xbf22bf6d,0x3e95be48,0xbdc93ec4,0xbf62bf0e
.long 0xbec4a554,0xbf6dbf35,0x3ec4248d,0x3f6d3f35,0x3f7f3f6d,0x3f623f7b,0xbf22bec4,0xbf75bf55
.long 0xbf0ebf35,0xbe48bec4,0x3f553f35,0x3f7b3f6d,0xbef1bec4,0xbf22bf0e,0xbf75bf6d,0xbf7fbf7b
.long 0xbf803f80,0xbf803f80,0xbf803f80,0xbf803f80,0x3f7fbf80,0x3f75bf7b,0x3f22bf35,0x3ef1bf0e
.long 0xbf7b3f80,0xbf553f6d,0x3e48248d,0x3f0ebec4,0x3f75bf80,0x3f22bf55,0xbf623f35,0xbf7f3f7b
.long 0xbf6d3f80,0xbec43f35,0x3f6dbf80,0x3ec4bf35,0x3f62bf80,0x3dc9bf0e,0xbe953f35,0x3f22be48
.long 0xbf553f80,0x3e483ec4,0xbf0ea554,0xbf7b3f6d,0x3f46bf80,0xbef1be48,0x3f7fbf35,0x3e95bf55
.long 0xbf353f80,0x3f35248d,0xbf353f80,0x3f35248d,0x3f22bf80,0xbf623e48,0xbdc9bf35,0xbf753f55
.long 0xbf0e3f80,0x3f7bbec4,0x3f55248d,0x3e48bf6d,0x3ef1bf80,0xbf7f3f0e,0xbf753f35,0x3f463e48
.long 0xbec43f80,0x3f6dbf35,0x3ec4bf80,0xbf6d3f35,0x3e95bf80,0xbf463f55,0x3ef13f35,0x3dc9bf7b
.long 0xbe483f80,0x3f0ebf6d,0xbf7ba554,0x3f553ec4,0x3dc9bf80,0xbe953f7b,0x3f46bf35,0xbf623f0e
.long 0xa5543f80,0x248dbf80,0xa5543f80,0x248dbf80,0xbdc9bf80,0x3e953f7b,0xbf46bf35,0x3f623f0e
.long 0x3e483f80,0xbf0ebf6d,0x3f7b248d,0xbf553ec4,0xbe95bf80,0x3f463f55,0xbef13f35,0xbdc9bf7b
.long 0x3ec43f80,0xbf6dbf35,0xbec4bf80,0x3f6d3f35,0xbef1bf80,0x3f7f3f0e,0x3f753f35,0xbf463e48
.long 0x3f0e3f80,0xbf7bbec4,0xbf55a554,0xbe48bf6d,0xbf22bf80,0x3f623e48,0x3dc9bf35,0x3f753f55
.long 0x3f353f80,0xbf35a554,0x3f353f80,0xbf35a554,0xbf46bf80,0x3ef1be48,0xbf7fbf35,0xbe95bf55
.long 0x3f553f80,0xbe483ec4,0x3f0e248d,0x3f7b3f6d,0xbf62bf80,0xbdc9bf0e,0x3e953f35,0xbf22be48
.long 0x3f6d3f80,0x3ec43f35,0xbf6dbf80,0xbec4bf35,0xbf75bf80,0xbf22bf55,0x3f623f35,0x3f7f3f7b
.long 0x3f7b3f80,0x3f553f6d,0xbe48a554,0xbf0ebec4,0xbf7fbf80,0xbf75bf7b,0xbf22bf35,0xbef1bf0e
.long 0xbf803f80,0xbf803f80,0xbf803f80,0xbf803f80,0x3f62bf6d,0x3f46bf55,0x3e95bec4,0x3dc9be48
.long 0xbf0e3f35,0xbe483ec4,0x3f55bf35,0x3f7bbf6d,0x3dc9bec4,0xbef13e48,0xbf463f6d,0xbe953f0e
.long 0x3ec4248d,0x3f6dbf35,0xbec4a554,0xbf6d3f35,0xbf463ec4,0xbf753f7b,0x3f7fbf6d,0x3ef1bf55
.long 0x3f7bbf35,0x3f0ebf6d,0xbe483f35,0x3f55bec4,0xbf753f6d,0x3dc93f0e,0xbf623ec4,0xbf223f7b
.long 0x3f35bf80,0xbf35a554,0x3f35bf80,0xbf35a554,0xbe953f6d,0x3f7fbf0e,0x3ef13ec4,0x3f46bf7b
.long 0xbe48bf35,0xbf553f6d,0xbf7b3f35,0x3f0e3ec4,0x3f223ec4,0x3e95bf7b,0x3dc9bf6d,0xbf623f55
.long 0xbf6da554,0x3ec43f35,0x3f6d248d,0xbec4bf35,0x3f7fbec4,0xbf62be48,0xbf223f6d,0x3f75bf0e
.long 0xbf553f35,0x3f7bbec4,0xbf0ebf35,0x3e483f6d,0x3ef1bf6d,0xbf223f55,0x3f75bec4,0xbf7f3e48
.long 0xa5543f80,0x248dbf80,0xa5543f80,0x248dbf80,0xbef1bf6d,0x3f223f55,0xbf75bec4,0x3f7f3e48
.long 0x3f553f35,0xbf7bbec4,0x3f0ebf35,0xbe483f6d,0xbf7fbec4,0x3f62be48,0x3f223f6d,0xbf75bf0e
.long 0x3f6d248d,0xbec43f35,0xbf6da554,0x3ec4bf35,0xbf223ec4,0xbe95bf7b,0xbdc9bf6d,0x3f623f55
.long 0x3e48bf35,0x3f553f6d,0x3f7b3f35,0xbf0e3ec4,0x3e953f6d,0xbf7fbf0e,0xbef13ec4,0xbf46bf7b
.long 0xbf35bf80,0x3f35248d,0xbf35bf80,0x3f35248d,0x3f753f6d,0xbdc93f0e,0x3f623ec4,0x3f223f7b
.long 0xbf7bbf35,0xbf0ebf6d,0x3e483f35,0xbf55bec4,0x3f463ec4,0x3f753f7b,0xbf7fbf6d,0xbef1bf55
.long 0xbec4a554,0xbf6dbf35,0x3ec4248d,0x3f6d3f35,0xbdc9bec4,0x3ef13e48,0x3f463f6d,0x3e953f0e
.long 0x3f0e3f35,0x3e483ec4,0xbf55bf35,0xbf7bbf6d,0xbf62bf6d,0xbf46bf55,0xbe95bec4,0xbdc9be48
.long 0xbf803f80,0xbf803f80,0xbf803f80,0xbf803f80,0xbdc9a554,0xbe953e48,0xbf463f35,0xbf623f55
.long 0x3f7bbf80,0x3f55bf6d,0xbe48a554,0xbf0e3ec4,0x3e95248d,0x3f46bf0e,0x3ef1bf35,0xbdc9be48
.long 0xbf6d3f80,0xbec43f35,0x3f6dbf80,0x3ec4bf35,0xbef1a554,0xbf7f3f55,0x3f75bf35,0x3f46bf7b
.long 0x3f55bf80,0xbe48bec4,0x3f0e248d,0x3f7bbf6d,0x3f22248d,0x3f62bf7b,0xbdc93f35,0x3f75bf0e
.long 0xbf353f80,0x3f35248d,0xbf353f80,0x3f35248d,0xbf46a554,0xbef13f7b,0xbf7f3f35,0x3e953f0e
.long 0x3f0ebf80,0xbf7b3ec4,0xbf55a554,0xbe483f6d,0x3f62248d,0xbdc9bf55,0xbe95bf35,0xbf223f7b
.long 0xbec43f80,0x3f6dbf35,0x3ec4bf80,0xbf6d3f35,0xbf75a554,0x3f223f0e,0x3f62bf35,0xbf7f3e48
.long 0x3e48bf80,0xbf0e3f6d,0x3f7b248d,0xbf55bec4,0x3f7f248d,0xbf75be48,0x3f223f35,0xbef1bf55
.long 0xa5543f80,0x248dbf80,0xa5543f80,0x248dbf80,0xbf7fa554,0x3f75be48,0xbf223f35,0x3ef1bf55
.long 0xbe48bf80,0x3f0e3f6d,0xbf7ba554,0x3f55bec4,0x3f75248d,0xbf223f0e,0xbf62bf35,0x3f7f3e48
.long 0x3ec43f80,0xbf6dbf35,0xbec4bf80,0x3f6d3f35,0xbf62a554,0x3dc9bf55,0x3e95bf35,0x3f223f7b
.long 0xbf0ebf80,0x3f7b3ec4,0x3f55248d,0x3e483f6d,0x3f46248d,0x3ef13f7b,0x3f7f3f35,0xbe953f0e
.long 0x3f353f80,0xbf35a554,0x3f353f80,0xbf35a554,0xbf22a554,0xbf62bf7b,0x3dc93f35,0xbf75bf0e
.long 0xbf55bf80,0x3e48bec4,0xbf0ea554,0xbf7bbf6d,0x3ef1248d,0x3f7f3f55,0xbf75bf35,0xbf46bf7b
.long 0x3f6d3f80,0x3ec43f35,0xbf6dbf80,0xbec4bf35,0xbe95a554,0xbf46bf0e,0xbef1bf35,0x3dc9be48
.long 0xbf7bbf80,0xbf55bf6d,0x3e48248d,0x3f0e3ec4,0x3dc9248d,0x3e953e48,0x3f463f35,0x3f623f55
.long 0xbf803f80,0xbf803f80,0xbf803f80,0xbf803f80,0xbef13ec4,0xbf223f0e,0xbf753f6d,0xbf7f3f7b
.long 0x3f0ebf35,0x3e48bec4,0xbf553f35,0xbf7b3f6d,0x3f7fbf6d,0x3f62bf7b,0xbf223ec4,0xbf753f55
.long 0x3ec4248d,0x3f6dbf35,0xbec4a554,0xbf6d3f35,0xbf223f6d,0x3e953e48,0xbdc9bec4,0xbf623f0e
.long 0xbf7b3f35,0xbf0e3f6d,0x3e48bf35,0xbf553ec4,0xbe95bec4,0xbf7f3f55,0x3ef1bf6d,0xbf463e48
.long 0x3f35bf80,0xbf35a554,0x3f35bf80,0xbf35a554,0x3f75bec4,0x3dc9bf55,0x3f62bf6d,0xbf22be48
.long 0x3e483f35,0x3f55bf6d,0x3f7bbf35,0xbf0ebec4,0xbf463f6d,0x3f75be48,0x3f7fbec4,0xbef1bf0e
.long 0xbf6da554,0x3ec43f35,0x3f6d248d,0xbec4bf35,0xbdc9bf6d,0xbef13f7b,0x3f463ec4,0xbe95bf55
.long 0x3f55bf35,0xbf7b3ec4,0x3f0e3f35,0xbe48bf6d,0x3f623ec4,0xbf46bf0e,0x3e953f6d,0xbdc9bf7b
.long 0xa5543f80,0x248dbf80,0xa5543f80,0x248dbf80,0xbf623ec4,0x3f46bf0e,0xbe953f6d,0x3dc9bf7b
.long 0xbf55bf35,0x3f7b3ec4,0xbf0e3f35,0x3e48bf6d,0x3dc9bf6d,0x3ef13f7b,0xbf463ec4,0x3e95bf55
.long 0x3f6d248d,0xbec43f35,0xbf6da554,0x3ec4bf35,0x3f463f6d,0xbf75be48,0xbf7fbec4,0x3ef1bf0e
.long 0xbe483f35,0xbf55bf6d,0xbf7bbf35,0x3f0ebec4,0xbf75bec4,0xbdc9bf55,0xbf62bf6d,0x3f22be48
.long 0xbf35bf80,0x3f35248d,0xbf35bf80,0x3f35248d,0x3e95bec4,0x3f7f3f55,0xbef1bf6d,0x3f463e48
.long 0x3f7b3f35,0x3f0e3f6d,0xbe48bf35,0x3f553ec4,0x3f223f6d,0xbe953e48,0x3dc9bec4,0x3f623f0e
.long 0xbec4a554,0xbf6dbf35,0x3ec4248d,0x3f6d3f35,0xbf7fbf6d,0xbf62bf7b,0x3f223ec4,0x3f753f55
.long 0xbf0ebf35,0xbe48bec4,0x3f553f35,0x3f7b3f6d,0x3ef13ec4,0x3f223f0e,0x3f753f6d,0x3f7f3f7b
.long 0x0,0x0,0x0,0x0,0x3dc90000,0x3e953e48,0x3f463f35,0x3f623f55
.long 0x3e480000,0x3f0e3ec4,0x3f7b3f80,0x3f553f6d,0x3e950000,0x3f463f0e,0x3ef13f35,0xbdc93e48
.long 0x3ec40000,0x3f6d3f35,0xbec4250d,0xbf6dbf35,0x3ef10000,0x3f7f3f55,0xbf75bf35,0xbf46bf7b
.long 0x3f0e0000,0x3f7b3f6d,0xbf55bf80,0x3e48bec4,0x3f220000,0x3f623f7b,0xbdc9bf35,0x3f753f0e
.long 0x3f350000,0x3f353f80,0x3f350000,0x3f353f80,0x3f460000,0x3ef13f7b,0x3f7f3f35,0xbe953f0e
.long 0x3f550000,0x3e483f6d,0x3f0e3f80,0xbf7bbec4,0x3f620000,0xbdc93f55,0xbe953f35,0xbf22bf7b
.long 0x3f6d0000,0xbec43f35,0xbf6d250d,0x3ec4bf35,0x3f750000,0xbf223f0e,0xbf62bf35,0x3f7f3e48
.long 0x3f7b0000,0xbf553ec4,0xbe48bf80,0x3f0e3f6d,0x3f7f0000,0xbf753e48,0x3f22bf35,0xbef13f55
.long 0x3f800000,0xbf80250d,0x3f800000,0xbf80250d,0x3f7f0000,0xbf75be48,0x3f223f35,0xbef1bf55
.long 0x3f7b0000,0xbf55bec4,0xbe483f80,0x3f0ebf6d,0x3f750000,0xbf22bf0e,0xbf623f35,0x3f7fbe48
.long 0x3f6d0000,0xbec4bf35,0xbf6d250d,0x3ec43f35,0x3f620000,0xbdc9bf55,0xbe95bf35,0xbf223f7b
.long 0x3f550000,0x3e48bf6d,0x3f0ebf80,0xbf7b3ec4,0x3f460000,0x3ef1bf7b,0x3f7fbf35,0xbe95bf0e
.long 0x3f350000,0x3f35bf80,0x3f350000,0x3f35bf80,0x3f220000,0x3f62bf7b,0xbdc93f35,0x3f75bf0e
.long 0x3f0e0000,0x3f7bbf6d,0xbf553f80,0x3e483ec4,0x3ef10000,0x3f7fbf55,0xbf753f35,0xbf463f7b
.long 0x3ec40000,0x3f6dbf35,0xbec4250d,0xbf6d3f35,0x3e950000,0x3f46bf0e,0x3ef1bf35,0xbdc9be48
.long 0x3e480000,0x3f0ebec4,0x3f7bbf80,0x3f55bf6d,0x3dc90000,0x3e95be48,0x3f46bf35,0x3f62bf55
.long 0x0,0x0,0x0,0x0,0x3ef13ec4,0x3f223f0e,0x3f753f6d,0x3f7f3f7b
.long 0x3f553f35,0x3f7b3f6d,0x3f0e3f35,0x3e483ec4,0x3f7f3f6d,0x3f623f7b,0xbf22bec4,0xbf75bf55
.long 0x3f6d3f80,0x3ec43f35,0xbf6dbf80,0xbec4bf35,0x3f223f6d,0xbe953e48,0x3dc9bec4,0x3f623f0e
.long 0x3e483f35,0xbf55bec4,0x3f7b3f35,0x3f0e3f6d,0xbe953ec4,0xbf7fbf55,0x3ef13f6d,0xbf46be48
.long 0xbf35250d,0xbf35bf80,0xbf35250d,0xbf35bf80,0xbf75bec4,0xbdc9bf55,0xbf62bf6d,0x3f22be48
.long 0xbf7bbf35,0x3f0ebec4,0x3e48bf35,0x3f553f6d,0xbf46bf6d,0x3f753e48,0x3f7f3ec4,0xbef13f0e
.long 0xbec4bf80,0x3f6d3f35,0x3ec43f80,0xbf6dbf35,0x3dc9bf6d,0x3ef13f7b,0xbf463ec4,0x3e95bf55
.long 0x3f0ebf35,0xbe483f6d,0xbf55bf35,0x3f7b3ec4,0x3f62bec4,0xbf463f0e,0x3e95bf6d,0xbdc93f7b
.long 0x3f800000,0xbf80250d,0x3f800000,0xbf80250d,0x3f623ec4,0xbf46bf0e,0x3e953f6d,0xbdc9bf7b
.long 0x3f0e3f35,0xbe48bf6d,0xbf553f35,0x3f7bbec4,0x3dc93f6d,0x3ef1bf7b,0xbf46bec4,0x3e953f55
.long 0xbec43f80,0x3f6dbf35,0x3ec4bf80,0xbf6d3f35,0xbf463f6d,0x3f75be48,0x3f7fbec4,0xbef1bf0e
.long 0xbf7b3f35,0x3f0e3ec4,0x3e483f35,0x3f55bf6d,0xbf753ec4,0xbdc93f55,0xbf623f6d,0x3f223e48
.long 0xbf35250d,0xbf353f80,0xbf35250d,0xbf353f80,0xbe95bec4,0xbf7f3f55,0x3ef1bf6d,0xbf463e48
.long 0x3e48bf35,0xbf553ec4,0x3f7bbf35,0x3f0ebf6d,0x3f22bf6d,0xbe95be48,0x3dc93ec4,0x3f62bf0e
.long 0x3f6dbf80,0x3ec4bf35,0xbf6d3f80,0xbec43f35,0x3f7fbf6d,0x3f62bf7b,0xbf223ec4,0xbf753f55
.long 0x3f55bf35,0x3f7bbf6d,0x3f0ebf35,0x3e48bec4,0x3ef1bec4,0x3f22bf0e,0x3f75bf6d,0x3f7fbf7b
.long 0x0,0x0,0x0,0x0,0x3f7f3f80,0x3f753f7b,0x3f223f35,0x3ef13f0e
.long 0xbe48250d,0xbf0ebec4,0xbf7bbf80,0xbf55bf6d,0xbf75bf80,0xbf22bf55,0x3f623f35,0x3f7f3f7b
.long 0x3ec40000,0x3f6d3f35,0xbec4250d,0xbf6dbf35,0x3f623f80,0x3dc93f0e,0xbe95bf35,0x3f223e48
.long 0xbf0e250d,0xbf7bbf6d,0x3f553f80,0xbe483ec4,0xbf46bf80,0x3ef1be48,0xbf7fbf35,0xbe95bf55
.long 0x3f350000,0x3f353f80,0x3f350000,0x3f353f80,0x3f223f80,0xbf62be48,0xbdc93f35,0xbf75bf55
.long 0xbf55250d,0xbe48bf6d,0xbf0ebf80,0x3f7b3ec4,0xbef1bf80,0x3f7f3f0e,0x3f753f35,0xbf463e48
.long 0x3f6d0000,0xbec43f35,0xbf6d250d,0x3ec4bf35,0x3e953f80,0xbf46bf55,0x3ef1bf35,0x3dc93f7b
.long 0xbf7b250d,0x3f55bec4,0x3e483f80,0xbf0ebf6d,0xbdc9bf80,0x3e953f7b,0xbf46bf35,0x3f623f0e
.long 0x3f800000,0xbf80250d,0x3f800000,0xbf80250d,0xbdc93f80,0x3e95bf7b,0xbf463f35,0x3f62bf0e
.long 0xbf7b250d,0x3f553ec4,0x3e48bf80,0xbf0e3f6d,0x3e95bf80,0xbf463f55,0x3ef13f35,0x3dc9bf7b
.long 0x3f6d0000,0xbec4bf35,0xbf6d250d,0x3ec43f35,0xbef13f80,0x3f7fbf0e,0x3f75bf35,0xbf46be48
.long 0xbf55250d,0xbe483f6d,0xbf0e3f80,0x3f7bbec4,0x3f22bf80,0xbf623e48,0xbdc9bf35,0xbf753f55
.long 0x3f350000,0x3f35bf80,0x3f350000,0x3f35bf80,0xbf463f80,0x3ef13e48,0xbf7f3f35,0xbe953f55
.long 0xbf0e250d,0xbf7b3f6d,0x3f55bf80,0xbe48bec4,0x3f62bf80,0x3dc9bf0e,0xbe953f35,0x3f22be48
.long 0x3ec40000,0x3f6dbf35,0xbec4250d,0xbf6d3f35,0xbf753f80,0xbf223f55,0x3f62bf35,0x3f7fbf7b
.long 0xbe48250d,0xbf0e3ec4,0xbf7b3f80,0xbf553f6d,0x3f7fbf80,0x3f75bf7b,0x3f22bf35,0x3ef1bf0e
.long 0x0,0x0,0x0,0x0,0x3f623f6d,0x3f463f55,0x3e953ec4,0x3dc93e48
.long 0xbf55bf35,0xbf7bbf6d,0xbf0ebf35,0xbe48bec4,0xbdc9bec4,0x3ef13e48,0x3f463f6d,0x3e953f0e
.long 0x3f6d3f80,0x3ec43f35,0xbf6dbf80,0xbec4bf35,0xbf46bec4,0xbf75bf7b,0x3f7f3f6d,0x3ef13f55
.long 0xbe48bf35,0x3f553ec4,0xbf7bbf35,0xbf0ebf6d,0x3f753f6d,0xbdc93f0e,0x3f623ec4,0x3f223f7b
.long 0xbf35250d,0xbf35bf80,0xbf35250d,0xbf35bf80,0xbe95bf6d,0x3f7f3f0e,0x3ef1bec4,0x3f463f7b
.long 0x3f7b3f35,0xbf0e3ec4,0xbe483f35,0xbf55bf6d,0xbf223ec4,0xbe95bf7b,0xbdc9bf6d,0x3f623f55
.long 0xbec4bf80,0x3f6d3f35,0x3ec43f80,0xbf6dbf35,0x3f7f3ec4,0xbf623e48,0xbf22bf6d,0x3f753f0e
.long 0xbf0e3f35,0x3e48bf6d,0x3f553f35,0xbf7bbec4,0xbef1bf6d,0x3f223f55,0xbf75bec4,0x3f7f3e48
.long 0x3f800000,0xbf80250d,0x3f800000,0xbf80250d,0xbef13f6d,0x3f22bf55,0xbf753ec4,0x3f7fbe48
.long 0xbf0ebf35,0x3e483f6d,0x3f55bf35,0xbf7b3ec4,0x3f7fbec4,0xbf62be48,0xbf223f6d,0x3f75bf0e
.long 0xbec43f80,0x3f6dbf35,0x3ec4bf80,0xbf6d3f35,0xbf22bec4,0xbe953f7b,0xbdc93f6d,0x3f62bf55
.long 0x3f7bbf35,0xbf0ebec4,0xbe48bf35,0xbf553f6d,0xbe953f6d,0x3f7fbf0e,0x3ef13ec4,0x3f46bf7b
.long 0xbf35250d,0xbf353f80,0xbf35250d,0xbf353f80,0x3f75bf6d,0xbdc9bf0e,0x3f62bec4,0x3f22bf7b
.long 0xbe483f35,0x3f55bec4,0xbf7b3f35,0xbf0e3f6d,0xbf463ec4,0xbf753f7b,0x3f7fbf6d,0x3ef1bf55
.long 0x3f6dbf80,0x3ec4bf35,0xbf6d3f80,0xbec43f35,0xbdc93ec4,0x3ef1be48,0x3f46bf6d,0x3e95bf0e
.long 0xbf553f35,0xbf7b3f6d,0xbf0e3f35,0xbe483ec4,0x3f62bf6d,0x3f46bf55,0x3e95bec4,0x3dc9be48
.long 0x0,0x0,0x0,0x0,0xbdc9250d,0xbe95be48,0xbf46bf35,0xbf62bf55
.long 0x3e480000,0x3f0e3ec4,0x3f7b3f80,0x3f553f6d,0xbe95250d,0xbf46bf0e,0xbef1bf35,0x3dc9be48
.long 0x3ec40000,0x3f6d3f35,0xbec4250d,0xbf6dbf35,0xbef1250d,0xbf7fbf55,0x3f753f35,0x3f463f7b
.long 0x3f0e0000,0x3f7b3f6d,0xbf55bf80,0x3e48bec4,0xbf22250d,0xbf62bf7b,0x3dc93f35,0xbf75bf0e
.long 0x3f350000,0x3f353f80,0x3f350000,0x3f353f80,0xbf46250d,0xbef1bf7b,0xbf7fbf35,0x3e95bf0e
.long 0x3f550000,0x3e483f6d,0x3f0e3f80,0xbf7bbec4,0xbf62250d,0x3dc9bf55,0x3e95bf35,0x3f223f7b
.long 0x3f6d0000,0xbec43f35,0xbf6d250d,0x3ec4bf35,0xbf75250d,0x3f22bf0e,0x3f623f35,0xbf7fbe48
.long 0x3f7b0000,0xbf553ec4,0xbe48bf80,0x3f0e3f6d,0xbf7f250d,0x3f75be48,0xbf223f35,0x3ef1bf55
.long 0x3f800000,0xbf80250d,0x3f800000,0xbf80250d,0xbf7f250d,0x3f753e48,0xbf22bf35,0x3ef13f55
.long 0x3f7b0000,0xbf55bec4,0xbe483f80,0x3f0ebf6d,0xbf75250d,0x3f223f0e,0x3f62bf35,0xbf7f3e48
.long 0x3f6d0000,0xbec4bf35,0xbf6d250d,0x3ec43f35,0xbf62250d,0x3dc93f55,0x3e953f35,0x3f22bf7b
.long 0x3f550000,0x3e48bf6d,0x3f0ebf80,0xbf7b3ec4,0xbf46250d,0xbef13f7b,0xbf7f3f35,0x3e953f0e
.long 0x3f350000,0x3f35bf80,0x3f350000,0x3f35bf80,0xbf22250d,0xbf623f7b,0x3dc9bf35,0xbf753f0e
.long 0x3f0e0000,0x3f7bbf6d,0xbf553f80,0x3e483ec4,0xbef1250d,0xbf7f3f55,0x3f75bf35,0x3f46bf7b
.long 0x3ec40000,0x3f6dbf35,0xbec4250d,0xbf6d3f35,0xbe95250d,0xbf463f0e,0xbef13f35,0x3dc93e48
.long 0x3e480000,0x3f0ebec4,0x3f7bbf80,0x3f55bf6d,0xbdc9250d,0xbe953e48,0xbf463f35,0xbf623f55
.long 0x0,0x0,0x0,0x0,0xbef1bec4,0xbf22bf0e,0xbf75bf6d,0xbf7fbf7b
.long 0x3f553f35,0x3f7b3f6d,0x3f0e3f35,0x3e483ec4,0xbf7fbf6d,0xbf62bf7b,0x3f223ec4,0x3f753f55
.long 0x3f6d3f80,0x3ec43f35,0xbf6dbf80,0xbec4bf35,0xbf22bf6d,0x3e95be48,0xbdc93ec4,0xbf62bf0e
.long 0x3e483f35,0xbf55bec4,0x3f7b3f35,0x3f0e3f6d,0x3e95bec4,0x3f7f3f55,0xbef1bf6d,0x3f463e48
.long 0xbf35250d,0xbf35bf80,0xbf35250d,0xbf35bf80,0x3f753ec4,0x3dc93f55,0x3f623f6d,0xbf223e48
.long 0xbf7bbf35,0x3f0ebec4,0x3e48bf35,0x3f553f6d,0x3f463f6d,0xbf75be48,0xbf7fbec4,0x3ef1bf0e
.long 0xbec4bf80,0x3f6d3f35,0x3ec43f80,0xbf6dbf35,0xbdc93f6d,0xbef1bf7b,0x3f46bec4,0xbe953f55
.long 0x3f0ebf35,0xbe483f6d,0xbf55bf35,0x3f7b3ec4,0xbf623ec4,0x3f46bf0e,0xbe953f6d,0x3dc9bf7b
.long 0x3f800000,0xbf80250d,0x3f800000,0xbf80250d,0xbf62bec4,0x3f463f0e,0xbe95bf6d,0x3dc93f7b
.long 0x3f0e3f35,0xbe48bf6d,0xbf553f35,0x3f7bbec4,0xbdc9bf6d,0xbef13f7b,0x3f463ec4,0xbe95bf55
.long 0xbec43f80,0x3f6dbf35,0x3ec4bf80,0xbf6d3f35,0x3f46bf6d,0xbf753e48,0xbf7f3ec4,0x3ef13f0e
.long 0xbf7b3f35,0x3f0e3ec4,0x3e483f35,0x3f55bf6d,0x3f75bec4,0x3dc9bf55,0x3f62bf6d,0xbf22be48
.long 0xbf35250d,0xbf353f80,0xbf35250d,0xbf353f80,0x3e953ec4,0x3f7fbf55,0xbef13f6d,0x3f46be48
.long 0x3e48bf35,0xbf553ec4,0x3f7bbf35,0x3f0ebf6d,0xbf223f6d,0x3e953e48,0xbdc9bec4,0xbf623f0e
.long 0x3f6dbf80,0x3ec4bf35,0xbf6d3f80,0xbec43f35,0xbf7f3f6d,0xbf623f7b,0x3f22bec4,0x3f75bf55
.long 0x3f55bf35,0x3f7bbf6d,0x3f0ebf35,0x3e48bec4,0xbef13ec4,0xbf223f0e,0xbf753f6d,0xbf7f3f7b
.long 0x0,0x0,0x0,0x0,0xbf7fbf80,0xbf75bf7b,0xbf22bf35,0xbef1bf0e
.long 0xbe48250d,0xbf0ebec4,0xbf7bbf80,0xbf55bf6d,0x3f753f80,0x3f223f55,0xbf62bf35,0xbf7fbf7b
.long 0x3ec40000,0x3f6d3f35,0xbec4250d,0xbf6dbf35,0xbf62bf80,0xbdc9bf0e,0x3e953f35,0xbf22be48
.long 0xbf0e250d,0xbf7bbf6d,0x3f553f80,0xbe483ec4,0x3f463f80,0xbef13e48,0x3f7f3f35,0x3e953f55
.long 0x3f350000,0x3f353f80,0x3f350000,0x3f353f80,0xbf22bf80,0x3f623e48,0x3dc9bf35,0x3f753f55
.long 0xbf55250d,0xbe48bf6d,0xbf0ebf80,0x3f7b3ec4,0x3ef13f80,0xbf7fbf0e,0xbf75bf35,0x3f46be48
.long 0x3f6d0000,0xbec43f35,0xbf6d250d,0x3ec4bf35,0xbe95bf80,0x3f463f55,0xbef13f35,0xbdc9bf7b
.long 0xbf7b250d,0x3f55bec4,0x3e483f80,0xbf0ebf6d,0x3dc93f80,0xbe95bf7b,0x3f463f35,0xbf62bf0e
.long 0x3f800000,0xbf80250d,0x3f800000,0xbf80250d,0x3dc9bf80,0xbe953f7b,0x3f46bf35,0xbf623f0e
.long 0xbf7b250d,0x3f553ec4,0x3e48bf80,0xbf0e3f6d,0xbe953f80,0x3f46bf55,0xbef1bf35,0xbdc93f7b
.long 0x3f6d0000,0xbec4bf35,0xbf6d250d,0x3ec43f35,0x3ef1bf80,0xbf7f3f0e,0xbf753f35,0x3f463e48
.long 0xbf55250d,0xbe483f6d,0xbf0e3f80,0x3f7bbec4,0xbf223f80,0x3f62be48,0x3dc93f35,0x3f75bf55
.long 0x3f350000,0x3f35bf80,0x3f350000,0x3f35bf80,0x3f46bf80,0xbef1be48,0x3f7fbf35,0x3e95bf55
.long 0xbf0e250d,0xbf7b3f6d,0x3f55bf80,0xbe48bec4,0xbf623f80,0xbdc93f0e,0x3e95bf35,0xbf223e48
.long 0x3ec40000,0x3f6dbf35,0xbec4250d,0xbf6d3f35,0x3f75bf80,0x3f22bf55,0xbf623f35,0xbf7f3f7b
.long 0xbe48250d,0xbf0e3ec4,0xbf7b3f80,0xbf553f6d,0xbf7f3f80,0xbf753f7b,0xbf223f35,0xbef13f0e
.long 0x0,0x0,0x0,0x0,0xbf62bf6d,0xbf46bf55,0xbe95bec4,0xbdc9be48
.long 0xbf55bf35,0xbf7bbf6d,0xbf0ebf35,0xbe48bec4,0x3dc93ec4,0xbef1be48,0xbf46bf6d,0xbe95bf0e
.long 0x3f6d3f80,0x3ec43f35,0xbf6dbf80,0xbec4bf35,0x3f463ec4,0x3f753f7b,0xbf7fbf6d,0xbef1bf55
.long 0xbe48bf35,0x3f553ec4,0xbf7bbf35,0xbf0ebf6d,0xbf75bf6d,0x3dc9bf0e,0xbf62bec4,0xbf22bf7b
.long 0xbf35250d,0xbf35bf80,0xbf35250d,0xbf35bf80,0x3e953f6d,0xbf7fbf0e,0xbef13ec4,0xbf46bf7b
.long 0x3f7b3f35,0xbf0e3ec4,0xbe483f35,0xbf55bf6d,0x3f22bec4,0x3e953f7b,0x3dc93f6d,0xbf62bf55
.long 0xbec4bf80,0x3f6d3f35,0x3ec43f80,0xbf6dbf35,0xbf7fbec4,0x3f62be48,0x3f223f6d,0xbf75bf0e
.long 0xbf0e3f35,0x3e48bf6d,0x3f553f35,0xbf7bbec4,0x3ef13f6d,0xbf22bf55,0x3f753ec4,0xbf7fbe48
.long 0x3f800000,0xbf80250d,0x3f800000,0xbf80250d,0x3ef1bf6d,0xbf223f55,0x3f75bec4,0xbf7f3e48
.long 0xbf0ebf35,0x3e483f6d,0x3f55bf35,0xbf7b3ec4,0xbf7f3ec4,0x3f623e48,0x3f22bf6d,0xbf753f0e
.long 0xbec43f80,0x3f6dbf35,0x3ec4bf80,0xbf6d3f35,0x3f223ec4,0x3e95bf7b,0x3dc9bf6d,0xbf623f55
.long 0x3f7bbf35,0xbf0ebec4,0xbe48bf35,0xbf553f6d,0x3e95bf6d,0xbf7f3f0e,0xbef1bec4,0xbf463f7b
.long 0xbf35250d,0xbf353f80,0xbf35250d,0xbf353f80,0xbf753f6d,0x3dc93f0e,0xbf623ec4,0xbf223f7b
.long 0xbe483f35,0x3f55bec4,0xbf7b3f35,0xbf0e3f6d,0x3f46bec4,0x3f75bf7b,0xbf7f3f6d,0xbef13f55
.long 0x3f6dbf80,0x3ec4bf35,0xbf6d3f80,0xbec43f35,0x3dc9bec4,0xbef13e48,0xbf463f6d,0xbe953f0e
.long 0xbf553f35,0xbf7b3f6d,0xbf0e3f35,0xbe483ec4,0xbf623f6d,0xbf463f55,0xbe953ec4,0xbdc93e48
.long 0x250d0000,0x250d0000,0x250d0000,0x250d0000,0xbdc90000,0xbe953e48,0xbf463f35,0xbf623f55
.long 0xbe480000,0xbf0e3ec4,0xbf7b3f80,0xbf553f6d,0xbe950000,0xbf463f0e,0xbef13f35,0x3dc93e48
.long 0xbec40000,0xbf6d3f35,0x3ec4250d,0x3f6dbf35,0xbef10000,0xbf7f3f55,0x3f75bf35,0x3f46bf7b
.long 0xbf0e0000,0xbf7b3f6d,0x3f55bf80,0xbe48bec4,0xbf220000,0xbf623f7b,0x3dc9bf35,0xbf753f0e
.long 0xbf350000,0xbf353f80,0xbf350000,0xbf353f80,0xbf460000,0xbef13f7b,0xbf7f3f35,0x3e953f0e
.long 0xbf550000,0xbe483f6d,0xbf0e3f80,0x3f7bbec4,0xbf620000,0x3dc93f55,0x3e953f35,0x3f22bf7b
.long 0xbf6d0000,0x3ec43f35,0x3f6d250d,0xbec4bf35,0xbf750000,0x3f223f0e,0x3f62bf35,0xbf7f3e48
.long 0xbf7b0000,0x3f553ec4,0x3e48bf80,0xbf0e3f6d,0xbf7f0000,0x3f753e48,0xbf22bf35,0x3ef13f55
.long 0xbf800000,0x3f80250d,0xbf800000,0x3f80250d,0xbf7f0000,0x3f75be48,0xbf223f35,0x3ef1bf55
.long 0xbf7b0000,0x3f55bec4,0x3e483f80,0xbf0ebf6d,0xbf750000,0x3f22bf0e,0x3f623f35,0xbf7fbe48
.long 0xbf6d0000,0x3ec4bf35,0x3f6d250d,0xbec43f35,0xbf620000,0x3dc9bf55,0x3e95bf35,0x3f223f7b
.long 0xbf550000,0xbe48bf6d,0xbf0ebf80,0x3f7b3ec4,0xbf460000,0xbef1bf7b,0xbf7fbf35,0x3e95bf0e
.long 0xbf350000,0xbf35bf80,0xbf350000,0xbf35bf80,0xbf220000,0xbf62bf7b,0x3dc93f35,0xbf75bf0e
.long 0xbf0e0000,0xbf7bbf6d,0x3f553f80,0xbe483ec4,0xbef10000,0xbf7fbf55,0x3f753f35,0x3f463f7b
.long 0xbec40000,0xbf6dbf35,0x3ec4250d,0x3f6d3f35,0xbe950000,0xbf46bf0e,0xbef1bf35,0x3dc9be48
.long 0xbe480000,0xbf0ebec4,0xbf7bbf80,0xbf55bf6d,0xbdc90000,0xbe95be48,0xbf46bf35,0xbf62bf55
.long 0x250d0000,0x250d0000,0x250d0000,0x250d0000,0xbef13ec4,0xbf223f0e,0xbf753f6d,0xbf7f3f7b
.long 0xbf553f35,0xbf7b3f6d,0xbf0e3f35,0xbe483ec4,0xbf7f3f6d,0xbf623f7b,0x3f22bec4,0x3f75bf55
.long 0xbf6d3f80,0xbec43f35,0x3f6dbf80,0x3ec4bf35,0xbf223f6d,0x3e953e48,0xbdc9bec4,0xbf623f0e
.long 0xbe483f35,0x3f55bec4,0xbf7b3f35,0xbf0e3f6d,0x3e953ec4,0x3f7fbf55,0xbef13f6d,0x3f46be48
.long 0x3f35250d,0x3f35bf80,0x3f35250d,0x3f35bf80,0x3f75bec4,0x3dc9bf55,0x3f62bf6d,0xbf22be48
.long 0x3f7bbf35,0xbf0ebec4,0xbe48bf35,0xbf553f6d,0x3f46bf6d,0xbf753e48,0xbf7f3ec4,0x3ef13f0e
.long 0x3ec4bf80,0xbf6d3f35,0xbec43f80,0x3f6dbf35,0xbdc9bf6d,0xbef13f7b,0x3f463ec4,0xbe95bf55
.long 0xbf0ebf35,0x3e483f6d,0x3f55bf35,0xbf7b3ec4,0xbf62bec4,0x3f463f0e,0xbe95bf6d,0x3dc93f7b
.long 0xbf800000,0x3f80250d,0xbf800000,0x3f80250d,0xbf623ec4,0x3f46bf0e,0xbe953f6d,0x3dc9bf7b
.long 0xbf0e3f35,0x3e48bf6d,0x3f553f35,0xbf7bbec4,0xbdc93f6d,0xbef1bf7b,0x3f46bec4,0xbe953f55
.long 0x3ec43f80,0xbf6dbf35,0xbec4bf80,0x3f6d3f35,0x3f463f6d,0xbf75be48,0xbf7fbec4,0x3ef1bf0e
.long 0x3f7b3f35,0xbf0e3ec4,0xbe483f35,0xbf55bf6d,0x3f753ec4,0x3dc93f55,0x3f623f6d,0xbf223e48
.long 0x3f35250d,0x3f353f80,0x3f35250d,0x3f353f80,0x3e95bec4,0x3f7f3f55,0xbef1bf6d,0x3f463e48
.long 0xbe48bf35,0x3f553ec4,0xbf7bbf35,0xbf0ebf6d,0xbf22bf6d,0x3e95be48,0xbdc93ec4,0xbf62bf0e
.long 0xbf6dbf80,0xbec4bf35,0x3f6d3f80,0x3ec43f35,0xbf7fbf6d,0xbf62bf7b,0x3f223ec4,0x3f753f55
.long 0xbf55bf35,0xbf7bbf6d,0xbf0ebf35,0xbe48bec4,0xbef1bec4,0xbf22bf0e,0xbf75bf6d,0xbf7fbf7b
.long 0x250d0000,0x250d0000,0x250d0000,0x250d0000,0xbf7f3f80,0xbf753f7b,0xbf223f35,0xbef13f0e
.long 0x3e48250d,0x3f0ebec4,0x3f7bbf80,0x3f55bf6d,0x3f75bf80,0x3f22bf55,0xbf623f35,0xbf7f3f7b
.long 0xbec40000,0xbf6d3f35,0x3ec4250d,0x3f6dbf35,0xbf623f80,0xbdc93f0e,0x3e95bf35,0xbf223e48
.long 0x3f0e250d,0x3f7bbf6d,0xbf553f80,0x3e483ec4,0x3f46bf80,0xbef1be48,0x3f7fbf35,0x3e95bf55
.long 0xbf350000,0xbf353f80,0xbf350000,0xbf353f80,0xbf223f80,0x3f62be48,0x3dc93f35,0x3f75bf55
.long 0x3f55250d,0x3e48bf6d,0x3f0ebf80,0xbf7b3ec4,0x3ef1bf80,0xbf7f3f0e,0xbf753f35,0x3f463e48
.long 0xbf6d0000,0x3ec43f35,0x3f6d250d,0xbec4bf35,0xbe953f80,0x3f46bf55,0xbef1bf35,0xbdc93f7b
.long 0x3f7b250d,0xbf55bec4,0xbe483f80,0x3f0ebf6d,0x3dc9bf80,0xbe953f7b,0x3f46bf35,0xbf623f0e
.long 0xbf800000,0x3f80250d,0xbf800000,0x3f80250d,0x3dc93f80,0xbe95bf7b,0x3f463f35,0xbf62bf0e
.long 0x3f7b250d,0xbf553ec4,0xbe48bf80,0x3f0e3f6d,0xbe95bf80,0x3f463f55,0xbef13f35,0xbdc9bf7b
.long 0xbf6d0000,0x3ec4bf35,0x3f6d250d,0xbec43f35,0x3ef13f80,0xbf7fbf0e,0xbf75bf35,0x3f46be48
.long 0x3f55250d,0x3e483f6d,0x3f0e3f80,0xbf7bbec4,0xbf22bf80,0x3f623e48,0x3dc9bf35,0x3f753f55
.long 0xbf350000,0xbf35bf80,0xbf350000,0xbf35bf80,0x3f463f80,0xbef13e48,0x3f7f3f35,0x3e953f55
.long 0x3f0e250d,0x3f7b3f6d,0xbf55bf80,0x3e48bec4,0xbf62bf80,0xbdc9bf0e,0x3e953f35,0xbf22be48
.long 0xbec40000,0xbf6dbf35,0x3ec4250d,0x3f6d3f35,0x3f753f80,0x3f223f55,0xbf62bf35,0xbf7fbf7b
.long 0x3e48250d,0x3f0e3ec4,0x3f7b3f80,0x3f553f6d,0xbf7fbf80,0xbf75bf7b,0xbf22bf35,0xbef1bf0e
.long 0x250d0000,0x250d0000,0x250d0000,0x250d0000,0xbf623f6d,0xbf463f55,0xbe953ec4,0xbdc93e48
.long 0x3f55bf35,0x3f7bbf6d,0x3f0ebf35,0x3e48bec4,0x3dc9bec4,0xbef13e48,0xbf463f6d,0xbe953f0e
.long 0xbf6d3f80,0xbec43f35,0x3f6dbf80,0x3ec4bf35,0x3f46bec4,0x3f75bf7b,0xbf7f3f6d,0xbef13f55
.long 0x3e48bf35,0xbf553ec4,0x3f7bbf35,0x3f0ebf6d,0xbf753f6d,0x3dc93f0e,0xbf623ec4,0xbf223f7b
.long 0x3f35250d,0x3f35bf80,0x3f35250d,0x3f35bf80,0x3e95bf6d,0xbf7f3f0e,0xbef1bec4,0xbf463f7b
.long 0xbf7b3f35,0x3f0e3ec4,0x3e483f35,0x3f55bf6d,0x3f223ec4,0x3e95bf7b,0x3dc9bf6d,0xbf623f55
.long 0x3ec4bf80,0xbf6d3f35,0xbec43f80,0x3f6dbf35,0xbf7f3ec4,0x3f623e48,0x3f22bf6d,0xbf753f0e
.long 0x3f0e3f35,0xbe48bf6d,0xbf553f35,0x3f7bbec4,0x3ef1bf6d,0xbf223f55,0x3f75bec4,0xbf7f3e48
.long 0xbf800000,0x3f80250d,0xbf800000,0x3f80250d,0x3ef13f6d,0xbf22bf55,0x3f753ec4,0xbf7fbe48
.long 0x3f0ebf35,0xbe483f6d,0xbf55bf35,0x3f7b3ec4,0xbf7fbec4,0x3f62be48,0x3f223f6d,0xbf75bf0e
.long 0x3ec43f80,0xbf6dbf35,0xbec4bf80,0x3f6d3f35,0x3f22bec4,0x3e953f7b,0x3dc93f6d,0xbf62bf55
.long 0xbf7bbf35,0x3f0ebec4,0x3e48bf35,0x3f553f6d,0x3e953f6d,0xbf7fbf0e,0xbef13ec4,0xbf46bf7b
.long 0x3f35250d,0x3f353f80,0x3f35250d,0x3f353f80,0xbf75bf6d,0x3dc9bf0e,0xbf62bec4,0xbf22bf7b
.long 0x3e483f35,0xbf55bec4,0x3f7b3f35,0x3f0e3f6d,0x3f463ec4,0x3f753f7b,0xbf7fbf6d,0xbef1bf55
.long 0xbf6dbf80,0xbec4bf35,0x3f6d3f80,0x3ec43f35,0x3dc93ec4,0xbef1be48,0xbf46bf6d,0xbe95bf0e
.long 0x3f553f35,0x3f7b3f6d,0x3f0e3f35,0x3e483ec4,0xbf62bf6d,0xbf46bf55,0xbe95bec4,0xbdc9be48
.long 0x250d0000,0x250d0000,0x250d0000,0x250d0000,0x3dc9250d,0x3e95be48,0x3f46bf35,0x3f62bf55
.long 0xbe480000,0xbf0e3ec4,0xbf7b3f80,0xbf553f6d,0x3e95250d,0x3f46bf0e,0x3ef1bf35,0xbdc9be48
.long 0xbec40000,0xbf6d3f35,0x3ec4250d,0x3f6dbf35,0x3ef1250d,0x3f7fbf55,0xbf753f35,0xbf463f7b
.long 0xbf0e0000,0xbf7b3f6d,0x3f55bf80,0xbe48bec4,0x3f22250d,0x3f62bf7b,0xbdc93f35,0x3f75bf0e
.long 0xbf350000,0xbf353f80,0xbf350000,0xbf353f80,0x3f46250d,0x3ef1bf7b,0x3f7fbf35,0xbe95bf0e
.long 0xbf550000,0xbe483f6d,0xbf0e3f80,0x3f7bbec4,0x3f62250d,0xbdc9bf55,0xbe95bf35,0xbf223f7b
.long 0xbf6d0000,0x3ec43f35,0x3f6d250d,0xbec4bf35,0x3f75250d,0xbf22bf0e,0xbf623f35,0x3f7fbe48
.long 0xbf7b0000,0x3f553ec4,0x3e48bf80,0xbf0e3f6d,0x3f7f250d,0xbf75be48,0x3f223f35,0xbef1bf55
.long 0xbf800000,0x3f80250d,0xbf800000,0x3f80250d,0x3f7f250d,0xbf753e48,0x3f22bf35,0xbef13f55
.long 0xbf7b0000,0x3f55bec4,0x3e483f80,0xbf0ebf6d,0x3f75250d,0xbf223f0e,0xbf62bf35,0x3f7f3e48
.long 0xbf6d0000,0x3ec4bf35,0x3f6d250d,0xbec43f35,0x3f62250d,0xbdc93f55,0xbe953f35,0xbf22bf7b
.long 0xbf550000,0xbe48bf6d,0xbf0ebf80,0x3f7b3ec4,0x3f46250d,0x3ef13f7b,0x3f7f3f35,0xbe953f0e
.long 0xbf350000,0xbf35bf80,0xbf350000,0xbf35bf80,0x3f22250d,0x3f623f7b,0xbdc9bf35,0x3f753f0e
.long 0xbf0e0000,0xbf7bbf6d,0x3f553f80,0xbe483ec4,0x3ef1250d,0x3f7f3f55,0xbf75bf35,0xbf46bf7b
.long 0xbec40000,0xbf6dbf35,0x3ec4250d,0x3f6d3f35,0x3e95250d,0x3f463f0e,0x3ef13f35,0xbdc93e48
.long 0xbe480000,0xbf0ebec4,0xbf7bbf80,0xbf55bf6d,0x3dc9250d,0x3e953e48,0x3f463f35,0x3f623f55
.long 0x250d0000,0x250d0000,0x250d0000,0x250d0000,0x3ef1bec4,0x3f22bf0e,0x3f75bf6d,0x3f7fbf7b
.long 0xbf553f35,0xbf7b3f6d,0xbf0e3f35,0xbe483ec4,0x3f7fbf6d,0x3f62bf7b,0xbf223ec4,0xbf753f55
.long 0xbf6d3f80,0xbec43f35,0x3f6dbf80,0x3ec4bf35,0x3f22bf6d,0xbe95be48,0x3dc93ec4,0x3f62bf0e
.long 0xbe483f35,0x3f55bec4,0xbf7b3f35,0xbf0e3f6d,0xbe95bec4,0xbf7f3f55,0x3ef1bf6d,0xbf463e48
.long 0x3f35250d,0x3f35bf80,0x3f35250d,0x3f35bf80,0xbf753ec4,0xbdc93f55,0xbf623f6d,0x3f223e48
.long 0x3f7bbf35,0xbf0ebec4,0xbe48bf35,0xbf553f6d,0xbf463f6d,0x3f75be48,0x3f7fbec4,0xbef1bf0e
.long 0x3ec4bf80,0xbf6d3f35,0xbec43f80,0x3f6dbf35,0x3dc93f6d,0x3ef1bf7b,0xbf46bec4,0x3e953f55
.long 0xbf0ebf35,0x3e483f6d,0x3f55bf35,0xbf7b3ec4,0x3f623ec4,0xbf46bf0e,0x3e953f6d,0xbdc9bf7b
.long 0xbf800000,0x3f80250d,0xbf800000,0x3f80250d,0x3f62bec4,0xbf463f0e,0x3e95bf6d,0xbdc93f7b
.long 0xbf0e3f35,0x3e48bf6d,0x3f553f35,0xbf7bbec4,0x3dc9bf6d,0x3ef13f7b,0xbf463ec4,0x3e95bf55
.long 0x3ec43f80,0xbf6dbf35,0xbec4bf80,0x3f6d3f35,0xbf46bf6d,0x3f753e48,0x3f7f3ec4,0xbef13f0e
.long 0x3f7b3f35,0xbf0e3ec4,0xbe483f35,0xbf55bf6d,0xbf75bec4,0xbdc9bf55,0xbf62bf6d,0x3f22be48
.long 0x3f35250d,0x3f353f80,0x3f35250d,0x3f353f80,0xbe953ec4,0xbf7fbf55,0x3ef13f6d,0xbf46be48
.long 0xbe48bf35,0x3f553ec4,0xbf7bbf35,0xbf0ebf6d,0x3f223f6d,0xbe953e48,0x3dc9bec4,0x3f623f0e
.long 0xbf6dbf80,0xbec4bf35,0x3f6d3f80,0x3ec43f35,0x3f7f3f6d,0x3f623f7b,0xbf22bec4,0xbf75bf55
.long 0xbf55bf35,0xbf7bbf6d,0xbf0ebf35,0xbe48bec4,0x3ef13ec4,0x3f223f0e,0x3f753f6d,0x3f7f3f7b
.long 0x250d0000,0x250d0000,0x250d0000,0x250d0000,0x3f7fbf80,0x3f75bf7b,0x3f22bf35,0x3ef1bf0e
.long 0x3e48250d,0x3f0ebec4,0x3f7bbf80,0x3f55bf6d,0xbf753f80,0xbf223f55,0x3f62bf35,0x3f7fbf7b
.long 0xbec40000,0xbf6d3f35,0x3ec4250d,0x3f6dbf35,0x3f62bf80,0x3dc9bf0e,0xbe953f35,0x3f22be48
.long 0x3f0e250d,0x3f7bbf6d,0xbf553f80,0x3e483ec4,0xbf463f80,0x3ef13e48,0xbf7f3f35,0xbe953f55
.long 0xbf350000,0xbf353f80,0xbf350000,0xbf353f80,0x3f22bf80,0xbf623e48,0xbdc9bf35,0xbf753f55
.long 0x3f55250d,0x3e48bf6d,0x3f0ebf80,0xbf7b3ec4,0xbef13f80,0x3f7fbf0e,0x3f75bf35,0xbf46be48
.long 0xbf6d0000,0x3ec43f35,0x3f6d250d,0xbec4bf35,0x3e95bf80,0xbf463f55,0x3ef13f35,0x3dc9bf7b
.long 0x3f7b250d,0xbf55bec4,0xbe483f80,0x3f0ebf6d,0xbdc93f80,0x3e95bf7b,0xbf463f35,0x3f62bf0e
.long 0xbf800000,0x3f80250d,0xbf800000,0x3f80250d,0xbdc9bf80,0x3e953f7b,0xbf46bf35,0x3f623f0e
.long 0x3f7b250d,0xbf553ec4,0xbe48bf80,0x3f0e3f6d,0x3e953f80,0xbf46bf55,0x3ef1bf35,0x3dc93f7b
.long 0xbf6d0000,0x3ec4bf35,0x3f6d250d,0xbec43f35,0xbef1bf80,0x3f7f3f0e,0x3f753f35,0xbf463e48
.long 0x3f55250d,0x3e483f6d,0x3f0e3f80,0xbf7bbec4,0x3f223f80,0xbf62be48,0xbdc93f35,0xbf75bf55
.long 0xbf350000,0xbf35bf80,0xbf350000,0xbf35bf80,0xbf46bf80,0x3ef1be48,0xbf7fbf35,0xbe95bf55
.long 0x3f0e250d,0x3f7b3f6d,0xbf55bf80,0x3e48bec4,0x3f623f80,0x3dc93f0e,0xbe95bf35,0x3f223e48
.long 0xbec40000,0xbf6dbf35,0x3ec4250d,0x3f6d3f35,0xbf75bf80,0xbf22bf55,0x3f623f35,0x3f7f3f7b
.long 0x3e48250d,0x3f0e3ec4,0x3f7b3f80,0x3f553f6d,0x3f7f3f80,0x3f753f7b,0x3f223f35,0x3ef13f0e
.long 0x250d0000,0x250d0000,0x250d0000,0x250d0000,0x3f62bf6d,0x3f46bf55,0x3e95bec4,0x3dc9be48
.long 0x3f55bf35,0x3f7bbf6d,0x3f0ebf35,0x3e48bec4,0xbdc93ec4,0x3ef1be48,0x3f46bf6d,0x3e95bf0e
.long 0xbf6d3f80,0xbec43f35,0x3f6dbf80,0x3ec4bf35,0xbf463ec4,0xbf753f7b,0x3f7fbf6d,0x3ef1bf55
.long 0x3e48bf35,0xbf553ec4,0x3f7bbf35,0x3f0ebf6d,0x3f75bf6d,0xbdc9bf0e,0x3f62bec4,0x3f22bf7b
.long 0x3f35250d,0x3f35bf80,0x3f35250d,0x3f35bf80,0xbe953f6d,0x3f7fbf0e,0x3ef13ec4,0x3f46bf7b
.long 0xbf7b3f35,0x3f0e3ec4,0x3e483f35,0x3f55bf6d,0xbf22bec4,0xbe953f7b,0xbdc93f6d,0x3f62bf55
.long 0x3ec4bf80,0xbf6d3f35,0xbec43f80,0x3f6dbf35,0x3f7fbec4,0xbf62be48,0xbf223f6d,0x3f75bf0e
.long 0x3f0e3f35,0xbe48bf6d,0xbf553f35,0x3f7bbec4,0xbef13f6d,0x3f22bf55,0xbf753ec4,0x3f7fbe48
.long 0xbf800000,0x3f80250d,0xbf800000,0x3f80250d,0xbef1bf6d,0x3f223f55,0xbf75bec4,0x3f7f3e48
.long 0x3f0ebf35,0xbe483f6d,0xbf55bf35,0x3f7b3ec4,0x3f7f3ec4,0xbf623e48,0xbf22bf6d,0x3f753f0e
.long 0x3ec43f80,0xbf6dbf35,0xbec4bf80,0x3f6d3f35,0xbf223ec4,0xbe95bf7b,0xbdc9bf6d,0x3f623f55
.long 0xbf7bbf35,0x3f0ebec4,0x3e48bf35,0x3f553f6d,0xbe95bf6d,0x3f7f3f0e,0x3ef1bec4,0x3f463f7b
.long 0x3f35250d,0x3f353f80,0x3f35250d,0x3f353f80,0x3f753f6d,0xbdc93f0e,0x3f623ec4,0x3f223f7b
.long 0x3e483f35,0xbf55bec4,0x3f7b3f35,0x3f0e3f6d,0xbf46bec4,0xbf75bf7b,0x3f7f3f6d,0x3ef13f55
.long 0xbf6dbf80,0xbec4bf35,0x3f6d3f80,0x3ec43f35,0xbdc9bec4,0x3ef13e48,0x3f463f6d,0x3e953f0e
.long 0x3f553f35,0x3f7b3f6d,0x3f0e3f35,0x3e483ec4,0x3f623f6d,0x3f463f55,0x3e953ec4,0x3dc93e48
.long 0x80008000,0x80008000,0x80008000,0x80008000,0xbdc98000,0xbe95be48,0xbf46bf35,0xbf62bf55
.long 0xbe488000,0xbf0ebec4,0xbf7bbf80,0xbf55bf6d,0xbe958000,0xbf46bf0e,0xbef1bf35,0x3dc9be48
.long 0xbec48000,0xbf6dbf35,0x3ec4a50d,0x3f6d3f35,0xbef18000,0xbf7fbf55,0x3f753f35,0x3f463f7b
.long 0xbf0e8000,0xbf7bbf6d,0x3f553f80,0xbe483ec4,0xbf228000,0xbf62bf7b,0x3dc93f35,0xbf75bf0e
.long 0xbf358000,0xbf35bf80,0xbf358000,0xbf35bf80,0xbf468000,0xbef1bf7b,0xbf7fbf35,0x3e95bf0e
.long 0xbf558000,0xbe48bf6d,0xbf0ebf80,0x3f7b3ec4,0xbf628000,0x3dc9bf55,0x3e95bf35,0x3f223f7b
.long 0xbf6d8000,0x3ec4bf35,0x3f6da50d,0xbec43f35,0xbf758000,0x3f22bf0e,0x3f623f35,0xbf7fbe48
.long 0xbf7b8000,0x3f55bec4,0x3e483f80,0xbf0ebf6d,0xbf7f8000,0x3f75be48,0xbf223f35,0x3ef1bf55
.long 0xbf808000,0x3f80a50d,0xbf808000,0x3f80a50d,0xbf7f8000,0x3f753e48,0xbf22bf35,0x3ef13f55
.long 0xbf7b8000,0x3f553ec4,0x3e48bf80,0xbf0e3f6d,0xbf758000,0x3f223f0e,0x3f62bf35,0xbf7f3e48
.long 0xbf6d8000,0x3ec43f35,0x3f6da50d,0xbec4bf35,0xbf628000,0x3dc93f55,0x3e953f35,0x3f22bf7b
.long 0xbf558000,0xbe483f6d,0xbf0e3f80,0x3f7bbec4,0xbf468000,0xbef13f7b,0xbf7f3f35,0x3e953f0e
.long 0xbf358000,0xbf353f80,0xbf358000,0xbf353f80,0xbf228000,0xbf623f7b,0x3dc9bf35,0xbf753f0e
.long 0xbf0e8000,0xbf7b3f6d,0x3f55bf80,0xbe48bec4,0xbef18000,0xbf7f3f55,0x3f75bf35,0x3f46bf7b
.long 0xbec48000,0xbf6d3f35,0x3ec4a50d,0x3f6dbf35,0xbe958000,0xbf463f0e,0xbef13f35,0x3dc93e48
.long 0xbe488000,0xbf0e3ec4,0xbf7b3f80,0xbf553f6d,0xbdc98000,0xbe953e48,0xbf463f35,0xbf623f55
.long 0x80008000,0x80008000,0x80008000,0x80008000,0xbef1bec4,0xbf22bf0e,0xbf75bf6d,0xbf7fbf7b
.long 0xbf55bf35,0xbf7bbf6d,0xbf0ebf35,0xbe48bec4,0xbf7fbf6d,0xbf62bf7b,0x3f223ec4,0x3f753f55
.long 0xbf6dbf80,0xbec4bf35,0x3f6d3f80,0x3ec43f35,0xbf22bf6d,0x3e95be48,0xbdc93ec4,0xbf62bf0e
.long 0xbe48bf35,0x3f553ec4,0xbf7bbf35,0xbf0ebf6d,0x3e95bec4,0x3f7f3f55,0xbef1bf6d,0x3f463e48
.long 0x3f35a50d,0x3f353f80,0x3f35a50d,0x3f353f80,0x3f753ec4,0x3dc93f55,0x3f623f6d,0xbf223e48
.long 0x3f7b3f35,0xbf0e3ec4,0xbe483f35,0xbf55bf6d,0x3f463f6d,0xbf75be48,0xbf7fbec4,0x3ef1bf0e
.long 0x3ec43f80,0xbf6dbf35,0xbec4bf80,0x3f6d3f35,0xbdc93f6d,0xbef1bf7b,0x3f46bec4,0xbe953f55
.long 0xbf0e3f35,0x3e48bf6d,0x3f553f35,0xbf7bbec4,0xbf623ec4,0x3f46bf0e,0xbe953f6d,0x3dc9bf7b
.long 0xbf808000,0x3f80a50d,0xbf808000,0x3f80a50d,0xbf62bec4,0x3f463f0e,0xbe95bf6d,0x3dc93f7b
.long 0xbf0ebf35,0x3e483f6d,0x3f55bf35,0xbf7b3ec4,0xbdc9bf6d,0xbef13f7b,0x3f463ec4,0xbe95bf55
.long 0x3ec4bf80,0xbf6d3f35,0xbec43f80,0x3f6dbf35,0x3f46bf6d,0xbf753e48,0xbf7f3ec4,0x3ef13f0e
.long 0x3f7bbf35,0xbf0ebec4,0xbe48bf35,0xbf553f6d,0x3f75bec4,0x3dc9bf55,0x3f62bf6d,0xbf22be48
.long 0x3f35a50d,0x3f35bf80,0x3f35a50d,0x3f35bf80,0x3e953ec4,0x3f7fbf55,0xbef13f6d,0x3f46be48
.long 0xbe483f35,0x3f55bec4,0xbf7b3f35,0xbf0e3f6d,0xbf223f6d,0x3e953e48,0xbdc9bec4,0xbf623f0e
.long 0xbf6d3f80,0xbec43f35,0x3f6dbf80,0x3ec4bf35,0xbf7f3f6d,0xbf623f7b,0x3f22bec4,0x3f75bf55
.long 0xbf553f35,0xbf7b3f6d,0xbf0e3f35,0xbe483ec4,0xbef13ec4,0xbf223f0e,0xbf753f6d,0xbf7f3f7b
.long 0x80008000,0x80008000,0x80008000,0x80008000,0xbf7fbf80,0xbf75bf7b,0xbf22bf35,0xbef1bf0e
.long 0x3e48a50d,0x3f0e3ec4,0x3f7b3f80,0x3f553f6d,0x3f753f80,0x3f223f55,0xbf62bf35,0xbf7fbf7b
.long 0xbec48000,0xbf6dbf35,0x3ec4a50d,0x3f6d3f35,0xbf62bf80,0xbdc9bf0e,0x3e953f35,0xbf22be48
.long 0x3f0ea50d,0x3f7b3f6d,0xbf55bf80,0x3e48bec4,0x3f463f80,0xbef13e48,0x3f7f3f35,0x3e953f55
.long 0xbf358000,0xbf35bf80,0xbf358000,0xbf35bf80,0xbf22bf80,0x3f623e48,0x3dc9bf35,0x3f753f55
.long 0x3f55a50d,0x3e483f6d,0x3f0e3f80,0xbf7bbec4,0x3ef13f80,0xbf7fbf0e,0xbf75bf35,0x3f46be48
.long 0xbf6d8000,0x3ec4bf35,0x3f6da50d,0xbec43f35,0xbe95bf80,0x3f463f55,0xbef13f35,0xbdc9bf7b
.long 0x3f7ba50d,0xbf553ec4,0xbe48bf80,0x3f0e3f6d,0x3dc93f80,0xbe95bf7b,0x3f463f35,0xbf62bf0e
.long 0xbf808000,0x3f80a50d,0xbf808000,0x3f80a50d,0x3dc9bf80,0xbe953f7b,0x3f46bf35,0xbf623f0e
.long 0x3f7ba50d,0xbf55bec4,0xbe483f80,0x3f0ebf6d,0xbe953f80,0x3f46bf55,0xbef1bf35,0xbdc93f7b
.long 0xbf6d8000,0x3ec43f35,0x3f6da50d,0xbec4bf35,0x3ef1bf80,0xbf7f3f0e,0xbf753f35,0x3f463e48
.long 0x3f55a50d,0x3e48bf6d,0x3f0ebf80,0xbf7b3ec4,0xbf223f80,0x3f62be48,0x3dc93f35,0x3f75bf55
.long 0xbf358000,0xbf353f80,0xbf358000,0xbf353f80,0x3f46bf80,0xbef1be48,0x3f7fbf35,0x3e95bf55
.long 0x3f0ea50d,0x3f7bbf6d,0xbf553f80,0x3e483ec4,0xbf623f80,0xbdc93f0e,0x3e95bf35,0xbf223e48
.long 0xbec48000,0xbf6d3f35,0x3ec4a50d,0x3f6dbf35,0x3f75bf80,0x3f22bf55,0xbf623f35,0xbf7f3f7b
.long 0x3e48a50d,0x3f0ebec4,0x3f7bbf80,0x3f55bf6d,0xbf7f3f80,0xbf753f7b,0xbf223f35,0xbef13f0e
.long 0x80008000,0x80008000,0x80008000,0x80008000,0xbf62bf6d,0xbf46bf55,0xbe95bec4,0xbdc9be48
.long 0x3f553f35,0x3f7b3f6d,0x3f0e3f35,0x3e483ec4,0x3dc93ec4,0xbef1be48,0xbf46bf6d,0xbe95bf0e
.long 0xbf6dbf80,0xbec4bf35,0x3f6d3f80,0x3ec43f35,0x3f463ec4,0x3f753f7b,0xbf7fbf6d,0xbef1bf55
.long 0x3e483f35,0xbf55bec4,0x3f7b3f35,0x3f0e3f6d,0xbf75bf6d,0x3dc9bf0e,0xbf62bec4,0xbf22bf7b
.long 0x3f35a50d,0x3f353f80,0x3f35a50d,0x3f353f80,0x3e953f6d,0xbf7fbf0e,0xbef13ec4,0xbf46bf7b
.long 0xbf7bbf35,0x3f0ebec4,0x3e48bf35,0x3f553f6d,0x3f22bec4,0x3e953f7b,0x3dc93f6d,0xbf62bf55
.long 0x3ec43f80,0xbf6dbf35,0xbec4bf80,0x3f6d3f35,0xbf7fbec4,0x3f62be48,0x3f223f6d,0xbf75bf0e
.long 0x3f0ebf35,0xbe483f6d,0xbf55bf35,0x3f7b3ec4,0x3ef13f6d,0xbf22bf55,0x3f753ec4,0xbf7fbe48
.long 0xbf808000,0x3f80a50d,0xbf808000,0x3f80a50d,0x3ef1bf6d,0xbf223f55,0x3f75bec4,0xbf7f3e48
.long 0x3f0e3f35,0xbe48bf6d,0xbf553f35,0x3f7bbec4,0xbf7f3ec4,0x3f623e48,0x3f22bf6d,0xbf753f0e
.long 0x3ec4bf80,0xbf6d3f35,0xbec43f80,0x3f6dbf35,0x3f223ec4,0x3e95bf7b,0x3dc9bf6d,0xbf623f55
.long 0xbf7b3f35,0x3f0e3ec4,0x3e483f35,0x3f55bf6d,0x3e95bf6d,0xbf7f3f0e,0xbef1bec4,0xbf463f7b
.long 0x3f35a50d,0x3f35bf80,0x3f35a50d,0x3f35bf80,0xbf753f6d,0x3dc93f0e,0xbf623ec4,0xbf223f7b
.long 0x3e48bf35,0xbf553ec4,0x3f7bbf35,0x3f0ebf6d,0x3f46bec4,0x3f75bf7b,0xbf7f3f6d,0xbef13f55
.long 0xbf6d3f80,0xbec43f35,0x3f6dbf80,0x3ec4bf35,0x3dc9bec4,0xbef13e48,0xbf463f6d,0xbe953f0e
.long 0x3f55bf35,0x3f7bbf6d,0x3f0ebf35,0x3e48bec4,0xbf623f6d,0xbf463f55,0xbe953ec4,0xbdc93e48
.long 0x80008000,0x80008000,0x80008000,0x80008000,0x3dc9a50d,0x3e953e48,0x3f463f35,0x3f623f55
.long 0xbe488000,0xbf0ebec4,0xbf7bbf80,0xbf55bf6d,0x3e95a50d,0x3f463f0e,0x3ef13f35,0xbdc93e48
.long 0xbec48000,0xbf6dbf35,0x3ec4a50d,0x3f6d3f35,0x3ef1a50d,0x3f7f3f55,0xbf75bf35,0xbf46bf7b
.long 0xbf0e8000,0xbf7bbf6d,0x3f553f80,0xbe483ec4,0x3f22a50d,0x3f623f7b,0xbdc9bf35,0x3f753f0e
.long 0xbf358000,0xbf35bf80,0xbf358000,0xbf35bf80,0x3f46a50d,0x3ef13f7b,0x3f7f3f35,0xbe953f0e
.long 0xbf558000,0xbe48bf6d,0xbf0ebf80,0x3f7b3ec4,0x3f62a50d,0xbdc93f55,0xbe953f35,0xbf22bf7b
.long 0xbf6d8000,0x3ec4bf35,0x3f6da50d,0xbec43f35,0x3f75a50d,0xbf223f0e,0xbf62bf35,0x3f7f3e48
.long 0xbf7b8000,0x3f55bec4,0x3e483f80,0xbf0ebf6d,0x3f7fa50d,0xbf753e48,0x3f22bf35,0xbef13f55
.long 0xbf808000,0x3f80a50d,0xbf808000,0x3f80a50d,0x3f7fa50d,0xbf75be48,0x3f223f35,0xbef1bf55
.long 0xbf7b8000,0x3f553ec4,0x3e48bf80,0xbf0e3f6d,0x3f75a50d,0xbf22bf0e,0xbf623f35,0x3f7fbe48
.long 0xbf6d8000,0x3ec43f35,0x3f6da50d,0xbec4bf35,0x3f62a50d,0xbdc9bf55,0xbe95bf35,0xbf223f7b
.long 0xbf558000,0xbe483f6d,0xbf0e3f80,0x3f7bbec4,0x3f46a50d,0x3ef1bf7b,0x3f7fbf35,0xbe95bf0e
.long 0xbf358000,0xbf353f80,0xbf358000,0xbf353f80,0x3f22a50d,0x3f62bf7b,0xbdc93f35,0x3f75bf0e
.long 0xbf0e8000,0xbf7b3f6d,0x3f55bf80,0xbe48bec4,0x3ef1a50d,0x3f7fbf55,0xbf753f35,0xbf463f7b
.long 0xbec48000,0xbf6d3f35,0x3ec4a50d,0x3f6dbf35,0x3e95a50d,0x3f46bf0e,0x3ef1bf35,0xbdc9be48
.long 0xbe488000,0xbf0e3ec4,0xbf7b3f80,0xbf553f6d,0x3dc9a50d,0x3e95be48,0x3f46bf35,0x3f62bf55
.long 0x80008000,0x80008000,0x80008000,0x80008000,0x3ef13ec4,0x3f223f0e,0x3f753f6d,0x3f7f3f7b
.long 0xbf55bf35,0xbf7bbf6d,0xbf0ebf35,0xbe48bec4,0x3f7f3f6d,0x3f623f7b,0xbf22bec4,0xbf75bf55
.long 0xbf6dbf80,0xbec4bf35,0x3f6d3f80,0x3ec43f35,0x3f223f6d,0xbe953e48,0x3dc9bec4,0x3f623f0e
.long 0xbe48bf35,0x3f553ec4,0xbf7bbf35,0xbf0ebf6d,0xbe953ec4,0xbf7fbf55,0x3ef13f6d,0xbf46be48
.long 0x3f35a50d,0x3f353f80,0x3f35a50d,0x3f353f80,0xbf75bec4,0xbdc9bf55,0xbf62bf6d,0x3f22be48
.long 0x3f7b3f35,0xbf0e3ec4,0xbe483f35,0xbf55bf6d,0xbf46bf6d,0x3f753e48,0x3f7f3ec4,0xbef13f0e
.long 0x3ec43f80,0xbf6dbf35,0xbec4bf80,0x3f6d3f35,0x3dc9bf6d,0x3ef13f7b,0xbf463ec4,0x3e95bf55
.long 0xbf0e3f35,0x3e48bf6d,0x3f553f35,0xbf7bbec4,0x3f62bec4,0xbf463f0e,0x3e95bf6d,0xbdc93f7b
.long 0xbf808000,0x3f80a50d,0xbf808000,0x3f80a50d,0x3f623ec4,0xbf46bf0e,0x3e953f6d,0xbdc9bf7b
.long 0xbf0ebf35,0x3e483f6d,0x3f55bf35,0xbf7b3ec4,0x3dc93f6d,0x3ef1bf7b,0xbf46bec4,0x3e953f55
.long 0x3ec4bf80,0xbf6d3f35,0xbec43f80,0x3f6dbf35,0xbf463f6d,0x3f75be48,0x3f7fbec4,0xbef1bf0e
.long 0x3f7bbf35,0xbf0ebec4,0xbe48bf35,0xbf553f6d,0xbf753ec4,0xbdc93f55,0xbf623f6d,0x3f223e48
.long 0x3f35a50d,0x3f35bf80,0x3f35a50d,0x3f35bf80,0xbe95bec4,0xbf7f3f55,0x3ef1bf6d,0xbf463e48
.long 0xbe483f35,0x3f55bec4,0xbf7b3f35,0xbf0e3f6d,0x3f22bf6d,0xbe95be48,0x3dc93ec4,0x3f62bf0e
.long 0xbf6d3f80,0xbec43f35,0x3f6dbf80,0x3ec4bf35,0x3f7fbf6d,0x3f62bf7b,0xbf223ec4,0xbf753f55
.long 0xbf553f35,0xbf7b3f6d,0xbf0e3f35,0xbe483ec4,0x3ef1bec4,0x3f22bf0e,0x3f75bf6d,0x3f7fbf7b
.long 0x80008000,0x80008000,0x80008000,0x80008000,0x3f7f3f80,0x3f753f7b,0x3f223f35,0x3ef13f0e
.long 0x3e48a50d,0x3f0e3ec4,0x3f7b3f80,0x3f553f6d,0xbf75bf80,0xbf22bf55,0x3f623f35,0x3f7f3f7b
.long 0xbec48000,0xbf6dbf35,0x3ec4a50d,0x3f6d3f35,0x3f623f80,0x3dc93f0e,0xbe95bf35,0x3f223e48
.long 0x3f0ea50d,0x3f7b3f6d,0xbf55bf80,0x3e48bec4,0xbf46bf80,0x3ef1be48,0xbf7fbf35,0xbe95bf55
.long 0xbf358000,0xbf35bf80,0xbf358000,0xbf35bf80,0x3f223f80,0xbf62be48,0xbdc93f35,0xbf75bf55
.long 0x3f55a50d,0x3e483f6d,0x3f0e3f80,0xbf7bbec4,0xbef1bf80,0x3f7f3f0e,0x3f753f35,0xbf463e48
.long 0xbf6d8000,0x3ec4bf35,0x3f6da50d,0xbec43f35,0x3e953f80,0xbf46bf55,0x3ef1bf35,0x3dc93f7b
.long 0x3f7ba50d,0xbf553ec4,0xbe48bf80,0x3f0e3f6d,0xbdc9bf80,0x3e953f7b,0xbf46bf35,0x3f623f0e
.long 0xbf808000,0x3f80a50d,0xbf808000,0x3f80a50d,0xbdc93f80,0x3e95bf7b,0xbf463f35,0x3f62bf0e
.long 0x3f7ba50d,0xbf55bec4,0xbe483f80,0x3f0ebf6d,0x3e95bf80,0xbf463f55,0x3ef13f35,0x3dc9bf7b
.long 0xbf6d8000,0x3ec43f35,0x3f6da50d,0xbec4bf35,0xbef13f80,0x3f7fbf0e,0x3f75bf35,0xbf46be48
.long 0x3f55a50d,0x3e48bf6d,0x3f0ebf80,0xbf7b3ec4,0x3f22bf80,0xbf623e48,0xbdc9bf35,0xbf753f55
.long 0xbf358000,0xbf353f80,0xbf358000,0xbf353f80,0xbf463f80,0x3ef13e48,0xbf7f3f35,0xbe953f55
.long 0x3f0ea50d,0x3f7bbf6d,0xbf553f80,0x3e483ec4,0x3f62bf80,0x3dc9bf0e,0xbe953f35,0x3f22be48
.long 0xbec48000,0xbf6d3f35,0x3ec4a50d,0x3f6dbf35,0xbf753f80,0xbf223f55,0x3f62bf35,0x3f7fbf7b
.long 0x3e48a50d,0x3f0ebec4,0x3f7bbf80,0x3f55bf6d,0x3f7fbf80,0x3f75bf7b,0x3f22bf35,0x3ef1bf0e
.long 0x80008000,0x80008000,0x80008000,0x80008000,0x3f623f6d,0x3f463f55,0x3e953ec4,0x3dc93e48
.long 0x3f553f35,0x3f7b3f6d,0x3f0e3f35,0x3e483ec4,0xbdc9bec4,0x3ef13e48,0x3f463f6d,0x3e953f0e
.long 0xbf6dbf80,0xbec4bf35,0x3f6d3f80,0x3ec43f35,0xbf46bec4,0xbf75bf7b,0x3f7f3f6d,0x3ef13f55
.long 0x3e483f35,0xbf55bec4,0x3f7b3f35,0x3f0e3f6d,0x3f753f6d,0xbdc93f0e,0x3f623ec4,0x3f223f7b
.long 0x3f35a50d,0x3f353f80,0x3f35a50d,0x3f353f80,0xbe95bf6d,0x3f7f3f0e,0x3ef1bec4,0x3f463f7b
.long 0xbf7bbf35,0x3f0ebec4,0x3e48bf35,0x3f553f6d,0xbf223ec4,0xbe95bf7b,0xbdc9bf6d,0x3f623f55
.long 0x3ec43f80,0xbf6dbf35,0xbec4bf80,0x3f6d3f35,0x3f7f3ec4,0xbf623e48,0xbf22bf6d,0x3f753f0e
.long 0x3f0ebf35,0xbe483f6d,0xbf55bf35,0x3f7b3ec4,0xbef1bf6d,0x3f223f55,0xbf75bec4,0x3f7f3e48
.long 0xbf808000,0x3f80a50d,0xbf808000,0x3f80a50d,0xbef13f6d,0x3f22bf55,0xbf753ec4,0x3f7fbe48
.long 0x3f0e3f35,0xbe48bf6d,0xbf553f35,0x3f7bbec4,0x3f7fbec4,0xbf62be48,0xbf223f6d,0x3f75bf0e
.long 0x3ec4bf80,0xbf6d3f35,0xbec43f80,0x3f6dbf35,0xbf22bec4,0xbe953f7b,0xbdc93f6d,0x3f62bf55
.long 0xbf7b3f35,0x3f0e3ec4,0x3e483f35,0x3f55bf6d,0xbe953f6d,0x3f7fbf0e,0x3ef13ec4,0x3f46bf7b
.long 0x3f35a50d,0x3f35bf80,0x3f35a50d,0x3f35bf80,0x3f75bf6d,0xbdc9bf0e,0x3f62bec4,0x3f22bf7b
.long 0x3e48bf35,0xbf553ec4,0x3f7bbf35,0x3f0ebf6d,0xbf463ec4,0xbf753f7b,0x3f7fbf6d,0x3ef1bf55
.long 0xbf6d3f80,0xbec43f35,0x3f6dbf80,0x3ec4bf35,0xbdc93ec4,0x3ef1be48,0x3f46bf6d,0x3e95bf0e
.long 0x3f55bf35,0x3f7bbf6d,0x3f0ebf35,0x3e48bec4,0x3f62bf6d,0x3f46bf55,0x3e95bec4,0x3dc9be48
.long 0xa50d8000,0xa50d8000,0xa50d8000,0xa50d8000,0x3dc98000,0x3e95be48,0x3f46bf35,0x3f62bf55
.long 0x3e488000,0x3f0ebec4,0x3f7bbf80,0x3f55bf6d,0x3e958000,0x3f46bf0e,0x3ef1bf35,0xbdc9be48
.long 0x3ec48000,0x3f6dbf35,0xbec4a50d,0xbf6d3f35,0x3ef18000,0x3f7fbf55,0xbf753f35,0xbf463f7b
.long 0x3f0e8000,0x3f7bbf6d,0xbf553f80,0x3e483ec4,0x3f228000,0x3f62bf7b,0xbdc93f35,0x3f75bf0e
.long 0x3f358000,0x3f35bf80,0x3f358000,0x3f35bf80,0x3f468000,0x3ef1bf7b,0x3f7fbf35,0xbe95bf0e
.long 0x3f558000,0x3e48bf6d,0x3f0ebf80,0xbf7b3ec4,0x3f628000,0xbdc9bf55,0xbe95bf35,0xbf223f7b
.long 0x3f6d8000,0xbec4bf35,0xbf6da50d,0x3ec43f35,0x3f758000,0xbf22bf0e,0xbf623f35,0x3f7fbe48
.long 0x3f7b8000,0xbf55bec4,0xbe483f80,0x3f0ebf6d,0x3f7f8000,0xbf75be48,0x3f223f35,0xbef1bf55
.long 0x3f808000,0xbf80a50d,0x3f808000,0xbf80a50d,0x3f7f8000,0xbf753e48,0x3f22bf35,0xbef13f55
.long 0x3f7b8000,0xbf553ec4,0xbe48bf80,0x3f0e3f6d,0x3f758000,0xbf223f0e,0xbf62bf35,0x3f7f3e48
.long 0x3f6d8000,0xbec43f35,0xbf6da50d,0x3ec4bf35,0x3f628000,0xbdc93f55,0xbe953f35,0xbf22bf7b
.long 0x3f558000,0x3e483f6d,0x3f0e3f80,0xbf7bbec4,0x3f468000,0x3ef13f7b,0x3f7f3f35,0xbe953f0e
.long 0x3f358000,0x3f353f80,0x3f358000,0x3f353f80,0x3f228000,0x3f623f7b,0xbdc9bf35,0x3f753f0e
.long 0x3f0e8000,0x3f7b3f6d,0xbf55bf80,0x3e48bec4,0x3ef18000,0x3f7f3f55,0xbf75bf35,0xbf46bf7b
.long 0x3ec48000,0x3f6d3f35,0xbec4a50d,0xbf6dbf35,0x3e958000,0x3f463f0e,0x3ef13f35,0xbdc93e48
.long 0x3e488000,0x3f0e3ec4,0x3f7b3f80,0x3f553f6d,0x3dc98000,0x3e953e48,0x3f463f35,0x3f623f55
.long 0xa50d8000,0xa50d8000,0xa50d8000,0xa50d8000,0x3ef1bec4,0x3f22bf0e,0x3f75bf6d,0x3f7fbf7b
.long 0x3f55bf35,0x3f7bbf6d,0x3f0ebf35,0x3e48bec4,0x3f7fbf6d,0x3f62bf7b,0xbf223ec4,0xbf753f55
.long 0x3f6dbf80,0x3ec4bf35,0xbf6d3f80,0xbec43f35,0x3f22bf6d,0xbe95be48,0x3dc93ec4,0x3f62bf0e
.long 0x3e48bf35,0xbf553ec4,0x3f7bbf35,0x3f0ebf6d,0xbe95bec4,0xbf7f3f55,0x3ef1bf6d,0xbf463e48
.long 0xbf35a50d,0xbf353f80,0xbf35a50d,0xbf353f80,0xbf753ec4,0xbdc93f55,0xbf623f6d,0x3f223e48
.long 0xbf7b3f35,0x3f0e3ec4,0x3e483f35,0x3f55bf6d,0xbf463f6d,0x3f75be48,0x3f7fbec4,0xbef1bf0e
.long 0xbec43f80,0x3f6dbf35,0x3ec4bf80,0xbf6d3f35,0x3dc93f6d,0x3ef1bf7b,0xbf46bec4,0x3e953f55
.long 0x3f0e3f35,0xbe48bf6d,0xbf553f35,0x3f7bbec4,0x3f623ec4,0xbf46bf0e,0x3e953f6d,0xbdc9bf7b
.long 0x3f808000,0xbf80a50d,0x3f808000,0xbf80a50d,0x3f62bec4,0xbf463f0e,0x3e95bf6d,0xbdc93f7b
.long 0x3f0ebf35,0xbe483f6d,0xbf55bf35,0x3f7b3ec4,0x3dc9bf6d,0x3ef13f7b,0xbf463ec4,0x3e95bf55
.long 0xbec4bf80,0x3f6d3f35,0x3ec43f80,0xbf6dbf35,0xbf46bf6d,0x3f753e48,0x3f7f3ec4,0xbef13f0e
.long 0xbf7bbf35,0x3f0ebec4,0x3e48bf35,0x3f553f6d,0xbf75bec4,0xbdc9bf55,0xbf62bf6d,0x3f22be48
.long 0xbf35a50d,0xbf35bf80,0xbf35a50d,0xbf35bf80,0xbe953ec4,0xbf7fbf55,0x3ef13f6d,0xbf46be48
.long 0x3e483f35,0xbf55bec4,0x3f7b3f35,0x3f0e3f6d,0x3f223f6d,0xbe953e48,0x3dc9bec4,0x3f623f0e
.long 0x3f6d3f80,0x3ec43f35,0xbf6dbf80,0xbec4bf35,0x3f7f3f6d,0x3f623f7b,0xbf22bec4,0xbf75bf55
.long 0x3f553f35,0x3f7b3f6d,0x3f0e3f35,0x3e483ec4,0x3ef13ec4,0x3f223f0e,0x3f753f6d,0x3f7f3f7b
.long 0xa50d8000,0xa50d8000,0xa50d8000,0xa50d8000,0x3f7fbf80,0x3f75bf7b,0x3f22bf35,0x3ef1bf0e
.long 0xbe48a50d,0xbf0e3ec4,0xbf7b3f80,0xbf553f6d,0xbf753f80,0xbf223f55,0x3f62bf35,0x3f7fbf7b
.long 0x3ec48000,0x3f6dbf35,0xbec4a50d,0xbf6d3f35,0x3f62bf80,0x3dc9bf0e,0xbe953f35,0x3f22be48
.long 0xbf0ea50d,0xbf7b3f6d,0x3f55bf80,0xbe48bec4,0xbf463f80,0x3ef13e48,0xbf7f3f35,0xbe953f55
.long 0x3f358000,0x3f35bf80,0x3f358000,0x3f35bf80,0x3f22bf80,0xbf623e48,0xbdc9bf35,0xbf753f55
.long 0xbf55a50d,0xbe483f6d,0xbf0e3f80,0x3f7bbec4,0xbef13f80,0x3f7fbf0e,0x3f75bf35,0xbf46be48
.long 0x3f6d8000,0xbec4bf35,0xbf6da50d,0x3ec43f35,0x3e95bf80,0xbf463f55,0x3ef13f35,0x3dc9bf7b
.long 0xbf7ba50d,0x3f553ec4,0x3e48bf80,0xbf0e3f6d,0xbdc93f80,0x3e95bf7b,0xbf463f35,0x3f62bf0e
.long 0x3f808000,0xbf80a50d,0x3f808000,0xbf80a50d,0xbdc9bf80,0x3e953f7b,0xbf46bf35,0x3f623f0e
.long 0xbf7ba50d,0x3f55bec4,0x3e483f80,0xbf0ebf6d,0x3e953f80,0xbf46bf55,0x3ef1bf35,0x3dc93f7b
.long 0x3f6d8000,0xbec43f35,0xbf6da50d,0x3ec4bf35,0xbef1bf80,0x3f7f3f0e,0x3f753f35,0xbf463e48
.long 0xbf55a50d,0xbe48bf6d,0xbf0ebf80,0x3f7b3ec4,0x3f223f80,0xbf62be48,0xbdc93f35,0xbf75bf55
.long 0x3f358000,0x3f353f80,0x3f358000,0x3f353f80,0xbf46bf80,0x3ef1be48,0xbf7fbf35,0xbe95bf55
.long 0xbf0ea50d,0xbf7bbf6d,0x3f553f80,0xbe483ec4,0x3f623f80,0x3dc93f0e,0xbe95bf35,0x3f223e48
.long 0x3ec48000,0x3f6d3f35,0xbec4a50d,0xbf6dbf35,0xbf75bf80,0xbf22bf55,0x3f623f35,0x3f7f3f7b
.long 0xbe48a50d,0xbf0ebec4,0xbf7bbf80,0xbf55bf6d,0x3f7f3f80,0x3f753f7b,0x3f223f35,0x3ef13f0e
.long 0xa50d8000,0xa50d8000,0xa50d8000,0xa50d8000,0x3f62bf6d,0x3f46bf55,0x3e95bec4,0x3dc9be48
.long 0xbf553f35,0xbf7b3f6d,0xbf0e3f35,0xbe483ec4,0xbdc93ec4,0x3ef1be48,0x3f46bf6d,0x3e95bf0e
.long 0x3f6dbf80,0x3ec4bf35,0xbf6d3f80,0xbec43f35,0xbf463ec4,0xbf753f7b,0x3f7fbf6d,0x3ef1bf55
.long 0xbe483f35,0x3f55bec4,0xbf7b3f35,0xbf0e3f6d,0x3f75bf6d,0xbdc9bf0e,0x3f62bec4,0x3f22bf7b
.long 0xbf35a50d,0xbf353f80,0xbf35a50d,0xbf353f80,0xbe953f6d,0x3f7fbf0e,0x3ef13ec4,0x3f46bf7b
.long 0x3f7bbf35,0xbf0ebec4,0xbe48bf35,0xbf553f6d,0xbf22bec4,0xbe953f7b,0xbdc93f6d,0x3f62bf55
.long 0xbec43f80,0x3f6dbf35,0x3ec4bf80,0xbf6d3f35,0x3f7fbec4,0xbf62be48,0xbf223f6d,0x3f75bf0e
.long 0xbf0ebf35,0x3e483f6d,0x3f55bf35,0xbf7b3ec4,0xbef13f6d,0x3f22bf55,0xbf753ec4,0x3f7fbe48
.long 0x3f808000,0xbf80a50d,0x3f808000,0xbf80a50d,0xbef1bf6d,0x3f223f55,0xbf75bec4,0x3f7f3e48
.long 0xbf0e3f35,0x3e48bf6d,0x3f553f35,0xbf7bbec4,0x3f7f3ec4,0xbf623e48,0xbf22bf6d,0x3f753f0e
.long 0xbec4bf80,0x3f6d3f35,0x3ec43f80,0xbf6dbf35,0xbf223ec4,0xbe95bf7b,0xbdc9bf6d,0x3f623f55
.long 0x3f7b3f35,0xbf0e3ec4,0xbe483f35,0xbf55bf6d,0xbe95bf6d,0x3f7f3f0e,0x3ef1bec4,0x3f463f7b
.long 0xbf35a50d,0xbf35bf80,0xbf35a50d,0xbf35bf80,0x3f753f6d,0xbdc93f0e,0x3f623ec4,0x3f223f7b
.long 0xbe48bf35,0x3f553ec4,0xbf7bbf35,0xbf0ebf6d,0xbf46bec4,0xbf75bf7b,0x3f7f3f6d,0x3ef13f55
.long 0x3f6d3f80,0x3ec43f35,0xbf6dbf80,0xbec4bf35,0xbdc9bec4,0x3ef13e48,0x3f463f6d,0x3e953f0e
.long 0xbf55bf35,0xbf7bbf6d,0xbf0ebf35,0xbe48bec4,0x3f623f6d,0x3f463f55,0x3e953ec4,0x3dc93e48
.long 0xa50d8000,0xa50d8000,0xa50d8000,0xa50d8000,0xbdc9a50d,0xbe953e48,0xbf463f35,0xbf623f55
.long 0x3e488000,0x3f0ebec4,0x3f7bbf80,0x3f55bf6d,0xbe95a50d,0xbf463f0e,0xbef13f35,0x3dc93e48
.long 0x3ec48000,0x3f6dbf35,0xbec4a50d,0xbf6d3f35,0xbef1a50d,0xbf7f3f55,0x3f75bf35,0x3f46bf7b
.long 0x3f0e8000,0x3f7bbf6d,0xbf553f80,0x3e483ec4,0xbf22a50d,0xbf623f7b,0x3dc9bf35,0xbf753f0e
.long 0x3f358000,0x3f35bf80,0x3f358000,0x3f35bf80,0xbf46a50d,0xbef13f7b,0xbf7f3f35,0x3e953f0e
.long 0x3f558000,0x3e48bf6d,0x3f0ebf80,0xbf7b3ec4,0xbf62a50d,0x3dc93f55,0x3e953f35,0x3f22bf7b
.long 0x3f6d8000,0xbec4bf35,0xbf6da50d,0x3ec43f35,0xbf75a50d,0x3f223f0e,0x3f62bf35,0xbf7f3e48
.long 0x3f7b8000,0xbf55bec4,0xbe483f80,0x3f0ebf6d,0xbf7fa50d,0x3f753e48,0xbf22bf35,0x3ef13f55
.long 0x3f808000,0xbf80a50d,0x3f808000,0xbf80a50d,0xbf7fa50d,0x3f75be48,0xbf223f35,0x3ef1bf55
.long 0x3f7b8000,0xbf553ec4,0xbe48bf80,0x3f0e3f6d,0xbf75a50d,0x3f22bf0e,0x3f623f35,0xbf7fbe48
.long 0x3f6d8000,0xbec43f35,0xbf6da50d,0x3ec4bf35,0xbf62a50d,0x3dc9bf55,0x3e95bf35,0x3f223f7b
.long 0x3f558000,0x3e483f6d,0x3f0e3f80,0xbf7bbec4,0xbf46a50d,0xbef1bf7b,0xbf7fbf35,0x3e95bf0e
.long 0x3f358000,0x3f353f80,0x3f358000,0x3f353f80,0xbf22a50d,0xbf62bf7b,0x3dc93f35,0xbf75bf0e
.long 0x3f0e8000,0x3f7b3f6d,0xbf55bf80,0x3e48bec4,0xbef1a50d,0xbf7fbf55,0x3f753f35,0x3f463f7b
.long 0x3ec48000,0x3f6d3f35,0xbec4a50d,0xbf6dbf35,0xbe95a50d,0xbf46bf0e,0xbef1bf35,0x3dc9be48
.long 0x3e488000,0x3f0e3ec4,0x3f7b3f80,0x3f553f6d,0xbdc9a50d,0xbe95be48,0xbf46bf35,0xbf62bf55
.long 0xa50d8000,0xa50d8000,0xa50d8000,0xa50d8000,0xbef13ec4,0xbf223f0e,0xbf753f6d,0xbf7f3f7b
.long 0x3f55bf35,0x3f7bbf6d,0x3f0ebf35,0x3e48bec4,0xbf7f3f6d,0xbf623f7b,0x3f22bec4,0x3f75bf55
.long 0x3f6dbf80,0x3ec4bf35,0xbf6d3f80,0xbec43f35,0xbf223f6d,0x3e953e48,0xbdc9bec4,0xbf623f0e
.long 0x3e48bf35,0xbf553ec4,0x3f7bbf35,0x3f0ebf6d,0x3e953ec4,0x3f7fbf55,0xbef13f6d,0x3f46be48
.long 0xbf35a50d,0xbf353f80,0xbf35a50d,0xbf353f80,0x3f75bec4,0x3dc9bf55,0x3f62bf6d,0xbf22be48
.long 0xbf7b3f35,0x3f0e3ec4,0x3e483f35,0x3f55bf6d,0x3f46bf6d,0xbf753e48,0xbf7f3ec4,0x3ef13f0e
.long 0xbec43f80,0x3f6dbf35,0x3ec4bf80,0xbf6d3f35,0xbdc9bf6d,0xbef13f7b,0x3f463ec4,0xbe95bf55
.long 0x3f0e3f35,0xbe48bf6d,0xbf553f35,0x3f7bbec4,0xbf62bec4,0x3f463f0e,0xbe95bf6d,0x3dc93f7b
.long 0x3f808000,0xbf80a50d,0x3f808000,0xbf80a50d,0xbf623ec4,0x3f46bf0e,0xbe953f6d,0x3dc9bf7b
.long 0x3f0ebf35,0xbe483f6d,0xbf55bf35,0x3f7b3ec4,0xbdc93f6d,0xbef1bf7b,0x3f46bec4,0xbe953f55
.long 0xbec4bf80,0x3f6d3f35,0x3ec43f80,0xbf6dbf35,0x3f463f6d,0xbf75be48,0xbf7fbec4,0x3ef1bf0e
.long 0xbf7bbf35,0x3f0ebec4,0x3e48bf35,0x3f553f6d,0x3f753ec4,0x3dc93f55,0x3f623f6d,0xbf223e48
.long 0xbf35a50d,0xbf35bf80,0xbf35a50d,0xbf35bf80,0x3e95bec4,0x3f7f3f55,0xbef1bf6d,0x3f463e48
.long 0x3e483f35,0xbf55bec4,0x3f7b3f35,0x3f0e3f6d,0xbf22bf6d,0x3e95be48,0xbdc93ec4,0xbf62bf0e
.long 0x3f6d3f80,0x3ec43f35,0xbf6dbf80,0xbec4bf35,0xbf7fbf6d,0xbf62bf7b,0x3f223ec4,0x3f753f55
.long 0x3f553f35,0x3f7b3f6d,0x3f0e3f35,0x3e483ec4,0xbef1bec4,0xbf22bf0e,0xbf75bf6d,0xbf7fbf7b
.long 0xa50d8000,0xa50d8000,0xa50d8000,0xa50d8000,0xbf7f3f80,0xbf753f7b,0xbf223f35,0xbef13f0e
.long 0xbe48a50d,0xbf0e3ec4,0xbf7b3f80,0xbf553f6d,0x3f75bf80,0x3f22bf55,0xbf623f35,0xbf7f3f7b
.long 0x3ec48000,0x3f6dbf35,0xbec4a50d,0xbf6d3f35,0xbf623f80,0xbdc93f0e,0x3e95bf35,0xbf223e48
.long 0xbf0ea50d,0xbf7b3f6d,0x3f55bf80,0xbe48bec4,0x3f46bf80,0xbef1be48,0x3f7fbf35,0x3e95bf55
.long 0x3f358000,0x3f35bf80,0x3f358000,0x3f35bf80,0xbf223f80,0x3f62be48,0x3dc93f35,0x3f75bf55
.long 0xbf55a50d,0xbe483f6d,0xbf0e3f80,0x3f7bbec4,0x3ef1bf80,0xbf7f3f0e,0xbf753f35,0x3f463e48
.long 0x3f6d8000,0xbec4bf35,0xbf6da50d,0x3ec43f35,0xbe953f80,0x3f46bf55,0xbef1bf35,0xbdc93f7b
.long 0xbf7ba50d,0x3f553ec4,0x3e48bf80,0xbf0e3f6d,0x3dc9bf80,0xbe953f7b,0x3f46bf35,0xbf623f0e
.long 0x3f808000,0xbf80a50d,0x3f808000,0xbf80a50d,0x3dc93f80,0xbe95bf7b,0x3f463f35,0xbf62bf0e
.long 0xbf7ba50d,0x3f55bec4,0x3e483f80,0xbf0ebf6d,0xbe95bf80,0x3f463f55,0xbef13f35,0xbdc9bf7b
.long 0x3f6d8000,0xbec43f35,0xbf6da50d,0x3ec4bf35,0x3ef13f80,0xbf7fbf0e,0xbf75bf35,0x3f46be48
.long 0xbf55a50d,0xbe48bf6d,0xbf0ebf80,0x3f7b3ec4,0xbf22bf80,0x3f623e48,0x3dc9bf35,0x3f753f55
.long 0x3f358000,0x3f353f80,0x3f358000,0x3f353f80,0x3f463f80,0xbef13e48,0x3f7f3f35,0x3e953f55
.long 0xbf0ea50d,0xbf7bbf6d,0x3f553f80,0xbe483ec4,0xbf62bf80,0xbdc9bf0e,0x3e953f35,0xbf22be48
.long 0x3ec48000,0x3f6d3f35,0xbec4a50d,0xbf6dbf35,0x3f753f80,0x3f223f55,0xbf62bf35,0xbf7fbf7b
.long 0xbe48a50d,0xbf0ebec4,0xbf7bbf80,0xbf55bf6d,0xbf7fbf80,0xbf75bf7b,0xbf22bf35,0xbef1bf0e
.long 0xa50d8000,0xa50d8000,0xa50d8000,0xa50d8000,0xbf623f6d,0xbf463f55,0xbe953ec4,0xbdc93e48
.long 0xbf553f35,0xbf7b3f6d,0xbf0e3f35,0xbe483ec4,0x3dc9bec4,0xbef13e48,0xbf463f6d,0xbe953f0e
.long 0x3f6dbf80,0x3ec4bf35,0xbf6d3f80,0xbec43f35,0x3f46bec4,0x3f75bf7b,0xbf7f3f6d,0xbef13f55
.long 0xbe483f35,0x3f55bec4,0xbf7b3f35,0xbf0e3f6d,0xbf753f6d,0x3dc93f0e,0xbf623ec4,0xbf223f7b
.long 0xbf35a50d,0xbf353f80,0xbf35a50d,0xbf353f80,0x3e95bf6d,0xbf7f3f0e,0xbef1bec4,0xbf463f7b
.long 0x3f7bbf35,0xbf0ebec4,0xbe48bf35,0xbf553f6d,0x3f223ec4,0x3e95bf7b,0x3dc9bf6d,0xbf623f55
.long 0xbec43f80,0x3f6dbf35,0x3ec4bf80,0xbf6d3f35,0xbf7f3ec4,0x3f623e48,0x3f22bf6d,0xbf753f0e
.long 0xbf0ebf35,0x3e483f6d,0x3f55bf35,0xbf7b3ec4,0x3ef1bf6d,0xbf223f55,0x3f75bec4,0xbf7f3e48
.long 0x3f808000,0xbf80a50d,0x3f808000,0xbf80a50d,0x3ef13f6d,0xbf22bf55,0x3f753ec4,0xbf7fbe48
.long 0xbf0e3f35,0x3e48bf6d,0x3f553f35,0xbf7bbec4,0xbf7fbec4,0x3f62be48,0x3f223f6d,0xbf75bf0e
.long 0xbec4bf80,0x3f6d3f35,0x3ec43f80,0xbf6dbf35,0x3f22bec4,0x3e953f7b,0x3dc93f6d,0xbf62bf55
.long 0x3f7b3f35,0xbf0e3ec4,0xbe483f35,0xbf55bf6d,0x3e953f6d,0xbf7fbf0e,0xbef13ec4,0xbf46bf7b
.long 0xbf35a50d,0xbf35bf80,0xbf35a50d,0xbf35bf80,0xbf75bf6d,0x3dc9bf0e,0xbf62bec4,0xbf22bf7b
.long 0xbe48bf35,0x3f553ec4,0xbf7bbf35,0xbf0ebf6d,0x3f463ec4,0x3f753f7b,0xbf7fbf6d,0xbef1bf55
.long 0x3f6d3f80,0x3ec43f35,0xbf6dbf80,0xbec4bf35,0x3dc93ec4,0xbef1be48,0xbf46bf6d,0xbe95bf0e
.long 0xbf55bf35,0xbf7bbf6d,0xbf0ebf35,0xbe48bec4,0xbf62bf6d,0xbf46bf55,0xbe95bec4,0xbdc9be48
.size FFT_TBL, 49152
CODE_END:
.section .rodata,"a"
.p2align 6
.amdhsa_kernel recurrent_scan__spectral_gfnet__glu_gated_geglu__prompt_kernel
  .amdhsa_next_free_vgpr 512
  .amdhsa_next_free_sgpr 102
  .amdhsa_accum_offset 256
  .amdhsa_group_segment_fixed_size 0
  .amdhsa_kernarg_size 80
  .amdhsa_user_sgpr_count 2
  .amdhsa_user_sgpr_kernarg_segment_ptr 1
  .amdhsa_system_sgpr_workgroup_id_x 1
.end_amdhsa_kernel
```
